```python
import torch

def _softmax(x, axis=-1):
    return torch.softmax(x, dim=axis)

def _gelu(x):
    return torch.nn.functional.gelu(x, approximate='tanh')

def _silu(x):
    return torch.nn.functional.silu(x)

def _sigmoid(x):
    return torch.sigmoid(x)

def _layernorm(x, axis=-1, eps=1e-05):
    m = x.mean(dim=axis, keepdim=True)
    v = x.var(dim=axis, keepdim=True, unbiased=False)
    return (x - m) / torch.sqrt(v + eps)

def _scatter_add(tgt, idx, src, axis=0):
    return tgt.clone().index_add_(axis, idx, src)

def _segment_sum(src, seg, n):
    out = torch.zeros((n,) + src.shape[1:], dtype=src.dtype)
    return out.index_add_(0, seg, src)

def _pad(x, pw):
    flat = tuple((v for pair in reversed(pw) for v in pair))
    return torch.nn.functional.pad(x, flat)
kernel_name = 'parallel_sum__memory_aug_recurrent_mem_tr__glu_gated_bilinear__prompt'

def setup_inputs():

    _w = lambda a: (lambda t: t.to(torch.bfloat16) if t.is_floating_point() else t)(torch.as_tensor(a))

    def _A_setup():
        B, S, Dm = (1, 2048, 640)
        H, Dh = (32, 192)
        M, seg = (8, 32)
        seg = min(seg, S)
        S = S // seg * seg
        return {'x': _w((lambda *s: torch.randn(*s, dtype=torch.bfloat16) * 0.05)(B, S, Dm)), 'mem0': _w((lambda *s: torch.randn(*s, dtype=torch.bfloat16) * 0.2)(B, M, Dm)), 'Wq': _w((lambda *s: torch.randn(*s, dtype=torch.bfloat16) * 1.6)(Dm, H, Dh) * Dm ** (-0.5)), 'Wk': _w((lambda *s: torch.randn(*s, dtype=torch.bfloat16) * 1.6)(Dm, H, Dh) * Dm ** (-0.5)), 'Wv': _w((lambda *s: torch.randn(*s, dtype=torch.bfloat16) * 0.2)(Dm, H, Dh) * Dm ** (-0.5)), 'Wo': _w((lambda *s: torch.randn(*s, dtype=torch.bfloat16) * 0.2)(H, Dh, Dm) * (H * Dh) ** (-0.5)), 'seg_len': seg}
    _A_in = _A_setup()

    def _B_setup():
        B, S, D, F = (1, 2048, 640, 1536)
        return {'x': _w((lambda *s: torch.randn(*s, dtype=torch.bfloat16) * 0.05)(B, S, D)), 'w_gate': _w((lambda *s: torch.randn(*s, dtype=torch.bfloat16) * 0.2)(D, F) * D ** (-0.5)), 'w_up': _w((lambda *s: torch.randn(*s, dtype=torch.bfloat16) * 0.2)(D, F) * D ** (-0.5)), 'w_down': _w((lambda *s: torch.randn(*s, dtype=torch.bfloat16) * 0.2)(F, D) * F ** (-0.5))}
    _B_in = _B_setup()
    return {'A_x': _A_in['x'], 'A_mem0': _A_in['mem0'], 'A_Wq': _A_in['Wq'], 'A_Wk': _A_in['Wk'], 'A_Wv': _A_in['Wv'], 'A_Wo': _A_in['Wo'], 'A_seg_len': _A_in['seg_len'], 'B_x': _B_in['x'], 'B_w_gate': _B_in['w_gate'], 'B_w_up': _B_in['w_up'], 'B_w_down': _B_in['w_down']}

def reference(A_x, A_mem0, A_Wq, A_Wk, A_Wv, A_Wo, A_seg_len, B_x, B_w_gate, B_w_up, B_w_down):

    def _A_ref(x, mem0, Wq, Wk, Wv, Wo, seg_len):
        B, S, Dm = x.shape
        H, Dh = (Wq.shape[1], Wq.shape[2])
        M = mem0.shape[1]
        scale = Dh ** (-0.5)
        n_seg = S // seg_len
        L = M + seg_len
        idx = torch.arange(L)
        mask = (idx[:, None] < M) | (idx[:, None] >= idx[None, :])
        mem = mem0
        outs = []
        for s in range(n_seg):
            xs = x[:, s * seg_len:(s + 1) * seg_len, :].clone()
            h = torch.concatenate([mem, xs], axis=1)
            q = torch.einsum('btd,dhe->bhte', h, Wq)
            k = torch.einsum('btd,dhe->bhte', h, Wk)
            v = torch.einsum('btd,dhe->bhte', h, Wv)
            scores = torch.einsum('bhqe,bhke->bhqk', q, k) * scale
            scores = torch.where(mask[None, None], scores, -1000000000.0)
            p = _softmax(scores, axis=-1)
            o = torch.einsum('bhqk,bhke->bhqe', p, v)
            o = torch.einsum('bhte,hed->btd', o, Wo)
            mem = o[:, :M, :].clone()
            outs.append(o[:, M:, :])
        return torch.concatenate(outs, axis=1)

    def _B_ref(x, w_gate, w_up, w_down):
        g = torch.einsum('bsd,df->bsf', x, w_gate)
        u = torch.einsum('bsd,df->bsf', x, w_up)
        h = g * u
        return torch.einsum('bsf,fd->bsd', h, w_down)
    x = A_x
    xn = _layernorm(x, axis=-1)
    return x + _A_ref(xn, A_mem0, A_Wq, A_Wk, A_Wv, A_Wo, A_seg_len) + _B_ref(xn, B_w_gate, B_w_up, B_w_down)
```

```asm
; @launch grid=(256,1,1) block=(256,1,1) lds=155648
.amdgcn_target "amdgcn-amd-amdhsa--gfx950"
.text
.globl parallel_sum__memory_aug_recurrent_mem_tr__glu_gated_bilinear__prompt_kernel
.p2align 8
.type parallel_sum__memory_aug_recurrent_mem_tr__glu_gated_bilinear__prompt_kernel,@function
parallel_sum__memory_aug_recurrent_mem_tr__glu_gated_bilinear__prompt_kernel:
  s_cmp_ge_u32 s2, 256
  s_cbranch_scc1 L_exit
  s_mov_b32 s37, 131072
  s_mov_b32 s95, s2
  s_mov_b32 s97, 0
  v_lshrrev_b32 v1, 6, v0
  s_getreg_b32 s3, hwreg(HW_REG_XCC_ID)
  v_readfirstlane_b32 s96, v1
  s_and_b32 s3, s3, 7
  s_andn2_b32 s2, s2, 7
  s_or_b32 s2, s2, s3
L_start:
  s_and_b32 s3, s2, 7
  s_cmp_lt_u32 s3, 2
  s_cbranch_scc1 L_rec
  s_cmp_lt_u32 s3, 4
  s_cbranch_scc1 L_d
  s_branch L_gemm
L_restart0:
  s_cmp_lg_u32 s96, 0
  s_cbranch_scc1 L_restart
  s_barrier
L_restart:
  s_cmp_lg_u32 s97, 0
  s_cbranch_scc1 L_exit
  s_waitcnt vmcnt(0) lgkmcnt(0)
  s_barrier
  s_mov_b32 s97, 128
  s_mov_b32 s2, s95
  v_mbcnt_lo_u32_b32 v0, -1, 0
  v_mbcnt_hi_u32_b32 v0, -1, v0
  v_lshl_add_u32 v0, s96, 6, v0
  s_branch L_start
L_exit:
  s_endpgm
L_d2:
  s_load_dwordx2 s[8:9], s[0:1], 104
  s_load_dwordx2 s[12:13], s[0:1], 96
  s_load_dwordx2 s[16:17], s[0:1], 0
  s_load_dwordx2 s[20:21], s[0:1], 40
  s_load_dwordx2 s[24:25], s[0:1], 80
  s_load_dwordx2 s[28:29], s[0:1], 88
  s_mov_b32 s10, 268435456
  s_mov_b32 s11, 0x20000
  s_mov_b32 s14, 256
  s_mov_b32 s15, 0x20000
  s_mov_b32 s18, 2621440
  s_mov_b32 s19, 0x20000
  s_mov_b32 s22, 7864320
  s_mov_b32 s23, 0x20000
  s_mov_b32 s26, 1966080
  s_mov_b32 s27, 0x20000
  s_mov_b32 s30, 2621440
  s_mov_b32 s31, 0x20000
  s_waitcnt lgkmcnt(0)
  s_and_b32 s4, s2, 7
  s_sub_u32 s4, s4, 2
  s_lshr_b32 s5, s2, 3
  s_lshr_b32 s7, s5, 2
  s_and_b32 s32, s5, 3
  s_mov_b32 s6, s96
  s_lshl_b32 s33, s7, 2
  s_add_u32 s33, s33, s6
  s_branch L_d3
L_d:
  s_load_dwordx2 s[8:9], s[0:1], 104
  s_load_dwordx2 s[12:13], s[0:1], 96
  s_load_dwordx2 s[16:17], s[0:1], 0
  s_load_dwordx2 s[20:21], s[0:1], 40
  s_load_dwordx2 s[24:25], s[0:1], 80
  s_load_dwordx2 s[28:29], s[0:1], 88
  s_mov_b32 s10, 268435456
  s_mov_b32 s11, 0x20000
  s_mov_b32 s14, 256
  s_mov_b32 s15, 0x20000
  s_mov_b32 s18, 2621440
  s_mov_b32 s19, 0x20000
  s_mov_b32 s22, 7864320
  s_mov_b32 s23, 0x20000
  s_mov_b32 s26, 1966080
  s_mov_b32 s27, 0x20000
  s_mov_b32 s30, 2621440
  s_mov_b32 s31, 0x20000
  s_waitcnt lgkmcnt(0)
  s_and_b32 s4, s2, 7
  s_sub_u32 s4, s4, 2
  s_lshr_b32 s5, s2, 3
  s_lshr_b32 s7, s5, 2
  s_and_b32 s32, s5, 3
  s_mov_b32 s6, s96
  s_lshl_b32 s33, s7, 2
  s_add_u32 s33, s33, s6
  s_lshl_b32 s3, s4, 5
  s_add_u32 s3, s3, s5
  s_mul_i32 s48, s3, 40960
  s_mul_i32 s3, s6, 10240
  s_add_u32 s49, s48, s3
  v_and_b32 v12, 7, v0
  v_bfe_u32 v13, v0, 3, 3
  v_mul_u32_u24 v16, 1280, v12
  v_lshl_add_u32 v16, v13, 4, v16
  v_lshlrev_b32 v17, 4, v12
  v_lshl_add_u32 v17, v13, 8, v17
  buffer_load_dwordx4 v[20:23], v16, s[16:19], s49 offen offset:0
  buffer_load_dwordx4 v[24:27], v16, s[16:19], s49 offen offset:128
  buffer_load_dwordx4 v[28:31], v16, s[16:19], s49 offen offset:256
  buffer_load_dwordx4 v[32:35], v16, s[16:19], s49 offen offset:384
  buffer_load_dwordx4 v[36:39], v16, s[16:19], s49 offen offset:512
  buffer_load_dwordx4 v[40:43], v16, s[16:19], s49 offen offset:640
  buffer_load_dwordx4 v[44:47], v16, s[16:19], s49 offen offset:768
  buffer_load_dwordx4 v[48:51], v16, s[16:19], s49 offen offset:896
  buffer_load_dwordx4 v[52:55], v16, s[16:19], s49 offen offset:1024
  buffer_load_dwordx4 v[56:59], v16, s[16:19], s49 offen offset:1152
  s_lshr_b32 s3, s6, 1
  s_mul_i32 s3, s3, 20480
  s_add_u32 s48, s48, s3
  s_and_b32 s3, s6, 1
  s_lshl_b32 s3, s3, 7
  s_add_u32 s48, s48, s3
  s_add_u32 s48, s48, 0
  s_waitcnt vmcnt(9)
  v_lshlrev_b32 v60, 16, v20
  v_and_b32 v61, 0xffff0000, v20
  v_lshlrev_b32 v62, 16, v21
  v_and_b32 v63, 0xffff0000, v21
  v_pk_add_f32 v[14:15], v[60:61], v[62:63]
  v_lshlrev_b32 v64, 16, v22
  v_and_b32 v65, 0xffff0000, v22
  v_pk_add_f32 v[14:15], v[14:15], v[64:65]
  v_lshlrev_b32 v66, 16, v23
  v_and_b32 v67, 0xffff0000, v23
  v_pk_add_f32 v[14:15], v[14:15], v[66:67]
  s_waitcnt vmcnt(8)
  v_lshlrev_b32 v68, 16, v24
  v_and_b32 v69, 0xffff0000, v24
  v_pk_add_f32 v[14:15], v[14:15], v[68:69]
  v_lshlrev_b32 v70, 16, v25
  v_and_b32 v71, 0xffff0000, v25
  v_pk_add_f32 v[14:15], v[14:15], v[70:71]
  v_lshlrev_b32 v72, 16, v26
  v_and_b32 v73, 0xffff0000, v26
  v_pk_add_f32 v[14:15], v[14:15], v[72:73]
  v_lshlrev_b32 v74, 16, v27
  v_and_b32 v75, 0xffff0000, v27
  v_pk_add_f32 v[14:15], v[14:15], v[74:75]
  s_waitcnt vmcnt(7)
  v_lshlrev_b32 v76, 16, v28
  v_and_b32 v77, 0xffff0000, v28
  v_pk_add_f32 v[14:15], v[14:15], v[76:77]
  v_lshlrev_b32 v78, 16, v29
  v_and_b32 v79, 0xffff0000, v29
  v_pk_add_f32 v[14:15], v[14:15], v[78:79]
  v_lshlrev_b32 v80, 16, v30
  v_and_b32 v81, 0xffff0000, v30
  v_pk_add_f32 v[14:15], v[14:15], v[80:81]
  v_lshlrev_b32 v82, 16, v31
  v_and_b32 v83, 0xffff0000, v31
  v_pk_add_f32 v[14:15], v[14:15], v[82:83]
  s_waitcnt vmcnt(6)
  v_lshlrev_b32 v84, 16, v32
  v_and_b32 v85, 0xffff0000, v32
  v_pk_add_f32 v[14:15], v[14:15], v[84:85]
  v_lshlrev_b32 v86, 16, v33
  v_and_b32 v87, 0xffff0000, v33
  v_pk_add_f32 v[14:15], v[14:15], v[86:87]
  v_lshlrev_b32 v88, 16, v34
  v_and_b32 v89, 0xffff0000, v34
  v_pk_add_f32 v[14:15], v[14:15], v[88:89]
  v_lshlrev_b32 v90, 16, v35
  v_and_b32 v91, 0xffff0000, v35
  v_pk_add_f32 v[14:15], v[14:15], v[90:91]
  s_waitcnt vmcnt(5)
  v_lshlrev_b32 v92, 16, v36
  v_and_b32 v93, 0xffff0000, v36
  v_pk_add_f32 v[14:15], v[14:15], v[92:93]
  v_lshlrev_b32 v94, 16, v37
  v_and_b32 v95, 0xffff0000, v37
  v_pk_add_f32 v[14:15], v[14:15], v[94:95]
  v_lshlrev_b32 v96, 16, v38
  v_and_b32 v97, 0xffff0000, v38
  v_pk_add_f32 v[14:15], v[14:15], v[96:97]
  v_lshlrev_b32 v98, 16, v39
  v_and_b32 v99, 0xffff0000, v39
  v_pk_add_f32 v[14:15], v[14:15], v[98:99]
  s_waitcnt vmcnt(4)
  v_lshlrev_b32 v100, 16, v40
  v_and_b32 v101, 0xffff0000, v40
  v_pk_add_f32 v[14:15], v[14:15], v[100:101]
  v_lshlrev_b32 v102, 16, v41
  v_and_b32 v103, 0xffff0000, v41
  v_pk_add_f32 v[14:15], v[14:15], v[102:103]
  v_lshlrev_b32 v104, 16, v42
  v_and_b32 v105, 0xffff0000, v42
  v_pk_add_f32 v[14:15], v[14:15], v[104:105]
  v_lshlrev_b32 v106, 16, v43
  v_and_b32 v107, 0xffff0000, v43
  v_pk_add_f32 v[14:15], v[14:15], v[106:107]
  s_waitcnt vmcnt(3)
  v_lshlrev_b32 v108, 16, v44
  v_and_b32 v109, 0xffff0000, v44
  v_pk_add_f32 v[14:15], v[14:15], v[108:109]
  v_lshlrev_b32 v110, 16, v45
  v_and_b32 v111, 0xffff0000, v45
  v_pk_add_f32 v[14:15], v[14:15], v[110:111]
  v_lshlrev_b32 v112, 16, v46
  v_and_b32 v113, 0xffff0000, v46
  v_pk_add_f32 v[14:15], v[14:15], v[112:113]
  v_lshlrev_b32 v114, 16, v47
  v_and_b32 v115, 0xffff0000, v47
  v_pk_add_f32 v[14:15], v[14:15], v[114:115]
  s_waitcnt vmcnt(2)
  v_lshlrev_b32 v116, 16, v48
  v_and_b32 v117, 0xffff0000, v48
  v_pk_add_f32 v[14:15], v[14:15], v[116:117]
  v_lshlrev_b32 v118, 16, v49
  v_and_b32 v119, 0xffff0000, v49
  v_pk_add_f32 v[14:15], v[14:15], v[118:119]
  v_lshlrev_b32 v120, 16, v50
  v_and_b32 v121, 0xffff0000, v50
  v_pk_add_f32 v[14:15], v[14:15], v[120:121]
  v_lshlrev_b32 v122, 16, v51
  v_and_b32 v123, 0xffff0000, v51
  v_pk_add_f32 v[14:15], v[14:15], v[122:123]
  s_waitcnt vmcnt(1)
  v_lshlrev_b32 v124, 16, v52
  v_and_b32 v125, 0xffff0000, v52
  v_pk_add_f32 v[14:15], v[14:15], v[124:125]
  v_lshlrev_b32 v126, 16, v53
  v_and_b32 v127, 0xffff0000, v53
  v_pk_add_f32 v[14:15], v[14:15], v[126:127]
  v_lshlrev_b32 v128, 16, v54
  v_and_b32 v129, 0xffff0000, v54
  v_pk_add_f32 v[14:15], v[14:15], v[128:129]
  v_lshlrev_b32 v130, 16, v55
  v_and_b32 v131, 0xffff0000, v55
  v_pk_add_f32 v[14:15], v[14:15], v[130:131]
  s_waitcnt vmcnt(0)
  v_lshlrev_b32 v132, 16, v56
  v_and_b32 v133, 0xffff0000, v56
  v_pk_add_f32 v[14:15], v[14:15], v[132:133]
  v_lshlrev_b32 v134, 16, v57
  v_and_b32 v135, 0xffff0000, v57
  v_pk_add_f32 v[14:15], v[14:15], v[134:135]
  v_lshlrev_b32 v136, 16, v58
  v_and_b32 v137, 0xffff0000, v58
  v_pk_add_f32 v[14:15], v[14:15], v[136:137]
  v_lshlrev_b32 v138, 16, v59
  v_and_b32 v139, 0xffff0000, v59
  v_pk_add_f32 v[14:15], v[14:15], v[138:139]
  v_add_f32 v14, v14, v15
  s_nop 1
  v_add_f32_dpp v14, v14, v14 row_ror:8 row_mask:0xf bank_mask:0xf
  v_mov_b32 v15, v14
  s_nop 1
  v_permlane16_swap_b32 v14, v15
  v_add_f32 v14, v14, v15
  v_mov_b32 v15, v14
  s_nop 1
  v_permlane32_swap_b32 v14, v15
  v_add_f32 v14, v14, v15
  v_mul_f32 v12, 0xbacccccd, v14
  v_mul_f32 v13, 0xbacccccd, v14
  v_pk_add_f32 v[60:61], v[60:61], v[12:13]
  v_pk_mul_f32 v[14:15], v[60:61], v[60:61]
  v_pk_add_f32 v[62:63], v[62:63], v[12:13]
  v_pk_fma_f32 v[14:15], v[62:63], v[62:63], v[14:15]
  v_pk_add_f32 v[64:65], v[64:65], v[12:13]
  v_pk_fma_f32 v[14:15], v[64:65], v[64:65], v[14:15]
  v_pk_add_f32 v[66:67], v[66:67], v[12:13]
  v_pk_fma_f32 v[14:15], v[66:67], v[66:67], v[14:15]
  v_pk_add_f32 v[68:69], v[68:69], v[12:13]
  v_pk_fma_f32 v[14:15], v[68:69], v[68:69], v[14:15]
  v_pk_add_f32 v[70:71], v[70:71], v[12:13]
  v_pk_fma_f32 v[14:15], v[70:71], v[70:71], v[14:15]
  v_pk_add_f32 v[72:73], v[72:73], v[12:13]
  v_pk_fma_f32 v[14:15], v[72:73], v[72:73], v[14:15]
  v_pk_add_f32 v[74:75], v[74:75], v[12:13]
  v_pk_fma_f32 v[14:15], v[74:75], v[74:75], v[14:15]
  v_pk_add_f32 v[76:77], v[76:77], v[12:13]
  v_pk_fma_f32 v[14:15], v[76:77], v[76:77], v[14:15]
  v_pk_add_f32 v[78:79], v[78:79], v[12:13]
  v_pk_fma_f32 v[14:15], v[78:79], v[78:79], v[14:15]
  v_pk_add_f32 v[80:81], v[80:81], v[12:13]
  v_pk_fma_f32 v[14:15], v[80:81], v[80:81], v[14:15]
  v_pk_add_f32 v[82:83], v[82:83], v[12:13]
  v_pk_fma_f32 v[14:15], v[82:83], v[82:83], v[14:15]
  v_pk_add_f32 v[84:85], v[84:85], v[12:13]
  v_pk_fma_f32 v[14:15], v[84:85], v[84:85], v[14:15]
  v_pk_add_f32 v[86:87], v[86:87], v[12:13]
  v_pk_fma_f32 v[14:15], v[86:87], v[86:87], v[14:15]
  v_pk_add_f32 v[88:89], v[88:89], v[12:13]
  v_pk_fma_f32 v[14:15], v[88:89], v[88:89], v[14:15]
  v_pk_add_f32 v[90:91], v[90:91], v[12:13]
  v_pk_fma_f32 v[14:15], v[90:91], v[90:91], v[14:15]
  v_pk_add_f32 v[92:93], v[92:93], v[12:13]
  v_pk_fma_f32 v[14:15], v[92:93], v[92:93], v[14:15]
  v_pk_add_f32 v[94:95], v[94:95], v[12:13]
  v_pk_fma_f32 v[14:15], v[94:95], v[94:95], v[14:15]
  v_pk_add_f32 v[96:97], v[96:97], v[12:13]
  v_pk_fma_f32 v[14:15], v[96:97], v[96:97], v[14:15]
  v_pk_add_f32 v[98:99], v[98:99], v[12:13]
  v_pk_fma_f32 v[14:15], v[98:99], v[98:99], v[14:15]
  v_pk_add_f32 v[100:101], v[100:101], v[12:13]
  v_pk_fma_f32 v[14:15], v[100:101], v[100:101], v[14:15]
  v_pk_add_f32 v[102:103], v[102:103], v[12:13]
  v_pk_fma_f32 v[14:15], v[102:103], v[102:103], v[14:15]
  v_pk_add_f32 v[104:105], v[104:105], v[12:13]
  v_pk_fma_f32 v[14:15], v[104:105], v[104:105], v[14:15]
  v_pk_add_f32 v[106:107], v[106:107], v[12:13]
  v_pk_fma_f32 v[14:15], v[106:107], v[106:107], v[14:15]
  v_pk_add_f32 v[108:109], v[108:109], v[12:13]
  v_pk_fma_f32 v[14:15], v[108:109], v[108:109], v[14:15]
  v_pk_add_f32 v[110:111], v[110:111], v[12:13]
  v_pk_fma_f32 v[14:15], v[110:111], v[110:111], v[14:15]
  v_pk_add_f32 v[112:113], v[112:113], v[12:13]
  v_pk_fma_f32 v[14:15], v[112:113], v[112:113], v[14:15]
  v_pk_add_f32 v[114:115], v[114:115], v[12:13]
  v_pk_fma_f32 v[14:15], v[114:115], v[114:115], v[14:15]
  v_pk_add_f32 v[116:117], v[116:117], v[12:13]
  v_pk_fma_f32 v[14:15], v[116:117], v[116:117], v[14:15]
  v_pk_add_f32 v[118:119], v[118:119], v[12:13]
  v_pk_fma_f32 v[14:15], v[118:119], v[118:119], v[14:15]
  v_pk_add_f32 v[120:121], v[120:121], v[12:13]
  v_pk_fma_f32 v[14:15], v[120:121], v[120:121], v[14:15]
  v_pk_add_f32 v[122:123], v[122:123], v[12:13]
  v_pk_fma_f32 v[14:15], v[122:123], v[122:123], v[14:15]
  v_pk_add_f32 v[124:125], v[124:125], v[12:13]
  v_pk_fma_f32 v[14:15], v[124:125], v[124:125], v[14:15]
  v_pk_add_f32 v[126:127], v[126:127], v[12:13]
  v_pk_fma_f32 v[14:15], v[126:127], v[126:127], v[14:15]
  v_pk_add_f32 v[128:129], v[128:129], v[12:13]
  v_pk_fma_f32 v[14:15], v[128:129], v[128:129], v[14:15]
  v_pk_add_f32 v[130:131], v[130:131], v[12:13]
  v_pk_fma_f32 v[14:15], v[130:131], v[130:131], v[14:15]
  v_pk_add_f32 v[132:133], v[132:133], v[12:13]
  v_pk_fma_f32 v[14:15], v[132:133], v[132:133], v[14:15]
  v_pk_add_f32 v[134:135], v[134:135], v[12:13]
  v_pk_fma_f32 v[14:15], v[134:135], v[134:135], v[14:15]
  v_pk_add_f32 v[136:137], v[136:137], v[12:13]
  v_pk_fma_f32 v[14:15], v[136:137], v[136:137], v[14:15]
  v_pk_add_f32 v[138:139], v[138:139], v[12:13]
  v_pk_fma_f32 v[14:15], v[138:139], v[138:139], v[14:15]
  v_add_f32 v14, v14, v15
  s_nop 1
  v_add_f32_dpp v14, v14, v14 row_ror:8 row_mask:0xf bank_mask:0xf
  v_mov_b32 v15, v14
  s_nop 1
  v_permlane16_swap_b32 v14, v15
  v_add_f32 v14, v14, v15
  v_mov_b32 v15, v14
  s_nop 1
  v_permlane32_swap_b32 v14, v15
  v_add_f32 v14, v14, v15
  v_mov_b32 v12, 0x3727c5ac
  v_fmac_f32 v12, 0x3acccccd, v14
  v_rsq_f32 v12, v12
  s_nop 0
  v_mov_b32 v13, v12
  v_pk_mul_f32 v[60:61], v[60:61], v[12:13]
  v_cvt_pk_bf16_f32 v20, v60, v61
  v_pk_mul_f32 v[62:63], v[62:63], v[12:13]
  v_cvt_pk_bf16_f32 v21, v62, v63
  v_pk_mul_f32 v[64:65], v[64:65], v[12:13]
  v_cvt_pk_bf16_f32 v22, v64, v65
  v_pk_mul_f32 v[66:67], v[66:67], v[12:13]
  v_cvt_pk_bf16_f32 v23, v66, v67
  buffer_store_dwordx4 v[20:23], v17, s[8:11], s48 offen offset:0 sc1
  v_pk_mul_f32 v[68:69], v[68:69], v[12:13]
  v_cvt_pk_bf16_f32 v24, v68, v69
  v_pk_mul_f32 v[70:71], v[70:71], v[12:13]
  v_cvt_pk_bf16_f32 v25, v70, v71
  v_pk_mul_f32 v[72:73], v[72:73], v[12:13]
  v_cvt_pk_bf16_f32 v26, v72, v73
  v_pk_mul_f32 v[74:75], v[74:75], v[12:13]
  v_cvt_pk_bf16_f32 v27, v74, v75
  buffer_store_dwordx4 v[24:27], v17, s[8:11], s48 offen offset:2048 sc1
  v_pk_mul_f32 v[76:77], v[76:77], v[12:13]
  v_cvt_pk_bf16_f32 v28, v76, v77
  v_pk_mul_f32 v[78:79], v[78:79], v[12:13]
  v_cvt_pk_bf16_f32 v29, v78, v79
  v_pk_mul_f32 v[80:81], v[80:81], v[12:13]
  v_cvt_pk_bf16_f32 v30, v80, v81
  v_pk_mul_f32 v[82:83], v[82:83], v[12:13]
  v_cvt_pk_bf16_f32 v31, v82, v83
  s_add_u32 s48, s48, 4096
  buffer_store_dwordx4 v[28:31], v17, s[8:11], s48 offen offset:0 sc1
  v_pk_mul_f32 v[84:85], v[84:85], v[12:13]
  v_cvt_pk_bf16_f32 v32, v84, v85
  v_pk_mul_f32 v[86:87], v[86:87], v[12:13]
  v_cvt_pk_bf16_f32 v33, v86, v87
  v_pk_mul_f32 v[88:89], v[88:89], v[12:13]
  v_cvt_pk_bf16_f32 v34, v88, v89
  v_pk_mul_f32 v[90:91], v[90:91], v[12:13]
  v_cvt_pk_bf16_f32 v35, v90, v91
  buffer_store_dwordx4 v[32:35], v17, s[8:11], s48 offen offset:2048 sc1
  v_pk_mul_f32 v[92:93], v[92:93], v[12:13]
  v_cvt_pk_bf16_f32 v36, v92, v93
  v_pk_mul_f32 v[94:95], v[94:95], v[12:13]
  v_cvt_pk_bf16_f32 v37, v94, v95
  v_pk_mul_f32 v[96:97], v[96:97], v[12:13]
  v_cvt_pk_bf16_f32 v38, v96, v97
  v_pk_mul_f32 v[98:99], v[98:99], v[12:13]
  v_cvt_pk_bf16_f32 v39, v98, v99
  s_add_u32 s48, s48, 4096
  buffer_store_dwordx4 v[36:39], v17, s[8:11], s48 offen offset:0 sc1
  v_pk_mul_f32 v[100:101], v[100:101], v[12:13]
  v_cvt_pk_bf16_f32 v40, v100, v101
  v_pk_mul_f32 v[102:103], v[102:103], v[12:13]
  v_cvt_pk_bf16_f32 v41, v102, v103
  v_pk_mul_f32 v[104:105], v[104:105], v[12:13]
  v_cvt_pk_bf16_f32 v42, v104, v105
  v_pk_mul_f32 v[106:107], v[106:107], v[12:13]
  v_cvt_pk_bf16_f32 v43, v106, v107
  buffer_store_dwordx4 v[40:43], v17, s[8:11], s48 offen offset:2048 sc1
  v_pk_mul_f32 v[108:109], v[108:109], v[12:13]
  v_cvt_pk_bf16_f32 v44, v108, v109
  v_pk_mul_f32 v[110:111], v[110:111], v[12:13]
  v_cvt_pk_bf16_f32 v45, v110, v111
  v_pk_mul_f32 v[112:113], v[112:113], v[12:13]
  v_cvt_pk_bf16_f32 v46, v112, v113
  v_pk_mul_f32 v[114:115], v[114:115], v[12:13]
  v_cvt_pk_bf16_f32 v47, v114, v115
  s_add_u32 s48, s48, 4096
  buffer_store_dwordx4 v[44:47], v17, s[8:11], s48 offen offset:0 sc1
  v_pk_mul_f32 v[116:117], v[116:117], v[12:13]
  v_cvt_pk_bf16_f32 v48, v116, v117
  v_pk_mul_f32 v[118:119], v[118:119], v[12:13]
  v_cvt_pk_bf16_f32 v49, v118, v119
  v_pk_mul_f32 v[120:121], v[120:121], v[12:13]
  v_cvt_pk_bf16_f32 v50, v120, v121
  v_pk_mul_f32 v[122:123], v[122:123], v[12:13]
  v_cvt_pk_bf16_f32 v51, v122, v123
  buffer_store_dwordx4 v[48:51], v17, s[8:11], s48 offen offset:2048 sc1
  v_pk_mul_f32 v[124:125], v[124:125], v[12:13]
  v_cvt_pk_bf16_f32 v52, v124, v125
  v_pk_mul_f32 v[126:127], v[126:127], v[12:13]
  v_cvt_pk_bf16_f32 v53, v126, v127
  v_pk_mul_f32 v[128:129], v[128:129], v[12:13]
  v_cvt_pk_bf16_f32 v54, v128, v129
  v_pk_mul_f32 v[130:131], v[130:131], v[12:13]
  v_cvt_pk_bf16_f32 v55, v130, v131
  s_add_u32 s48, s48, 4096
  buffer_store_dwordx4 v[52:55], v17, s[8:11], s48 offen offset:0 sc1
  v_pk_mul_f32 v[132:133], v[132:133], v[12:13]
  v_cvt_pk_bf16_f32 v56, v132, v133
  v_pk_mul_f32 v[134:135], v[134:135], v[12:13]
  v_cvt_pk_bf16_f32 v57, v134, v135
  v_pk_mul_f32 v[136:137], v[136:137], v[12:13]
  v_cvt_pk_bf16_f32 v58, v136, v137
  v_pk_mul_f32 v[138:139], v[138:139], v[12:13]
  v_cvt_pk_bf16_f32 v59, v138, v139
  buffer_store_dwordx4 v[56:59], v17, s[8:11], s48 offen offset:2048 sc1
  s_and_b32 s3, s2, 7
  s_sub_u32 s3, s3, 2
  s_lshl_b32 s3, s3, 2
  s_bfe_u32 vcc_lo, s2, 0x20003
  s_add_u32 s3, s3, vcc_lo
  s_lshl_b32 s3, s3, 3
  s_lshr_b32 vcc_lo, s2, 5
  s_add_u32 s3, s3, vcc_lo
  s_mul_i32 vcc_lo, s3, 8192
  s_mul_i32 s3, s3, 20480
  s_add_u32 s3, s3, 134217728
  v_lshlrev_b32 v16, 4, v0
  v_mov_b32 v12, 0
  v_mov_b32 v13, 0
  v_mov_b32 v14, 0
  v_mov_b32 v15, 0
  v_mov_b32 v12, -1
  v_mov_b32 v13, -1
  v_mov_b32 v14, -1
  v_mov_b32 v15, -1
  s_add_u32 s3, vcc_lo, 29884416
  buffer_store_dwordx4 v[12:15], v16, s[8:11], s3 offen sc1
  s_add_u32 s3, vcc_lo, 29888512
  buffer_store_dwordx4 v[12:15], v16, s[8:11], s3 offen sc1
  s_cmp_lg_u32 s6, 0
  s_waitcnt vmcnt(0)
  s_barrier
  s_cbranch_scc1 L_d4
  s_lshr_b32 s3, s2, 3
  s_lshl_b32 s3, 1, s3
  v_mov_b32 v12, s3
  v_mov_b32 v13, 256
  s_and_b32 s3, s2, 7
  s_lshl_b32 s3, s3, 3
  s_add_u32 s3, s3, s97
  s_mov_b64 exec, 1
  buffer_atomic_add_x2 v[12:13], off, s[12:15], s3 sc1
  s_mov_b64 exec, -1
  s_cmp_lg_u32 s2, 2
  s_cbranch_scc1 L_d4
  s_waitcnt vmcnt(0)
  s_mov_b32 s64, -1
  s_mov_b32 s65, -1
  s_mov_b32 s3, 122421376
  s_mov_b64 exec, 1
L2_probe:
  s_memtime s[60:61]
  s_waitcnt lgkmcnt(0)
  buffer_store_dword v12, off, s[8:11], s3 sc1
  s_waitcnt vmcnt(0)
  s_memtime s[62:63]
  s_xor_b32 s3, s3, 8192
  s_waitcnt lgkmcnt(0)
  s_sub_u32 s60, s62, s60
  s_min_u32 s64, s64, s60
  s_memtime s[60:61]
  s_waitcnt lgkmcnt(0)
  buffer_store_dword v12, off, s[8:11], s3 sc1
  s_waitcnt vmcnt(0)
  s_memtime s[62:63]
  s_xor_b32 s3, s3, 8192
  s_waitcnt lgkmcnt(0)
  s_sub_u32 s60, s62, s60
  s_min_u32 s65, s65, s60
  s_add_u32 s3, s3, 1024
  s_cmp_lt_u32 s3, 122427520
  s_cbranch_scc1 L2_probe
  s_cmp_lt_u32 s65, s64
  s_cselect_b32 s3, 8193, 1
  v_mov_b32 v12, s3
  v_mov_b32 v13, s64
  v_mov_b32 v14, s65
  buffer_store_dwordx3 v[12:14], off, s[12:15], s97 offset:64 sc1
  s_mov_b64 exec, -1
L_d4:
  s_barrier
L_d3:
  s_cmp_eq_u32 s96, 0
  s_cbranch_scc1 L3_hs
  s_barrier
L3_hs:
  v_mbcnt_lo_u32_b32 v30, -1, 0
  v_min_u32 v30, 8, v30
  v_lshlrev_b32 v30, 3, v30
L5_cen:
  buffer_load_dwordx2 v[28:29], v30, s[12:15], s97 offen sc1
  s_sub_u32 s37, s37, 1
  s_cbranch_scc1 L1_dbail
  s_waitcnt vmcnt(0)
  v_not_b32 v31, v28
  v_xor_b32 v32, 0x2000, v29
  v_or_b32 v31, v31, v32
  v_cmp_ne_u32 vcc, 0, v31
  s_and_b32 s3, vcc_lo, 0xff
  s_cbranch_scc0 L6_cok
  v_lshrrev_b32 v29, 8, v29
  s_nop 1
  v_add_u32_dpp v29, v29, v29 row_shr:1 row_mask:0xf bank_mask:0xf bound_ctrl:1
  s_nop 1
  v_add_u32_dpp v29, v29, v29 row_shr:2 row_mask:0xf bank_mask:0xf bound_ctrl:1
  s_nop 1
  v_add_u32_dpp v29, v29, v29 row_shr:4 row_mask:0xf bank_mask:0xf bound_ctrl:1
  s_nop 0
  v_readlane_b32 s3, v29, 7
  s_cmp_lt_u32 s3, 256
  s_cbranch_scc1 L5_cen
  s_branch L_restart0
L6_cok:
  s_lshl_b32 s3, s33, 7
  s_add_u32 s3, s3, 3145728
L4_hp:
  buffer_load_dword v28, off, s[8:11], s3 sc1
  s_sub_u32 s37, s37, 1
  s_cbranch_scc1 L1_dbail
  s_waitcnt vmcnt(0)
  v_cmp_gt_u32 vcc, 4, v28
  s_cbranch_vccnz L4_hp
  s_cmp_lg_u32 s96, 0
  s_cbranch_scc1 L7_hs
  s_barrier
L7_hs:
  s_and_b32 s3, s2, 7
  s_sub_u32 s3, s3, 2
  s_lshl_b32 s3, s3, 2
  s_bfe_u32 vcc_lo, s2, 0x20003
  s_add_u32 s3, s3, vcc_lo
  s_lshl_b32 s3, s3, 3
  s_lshr_b32 vcc_lo, s2, 5
  s_add_u32 s3, s3, vcc_lo
  s_mul_i32 vcc_lo, s3, 4096
  s_mul_i32 s3, s3, 20480
  s_add_u32 s3, s3, 134217728
  v_lshlrev_b32 v16, 4, v0
  v_mov_b32 v12, 0
  v_mov_b32 v13, 0
  v_mov_b32 v14, 0
  v_mov_b32 v15, 0
  buffer_store_dwordx4 v[12:15], v16, s[8:11], s3 offen sc1
  s_add_u32 s3, s3, 4096
  buffer_store_dwordx4 v[12:15], v16, s[8:11], s3 offen sc1
  s_add_u32 s3, s3, 4096
  buffer_store_dwordx4 v[12:15], v16, s[8:11], s3 offen sc1
  s_add_u32 s3, s3, 4096
  buffer_store_dwordx4 v[12:15], v16, s[8:11], s3 offen sc1
  s_add_u32 s3, s3, 4096
  buffer_store_dwordx4 v[12:15], v16, s[8:11], s3 offen sc1
  s_add_u32 s3, s3, 4177920
  buffer_store_dwordx4 v[12:15], v16, s[8:11], s3 offen sc1
  s_add_u32 s3, s3, 4096
  buffer_store_dwordx4 v[12:15], v16, s[8:11], s3 offen sc1
  s_add_u32 s3, s3, 4096
  buffer_store_dwordx4 v[12:15], v16, s[8:11], s3 offen sc1
  s_add_u32 s3, s3, 4096
  buffer_store_dwordx4 v[12:15], v16, s[8:11], s3 offen sc1
  s_add_u32 s3, s3, 4096
  buffer_store_dwordx4 v[12:15], v16, s[8:11], s3 offen sc1
  v_and_b32 v20, 63, v0
  v_lshrrev_b32 v21, 4, v20
  v_and_b32 v22, 15, v20
  s_mul_i32 s3, s32, 320
  v_add_u32 v23, 0, v20
  v_mul_u32_u24 v24, 3277, v23
  v_lshrrev_b32 v24, 16, v24
  v_mul_u32_u24 v25, 20, v24
  v_sub_u32 v23, v23, v25
  v_lshl_add_u32 v23, v23, 4, s3
  v_mul_u32_u24 v24, 1280, v24
  v_add_u32 v26, v23, v24
  v_add_u32 v23, 64, v20
  v_mul_u32_u24 v24, 3277, v23
  v_lshrrev_b32 v24, 16, v24
  v_mul_u32_u24 v25, 20, v24
  v_sub_u32 v23, v23, v25
  v_lshl_add_u32 v23, v23, 4, s3
  v_mul_u32_u24 v24, 1280, v24
  v_add_u32 v27, v23, v24
  v_add_u32 v23, 128, v20
  v_mul_u32_u24 v24, 3277, v23
  v_lshrrev_b32 v24, 16, v24
  v_mul_u32_u24 v25, 20, v24
  v_sub_u32 v23, v23, v25
  v_lshl_add_u32 v23, v23, 4, s3
  v_mul_u32_u24 v24, 1280, v24
  v_add_u32 v28, v23, v24
  v_add_u32 v23, 192, v20
  v_mul_u32_u24 v24, 3277, v23
  v_lshrrev_b32 v24, 16, v24
  v_mul_u32_u24 v25, 20, v24
  v_sub_u32 v23, v23, v25
  v_lshl_add_u32 v23, v23, 4, s3
  v_mul_u32_u24 v24, 1280, v24
  v_add_u32 v29, v23, v24
  v_add_u32 v23, 256, v20
  v_mul_u32_u24 v24, 3277, v23
  v_lshrrev_b32 v24, 16, v24
  v_mul_u32_u24 v25, 20, v24
  v_sub_u32 v23, v23, v25
  v_lshl_add_u32 v23, v23, 4, s3
  v_mul_u32_u24 v24, 1280, v24
  v_add_u32 v30, v23, v24
  s_mul_i32 s46, s6, 30720
  s_mul_i32 s35, s33, 245760
  s_mul_i32 s3, s7, 6
  s_add_u32 s36, s3, s6
  s_lshr_b32 s48, s6, 1
  s_add_u32 s3, s3, s48
  s_add_u32 s43, s3, 4
  s_mul_i32 s48, s36, 40960
  s_mul_i32 s49, s43, 40960
  s_add_u32 s3, s35, 0
  s_add_u32 m0, s46, 0
  s_nop 0
  buffer_load_dwordx4 v26, s[20:23], s3 offen lds
  s_add_u32 m0, s46, 1024
  s_nop 0
  buffer_load_dwordx4 v27, s[20:23], s3 offen lds
  s_add_u32 m0, s46, 2048
  s_nop 0
  buffer_load_dwordx4 v28, s[20:23], s3 offen lds
  s_add_u32 m0, s46, 3072
  s_nop 0
  buffer_load_dwordx4 v29, s[20:23], s3 offen lds
  s_add_u32 m0, s46, 4096
  s_nop 0
  buffer_load_dwordx4 v30, s[20:23], s3 offen lds
  s_add_u32 s3, s35, 20480
  s_add_u32 m0, s46, 5120
  s_nop 0
  buffer_load_dwordx4 v26, s[20:23], s3 offen lds
  s_add_u32 m0, s46, 6144
  s_nop 0
  buffer_load_dwordx4 v27, s[20:23], s3 offen lds
  s_add_u32 m0, s46, 7168
  s_nop 0
  buffer_load_dwordx4 v28, s[20:23], s3 offen lds
  s_add_u32 m0, s46, 8192
  s_nop 0
  buffer_load_dwordx4 v29, s[20:23], s3 offen lds
  s_add_u32 m0, s46, 9216
  s_nop 0
  buffer_load_dwordx4 v30, s[20:23], s3 offen lds
  s_add_u32 s3, s35, 40960
  s_add_u32 m0, s46, 10240
  s_nop 0
  buffer_load_dwordx4 v26, s[20:23], s3 offen lds
  s_add_u32 m0, s46, 11264
  s_nop 0
  buffer_load_dwordx4 v27, s[20:23], s3 offen lds
  s_add_u32 m0, s46, 12288
  s_nop 0
  buffer_load_dwordx4 v28, s[20:23], s3 offen lds
  s_add_u32 m0, s46, 13312
  s_nop 0
  buffer_load_dwordx4 v29, s[20:23], s3 offen lds
  s_add_u32 m0, s46, 14336
  s_nop 0
  buffer_load_dwordx4 v30, s[20:23], s3 offen lds
  s_add_u32 s3, s35, 61440
  s_add_u32 m0, s46, 15360
  s_nop 0
  buffer_load_dwordx4 v26, s[20:23], s3 offen lds
  s_add_u32 m0, s46, 16384
  s_nop 0
  buffer_load_dwordx4 v27, s[20:23], s3 offen lds
  s_add_u32 m0, s46, 17408
  s_nop 0
  buffer_load_dwordx4 v28, s[20:23], s3 offen lds
  s_add_u32 m0, s46, 18432
  s_nop 0
  buffer_load_dwordx4 v29, s[20:23], s3 offen lds
  s_add_u32 m0, s46, 19456
  s_nop 0
  buffer_load_dwordx4 v30, s[20:23], s3 offen lds
  s_add_u32 s3, s35, 81920
  s_add_u32 m0, s46, 20480
  s_nop 0
  buffer_load_dwordx4 v26, s[20:23], s3 offen lds
  s_add_u32 m0, s46, 21504
  s_nop 0
  buffer_load_dwordx4 v27, s[20:23], s3 offen lds
  s_add_u32 m0, s46, 22528
  s_nop 0
  buffer_load_dwordx4 v28, s[20:23], s3 offen lds
  s_add_u32 m0, s46, 23552
  s_nop 0
  buffer_load_dwordx4 v29, s[20:23], s3 offen lds
  s_add_u32 m0, s46, 24576
  s_nop 0
  buffer_load_dwordx4 v30, s[20:23], s3 offen lds
  s_add_u32 s3, s35, 102400
  s_add_u32 m0, s46, 25600
  s_nop 0
  buffer_load_dwordx4 v26, s[20:23], s3 offen lds
  s_add_u32 m0, s46, 26624
  s_nop 0
  buffer_load_dwordx4 v27, s[20:23], s3 offen lds
  s_add_u32 m0, s46, 27648
  s_nop 0
  buffer_load_dwordx4 v28, s[20:23], s3 offen lds
  s_add_u32 m0, s46, 28672
  s_nop 0
  buffer_load_dwordx4 v29, s[20:23], s3 offen lds
  s_add_u32 m0, s46, 29696
  s_nop 0
  buffer_load_dwordx4 v30, s[20:23], s3 offen lds
  s_and_b32 s3, s6, 1
  s_mul_i32 s3, s3, 160
  v_and_b32 v24, 3, v22
  v_lshl_add_u32 v24, v24, 3, s46
  v_lshrrev_b32 v23, 2, v22
  v_lshl_add_u32 v25, v21, 2, v23
  v_mul_u32_u24 v25, 320, v25
  v_add_u32 v25, v25, v24
  v_add_u32 v32, s3, v25
  v_subrev_u32 v33, s3, v25
  v_lshl_add_u32 v25, v21, 3, v23
  v_mul_u32_u24 v25, 320, v25
  v_add_u32 v25, v25, v24
  v_add_u32 v34, s3, v25
  v_subrev_u32 v35, s3, v25
  s_waitcnt vmcnt(20)
  ds_read_b64_tr_b16 a[0:1], v32 offset:0
  ds_read_b64_tr_b16 a[2:3], v32 offset:5120
  ds_read_b64_tr_b16 a[4:5], v32 offset:32
  ds_read_b64_tr_b16 a[6:7], v32 offset:5152
  ds_read_b64_tr_b16 a[8:9], v32 offset:64
  ds_read_b64_tr_b16 a[10:11], v32 offset:5184
  ds_read_b64_tr_b16 a[12:13], v32 offset:96
  ds_read_b64_tr_b16 a[14:15], v32 offset:5216
  ds_read_b64_tr_b16 a[16:17], v32 offset:128
  ds_read_b64_tr_b16 a[18:19], v32 offset:5248
  ds_read_b64_tr_b16 a[20:21], v33 offset:160
  ds_read_b64_tr_b16 a[22:23], v33 offset:5280
  ds_read_b64_tr_b16 a[24:25], v33 offset:192
  ds_read_b64_tr_b16 a[26:27], v33 offset:5312
  ds_read_b64_tr_b16 a[28:29], v33 offset:224
  ds_read_b64_tr_b16 a[30:31], v33 offset:5344
  ds_read_b64_tr_b16 a[32:33], v33 offset:256
  ds_read_b64_tr_b16 a[34:35], v33 offset:5376
  ds_read_b64_tr_b16 a[36:37], v33 offset:288
  ds_read_b64_tr_b16 a[38:39], v33 offset:5408
  s_waitcnt lgkmcnt(0)
  s_add_u32 s3, s35, 122880
  s_add_u32 m0, s46, 0
  s_nop 0
  buffer_load_dwordx4 v26, s[20:23], s3 offen lds
  s_add_u32 m0, s46, 1024
  s_nop 0
  buffer_load_dwordx4 v27, s[20:23], s3 offen lds
  s_add_u32 m0, s46, 2048
  s_nop 0
  buffer_load_dwordx4 v28, s[20:23], s3 offen lds
  s_add_u32 m0, s46, 3072
  s_nop 0
  buffer_load_dwordx4 v29, s[20:23], s3 offen lds
  s_add_u32 m0, s46, 4096
  s_nop 0
  buffer_load_dwordx4 v30, s[20:23], s3 offen lds
  s_add_u32 s3, s35, 143360
  s_add_u32 m0, s46, 5120
  s_nop 0
  buffer_load_dwordx4 v26, s[20:23], s3 offen lds
  s_add_u32 m0, s46, 6144
  s_nop 0
  buffer_load_dwordx4 v27, s[20:23], s3 offen lds
  s_add_u32 m0, s46, 7168
  s_nop 0
  buffer_load_dwordx4 v28, s[20:23], s3 offen lds
  s_add_u32 m0, s46, 8192
  s_nop 0
  buffer_load_dwordx4 v29, s[20:23], s3 offen lds
  s_add_u32 m0, s46, 9216
  s_nop 0
  buffer_load_dwordx4 v30, s[20:23], s3 offen lds
  s_waitcnt vmcnt(20)
  ds_read_b64_tr_b16 a[40:41], v32 offset:10240
  ds_read_b64_tr_b16 a[42:43], v32 offset:15360
  ds_read_b64_tr_b16 a[44:45], v32 offset:10272
  ds_read_b64_tr_b16 a[46:47], v32 offset:15392
  ds_read_b64_tr_b16 a[48:49], v32 offset:10304
  ds_read_b64_tr_b16 a[50:51], v32 offset:15424
  ds_read_b64_tr_b16 a[52:53], v32 offset:10336
  ds_read_b64_tr_b16 a[54:55], v32 offset:15456
  ds_read_b64_tr_b16 a[56:57], v32 offset:10368
  ds_read_b64_tr_b16 a[58:59], v32 offset:15488
  ds_read_b64_tr_b16 a[60:61], v33 offset:10400
  ds_read_b64_tr_b16 a[62:63], v33 offset:15520
  ds_read_b64_tr_b16 a[64:65], v33 offset:10432
  ds_read_b64_tr_b16 a[66:67], v33 offset:15552
  ds_read_b64_tr_b16 a[68:69], v33 offset:10464
  ds_read_b64_tr_b16 a[70:71], v33 offset:15584
  ds_read_b64_tr_b16 a[72:73], v33 offset:10496
  ds_read_b64_tr_b16 a[74:75], v33 offset:15616
  ds_read_b64_tr_b16 a[76:77], v33 offset:10528
  ds_read_b64_tr_b16 a[78:79], v33 offset:15648
  s_waitcnt lgkmcnt(0)
  s_add_u32 s3, s35, 163840
  s_add_u32 m0, s46, 10240
  s_nop 0
  buffer_load_dwordx4 v26, s[20:23], s3 offen lds
  s_add_u32 m0, s46, 11264
  s_nop 0
  buffer_load_dwordx4 v27, s[20:23], s3 offen lds
  s_add_u32 m0, s46, 12288
  s_nop 0
  buffer_load_dwordx4 v28, s[20:23], s3 offen lds
  s_add_u32 m0, s46, 13312
  s_nop 0
  buffer_load_dwordx4 v29, s[20:23], s3 offen lds
  s_add_u32 m0, s46, 14336
  s_nop 0
  buffer_load_dwordx4 v30, s[20:23], s3 offen lds
  s_add_u32 s3, s35, 184320
  s_add_u32 m0, s46, 15360
  s_nop 0
  buffer_load_dwordx4 v26, s[20:23], s3 offen lds
  s_add_u32 m0, s46, 16384
  s_nop 0
  buffer_load_dwordx4 v27, s[20:23], s3 offen lds
  s_add_u32 m0, s46, 17408
  s_nop 0
  buffer_load_dwordx4 v28, s[20:23], s3 offen lds
  s_add_u32 m0, s46, 18432
  s_nop 0
  buffer_load_dwordx4 v29, s[20:23], s3 offen lds
  s_add_u32 m0, s46, 19456
  s_nop 0
  buffer_load_dwordx4 v30, s[20:23], s3 offen lds
  s_waitcnt vmcnt(20)
  ds_read_b64_tr_b16 a[80:81], v32 offset:20480
  ds_read_b64_tr_b16 a[82:83], v32 offset:25600
  ds_read_b64_tr_b16 a[84:85], v32 offset:20512
  ds_read_b64_tr_b16 a[86:87], v32 offset:25632
  ds_read_b64_tr_b16 a[88:89], v32 offset:20544
  ds_read_b64_tr_b16 a[90:91], v32 offset:25664
  ds_read_b64_tr_b16 a[92:93], v32 offset:20576
  ds_read_b64_tr_b16 a[94:95], v32 offset:25696
  ds_read_b64_tr_b16 a[96:97], v32 offset:20608
  ds_read_b64_tr_b16 a[98:99], v32 offset:25728
  ds_read_b64_tr_b16 a[100:101], v33 offset:20640
  ds_read_b64_tr_b16 a[102:103], v33 offset:25760
  ds_read_b64_tr_b16 a[104:105], v33 offset:20672
  ds_read_b64_tr_b16 a[106:107], v33 offset:25792
  ds_read_b64_tr_b16 a[108:109], v33 offset:20704
  ds_read_b64_tr_b16 a[110:111], v33 offset:25824
  ds_read_b64_tr_b16 a[112:113], v33 offset:20736
  ds_read_b64_tr_b16 a[114:115], v33 offset:25856
  ds_read_b64_tr_b16 a[116:117], v33 offset:20768
  ds_read_b64_tr_b16 a[118:119], v33 offset:25888
  s_waitcnt lgkmcnt(0)
  s_add_u32 s3, s35, 204800
  s_add_u32 m0, s46, 20480
  s_nop 0
  buffer_load_dwordx4 v26, s[20:23], s3 offen lds
  s_add_u32 m0, s46, 21504
  s_nop 0
  buffer_load_dwordx4 v27, s[20:23], s3 offen lds
  s_add_u32 m0, s46, 22528
  s_nop 0
  buffer_load_dwordx4 v28, s[20:23], s3 offen lds
  s_add_u32 m0, s46, 23552
  s_nop 0
  buffer_load_dwordx4 v29, s[20:23], s3 offen lds
  s_add_u32 m0, s46, 24576
  s_nop 0
  buffer_load_dwordx4 v30, s[20:23], s3 offen lds
  s_add_u32 s3, s35, 225280
  s_add_u32 m0, s46, 25600
  s_nop 0
  buffer_load_dwordx4 v26, s[20:23], s3 offen lds
  s_add_u32 m0, s46, 26624
  s_nop 0
  buffer_load_dwordx4 v27, s[20:23], s3 offen lds
  s_add_u32 m0, s46, 27648
  s_nop 0
  buffer_load_dwordx4 v28, s[20:23], s3 offen lds
  s_add_u32 m0, s46, 28672
  s_nop 0
  buffer_load_dwordx4 v29, s[20:23], s3 offen lds
  s_add_u32 m0, s46, 29696
  s_nop 0
  buffer_load_dwordx4 v30, s[20:23], s3 offen lds
  s_waitcnt vmcnt(20)
  ds_read_b64_tr_b16 a[120:121], v32 offset:0
  ds_read_b64_tr_b16 a[122:123], v32 offset:5120
  ds_read_b64_tr_b16 a[124:125], v32 offset:32
  ds_read_b64_tr_b16 a[126:127], v32 offset:5152
  ds_read_b64_tr_b16 a[128:129], v32 offset:64
  ds_read_b64_tr_b16 a[130:131], v32 offset:5184
  ds_read_b64_tr_b16 a[132:133], v32 offset:96
  ds_read_b64_tr_b16 a[134:135], v32 offset:5216
  ds_read_b64_tr_b16 a[136:137], v32 offset:128
  ds_read_b64_tr_b16 a[138:139], v32 offset:5248
  ds_read_b64_tr_b16 a[140:141], v33 offset:160
  ds_read_b64_tr_b16 a[142:143], v33 offset:5280
  ds_read_b64_tr_b16 a[144:145], v33 offset:192
  ds_read_b64_tr_b16 a[146:147], v33 offset:5312
  ds_read_b64_tr_b16 a[148:149], v33 offset:224
  ds_read_b64_tr_b16 a[150:151], v33 offset:5344
  ds_read_b64_tr_b16 a[152:153], v33 offset:256
  ds_read_b64_tr_b16 a[154:155], v33 offset:5376
  ds_read_b64_tr_b16 a[156:157], v33 offset:288
  ds_read_b64_tr_b16 a[158:159], v33 offset:5408
  s_waitcnt lgkmcnt(0)
  s_add_u32 s3, s48, 0
  s_add_u32 m0, s46, 0
  s_nop 0
  buffer_load_dwordx4 v26, s[24:27], s3 offen lds
  s_add_u32 m0, s46, 1024
  s_nop 0
  buffer_load_dwordx4 v27, s[24:27], s3 offen lds
  s_add_u32 m0, s46, 2048
  s_nop 0
  buffer_load_dwordx4 v28, s[24:27], s3 offen lds
  s_add_u32 m0, s46, 3072
  s_nop 0
  buffer_load_dwordx4 v29, s[24:27], s3 offen lds
  s_add_u32 m0, s46, 4096
  s_nop 0
  buffer_load_dwordx4 v30, s[24:27], s3 offen lds
  s_add_u32 s3, s48, 20480
  s_add_u32 m0, s46, 5120
  s_nop 0
  buffer_load_dwordx4 v26, s[24:27], s3 offen lds
  s_add_u32 m0, s46, 6144
  s_nop 0
  buffer_load_dwordx4 v27, s[24:27], s3 offen lds
  s_add_u32 m0, s46, 7168
  s_nop 0
  buffer_load_dwordx4 v28, s[24:27], s3 offen lds
  s_add_u32 m0, s46, 8192
  s_nop 0
  buffer_load_dwordx4 v29, s[24:27], s3 offen lds
  s_add_u32 m0, s46, 9216
  s_nop 0
  buffer_load_dwordx4 v30, s[24:27], s3 offen lds
  s_waitcnt vmcnt(20)
  ds_read_b64_tr_b16 a[160:161], v32 offset:10240
  ds_read_b64_tr_b16 a[162:163], v32 offset:15360
  ds_read_b64_tr_b16 a[164:165], v32 offset:10272
  ds_read_b64_tr_b16 a[166:167], v32 offset:15392
  ds_read_b64_tr_b16 a[168:169], v32 offset:10304
  ds_read_b64_tr_b16 a[170:171], v32 offset:15424
  ds_read_b64_tr_b16 a[172:173], v32 offset:10336
  ds_read_b64_tr_b16 a[174:175], v32 offset:15456
  ds_read_b64_tr_b16 a[176:177], v32 offset:10368
  ds_read_b64_tr_b16 a[178:179], v32 offset:15488
  ds_read_b64_tr_b16 a[180:181], v33 offset:10400
  ds_read_b64_tr_b16 a[182:183], v33 offset:15520
  ds_read_b64_tr_b16 a[184:185], v33 offset:10432
  ds_read_b64_tr_b16 a[186:187], v33 offset:15552
  ds_read_b64_tr_b16 a[188:189], v33 offset:10464
  ds_read_b64_tr_b16 a[190:191], v33 offset:15584
  ds_read_b64_tr_b16 a[192:193], v33 offset:10496
  ds_read_b64_tr_b16 a[194:195], v33 offset:15616
  ds_read_b64_tr_b16 a[196:197], v33 offset:10528
  ds_read_b64_tr_b16 a[198:199], v33 offset:15648
  s_waitcnt lgkmcnt(0)
  s_add_u32 s3, s49, 0
  s_add_u32 m0, s46, 10240
  s_nop 0
  buffer_load_dwordx4 v26, s[24:27], s3 offen lds
  s_add_u32 m0, s46, 11264
  s_nop 0
  buffer_load_dwordx4 v27, s[24:27], s3 offen lds
  s_add_u32 m0, s46, 12288
  s_nop 0
  buffer_load_dwordx4 v28, s[24:27], s3 offen lds
  s_add_u32 m0, s46, 13312
  s_nop 0
  buffer_load_dwordx4 v29, s[24:27], s3 offen lds
  s_add_u32 m0, s46, 14336
  s_nop 0
  buffer_load_dwordx4 v30, s[24:27], s3 offen lds
  s_add_u32 s3, s49, 20480
  s_add_u32 m0, s46, 15360
  s_nop 0
  buffer_load_dwordx4 v26, s[24:27], s3 offen lds
  s_add_u32 m0, s46, 16384
  s_nop 0
  buffer_load_dwordx4 v27, s[24:27], s3 offen lds
  s_add_u32 m0, s46, 17408
  s_nop 0
  buffer_load_dwordx4 v28, s[24:27], s3 offen lds
  s_add_u32 m0, s46, 18432
  s_nop 0
  buffer_load_dwordx4 v29, s[24:27], s3 offen lds
  s_add_u32 m0, s46, 19456
  s_nop 0
  buffer_load_dwordx4 v30, s[24:27], s3 offen lds
  s_waitcnt vmcnt(20)
  ds_read_b64_tr_b16 a[200:201], v32 offset:20480
  ds_read_b64_tr_b16 a[202:203], v32 offset:25600
  ds_read_b64_tr_b16 a[204:205], v32 offset:20512
  ds_read_b64_tr_b16 a[206:207], v32 offset:25632
  ds_read_b64_tr_b16 a[208:209], v32 offset:20544
  ds_read_b64_tr_b16 a[210:211], v32 offset:25664
  ds_read_b64_tr_b16 a[212:213], v32 offset:20576
  ds_read_b64_tr_b16 a[214:215], v32 offset:25696
  ds_read_b64_tr_b16 a[216:217], v32 offset:20608
  ds_read_b64_tr_b16 a[218:219], v32 offset:25728
  ds_read_b64_tr_b16 a[220:221], v33 offset:20640
  ds_read_b64_tr_b16 a[222:223], v33 offset:25760
  ds_read_b64_tr_b16 a[224:225], v33 offset:20672
  ds_read_b64_tr_b16 a[226:227], v33 offset:25792
  ds_read_b64_tr_b16 a[228:229], v33 offset:20704
  ds_read_b64_tr_b16 a[230:231], v33 offset:25824
  ds_read_b64_tr_b16 a[232:233], v33 offset:20736
  ds_read_b64_tr_b16 a[234:235], v33 offset:25856
  ds_read_b64_tr_b16 a[236:237], v33 offset:20768
  ds_read_b64_tr_b16 a[238:239], v33 offset:25888
  s_waitcnt lgkmcnt(0)
  s_waitcnt vmcnt(10)
  ds_read_b64_tr_b16 v[212:213], v34 offset:0
  ds_read_b64_tr_b16 v[214:215], v34 offset:1280
  ds_read_b64_tr_b16 v[216:217], v34 offset:32
  ds_read_b64_tr_b16 v[218:219], v34 offset:1312
  ds_read_b64_tr_b16 v[220:221], v34 offset:64
  ds_read_b64_tr_b16 v[222:223], v34 offset:1344
  ds_read_b64_tr_b16 v[224:225], v34 offset:96
  ds_read_b64_tr_b16 v[226:227], v34 offset:1376
  ds_read_b64_tr_b16 v[228:229], v34 offset:128
  ds_read_b64_tr_b16 v[230:231], v34 offset:1408
  ds_read_b64_tr_b16 v[232:233], v35 offset:160
  ds_read_b64_tr_b16 v[234:235], v35 offset:1440
  ds_read_b64_tr_b16 v[236:237], v35 offset:192
  ds_read_b64_tr_b16 v[238:239], v35 offset:1472
  ds_read_b64_tr_b16 v[240:241], v35 offset:224
  ds_read_b64_tr_b16 v[242:243], v35 offset:1504
  ds_read_b64_tr_b16 v[244:245], v35 offset:256
  ds_read_b64_tr_b16 v[246:247], v35 offset:1536
  ds_read_b64_tr_b16 v[248:249], v35 offset:288
  ds_read_b64_tr_b16 v[250:251], v35 offset:1568
  s_waitcnt lgkmcnt(0)
  s_waitcnt vmcnt(0)
  ds_read_b64_tr_b16 v[252:253], v34 offset:10240
  ds_read_b64_tr_b16 v[254:255], v34 offset:11520
  ds_read_b64_tr_b16 a[240:241], v34 offset:10272
  ds_read_b64_tr_b16 a[242:243], v34 offset:11552
  ds_read_b64_tr_b16 a[244:245], v34 offset:10304
  ds_read_b64_tr_b16 a[246:247], v34 offset:11584
  ds_read_b64_tr_b16 a[248:249], v34 offset:10336
  ds_read_b64_tr_b16 a[250:251], v34 offset:11616
  ds_read_b64_tr_b16 a[252:253], v34 offset:10368
  ds_read_b64_tr_b16 a[254:255], v34 offset:11648
  s_waitcnt lgkmcnt(0)
  v_lshlrev_b32 v1, 4, v20
  v_mov_b32 v11, 0xf149f2ca
  s_mov_b32 s47, 0x3dd53b95
  v_and_b32 v23, 3, v20
  v_min_u32 v23, 2, v23
  v_lshl_add_u32 v24, v23, 5, s33
  s_mul_i32 s3, s7, 3
  s_add_u32 s3, s3, 96
  v_add_u32 v23, s3, v23
  v_cmp_gt_u32 vcc, 4, v20
  s_nop 1
  v_cndmask_b32 v23, v23, v24, vcc
  v_lshlrev_b32 v23, 7, v23
  v_add_u32 v2, 3145728, v23
  v_and_b32 v23, 1, v20
  v_lshl_add_u32 v23, s33, 1, v23
  v_lshlrev_b32 v23, 7, v23
  v_add_u32 v3, 3178496, v23
  s_lshl_b32 s46, s6, 14
  v_add_u32 v4, s46, v1
  s_mul_i32 s3, s6, 5120
  s_add_u32 s3, s3, 65536
  v_add_u32 v23, s3, v1
  s_and_b32 s3, s6, 1
  s_mul_i32 s48, s3, 20480
  v_add_u32 v5, s48, v23
  s_sub_u32 s48, 20480, s48
  v_add_u32 v6, s48, v23
  s_mul_i32 s48, s6, 20480
  s_add_u32 s48, s48, 65536
  v_add_u32 v7, s48, v1
  s_mul_i32 s3, s3, 1280
  s_lshr_b32 s48, s6, 1
  s_mul_i32 s48, s48, 81920
  s_add_u32 s3, s3, s48
  v_lshrrev_b32 v23, 2, v22
  v_mul_u32_u24 v23, 20480, v23
  v_lshl_add_u32 v23, v21, 6, v23
  v_and_b32 v24, 3, v22
  v_lshl_add_u32 v23, v24, 4, v23
  v_add_u32 v8, s3, v23
  v_lshlrev_b32 v9, 4, v0
  v_mul_u32_u24 v24, 1280, v24
  v_lshrrev_b32 v23, 2, v0
  v_lshl_add_u32 v10, v23, 3, v24
  s_cmp_eq_u32 s6, 2
  s_mov_b32 s58, -1
  s_cselect_b32 s59, 0, -1
  s_cmp_lt_u32 s4, 2
  s_cselect_b32 s34, 0, 36
  s_cselect_b32 s42, 1, 2
  s_cselect_b32 s94, 36, 55
  s_lshl_b32 s3, s4, 2
  s_lshr_b32 s3, 1507856, s3
  s_and_b32 s3, s3, 15
  s_add_u32 s34, s34, s3
  s_cmp_eq_u32 s34, 37
  s_cselect_b32 s42, 1, s42
  s_mov_b32 s45, s34
  s_mov_b32 s44, 0
  s_mul_i32 s3, s34, 393216
  s_mul_i32 s35, s33, 12288
  s_add_u32 s35, s35, s3
  s_add_u32 s38, s35, 6291456
  s_sub_u32 s49, s43, s36
  s_lshl_b32 s49, s49, 10
  s_lshl_b32 s36, s36, 10
  s_mul_i32 s3, s34, 98304
  s_add_u32 s36, s36, s3
  s_add_u32 s36, s36, 109051904
  s_lshl_b32 s3, s4, 2
  s_add_u32 s3, s3, s32
  s_mul_i32 s3, s3, 163840
  s_add_u32 s3, s3, 134217728
  s_mul_i32 s39, s7, 2560
  s_add_u32 s39, s39, s3
  s_mul_i32 s40, s7, 20480
  s_add_u32 s40, s40, s3
  s_mov_b32 s41, 1
  s_mul_i32 s43, s34, 40960
  s_mul_i32 s3, s7, 5120
  s_add_u32 s43, s43, s3
  s_mul_i32 s3, s32, 320
  s_add_u32 s43, s43, s3
  v_lshl_add_u32 v23, v21, 2, 0
  v_cmp_le_u32 s[50:51], v23, v22
  v_lshl_add_u32 v23, v21, 2, 1
  v_cmp_le_u32 s[52:53], v23, v22
  v_lshl_add_u32 v23, v21, 2, 2
  v_cmp_le_u32 s[54:55], v23, v22
  v_lshl_add_u32 v23, v21, 2, 3
  v_cmp_le_u32 s[56:57], v23, v22
  v_mbcnt_lo_u32_b32 v30, -1, 0
  v_min_u32 v30, 8, v30
  v_lshlrev_b32 v30, 3, v30
L8_cen:
  buffer_load_dwordx2 v[28:29], v30, s[12:15], s97 offen sc1
  s_sub_u32 s37, s37, 1
  s_cbranch_scc1 L1_dbail
  s_waitcnt vmcnt(0)
  v_not_b32 v31, v28
  v_xor_b32 v32, 0x2000, v29
  v_or_b32 v31, v31, v32
  v_cmp_ne_u32 vcc, 0, v31
  s_and_b32 s3, vcc_lo, 0xff
  s_cbranch_scc0 L9_cok
  v_lshrrev_b32 v29, 8, v29
  s_nop 1
  v_add_u32_dpp v29, v29, v29 row_shr:1 row_mask:0xf bank_mask:0xf bound_ctrl:1
  s_nop 1
  v_add_u32_dpp v29, v29, v29 row_shr:2 row_mask:0xf bank_mask:0xf bound_ctrl:1
  s_nop 1
  v_add_u32_dpp v29, v29, v29 row_shr:4 row_mask:0xf bank_mask:0xf bound_ctrl:1
  s_nop 0
  v_readlane_b32 s3, v29, 7
  s_cmp_lt_u32 s3, 256
  s_cbranch_scc1 L8_cen
  s_branch L_restart
L9_cok:
  s_lshl_b32 s3, s4, 2
  s_add_u32 s3, s3, s97
  s_cmp_lg_u32 s6, 0
  s_waitcnt vmcnt(0)
  s_barrier
  s_cbranch_scc1 L10_dri
  v_mov_b32 v28, 1
  s_mov_b64 exec, 1
  buffer_atomic_add v28, off, s[12:15], s3 offset:96 sc1
  s_mov_b64 exec, -1
L11_drp:
  buffer_load_dword v29, off, s[12:15], s3 offset:96 sc1
  s_sub_u32 s37, s37, 1
  s_cbranch_scc1 L1_dbail
  s_waitcnt vmcnt(0)
  v_cmp_gt_u32 vcc, 32, v29
  s_cbranch_vccnz L11_drp
L10_dri:
  s_barrier
  s_cmp_lg_u32 s44, 0
  s_cbranch_scc1 L13_dsk
L14_dp:
  buffer_load_dword v12, v2, s[8:11], 0 offen sc1
  s_sub_u32 s37, s37, 1
  s_cbranch_scc1 L1_dbail
  s_waitcnt vmcnt(0)
  v_cmp_ge_u32 vcc, s45, v12
  s_cbranch_vccnz L14_dp
  v_cmp_gt_u32 vcc, 64, v12
  s_cmp_eq_u64 vcc, 0
  s_cselect_b32 s44, 1, 0
L13_dsk:
  s_add_u32 s3, s35, 33554432
  s_add_u32 s48, s35, 83886080
  buffer_load_dwordx4 v[36:39], v1, s[8:11], s3 offen offset:0 sc1
  buffer_load_dwordx4 v[84:87], v1, s[8:11], s48 offen offset:0 sc1
  buffer_load_dwordx4 v[40:43], v1, s[8:11], s3 offen offset:1024 sc1
  buffer_load_dwordx4 v[88:91], v1, s[8:11], s48 offen offset:1024 sc1
  buffer_load_dwordx4 v[44:47], v1, s[8:11], s3 offen offset:2048 sc1
  buffer_load_dwordx4 v[92:95], v1, s[8:11], s48 offen offset:2048 sc1
  buffer_load_dwordx4 v[48:51], v1, s[8:11], s3 offen offset:3072 sc1
  buffer_load_dwordx4 v[96:99], v1, s[8:11], s48 offen offset:3072 sc1
  s_add_u32 s3, s35, 33558528
  s_add_u32 s48, s35, 83890176
  buffer_load_dwordx4 v[52:55], v1, s[8:11], s3 offen offset:0 sc1
  buffer_load_dwordx4 v[100:103], v1, s[8:11], s48 offen offset:0 sc1
  buffer_load_dwordx4 v[56:59], v1, s[8:11], s3 offen offset:1024 sc1
  buffer_load_dwordx4 v[104:107], v1, s[8:11], s48 offen offset:1024 sc1
  buffer_load_dwordx4 v[60:63], v1, s[8:11], s3 offen offset:2048 sc1
  buffer_load_dwordx4 v[108:111], v1, s[8:11], s48 offen offset:2048 sc1
  buffer_load_dwordx4 v[64:67], v1, s[8:11], s3 offen offset:3072 sc1
  buffer_load_dwordx4 v[112:115], v1, s[8:11], s48 offen offset:3072 sc1
  s_add_u32 s3, s35, 33562624
  s_add_u32 s48, s35, 83894272
  buffer_load_dwordx4 v[68:71], v1, s[8:11], s3 offen offset:0 sc1
  buffer_load_dwordx4 v[116:119], v1, s[8:11], s48 offen offset:0 sc1
  buffer_load_dwordx4 v[72:75], v1, s[8:11], s3 offen offset:1024 sc1
  buffer_load_dwordx4 v[120:123], v1, s[8:11], s48 offen offset:1024 sc1
  buffer_load_dwordx4 v[76:79], v1, s[8:11], s3 offen offset:2048 sc1
  buffer_load_dwordx4 v[124:127], v1, s[8:11], s48 offen offset:2048 sc1
  buffer_load_dwordx4 v[80:83], v1, s[8:11], s3 offen offset:3072 sc1
  buffer_load_dwordx4 v[128:131], v1, s[8:11], s48 offen offset:3072 sc1
  s_add_u32 m0, s46, 12288
  s_add_u32 s3, s36, 0
  buffer_load_dwordx4 v1, s[8:11], s3 offen sc1 lds
  s_add_u32 m0, s46, 13312
  s_add_u32 s3, s36, 49152
  buffer_load_dwordx4 v1, s[8:11], s3 offen sc1 lds
  s_add_u32 m0, s46, 14336
  s_add_u32 s3, s36, 0
  s_add_u32 s3, s3, s49
  buffer_load_dwordx4 v1, s[8:11], s3 offen sc1 lds
  s_add_u32 m0, s46, 15360
  s_add_u32 s3, s36, 49152
  s_add_u32 s3, s3, s49
  buffer_load_dwordx4 v1, s[8:11], s3 offen sc1 lds
  s_add_u32 s3, s35, 58720256
  s_add_u32 m0, s46, 0
  s_nop 0
  buffer_load_dwordx4 v1, s[8:11], s3 offen offset:0 sc1 lds
  buffer_load_dwordx4 v1, s[8:11], s3 offen offset:1024 sc1 lds
  buffer_load_dwordx4 v1, s[8:11], s3 offen offset:2048 sc1 lds
  buffer_load_dwordx4 v1, s[8:11], s3 offen offset:3072 sc1 lds
  s_add_u32 s3, s35, 58724352
  s_add_u32 m0, s46, 4096
  s_nop 0
  buffer_load_dwordx4 v1, s[8:11], s3 offen offset:0 sc1 lds
  buffer_load_dwordx4 v1, s[8:11], s3 offen offset:1024 sc1 lds
  buffer_load_dwordx4 v1, s[8:11], s3 offen offset:2048 sc1 lds
  buffer_load_dwordx4 v1, s[8:11], s3 offen offset:3072 sc1 lds
  s_add_u32 s3, s35, 58728448
  s_add_u32 m0, s46, 8192
  s_nop 0
  buffer_load_dwordx4 v1, s[8:11], s3 offen offset:0 sc1 lds
  buffer_load_dwordx4 v1, s[8:11], s3 offen offset:1024 sc1 lds
  buffer_load_dwordx4 v1, s[8:11], s3 offen offset:2048 sc1 lds
  buffer_load_dwordx4 v1, s[8:11], s3 offen offset:3072 sc1 lds
L12_dtop:
  s_waitcnt vmcnt(38)
  v_mfma_f32_16x16x32_bf16 v[16:19], v[36:39], v[84:87], 0
  s_waitcnt vmcnt(36)
  v_mfma_f32_16x16x32_bf16 v[16:19], v[40:43], v[88:91], v[16:19]
  s_waitcnt vmcnt(34)
  v_mfma_f32_16x16x32_bf16 v[16:19], v[44:47], v[92:95], v[16:19]
  s_waitcnt vmcnt(32)
  v_mfma_f32_16x16x32_bf16 v[16:19], v[48:51], v[96:99], v[16:19]
  s_waitcnt vmcnt(30)
  v_mfma_f32_16x16x32_bf16 v[16:19], v[52:55], v[100:103], v[16:19]
  s_waitcnt vmcnt(28)
  v_mfma_f32_16x16x32_bf16 v[16:19], v[56:59], v[104:107], v[16:19]
  s_waitcnt vmcnt(26)
  v_mfma_f32_16x16x32_bf16 v[20:23], v[36:39], v[108:111], 0
  v_mfma_f32_16x16x32_bf16 v[24:27], v[60:63], v[108:111], 0
  s_waitcnt vmcnt(24)
  v_mfma_f32_16x16x32_bf16 v[20:23], v[40:43], v[112:115], v[20:23]
  v_mfma_f32_16x16x32_bf16 v[24:27], v[64:67], v[112:115], v[24:27]
  s_waitcnt vmcnt(22)
  v_mfma_f32_16x16x32_bf16 v[20:23], v[44:47], v[116:119], v[20:23]
  v_mfma_f32_16x16x32_bf16 v[24:27], v[68:71], v[116:119], v[24:27]
  s_waitcnt vmcnt(20)
  v_mfma_f32_16x16x32_bf16 v[20:23], v[48:51], v[120:123], v[20:23]
  v_mfma_f32_16x16x32_bf16 v[24:27], v[72:75], v[120:123], v[24:27]
  s_waitcnt vmcnt(18)
  v_mfma_f32_16x16x32_bf16 v[20:23], v[52:55], v[124:127], v[20:23]
  v_mfma_f32_16x16x32_bf16 v[24:27], v[76:79], v[124:127], v[24:27]
  s_waitcnt vmcnt(16)
  v_mfma_f32_16x16x32_bf16 v[20:23], v[56:59], v[128:131], v[20:23]
  v_mfma_f32_16x16x32_bf16 v[24:27], v[80:83], v[128:131], v[24:27]
  s_waitcnt vmcnt(12)
  ds_read_b128 v[36:39], v4 offset:12288
  ds_read_b128 v[40:43], v4 offset:13312
  ds_read_b128 v[44:47], v4 offset:14336
  ds_read_b128 v[48:51], v4 offset:15360
  v_cndmask_b32 v16, v11, v16, s[50:51]
  v_cndmask_b32 v17, v11, v17, s[52:53]
  v_cndmask_b32 v18, v11, v18, s[54:55]
  v_cndmask_b32 v19, v11, v19, s[56:57]
  v_cndmask_b32 v24, v11, v24, s[50:51]
  v_cndmask_b32 v25, v11, v25, s[52:53]
  v_cndmask_b32 v26, v11, v26, s[54:55]
  v_cndmask_b32 v27, v11, v27, s[56:57]
  v_max3_f32 v13, v16, v17, v18
  v_max3_f32 v14, v20, v21, v22
  v_max_f32 v13, v13, v19
  v_max3_f32 v14, v14, v23, v24
  v_max3_f32 v14, v14, v25, v26
  v_max_f32 v14, v14, v27
  s_waitcnt lgkmcnt(0)
  v_mfma_f32_16x16x32_bf16 v[132:135], v[212:215], v[36:39], 0
  v_mfma_f32_16x16x32_bf16 v[136:139], v[216:219], v[36:39], 0
  v_mfma_f32_16x16x32_bf16 v[140:143], v[220:223], v[36:39], 0
  v_mfma_f32_16x16x32_bf16 v[144:147], v[224:227], v[36:39], 0
  v_mfma_f32_16x16x32_bf16 v[148:151], v[228:231], v[36:39], 0
  v_mfma_f32_16x16x32_bf16 v[152:155], v[232:235], v[36:39], 0
  v_mfma_f32_16x16x32_bf16 v[156:159], v[236:239], v[36:39], 0
  v_mfma_f32_16x16x32_bf16 v[160:163], v[240:243], v[36:39], 0
  v_mfma_f32_16x16x32_bf16 v[164:167], v[244:247], v[36:39], 0
  v_mfma_f32_16x16x32_bf16 v[168:171], v[248:251], v[36:39], 0
  v_mfma_f32_16x16x32_bf16 v[172:175], v[212:215], v[40:43], 0
  v_mfma_f32_16x16x32_bf16 v[176:179], v[216:219], v[40:43], 0
  v_mfma_f32_16x16x32_bf16 v[180:183], v[220:223], v[40:43], 0
  v_mfma_f32_16x16x32_bf16 v[184:187], v[224:227], v[40:43], 0
  v_mfma_f32_16x16x32_bf16 v[188:191], v[228:231], v[40:43], 0
  v_mfma_f32_16x16x32_bf16 v[192:195], v[232:235], v[40:43], 0
  v_mfma_f32_16x16x32_bf16 v[196:199], v[236:239], v[40:43], 0
  v_mfma_f32_16x16x32_bf16 v[200:203], v[240:243], v[40:43], 0
  v_mfma_f32_16x16x32_bf16 v[204:207], v[244:247], v[40:43], 0
  v_mfma_f32_16x16x32_bf16 v[208:211], v[248:251], v[40:43], 0
  v_mfma_f32_16x16x32_bf16 v[132:135], v[252:255], v[44:47], v[132:135]
  v_mfma_f32_16x16x32_bf16 v[136:139], a[240:243], v[44:47], v[136:139]
  v_mfma_f32_16x16x32_bf16 v[140:143], a[244:247], v[44:47], v[140:143]
  v_mfma_f32_16x16x32_bf16 v[144:147], a[248:251], v[44:47], v[144:147]
  v_mfma_f32_16x16x32_bf16 v[148:151], a[252:255], v[44:47], v[148:151]
  v_mfma_f32_16x16x32_bf16 v[172:175], v[252:255], v[48:51], v[172:175]
  v_mfma_f32_16x16x32_bf16 v[176:179], a[240:243], v[48:51], v[176:179]
  v_mfma_f32_16x16x32_bf16 v[180:183], a[244:247], v[48:51], v[180:183]
  v_mfma_f32_16x16x32_bf16 v[184:187], a[248:251], v[48:51], v[184:187]
  v_mfma_f32_16x16x32_bf16 v[188:191], a[252:255], v[48:51], v[188:191]
L15_dp:
  buffer_load_dword v12, v3, s[8:11], 0 offen sc1
  s_sub_u32 s37, s37, 1
  s_cbranch_scc1 L1_dbail
  s_waitcnt vmcnt(0)
  v_cmp_ge_u32 vcc, s34, v12
  s_cbranch_vccnz L15_dp
  s_add_u32 s3, s38, 0
  buffer_load_dwordx4 v[36:39], v1, s[8:11], s3 offen offset:0 sc1
  buffer_load_dwordx4 v[40:43], v1, s[8:11], s3 offen offset:1024 sc1
  buffer_load_dwordx4 v[44:47], v1, s[8:11], s3 offen offset:2048 sc1
  s_add_u32 s3, s38, 6144
  buffer_load_dwordx4 v[48:51], v1, s[8:11], s3 offen offset:0 sc1
  buffer_load_dwordx4 v[52:55], v1, s[8:11], s3 offen offset:1024 sc1
  buffer_load_dwordx4 v[56:59], v1, s[8:11], s3 offen offset:2048 sc1
  s_add_u32 s3, s38, 3072
  buffer_load_dwordx4 v[60:63], v1, s[8:11], s3 offen offset:0 sc1
  buffer_load_dwordx4 v[64:67], v1, s[8:11], s3 offen offset:1024 sc1
  buffer_load_dwordx4 v[68:71], v1, s[8:11], s3 offen offset:2048 sc1
  s_add_u32 s3, s38, 9216
  buffer_load_dwordx4 v[72:75], v1, s[8:11], s3 offen offset:0 sc1
  buffer_load_dwordx4 v[76:79], v1, s[8:11], s3 offen offset:1024 sc1
  buffer_load_dwordx4 v[80:83], v1, s[8:11], s3 offen offset:2048 sc1
  s_waitcnt vmcnt(11)
  v_mfma_f32_16x16x32_bf16 v[28:31], v[36:39], v[84:87], 0
  v_mfma_f32_16x16x32_bf16 v[32:35], v[36:39], v[108:111], 0
  s_waitcnt vmcnt(10)
  v_mfma_f32_16x16x32_bf16 v[28:31], v[40:43], v[88:91], v[28:31]
  v_mfma_f32_16x16x32_bf16 v[32:35], v[40:43], v[112:115], v[32:35]
  s_waitcnt vmcnt(9)
  v_mfma_f32_16x16x32_bf16 v[28:31], v[44:47], v[92:95], v[28:31]
  v_mfma_f32_16x16x32_bf16 v[32:35], v[44:47], v[116:119], v[32:35]
  s_waitcnt vmcnt(8)
  v_mfma_f32_16x16x32_bf16 v[28:31], v[48:51], v[96:99], v[28:31]
  v_mfma_f32_16x16x32_bf16 v[32:35], v[48:51], v[120:123], v[32:35]
  s_waitcnt vmcnt(7)
  v_mfma_f32_16x16x32_bf16 v[28:31], v[52:55], v[100:103], v[28:31]
  v_mfma_f32_16x16x32_bf16 v[32:35], v[52:55], v[124:127], v[32:35]
  s_waitcnt vmcnt(6)
  v_mfma_f32_16x16x32_bf16 v[28:31], v[56:59], v[104:107], v[28:31]
  v_mfma_f32_16x16x32_bf16 v[32:35], v[56:59], v[128:131], v[32:35]
  s_nop 3
  v_max3_f32 v13, v13, v28, v29
  s_nop 2
  v_max3_f32 v14, v14, v32, v33
  ds_read_b128 v[84:87], v4 offset:0
  ds_read_b128 v[88:91], v4 offset:1024
  ds_read_b128 v[92:95], v4 offset:2048
  ds_read_b128 v[96:99], v4 offset:3072
  v_mov_b32 v38, 0
  v_mov_b32 v39, 0
  v_mov_b32 v42, 0
  v_mov_b32 v43, 0
  v_mov_b32 v46, 0
  v_mov_b32 v47, 0
  v_mov_b32 v15, v13
  s_nop 1
  v_permlane16_swap_b32 v13, v15
  v_max_f32 v13, v13, v15
  v_mov_b32 v15, v13
  s_nop 1
  v_permlane32_swap_b32 v13, v15
  v_max_f32 v13, v13, v15
  v_mov_b32 v15, v14
  s_nop 1
  v_permlane16_swap_b32 v14, v15
  v_max_f32 v14, v14, v15
  v_mov_b32 v15, v14
  s_nop 1
  v_permlane32_swap_b32 v14, v15
  v_max_f32 v14, v14, v15
  v_mul_f32 v13, s47, v13
  v_mul_f32 v14, s47, v14
  v_fma_f32 v16, v16, s47, -v13
  v_fma_f32 v17, v17, s47, -v13
  v_fma_f32 v18, v18, s47, -v13
  v_fma_f32 v19, v19, s47, -v13
  v_fma_f32 v28, v28, s47, -v13
  v_fma_f32 v29, v29, s47, -v13
  v_exp_f32 v16, v16
  v_exp_f32 v17, v17
  v_exp_f32 v18, v18
  v_exp_f32 v19, v19
  v_exp_f32 v28, v28
  v_exp_f32 v29, v29
  v_fma_f32 v20, v20, s47, -v14
  v_fma_f32 v21, v21, s47, -v14
  v_fma_f32 v22, v22, s47, -v14
  v_fma_f32 v23, v23, s47, -v14
  v_fma_f32 v24, v24, s47, -v14
  v_fma_f32 v25, v25, s47, -v14
  v_fma_f32 v26, v26, s47, -v14
  v_fma_f32 v27, v27, s47, -v14
  v_fma_f32 v32, v32, s47, -v14
  v_fma_f32 v33, v33, s47, -v14
  v_exp_f32 v20, v20
  v_exp_f32 v21, v21
  v_exp_f32 v22, v22
  v_exp_f32 v23, v23
  v_exp_f32 v24, v24
  v_exp_f32 v25, v25
  v_exp_f32 v26, v26
  v_exp_f32 v27, v27
  v_exp_f32 v32, v32
  v_exp_f32 v33, v33
  v_add_f32 v13, v16, v17
  v_add_f32 v13, v13, v18
  v_add_f32 v13, v13, v19
  v_add_f32 v13, v13, v28
  v_add_f32 v13, v13, v29
  v_mov_b32 v15, v13
  s_nop 1
  v_permlane16_swap_b32 v13, v15
  v_add_f32 v13, v13, v15
  v_mov_b32 v15, v13
  s_nop 1
  v_permlane32_swap_b32 v13, v15
  v_add_f32 v13, v13, v15
  v_rcp_f32 v13, v13
  v_add_f32 v14, v20, v21
  v_add_f32 v14, v14, v22
  v_add_f32 v14, v14, v23
  v_add_f32 v14, v14, v24
  v_add_f32 v14, v14, v25
  v_add_f32 v14, v14, v26
  v_add_f32 v14, v14, v27
  v_add_f32 v14, v14, v32
  v_add_f32 v14, v14, v33
  v_mov_b32 v15, v14
  s_nop 1
  v_permlane16_swap_b32 v14, v15
  v_add_f32 v14, v14, v15
  v_mov_b32 v15, v14
  s_nop 1
  v_permlane32_swap_b32 v14, v15
  v_add_f32 v14, v14, v15
  v_rcp_f32 v14, v14
  v_mul_f32 v16, v16, v13
  v_mul_f32 v17, v17, v13
  v_mul_f32 v18, v18, v13
  v_mul_f32 v19, v19, v13
  v_mul_f32 v28, v28, v13
  v_mul_f32 v29, v29, v13
  v_mul_f32 v20, v20, v14
  v_mul_f32 v21, v21, v14
  v_mul_f32 v22, v22, v14
  v_mul_f32 v23, v23, v14
  v_mul_f32 v24, v24, v14
  v_mul_f32 v25, v25, v14
  v_mul_f32 v26, v26, v14
  v_mul_f32 v27, v27, v14
  v_mul_f32 v32, v32, v14
  v_mul_f32 v33, v33, v14
  v_cvt_pk_bf16_f32 v36, v16, v17
  v_cvt_pk_bf16_f32 v37, v18, v19
  v_cvt_pk_bf16_f32 v40, v28, v29
  v_cvt_pk_bf16_f32 v41, v28, v29
  v_cvt_pk_bf16_f32 v44, v32, v33
  v_cvt_pk_bf16_f32 v45, v32, v33
  v_cvt_pk_bf16_f32 v48, v20, v21
  v_cvt_pk_bf16_f32 v49, v22, v23
  v_cvt_pk_bf16_f32 v50, v24, v25
  v_cvt_pk_bf16_f32 v51, v26, v27
  s_waitcnt lgkmcnt(2)
  v_mfma_f32_16x16x32_bf16 v[100:103], v[84:87], v[36:39], 0
  v_mfma_f32_16x16x32_bf16 v[104:107], v[88:91], v[36:39], 0
  v_mfma_f32_16x16x32_bf16 v[108:111], v[84:87], v[48:51], 0
  v_mfma_f32_16x16x32_bf16 v[112:115], v[88:91], v[48:51], 0
  s_waitcnt vmcnt(5)
  v_mfma_f32_16x16x32_bf16 v[100:103], v[60:63], v[40:43], v[100:103]
  v_mfma_f32_16x16x32_bf16 v[104:107], v[60:63], v[38:41], v[104:107]
  v_mfma_f32_16x16x32_bf16 v[108:111], v[60:63], v[44:47], v[108:111]
  v_mfma_f32_16x16x32_bf16 v[112:115], v[60:63], v[42:45], v[112:115]
  ds_read_b128 v[84:87], v4 offset:4096
  ds_read_b128 v[88:91], v4 offset:5120
  s_waitcnt lgkmcnt(2)
  v_mfma_f32_16x16x32_bf16 v[116:119], v[92:95], v[36:39], 0
  v_mfma_f32_16x16x32_bf16 v[120:123], v[96:99], v[36:39], 0
  v_mfma_f32_16x16x32_bf16 v[124:127], v[92:95], v[48:51], 0
  v_mfma_f32_16x16x32_bf16 v[128:131], v[96:99], v[48:51], 0
  s_waitcnt vmcnt(4)
  v_mfma_f32_16x16x32_bf16 v[116:119], v[64:67], v[40:43], v[116:119]
  v_cvt_pk_bf16_f32 v16, v100, v101
  v_cvt_pk_bf16_f32 v17, v102, v103
  v_mfma_f32_16x16x32_bf16 v[120:123], v[64:67], v[38:41], v[120:123]
  v_cvt_pk_bf16_f32 v18, v104, v105
  v_cvt_pk_bf16_f32 v19, v106, v107
  v_mfma_f32_16x16x32_bf16 v[124:127], v[64:67], v[44:47], v[124:127]
  v_cvt_pk_bf16_f32 v20, v108, v109
  v_cvt_pk_bf16_f32 v21, v110, v111
  v_mfma_f32_16x16x32_bf16 v[128:131], v[64:67], v[42:45], v[128:131]
  v_cvt_pk_bf16_f32 v22, v112, v113
  v_cvt_pk_bf16_f32 v23, v114, v115
  ds_read_b128 v[92:95], v4 offset:6144
  ds_read_b128 v[96:99], v4 offset:7168
  v_mfma_f32_16x16x32_bf16 v[132:135], a[0:3], v[16:19], v[132:135]
  v_mfma_f32_16x16x32_bf16 v[136:139], a[4:7], v[16:19], v[136:139]
  v_mfma_f32_16x16x32_bf16 v[140:143], a[8:11], v[16:19], v[140:143]
  v_mfma_f32_16x16x32_bf16 v[144:147], a[12:15], v[16:19], v[144:147]
  v_cvt_pk_bf16_f32 v24, v116, v117
  v_mfma_f32_16x16x32_bf16 v[148:151], a[16:19], v[16:19], v[148:151]
  v_cvt_pk_bf16_f32 v25, v118, v119
  v_mfma_f32_16x16x32_bf16 v[152:155], a[20:23], v[16:19], v[152:155]
  v_cvt_pk_bf16_f32 v26, v120, v121
  v_mfma_f32_16x16x32_bf16 v[156:159], a[24:27], v[16:19], v[156:159]
  v_cvt_pk_bf16_f32 v27, v122, v123
  v_mfma_f32_16x16x32_bf16 v[160:163], a[28:31], v[16:19], v[160:163]
  v_cvt_pk_bf16_f32 v28, v124, v125
  v_mfma_f32_16x16x32_bf16 v[164:167], a[32:35], v[16:19], v[164:167]
  v_cvt_pk_bf16_f32 v29, v126, v127
  v_mfma_f32_16x16x32_bf16 v[168:171], a[36:39], v[16:19], v[168:171]
  v_cvt_pk_bf16_f32 v30, v128, v129
  v_mfma_f32_16x16x32_bf16 v[172:175], a[0:3], v[20:23], v[172:175]
  v_cvt_pk_bf16_f32 v31, v130, v131
  v_mfma_f32_16x16x32_bf16 v[176:179], a[4:7], v[20:23], v[176:179]
  v_mfma_f32_16x16x32_bf16 v[180:183], a[8:11], v[20:23], v[180:183]
  v_mfma_f32_16x16x32_bf16 v[184:187], a[12:15], v[20:23], v[184:187]
  v_mfma_f32_16x16x32_bf16 v[188:191], a[16:19], v[20:23], v[188:191]
  v_mfma_f32_16x16x32_bf16 v[192:195], a[20:23], v[20:23], v[192:195]
  v_mfma_f32_16x16x32_bf16 v[196:199], a[24:27], v[20:23], v[196:199]
  v_mfma_f32_16x16x32_bf16 v[200:203], a[28:31], v[20:23], v[200:203]
  v_mfma_f32_16x16x32_bf16 v[204:207], a[32:35], v[20:23], v[204:207]
  v_mfma_f32_16x16x32_bf16 v[208:211], a[36:39], v[20:23], v[208:211]
  s_waitcnt lgkmcnt(2)
  v_mfma_f32_16x16x32_bf16 v[100:103], v[84:87], v[36:39], 0
  v_mfma_f32_16x16x32_bf16 v[104:107], v[88:91], v[36:39], 0
  v_mfma_f32_16x16x32_bf16 v[108:111], v[84:87], v[48:51], 0
  v_mfma_f32_16x16x32_bf16 v[112:115], v[88:91], v[48:51], 0
  s_waitcnt vmcnt(3)
  v_mfma_f32_16x16x32_bf16 v[100:103], v[68:71], v[40:43], v[100:103]
  v_mfma_f32_16x16x32_bf16 v[104:107], v[68:71], v[38:41], v[104:107]
  v_mfma_f32_16x16x32_bf16 v[108:111], v[68:71], v[44:47], v[108:111]
  v_mfma_f32_16x16x32_bf16 v[112:115], v[68:71], v[42:45], v[112:115]
  ds_read_b128 v[84:87], v4 offset:8192
  ds_read_b128 v[88:91], v4 offset:9216
  v_mfma_f32_16x16x32_bf16 v[132:135], a[40:43], v[24:27], v[132:135]
  v_mfma_f32_16x16x32_bf16 v[136:139], a[44:47], v[24:27], v[136:139]
  v_mfma_f32_16x16x32_bf16 v[140:143], a[48:51], v[24:27], v[140:143]
  v_mfma_f32_16x16x32_bf16 v[144:147], a[52:55], v[24:27], v[144:147]
  v_cvt_pk_bf16_f32 v16, v100, v101
  v_mfma_f32_16x16x32_bf16 v[148:151], a[56:59], v[24:27], v[148:151]
  v_cvt_pk_bf16_f32 v17, v102, v103
  v_mfma_f32_16x16x32_bf16 v[152:155], a[60:63], v[24:27], v[152:155]
  v_cvt_pk_bf16_f32 v18, v104, v105
  v_mfma_f32_16x16x32_bf16 v[156:159], a[64:67], v[24:27], v[156:159]
  v_cvt_pk_bf16_f32 v19, v106, v107
  v_mfma_f32_16x16x32_bf16 v[160:163], a[68:71], v[24:27], v[160:163]
  v_cvt_pk_bf16_f32 v20, v108, v109
  v_mfma_f32_16x16x32_bf16 v[164:167], a[72:75], v[24:27], v[164:167]
  v_cvt_pk_bf16_f32 v21, v110, v111
  v_mfma_f32_16x16x32_bf16 v[168:171], a[76:79], v[24:27], v[168:171]
  v_cvt_pk_bf16_f32 v22, v112, v113
  v_mfma_f32_16x16x32_bf16 v[172:175], a[40:43], v[28:31], v[172:175]
  v_cvt_pk_bf16_f32 v23, v114, v115
  v_mfma_f32_16x16x32_bf16 v[176:179], a[44:47], v[28:31], v[176:179]
  v_mfma_f32_16x16x32_bf16 v[180:183], a[48:51], v[28:31], v[180:183]
  v_mfma_f32_16x16x32_bf16 v[184:187], a[52:55], v[28:31], v[184:187]
  v_mfma_f32_16x16x32_bf16 v[188:191], a[56:59], v[28:31], v[188:191]
  v_mfma_f32_16x16x32_bf16 v[192:195], a[60:63], v[28:31], v[192:195]
  v_mfma_f32_16x16x32_bf16 v[196:199], a[64:67], v[28:31], v[196:199]
  v_mfma_f32_16x16x32_bf16 v[200:203], a[68:71], v[28:31], v[200:203]
  v_mfma_f32_16x16x32_bf16 v[204:207], a[72:75], v[28:31], v[204:207]
  v_mfma_f32_16x16x32_bf16 v[208:211], a[76:79], v[28:31], v[208:211]
  s_waitcnt lgkmcnt(2)
  v_mfma_f32_16x16x32_bf16 v[116:119], v[92:95], v[36:39], 0
  v_mfma_f32_16x16x32_bf16 v[120:123], v[96:99], v[36:39], 0
  v_mfma_f32_16x16x32_bf16 v[124:127], v[92:95], v[48:51], 0
  v_mfma_f32_16x16x32_bf16 v[128:131], v[96:99], v[48:51], 0
  s_waitcnt vmcnt(2)
  v_mfma_f32_16x16x32_bf16 v[116:119], v[72:75], v[40:43], v[116:119]
  v_mfma_f32_16x16x32_bf16 v[120:123], v[72:75], v[38:41], v[120:123]
  v_mfma_f32_16x16x32_bf16 v[124:127], v[72:75], v[44:47], v[124:127]
  v_mfma_f32_16x16x32_bf16 v[128:131], v[72:75], v[42:45], v[128:131]
  ds_read_b128 v[92:95], v4 offset:10240
  ds_read_b128 v[96:99], v4 offset:11264
  v_mfma_f32_16x16x32_bf16 v[132:135], a[80:83], v[16:19], v[132:135]
  v_mfma_f32_16x16x32_bf16 v[136:139], a[84:87], v[16:19], v[136:139]
  v_mfma_f32_16x16x32_bf16 v[140:143], a[88:91], v[16:19], v[140:143]
  v_mfma_f32_16x16x32_bf16 v[144:147], a[92:95], v[16:19], v[144:147]
  v_cvt_pk_bf16_f32 v24, v116, v117
  v_mfma_f32_16x16x32_bf16 v[148:151], a[96:99], v[16:19], v[148:151]
  v_cvt_pk_bf16_f32 v25, v118, v119
  v_mfma_f32_16x16x32_bf16 v[152:155], a[100:103], v[16:19], v[152:155]
  v_cvt_pk_bf16_f32 v26, v120, v121
  v_mfma_f32_16x16x32_bf16 v[156:159], a[104:107], v[16:19], v[156:159]
  v_cvt_pk_bf16_f32 v27, v122, v123
  v_mfma_f32_16x16x32_bf16 v[160:163], a[108:111], v[16:19], v[160:163]
  v_cvt_pk_bf16_f32 v28, v124, v125
  v_mfma_f32_16x16x32_bf16 v[164:167], a[112:115], v[16:19], v[164:167]
  v_cvt_pk_bf16_f32 v29, v126, v127
  v_mfma_f32_16x16x32_bf16 v[168:171], a[116:119], v[16:19], v[168:171]
  v_cvt_pk_bf16_f32 v30, v128, v129
  v_mfma_f32_16x16x32_bf16 v[172:175], a[80:83], v[20:23], v[172:175]
  v_cvt_pk_bf16_f32 v31, v130, v131
  v_mfma_f32_16x16x32_bf16 v[176:179], a[84:87], v[20:23], v[176:179]
  v_mfma_f32_16x16x32_bf16 v[180:183], a[88:91], v[20:23], v[180:183]
  v_mfma_f32_16x16x32_bf16 v[184:187], a[92:95], v[20:23], v[184:187]
  v_mfma_f32_16x16x32_bf16 v[188:191], a[96:99], v[20:23], v[188:191]
  v_mfma_f32_16x16x32_bf16 v[192:195], a[100:103], v[20:23], v[192:195]
  v_mfma_f32_16x16x32_bf16 v[196:199], a[104:107], v[20:23], v[196:199]
  v_mfma_f32_16x16x32_bf16 v[200:203], a[108:111], v[20:23], v[200:203]
  v_mfma_f32_16x16x32_bf16 v[204:207], a[112:115], v[20:23], v[204:207]
  v_mfma_f32_16x16x32_bf16 v[208:211], a[116:119], v[20:23], v[208:211]
  s_waitcnt lgkmcnt(2)
  v_mfma_f32_16x16x32_bf16 v[100:103], v[84:87], v[36:39], 0
  v_mfma_f32_16x16x32_bf16 v[104:107], v[88:91], v[36:39], 0
  v_mfma_f32_16x16x32_bf16 v[108:111], v[84:87], v[48:51], 0
  v_mfma_f32_16x16x32_bf16 v[112:115], v[88:91], v[48:51], 0
  s_waitcnt vmcnt(1)
  v_mfma_f32_16x16x32_bf16 v[100:103], v[76:79], v[40:43], v[100:103]
  v_mfma_f32_16x16x32_bf16 v[104:107], v[76:79], v[38:41], v[104:107]
  v_mfma_f32_16x16x32_bf16 v[108:111], v[76:79], v[44:47], v[108:111]
  v_mfma_f32_16x16x32_bf16 v[112:115], v[76:79], v[42:45], v[112:115]
  v_mfma_f32_16x16x32_bf16 v[132:135], a[120:123], v[24:27], v[132:135]
  v_mfma_f32_16x16x32_bf16 v[136:139], a[124:127], v[24:27], v[136:139]
  v_mfma_f32_16x16x32_bf16 v[140:143], a[128:131], v[24:27], v[140:143]
  v_mfma_f32_16x16x32_bf16 v[144:147], a[132:135], v[24:27], v[144:147]
  v_cvt_pk_bf16_f32 v16, v100, v101
  v_mfma_f32_16x16x32_bf16 v[148:151], a[136:139], v[24:27], v[148:151]
  v_cvt_pk_bf16_f32 v17, v102, v103
  v_mfma_f32_16x16x32_bf16 v[152:155], a[140:143], v[24:27], v[152:155]
  v_cvt_pk_bf16_f32 v18, v104, v105
  v_mfma_f32_16x16x32_bf16 v[156:159], a[144:147], v[24:27], v[156:159]
  v_cvt_pk_bf16_f32 v19, v106, v107
  v_mfma_f32_16x16x32_bf16 v[160:163], a[148:151], v[24:27], v[160:163]
  v_cvt_pk_bf16_f32 v20, v108, v109
  v_mfma_f32_16x16x32_bf16 v[164:167], a[152:155], v[24:27], v[164:167]
  v_cvt_pk_bf16_f32 v21, v110, v111
  v_mfma_f32_16x16x32_bf16 v[168:171], a[156:159], v[24:27], v[168:171]
  v_cvt_pk_bf16_f32 v22, v112, v113
  v_mfma_f32_16x16x32_bf16 v[172:175], a[120:123], v[28:31], v[172:175]
  v_cvt_pk_bf16_f32 v23, v114, v115
  v_mfma_f32_16x16x32_bf16 v[176:179], a[124:127], v[28:31], v[176:179]
  v_mfma_f32_16x16x32_bf16 v[180:183], a[128:131], v[28:31], v[180:183]
  v_mfma_f32_16x16x32_bf16 v[184:187], a[132:135], v[28:31], v[184:187]
  v_mfma_f32_16x16x32_bf16 v[188:191], a[136:139], v[28:31], v[188:191]
  v_mfma_f32_16x16x32_bf16 v[192:195], a[140:143], v[28:31], v[192:195]
  v_mfma_f32_16x16x32_bf16 v[196:199], a[144:147], v[28:31], v[196:199]
  v_mfma_f32_16x16x32_bf16 v[200:203], a[148:151], v[28:31], v[200:203]
  v_mfma_f32_16x16x32_bf16 v[204:207], a[152:155], v[28:31], v[204:207]
  v_mfma_f32_16x16x32_bf16 v[208:211], a[156:159], v[28:31], v[208:211]
  s_waitcnt lgkmcnt(0)
  v_mfma_f32_16x16x32_bf16 v[116:119], v[92:95], v[36:39], 0
  v_mfma_f32_16x16x32_bf16 v[120:123], v[96:99], v[36:39], 0
  v_mfma_f32_16x16x32_bf16 v[124:127], v[92:95], v[48:51], 0
  v_mfma_f32_16x16x32_bf16 v[128:131], v[96:99], v[48:51], 0
  s_waitcnt vmcnt(0)
  v_mfma_f32_16x16x32_bf16 v[116:119], v[80:83], v[40:43], v[116:119]
  v_mfma_f32_16x16x32_bf16 v[120:123], v[80:83], v[38:41], v[120:123]
  v_mfma_f32_16x16x32_bf16 v[124:127], v[80:83], v[44:47], v[124:127]
  v_mfma_f32_16x16x32_bf16 v[128:131], v[80:83], v[42:45], v[128:131]
  v_mfma_f32_16x16x32_bf16 v[132:135], a[160:163], v[16:19], v[132:135]
  v_mfma_f32_16x16x32_bf16 v[136:139], a[164:167], v[16:19], v[136:139]
  v_mfma_f32_16x16x32_bf16 v[140:143], a[168:171], v[16:19], v[140:143]
  v_mfma_f32_16x16x32_bf16 v[144:147], a[172:175], v[16:19], v[144:147]
  v_cvt_pk_bf16_f32 v24, v116, v117
  v_mfma_f32_16x16x32_bf16 v[148:151], a[176:179], v[16:19], v[148:151]
  v_cvt_pk_bf16_f32 v25, v118, v119
  v_mfma_f32_16x16x32_bf16 v[152:155], a[180:183], v[16:19], v[152:155]
  v_cvt_pk_bf16_f32 v26, v120, v121
  v_mfma_f32_16x16x32_bf16 v[156:159], a[184:187], v[16:19], v[156:159]
  v_cvt_pk_bf16_f32 v27, v122, v123
  v_mfma_f32_16x16x32_bf16 v[160:163], a[188:191], v[16:19], v[160:163]
  v_cvt_pk_bf16_f32 v28, v124, v125
  v_mfma_f32_16x16x32_bf16 v[164:167], a[192:195], v[16:19], v[164:167]
  v_cvt_pk_bf16_f32 v29, v126, v127
  v_mfma_f32_16x16x32_bf16 v[168:171], a[196:199], v[16:19], v[168:171]
  v_cvt_pk_bf16_f32 v30, v128, v129
  v_mfma_f32_16x16x32_bf16 v[172:175], a[160:163], v[20:23], v[172:175]
  v_cvt_pk_bf16_f32 v31, v130, v131
  v_mfma_f32_16x16x32_bf16 v[176:179], a[164:167], v[20:23], v[176:179]
  v_mfma_f32_16x16x32_bf16 v[180:183], a[168:171], v[20:23], v[180:183]
  v_mfma_f32_16x16x32_bf16 v[184:187], a[172:175], v[20:23], v[184:187]
  v_mfma_f32_16x16x32_bf16 v[188:191], a[176:179], v[20:23], v[188:191]
  v_mfma_f32_16x16x32_bf16 v[192:195], a[180:183], v[20:23], v[192:195]
  v_mfma_f32_16x16x32_bf16 v[196:199], a[184:187], v[20:23], v[196:199]
  v_mfma_f32_16x16x32_bf16 v[200:203], a[188:191], v[20:23], v[200:203]
  v_mfma_f32_16x16x32_bf16 v[204:207], a[192:195], v[20:23], v[204:207]
  v_mfma_f32_16x16x32_bf16 v[208:211], a[196:199], v[20:23], v[208:211]
  v_mfma_f32_16x16x32_bf16 v[132:135], a[200:203], v[24:27], v[132:135]
  v_mfma_f32_16x16x32_bf16 v[136:139], a[204:207], v[24:27], v[136:139]
  v_mfma_f32_16x16x32_bf16 v[140:143], a[208:211], v[24:27], v[140:143]
  v_mfma_f32_16x16x32_bf16 v[144:147], a[212:215], v[24:27], v[144:147]
  ds_write_b128 v5, v[132:135] offset:0
  v_mfma_f32_16x16x32_bf16 v[148:151], a[216:219], v[24:27], v[148:151]
  ds_write_b128 v5, v[136:139] offset:1024
  v_mfma_f32_16x16x32_bf16 v[152:155], a[220:223], v[24:27], v[152:155]
  ds_write_b128 v5, v[140:143] offset:2048
  v_mfma_f32_16x16x32_bf16 v[156:159], a[224:227], v[24:27], v[156:159]
  ds_write_b128 v5, v[144:147] offset:3072
  v_mfma_f32_16x16x32_bf16 v[160:163], a[228:231], v[24:27], v[160:163]
  ds_write_b128 v5, v[148:151] offset:4096
  v_mfma_f32_16x16x32_bf16 v[164:167], a[232:235], v[24:27], v[164:167]
  ds_write_b128 v6, v[152:155] offset:0
  v_mfma_f32_16x16x32_bf16 v[168:171], a[236:239], v[24:27], v[168:171]
  ds_write_b128 v6, v[156:159] offset:1024
  v_mfma_f32_16x16x32_bf16 v[172:175], a[200:203], v[28:31], v[172:175]
  ds_write_b128 v6, v[160:163] offset:2048
  v_mfma_f32_16x16x32_bf16 v[176:179], a[204:207], v[28:31], v[176:179]
  ds_write_b128 v6, v[164:167] offset:3072
  v_mfma_f32_16x16x32_bf16 v[180:183], a[208:211], v[28:31], v[180:183]
  ds_write_b128 v6, v[168:171] offset:4096
  v_mfma_f32_16x16x32_bf16 v[184:187], a[212:215], v[28:31], v[184:187]
  ds_write_b128 v5, v[172:175] offset:40960
  v_mfma_f32_16x16x32_bf16 v[188:191], a[216:219], v[28:31], v[188:191]
  ds_write_b128 v5, v[176:179] offset:41984
  v_mfma_f32_16x16x32_bf16 v[192:195], a[220:223], v[28:31], v[192:195]
  ds_write_b128 v5, v[180:183] offset:43008
  v_mfma_f32_16x16x32_bf16 v[196:199], a[224:227], v[28:31], v[196:199]
  ds_write_b128 v5, v[184:187] offset:44032
  v_mfma_f32_16x16x32_bf16 v[200:203], a[228:231], v[28:31], v[200:203]
  ds_write_b128 v5, v[188:191] offset:45056
  v_mfma_f32_16x16x32_bf16 v[204:207], a[232:235], v[28:31], v[204:207]
  ds_write_b128 v6, v[192:195] offset:40960
  v_mfma_f32_16x16x32_bf16 v[208:211], a[236:239], v[28:31], v[208:211]
  ds_write_b128 v6, v[196:199] offset:41984
  ds_write_b128 v6, v[200:203] offset:43008
  s_nop 1
  ds_write_b128 v6, v[204:207] offset:44032
  s_nop 2
  ds_write_b128 v6, v[208:211] offset:45056
  s_waitcnt lgkmcnt(0)
  s_barrier
  ds_read_b128 v[132:135], v7 offset:0
  ds_read_b128 v[136:139], v7 offset:5120
  ds_read_b128 v[140:143], v7 offset:10240
  ds_read_b128 v[144:147], v7 offset:15360
  ds_read_b128 v[148:151], v7 offset:1024
  ds_read_b128 v[152:155], v7 offset:6144
  ds_read_b128 v[156:159], v7 offset:11264
  ds_read_b128 v[160:163], v7 offset:16384
  ds_read_b128 v[164:167], v7 offset:2048
  ds_read_b128 v[168:171], v7 offset:7168
  ds_read_b128 v[172:175], v7 offset:12288
  ds_read_b128 v[176:179], v7 offset:17408
  ds_read_b128 v[180:183], v7 offset:3072
  ds_read_b128 v[184:187], v7 offset:8192
  ds_read_b128 v[188:191], v7 offset:13312
  ds_read_b128 v[192:195], v7 offset:18432
  ds_read_b128 v[196:199], v7 offset:4096
  ds_read_b128 v[200:203], v7 offset:9216
  ds_read_b128 v[204:207], v7 offset:14336
  ds_read_b128 v[208:211], v7 offset:19456
  s_waitcnt lgkmcnt(15)
  v_pk_add_f32 v[132:133], v[132:133], v[136:137]
  v_pk_add_f32 v[134:135], v[134:135], v[138:139]
  v_pk_add_f32 v[140:141], v[140:141], v[144:145]
  v_pk_add_f32 v[142:143], v[142:143], v[146:147]
  v_pk_add_f32 v[132:133], v[132:133], v[140:141]
  v_pk_add_f32 v[134:135], v[134:135], v[142:143]
  v_bfi_b32 v132, 1, s41, v132
  v_bfi_b32 v133, 1, s41, v133
  v_bfi_b32 v134, 1, s41, v134
  v_bfi_b32 v135, 1, s41, v135
  s_waitcnt lgkmcnt(12)
  v_pk_add_f32 v[148:149], v[148:149], v[152:153]
  v_pk_add_f32 v[150:151], v[150:151], v[154:155]
  v_pk_add_f32 v[156:157], v[156:157], v[160:161]
  v_pk_add_f32 v[158:159], v[158:159], v[162:163]
  v_pk_add_f32 v[148:149], v[148:149], v[156:157]
  v_pk_add_f32 v[150:151], v[150:151], v[158:159]
  v_bfi_b32 v148, 1, s41, v148
  v_bfi_b32 v149, 1, s41, v149
  v_bfi_b32 v150, 1, s41, v150
  v_bfi_b32 v151, 1, s41, v151
  s_waitcnt lgkmcnt(8)
  v_pk_add_f32 v[164:165], v[164:165], v[168:169]
  v_pk_add_f32 v[166:167], v[166:167], v[170:171]
  v_pk_add_f32 v[172:173], v[172:173], v[176:177]
  v_pk_add_f32 v[174:175], v[174:175], v[178:179]
  v_pk_add_f32 v[164:165], v[164:165], v[172:173]
  v_pk_add_f32 v[166:167], v[166:167], v[174:175]
  v_bfi_b32 v164, 1, s41, v164
  v_bfi_b32 v165, 1, s41, v165
  v_bfi_b32 v166, 1, s41, v166
  v_bfi_b32 v167, 1, s41, v167
  s_waitcnt lgkmcnt(4)
  v_pk_add_f32 v[180:181], v[180:181], v[184:185]
  v_pk_add_f32 v[182:183], v[182:183], v[186:187]
  v_pk_add_f32 v[188:189], v[188:189], v[192:193]
  v_pk_add_f32 v[190:191], v[190:191], v[194:195]
  v_pk_add_f32 v[180:181], v[180:181], v[188:189]
  v_pk_add_f32 v[182:183], v[182:183], v[190:191]
  v_bfi_b32 v180, 1, s41, v180
  v_bfi_b32 v181, 1, s41, v181
  v_bfi_b32 v182, 1, s41, v182
  v_bfi_b32 v183, 1, s41, v183
  s_waitcnt lgkmcnt(0)
  v_pk_add_f32 v[196:197], v[196:197], v[200:201]
  v_pk_add_f32 v[198:199], v[198:199], v[202:203]
  v_pk_add_f32 v[204:205], v[204:205], v[208:209]
  v_pk_add_f32 v[206:207], v[206:207], v[210:211]
  v_pk_add_f32 v[196:197], v[196:197], v[204:205]
  v_pk_add_f32 v[198:199], v[198:199], v[206:207]
  v_bfi_b32 v196, 1, s41, v196
  v_bfi_b32 v197, 1, s41, v197
  v_bfi_b32 v198, 1, s41, v198
  v_bfi_b32 v199, 1, s41, v199
  s_lshl_b32 s3, 2, s42
  s_add_u32 s3, s3, s34
  s_cmp_ge_u32 s3, s94
  s_cselect_b32 s3, 1, 0
  s_cmp_eq_u32 s34, 63
  s_cselect_b32 s3, 0, s3
  s_cmp_lg_u32 s3, 0
  s_cbranch_scc1 L18_dsl
  s_cmp_lg_u32 s97, 0
  s_cbranch_scc1 L18_dsl
  buffer_store_dwordx4 v[132:135], v8, s[8:11], s39 offen offset:0
  buffer_store_dwordx4 v[148:151], v8, s[8:11], s39 offen offset:256
  buffer_store_dwordx4 v[164:167], v8, s[8:11], s39 offen offset:512
  buffer_store_dwordx4 v[180:183], v8, s[8:11], s39 offen offset:768
  buffer_store_dwordx4 v[196:199], v8, s[8:11], s39 offen offset:1024
L19_dsb:
  s_barrier
  s_lshl_b32 s3, 393216, s42
  s_add_u32 s35, s35, s3
  s_lshl_b32 s3, 98304, s42
  s_add_u32 s36, s36, s3
  s_lshl_b32 s3, 1, s42
  s_add_u32 s45, s45, s3
  s_cmp_ge_u32 s45, s94
  s_cbranch_scc1 L17_dna
  s_cmp_lg_u32 s44, 0
  s_cbranch_scc1 L21_dsk
L22_dp:
  buffer_load_dword v12, v2, s[8:11], 0 offen sc1
  s_sub_u32 s37, s37, 1
  s_cbranch_scc1 L1_dbail
  s_waitcnt vmcnt(0)
  v_cmp_ge_u32 vcc, s45, v12
  s_cbranch_vccnz L22_dp
  v_cmp_gt_u32 vcc, 64, v12
  s_cmp_eq_u64 vcc, 0
  s_cselect_b32 s44, 1, 0
L21_dsk:
  s_add_u32 s3, s35, 33554432
  s_add_u32 s48, s35, 83886080
  buffer_load_dwordx4 v[36:39], v1, s[8:11], s3 offen offset:0 sc1
  buffer_load_dwordx4 v[84:87], v1, s[8:11], s48 offen offset:0 sc1
  buffer_load_dwordx4 v[40:43], v1, s[8:11], s3 offen offset:1024 sc1
  buffer_load_dwordx4 v[88:91], v1, s[8:11], s48 offen offset:1024 sc1
  buffer_load_dwordx4 v[44:47], v1, s[8:11], s3 offen offset:2048 sc1
  buffer_load_dwordx4 v[92:95], v1, s[8:11], s48 offen offset:2048 sc1
  buffer_load_dwordx4 v[48:51], v1, s[8:11], s3 offen offset:3072 sc1
  buffer_load_dwordx4 v[96:99], v1, s[8:11], s48 offen offset:3072 sc1
  s_add_u32 s3, s35, 33558528
  s_add_u32 s48, s35, 83890176
  buffer_load_dwordx4 v[52:55], v1, s[8:11], s3 offen offset:0 sc1
  buffer_load_dwordx4 v[100:103], v1, s[8:11], s48 offen offset:0 sc1
  buffer_load_dwordx4 v[56:59], v1, s[8:11], s3 offen offset:1024 sc1
  buffer_load_dwordx4 v[104:107], v1, s[8:11], s48 offen offset:1024 sc1
  buffer_load_dwordx4 v[60:63], v1, s[8:11], s3 offen offset:2048 sc1
  buffer_load_dwordx4 v[108:111], v1, s[8:11], s48 offen offset:2048 sc1
  buffer_load_dwordx4 v[64:67], v1, s[8:11], s3 offen offset:3072 sc1
  buffer_load_dwordx4 v[112:115], v1, s[8:11], s48 offen offset:3072 sc1
  s_add_u32 s3, s35, 33562624
  s_add_u32 s48, s35, 83894272
  buffer_load_dwordx4 v[68:71], v1, s[8:11], s3 offen offset:0 sc1
  buffer_load_dwordx4 v[116:119], v1, s[8:11], s48 offen offset:0 sc1
  buffer_load_dwordx4 v[72:75], v1, s[8:11], s3 offen offset:1024 sc1
  buffer_load_dwordx4 v[120:123], v1, s[8:11], s48 offen offset:1024 sc1
  buffer_load_dwordx4 v[76:79], v1, s[8:11], s3 offen offset:2048 sc1
  buffer_load_dwordx4 v[124:127], v1, s[8:11], s48 offen offset:2048 sc1
  buffer_load_dwordx4 v[80:83], v1, s[8:11], s3 offen offset:3072 sc1
  buffer_load_dwordx4 v[128:131], v1, s[8:11], s48 offen offset:3072 sc1
  s_add_u32 m0, s46, 12288
  s_add_u32 s3, s36, 0
  buffer_load_dwordx4 v1, s[8:11], s3 offen sc1 lds
  s_add_u32 m0, s46, 13312
  s_add_u32 s3, s36, 49152
  buffer_load_dwordx4 v1, s[8:11], s3 offen sc1 lds
  s_add_u32 m0, s46, 14336
  s_add_u32 s3, s36, 0
  s_add_u32 s3, s3, s49
  buffer_load_dwordx4 v1, s[8:11], s3 offen sc1 lds
  s_add_u32 m0, s46, 15360
  s_add_u32 s3, s36, 49152
  s_add_u32 s3, s3, s49
  buffer_load_dwordx4 v1, s[8:11], s3 offen sc1 lds
  s_add_u32 s3, s35, 58720256
  s_add_u32 m0, s46, 0
  s_nop 0
  buffer_load_dwordx4 v1, s[8:11], s3 offen offset:0 sc1 lds
  buffer_load_dwordx4 v1, s[8:11], s3 offen offset:1024 sc1 lds
  buffer_load_dwordx4 v1, s[8:11], s3 offen offset:2048 sc1 lds
  buffer_load_dwordx4 v1, s[8:11], s3 offen offset:3072 sc1 lds
  s_add_u32 s3, s35, 58724352
  s_add_u32 m0, s46, 4096
  s_nop 0
  buffer_load_dwordx4 v1, s[8:11], s3 offen offset:0 sc1 lds
  buffer_load_dwordx4 v1, s[8:11], s3 offen offset:1024 sc1 lds
  buffer_load_dwordx4 v1, s[8:11], s3 offen offset:2048 sc1 lds
  buffer_load_dwordx4 v1, s[8:11], s3 offen offset:3072 sc1 lds
  s_add_u32 s3, s35, 58728448
  s_add_u32 m0, s46, 8192
  s_nop 0
  buffer_load_dwordx4 v1, s[8:11], s3 offen offset:0 sc1 lds
  buffer_load_dwordx4 v1, s[8:11], s3 offen offset:1024 sc1 lds
  buffer_load_dwordx4 v1, s[8:11], s3 offen offset:2048 sc1 lds
  buffer_load_dwordx4 v1, s[8:11], s3 offen offset:3072 sc1 lds
L17_dna:
  s_cmp_ge_u32 s6, 3
  s_cbranch_scc1 L16_dnx
  s_mov_b64 exec, s[58:59]
  buffer_load_dwordx2 v[176:177], v10, s[16:19], s43 offen
L20_drt:
  s_add_u32 s3, s40, 0
  buffer_load_dwordx4 v[136:139], v9, s[8:11], s3 offen offset:0 sc1
  buffer_load_dwordx4 v[140:143], v9, s[8:11], s3 offen offset:2560 sc1
  s_add_u32 s3, s40, 5120
  buffer_load_dwordx4 v[144:147], v9, s[8:11], s3 offen offset:0 sc1
  buffer_load_dwordx4 v[152:155], v9, s[8:11], s3 offen offset:2560 sc1
  s_add_u32 s3, s40, 10240
  buffer_load_dwordx4 v[156:159], v9, s[8:11], s3 offen offset:0 sc1
  buffer_load_dwordx4 v[160:163], v9, s[8:11], s3 offen offset:2560 sc1
  s_add_u32 s3, s40, 15360
  buffer_load_dwordx4 v[168:171], v9, s[8:11], s3 offen offset:0 sc1
  buffer_load_dwordx4 v[172:175], v9, s[8:11], s3 offen offset:2560 sc1
  s_sub_u32 s37, s37, 1
  s_cbranch_scc1 L1_dbail
  s_waitcnt vmcnt(8)
  v_lshlrev_b32 v184, 16, v176
  v_and_b32 v185, 0xffff0000, v176
  v_lshlrev_b32 v186, 16, v177
  v_and_b32 v187, 0xffff0000, v177
  s_waitcnt vmcnt(7)
  v_pk_add_f32 v[184:185], v[184:185], v[136:137]
  v_pk_add_f32 v[186:187], v[186:187], v[138:139]
  v_bitop3_b32 v188, v136, v137, s41 bitop3:0x7e
  v_bitop3_b32 v189, v138, v139, s41 bitop3:0x7e
  v_or_b32 v188, v188, v189
  s_waitcnt vmcnt(6)
  v_pk_add_f32 v[184:185], v[184:185], v[140:141]
  v_pk_add_f32 v[186:187], v[186:187], v[142:143]
  v_bitop3_b32 v189, v140, v141, s41 bitop3:0x7e
  v_bitop3_b32 v190, v142, v143, s41 bitop3:0x7e
  v_or3_b32 v188, v188, v189, v190
  s_waitcnt vmcnt(5)
  v_pk_add_f32 v[184:185], v[184:185], v[144:145]
  v_pk_add_f32 v[186:187], v[186:187], v[146:147]
  v_bitop3_b32 v189, v144, v145, s41 bitop3:0x7e
  v_bitop3_b32 v190, v146, v147, s41 bitop3:0x7e
  v_or3_b32 v188, v188, v189, v190
  s_waitcnt vmcnt(4)
  v_pk_add_f32 v[184:185], v[184:185], v[152:153]
  v_pk_add_f32 v[186:187], v[186:187], v[154:155]
  v_bitop3_b32 v189, v152, v153, s41 bitop3:0x7e
  v_bitop3_b32 v190, v154, v155, s41 bitop3:0x7e
  v_or3_b32 v188, v188, v189, v190
  s_waitcnt vmcnt(3)
  v_pk_add_f32 v[184:185], v[184:185], v[156:157]
  v_pk_add_f32 v[186:187], v[186:187], v[158:159]
  v_bitop3_b32 v189, v156, v157, s41 bitop3:0x7e
  v_bitop3_b32 v190, v158, v159, s41 bitop3:0x7e
  v_or3_b32 v188, v188, v189, v190
  s_waitcnt vmcnt(2)
  v_pk_add_f32 v[184:185], v[184:185], v[160:161]
  v_pk_add_f32 v[186:187], v[186:187], v[162:163]
  v_bitop3_b32 v189, v160, v161, s41 bitop3:0x7e
  v_bitop3_b32 v190, v162, v163, s41 bitop3:0x7e
  v_or3_b32 v188, v188, v189, v190
  s_waitcnt vmcnt(1)
  v_pk_add_f32 v[184:185], v[184:185], v[168:169]
  v_pk_add_f32 v[186:187], v[186:187], v[170:171]
  v_bitop3_b32 v189, v168, v169, s41 bitop3:0x7e
  v_bitop3_b32 v190, v170, v171, s41 bitop3:0x7e
  v_or3_b32 v188, v188, v189, v190
  s_waitcnt vmcnt(0)
  v_pk_add_f32 v[184:185], v[184:185], v[172:173]
  v_pk_add_f32 v[186:187], v[186:187], v[174:175]
  v_bitop3_b32 v189, v172, v173, s41 bitop3:0x7e
  v_bitop3_b32 v190, v174, v175, s41 bitop3:0x7e
  v_or3_b32 v188, v188, v189, v190
  v_and_b32 v188, 1, v188
  v_cmp_ne_u32 vcc, 0, v188
  s_cbranch_vccnz L20_drt
  v_cvt_pk_bf16_f32 v184, v184, v185
  v_cvt_pk_bf16_f32 v185, v186, v187
  buffer_store_dwordx2 v[184:185], v10, s[28:31], s43 offen sc1
  s_mov_b64 exec, -1
L16_dnx:
  s_add_u32 s38, s35, 6291456
  s_lshl_b32 s3, 40960, s42
  s_add_u32 s43, s43, s3
  s_bfe_u32 s3, s39, 0x10016
  s_xor_b32 s41, s41, s3
  s_xor_b32 s39, s39, 4194304
  s_xor_b32 s40, s40, 4194304
  s_cmp_eq_u32 s45, 41
  s_cselect_b32 s42, 2, s42
  s_mov_b32 s34, s45
  s_cmp_lt_u32 s34, s94
  s_cbranch_scc1 L12_dtop
  s_lshr_b32 s3, s4, 1
  s_sub_u32 s34, 57, s3
  s_sub_u32 s3, s34, s45
  s_mov_b32 s45, s34
  s_mov_b32 s94, 64
  s_mul_i32 s48, s3, 393216
  s_add_u32 s35, s35, s48
  s_add_u32 s38, s35, 6291456
  s_mul_i32 s48, s3, 98304
  s_add_u32 s36, s36, s48
  s_mul_i32 s48, s3, 40960
  s_add_u32 s43, s43, s48
  s_mul_i32 s48, s7, 2560
  s_sub_u32 s43, s43, s48
  s_bitcmp1_b32 s4, 0
  s_cselect_b32 s71, 0, 6144
  s_cselect_b32 s3, 0, 49152
  s_cselect_b32 s48, 20480, 0
  s_cselect_b64 s[72:73], -1, s[50:51]
  s_cselect_b64 s[50:51], s[50:51], 0
  s_cselect_b64 s[74:75], -1, s[52:53]
  s_cselect_b64 s[52:53], s[52:53], 0
  s_cselect_b64 s[76:77], -1, s[54:55]
  s_cselect_b64 s[54:55], s[54:55], 0
  s_cselect_b64 s[78:79], -1, s[56:57]
  s_cselect_b64 s[56:57], s[56:57], 0
  s_sub_u32 s36, s36, s3
  s_add_u32 s43, s43, s48
  s_cmp_eq_u32 s6, 0
  s_cselect_b32 s58, -1, 0xffff
  s_cselect_b32 s59, -1, 0
  s_and_b32 s3, s6, 1
  s_lshr_b32 s48, s6, 1
  s_mul_i32 vcc_lo, s3, 20480
  s_lshl_b32 vcc_hi, s48, 11
  s_add_u32 vcc_lo, vcc_lo, vcc_hi
  s_add_u32 vcc_lo, vcc_lo, 65536
  v_add_u32 v7, vcc_lo, v1
  s_mul_i32 s3, s3, 640
  s_lshl_b32 s48, s48, 8
  s_add_u32 s3, s3, s48
  v_bfe_u32 v23, v0, 1, 3
  v_mul_u32_u24 v23, 20480, v23
  v_bfe_u32 v24, v0, 4, 2
  v_lshl_add_u32 v23, v24, 5, v23
  v_and_b32 v24, 1, v0
  v_lshl_add_u32 v23, v24, 4, v23
  v_add_u32 v8, s3, v23
  v_mul_u32_u24 v24, 1280, v24
  v_lshrrev_b32 v23, 1, v0
  v_lshl_add_u32 v10, v23, 3, v24
  s_cmp_lg_u32 s44, 0
  s_cbranch_scc1 L24_dsk
L25_dp:
  buffer_load_dword v12, v2, s[8:11], 0 offen sc1
  s_sub_u32 s37, s37, 1
  s_cbranch_scc1 L1_dbail
  s_waitcnt vmcnt(0)
  v_cmp_ge_u32 vcc, s45, v12
  s_cbranch_vccnz L25_dp
  v_cmp_gt_u32 vcc, 64, v12
  s_cmp_eq_u64 vcc, 0
  s_cselect_b32 s44, 1, 0
L24_dsk:
  s_add_u32 s3, s35, 33554432
  s_add_u32 s48, s35, 83886080
  s_sub_u32 s48, s48, s71
  buffer_load_dwordx4 v[36:39], v1, s[8:11], s3 offen offset:0 sc1
  buffer_load_dwordx4 v[40:43], v1, s[8:11], s3 offen offset:1024 sc1
  buffer_load_dwordx4 v[44:47], v1, s[8:11], s3 offen offset:2048 sc1
  buffer_load_dwordx4 v[48:51], v1, s[8:11], s3 offen offset:3072 sc1
  s_add_u32 s3, s35, 33558528
  s_add_u32 s48, s35, 83890176
  s_sub_u32 s48, s48, s71
  buffer_load_dwordx4 v[52:55], v1, s[8:11], s3 offen offset:0 sc1
  buffer_load_dwordx4 v[56:59], v1, s[8:11], s3 offen offset:1024 sc1
  buffer_load_dwordx4 v[60:63], v1, s[8:11], s3 offen offset:2048 sc1
  buffer_load_dwordx4 v[108:111], v1, s[8:11], s48 offen offset:2048 sc1
  buffer_load_dwordx4 v[64:67], v1, s[8:11], s3 offen offset:3072 sc1
  buffer_load_dwordx4 v[112:115], v1, s[8:11], s48 offen offset:3072 sc1
  s_add_u32 s3, s35, 33562624
  s_add_u32 s48, s35, 83894272
  s_sub_u32 s48, s48, s71
  buffer_load_dwordx4 v[68:71], v1, s[8:11], s3 offen offset:0 sc1
  buffer_load_dwordx4 v[116:119], v1, s[8:11], s48 offen offset:0 sc1
  buffer_load_dwordx4 v[72:75], v1, s[8:11], s3 offen offset:1024 sc1
  buffer_load_dwordx4 v[120:123], v1, s[8:11], s48 offen offset:1024 sc1
  buffer_load_dwordx4 v[76:79], v1, s[8:11], s3 offen offset:2048 sc1
  buffer_load_dwordx4 v[124:127], v1, s[8:11], s48 offen offset:2048 sc1
  buffer_load_dwordx4 v[80:83], v1, s[8:11], s3 offen offset:3072 sc1
  buffer_load_dwordx4 v[128:131], v1, s[8:11], s48 offen offset:3072 sc1
  s_add_u32 m0, s46, 13312
  s_add_u32 s3, s36, 49152
  buffer_load_dwordx4 v1, s[8:11], s3 offen sc1 lds
  s_add_u32 m0, s46, 15360
  s_add_u32 s3, s36, 49152
  s_add_u32 s3, s3, s49
  buffer_load_dwordx4 v1, s[8:11], s3 offen sc1 lds
  s_add_u32 s3, s35, 58720256
  s_add_u32 m0, s46, 0
  s_nop 0
  buffer_load_dwordx4 v1, s[8:11], s3 offen offset:0 sc1 lds
  buffer_load_dwordx4 v1, s[8:11], s3 offen offset:1024 sc1 lds
  buffer_load_dwordx4 v1, s[8:11], s3 offen offset:2048 sc1 lds
  buffer_load_dwordx4 v1, s[8:11], s3 offen offset:3072 sc1 lds
  s_add_u32 s3, s35, 58724352
  s_add_u32 m0, s46, 4096
  s_nop 0
  buffer_load_dwordx4 v1, s[8:11], s3 offen offset:0 sc1 lds
  buffer_load_dwordx4 v1, s[8:11], s3 offen offset:1024 sc1 lds
  buffer_load_dwordx4 v1, s[8:11], s3 offen offset:2048 sc1 lds
  buffer_load_dwordx4 v1, s[8:11], s3 offen offset:3072 sc1 lds
  s_add_u32 s3, s35, 58728448
  s_add_u32 m0, s46, 8192
  s_nop 0
  buffer_load_dwordx4 v1, s[8:11], s3 offen offset:0 sc1 lds
  buffer_load_dwordx4 v1, s[8:11], s3 offen offset:1024 sc1 lds
  buffer_load_dwordx4 v1, s[8:11], s3 offen offset:2048 sc1 lds
  buffer_load_dwordx4 v1, s[8:11], s3 offen offset:3072 sc1 lds
L23_dtop:
  s_waitcnt vmcnt(24)
  v_mfma_f32_16x16x32_bf16 v[20:23], v[36:39], v[108:111], 0
  v_mfma_f32_16x16x32_bf16 v[24:27], v[60:63], v[108:111], 0
  s_waitcnt vmcnt(22)
  v_mfma_f32_16x16x32_bf16 v[20:23], v[40:43], v[112:115], v[20:23]
  v_mfma_f32_16x16x32_bf16 v[24:27], v[64:67], v[112:115], v[24:27]
  s_waitcnt vmcnt(20)
  v_mfma_f32_16x16x32_bf16 v[20:23], v[44:47], v[116:119], v[20:23]
  v_mfma_f32_16x16x32_bf16 v[24:27], v[68:71], v[116:119], v[24:27]
  s_waitcnt vmcnt(18)
  v_mfma_f32_16x16x32_bf16 v[20:23], v[48:51], v[120:123], v[20:23]
  v_mfma_f32_16x16x32_bf16 v[24:27], v[72:75], v[120:123], v[24:27]
  s_waitcnt vmcnt(16)
  v_mfma_f32_16x16x32_bf16 v[20:23], v[52:55], v[124:127], v[20:23]
  v_mfma_f32_16x16x32_bf16 v[24:27], v[76:79], v[124:127], v[24:27]
  s_waitcnt vmcnt(14)
  v_mfma_f32_16x16x32_bf16 v[20:23], v[56:59], v[128:131], v[20:23]
  v_mfma_f32_16x16x32_bf16 v[24:27], v[80:83], v[128:131], v[24:27]
  s_waitcnt vmcnt(12)
  ds_read_b128 v[40:43], v4 offset:13312
  ds_read_b128 v[48:51], v4 offset:15360
  s_nop 0
  v_cndmask_b32 v20, v11, v20, s[72:73]
  v_cndmask_b32 v21, v11, v21, s[74:75]
  v_cndmask_b32 v22, v11, v22, s[76:77]
  v_cndmask_b32 v23, v11, v23, s[78:79]
  v_cndmask_b32 v24, v11, v24, s[50:51]
  v_cndmask_b32 v25, v11, v25, s[52:53]
  v_cndmask_b32 v26, v11, v26, s[54:55]
  v_cndmask_b32 v27, v11, v27, s[56:57]
  v_max3_f32 v13, v16, v17, v18
  v_max3_f32 v14, v20, v21, v22
  v_max_f32 v13, v13, v19
  v_max3_f32 v14, v14, v23, v24
  v_max3_f32 v14, v14, v25, v26
  v_max_f32 v14, v14, v27
  s_waitcnt lgkmcnt(0)
  v_mfma_f32_16x16x32_bf16 v[172:175], v[212:215], v[40:43], 0
  v_mfma_f32_16x16x32_bf16 v[176:179], v[216:219], v[40:43], 0
  v_mfma_f32_16x16x32_bf16 v[180:183], v[220:223], v[40:43], 0
  v_mfma_f32_16x16x32_bf16 v[184:187], v[224:227], v[40:43], 0
  v_mfma_f32_16x16x32_bf16 v[188:191], v[228:231], v[40:43], 0
  v_mfma_f32_16x16x32_bf16 v[192:195], v[232:235], v[40:43], 0
  v_mfma_f32_16x16x32_bf16 v[196:199], v[236:239], v[40:43], 0
  v_mfma_f32_16x16x32_bf16 v[200:203], v[240:243], v[40:43], 0
  v_mfma_f32_16x16x32_bf16 v[204:207], v[244:247], v[40:43], 0
  v_mfma_f32_16x16x32_bf16 v[208:211], v[248:251], v[40:43], 0
  v_mfma_f32_16x16x32_bf16 v[172:175], v[252:255], v[48:51], v[172:175]
  v_mfma_f32_16x16x32_bf16 v[176:179], a[240:243], v[48:51], v[176:179]
  v_mfma_f32_16x16x32_bf16 v[180:183], a[244:247], v[48:51], v[180:183]
  v_mfma_f32_16x16x32_bf16 v[184:187], a[248:251], v[48:51], v[184:187]
  v_mfma_f32_16x16x32_bf16 v[188:191], a[252:255], v[48:51], v[188:191]
  s_mov_b64 exec, s[58:59]
  buffer_load_dwordx2 v[18:19], v10, s[16:19], s43 offen
  s_mov_b64 exec, -1
  s_mov_b32 s70, 0
  s_cmp_lt_u32 s34, 60
  s_cbranch_scc1 L26_dfp
  v_and_b32 v16, 3, v0
  v_mul_u32_u24 v16, 3072, v16
L27_ddp:
  buffer_load_dword v17, v16, s[8:11], s38 offen offset:3068 sc1
  buffer_load_dword v12, v3, s[8:11], 0 offen sc1
  s_sub_u32 s37, s37, 1
  s_cbranch_scc1 L1_dbail
  s_waitcnt vmcnt(1)
  v_cmp_eq_u32 vcc, -1, v17
  s_cbranch_vccz L28_dld
  s_waitcnt vmcnt(0)
  v_cmp_ge_u32 vcc, s34, v12
  s_cbranch_vccnz L27_ddp
L26_dfp:
L33_dp:
  buffer_load_dword v12, v3, s[8:11], 0 offen sc1
  s_sub_u32 s37, s37, 1
  s_cbranch_scc1 L1_dbail
  s_waitcnt vmcnt(0)
  v_cmp_ge_u32 vcc, s34, v12
  s_cbranch_vccnz L33_dp
  s_mov_b32 s70, 1
L28_dld:
  s_add_u32 s3, s38, 0
  buffer_load_dwordx4 v[36:39], v1, s[8:11], s3 offen offset:0 sc1
  buffer_load_dwordx4 v[40:43], v1, s[8:11], s3 offen offset:1024 sc1
  buffer_load_dwordx4 v[44:47], v1, s[8:11], s3 offen offset:2048 sc1
  s_add_u32 s3, s38, 6144
  buffer_load_dwordx4 v[48:51], v1, s[8:11], s3 offen offset:0 sc1
  buffer_load_dwordx4 v[52:55], v1, s[8:11], s3 offen offset:1024 sc1
  buffer_load_dwordx4 v[56:59], v1, s[8:11], s3 offen offset:2048 sc1
  s_add_u32 s3, s38, 3072
  buffer_load_dwordx4 v[60:63], v1, s[8:11], s3 offen offset:0 sc1
  buffer_load_dwordx4 v[64:67], v1, s[8:11], s3 offen offset:1024 sc1
  buffer_load_dwordx4 v[68:71], v1, s[8:11], s3 offen offset:2048 sc1
  s_add_u32 s3, s38, 9216
  buffer_load_dwordx4 v[72:75], v1, s[8:11], s3 offen offset:0 sc1
  buffer_load_dwordx4 v[76:79], v1, s[8:11], s3 offen offset:1024 sc1
  buffer_load_dwordx4 v[80:83], v1, s[8:11], s3 offen offset:2048 sc1
  s_waitcnt vmcnt(11)
  v_mfma_f32_16x16x32_bf16 v[32:35], v[36:39], v[108:111], 0
  v_max3_u32 v17, v36, v36, v37
  v_max3_u32 v17, v17, v38, v39
  s_waitcnt vmcnt(10)
  v_mfma_f32_16x16x32_bf16 v[32:35], v[40:43], v[112:115], v[32:35]
  v_max3_u32 v17, v17, v40, v41
  v_max3_u32 v17, v17, v42, v43
  s_waitcnt vmcnt(9)
  v_mfma_f32_16x16x32_bf16 v[32:35], v[44:47], v[116:119], v[32:35]
  v_max3_u32 v17, v17, v44, v45
  v_max3_u32 v17, v17, v46, v47
  s_waitcnt vmcnt(8)
  v_mfma_f32_16x16x32_bf16 v[32:35], v[48:51], v[120:123], v[32:35]
  v_max3_u32 v17, v17, v48, v49
  v_max3_u32 v17, v17, v50, v51
  s_waitcnt vmcnt(7)
  v_mfma_f32_16x16x32_bf16 v[32:35], v[52:55], v[124:127], v[32:35]
  v_max3_u32 v17, v17, v52, v53
  v_max3_u32 v17, v17, v54, v55
  s_waitcnt vmcnt(6)
  v_mfma_f32_16x16x32_bf16 v[32:35], v[56:59], v[128:131], v[32:35]
  v_max3_u32 v17, v17, v56, v57
  v_max3_u32 v17, v17, v58, v59
  v_cmp_eq_u32 vcc, -1, v17
  s_cbranch_vccnz L29_dkr
L30_dkc:
  s_nop 3
  v_max3_f32 v14, v14, v32, v33
  ds_read_b128 v[84:87], v4 offset:0
  ds_read_b128 v[88:91], v4 offset:1024
  ds_read_b128 v[92:95], v4 offset:2048
  ds_read_b128 v[96:99], v4 offset:3072
  v_mov_b32 v42, 0
  v_mov_b32 v43, 0
  v_mov_b32 v46, 0
  v_mov_b32 v47, 0
  v_mov_b32 v15, v14
  s_nop 1
  v_permlane16_swap_b32 v14, v15
  v_max_f32 v14, v14, v15
  v_mov_b32 v15, v14
  s_nop 1
  v_permlane32_swap_b32 v14, v15
  v_max_f32 v14, v14, v15
  v_mul_f32 v14, s47, v14
  v_fma_f32 v20, v20, s47, -v14
  v_fma_f32 v21, v21, s47, -v14
  v_fma_f32 v22, v22, s47, -v14
  v_fma_f32 v23, v23, s47, -v14
  v_fma_f32 v24, v24, s47, -v14
  v_fma_f32 v25, v25, s47, -v14
  v_fma_f32 v26, v26, s47, -v14
  v_fma_f32 v27, v27, s47, -v14
  v_fma_f32 v32, v32, s47, -v14
  v_fma_f32 v33, v33, s47, -v14
  v_exp_f32 v20, v20
  v_exp_f32 v21, v21
  v_exp_f32 v22, v22
  v_exp_f32 v23, v23
  v_exp_f32 v24, v24
  v_exp_f32 v25, v25
  v_exp_f32 v26, v26
  v_exp_f32 v27, v27
  v_exp_f32 v32, v32
  v_exp_f32 v33, v33
  v_add_f32 v14, v20, v21
  v_add_f32 v14, v14, v22
  v_add_f32 v14, v14, v23
  v_add_f32 v14, v14, v24
  v_add_f32 v14, v14, v25
  v_add_f32 v14, v14, v26
  v_add_f32 v14, v14, v27
  v_add_f32 v14, v14, v32
  v_add_f32 v14, v14, v33
  v_mov_b32 v15, v14
  s_nop 1
  v_permlane16_swap_b32 v14, v15
  v_add_f32 v14, v14, v15
  v_mov_b32 v15, v14
  s_nop 1
  v_permlane32_swap_b32 v14, v15
  v_add_f32 v14, v14, v15
  v_rcp_f32 v14, v14
  s_nop 0
  v_mul_f32 v20, v20, v14
  v_mul_f32 v21, v21, v14
  v_mul_f32 v22, v22, v14
  v_mul_f32 v23, v23, v14
  v_mul_f32 v24, v24, v14
  v_mul_f32 v25, v25, v14
  v_mul_f32 v26, v26, v14
  v_mul_f32 v27, v27, v14
  v_mul_f32 v32, v32, v14
  v_mul_f32 v33, v33, v14
  v_cvt_pk_bf16_f32 v44, v32, v33
  v_cvt_pk_bf16_f32 v45, v32, v33
  v_cvt_pk_bf16_f32 v48, v20, v21
  v_cvt_pk_bf16_f32 v49, v22, v23
  v_cvt_pk_bf16_f32 v50, v24, v25
  v_cvt_pk_bf16_f32 v51, v26, v27
  s_waitcnt vmcnt(0)
  v_max3_u32 v17, v60, v60, v61
  v_max3_u32 v17, v17, v62, v63
  v_max3_u32 v17, v17, v64, v65
  v_max3_u32 v17, v17, v66, v67
  v_max3_u32 v17, v17, v68, v69
  v_max3_u32 v17, v17, v70, v71
  v_max3_u32 v17, v17, v72, v73
  v_max3_u32 v17, v17, v74, v75
  v_max3_u32 v17, v17, v76, v77
  v_max3_u32 v17, v17, v78, v79
  v_max3_u32 v17, v17, v80, v81
  v_max3_u32 v17, v17, v82, v83
  v_cmp_eq_u32 vcc, -1, v17
  s_cbranch_vccz L32_dvc
  s_cmp_lg_u32 s70, 0
  s_cbranch_scc1 L32_dvc
L34_dp:
  buffer_load_dword v12, v3, s[8:11], 0 offen sc1
  s_sub_u32 s37, s37, 1
  s_cbranch_scc1 L1_dbail
  s_waitcnt vmcnt(0)
  v_cmp_ge_u32 vcc, s34, v12
  s_cbranch_vccnz L34_dp
  s_add_u32 s3, s38, 3072
  buffer_load_dwordx4 v[60:63], v1, s[8:11], s3 offen offset:0 sc1
  buffer_load_dwordx4 v[64:67], v1, s[8:11], s3 offen offset:1024 sc1
  buffer_load_dwordx4 v[68:71], v1, s[8:11], s3 offen offset:2048 sc1
  s_add_u32 s3, s38, 9216
  buffer_load_dwordx4 v[72:75], v1, s[8:11], s3 offen offset:0 sc1
  buffer_load_dwordx4 v[76:79], v1, s[8:11], s3 offen offset:1024 sc1
  buffer_load_dwordx4 v[80:83], v1, s[8:11], s3 offen offset:2048 sc1
  s_waitcnt vmcnt(0)
L32_dvc:
  s_waitcnt lgkmcnt(2)
  v_mfma_f32_16x16x32_bf16 v[108:111], v[84:87], v[48:51], 0
  v_mfma_f32_16x16x32_bf16 v[112:115], v[88:91], v[48:51], 0
  s_waitcnt vmcnt(5)
  v_mfma_f32_16x16x32_bf16 v[108:111], v[60:63], v[44:47], v[108:111]
  v_mfma_f32_16x16x32_bf16 v[112:115], v[60:63], v[42:45], v[112:115]
  ds_read_b128 v[84:87], v4 offset:4096
  ds_read_b128 v[88:91], v4 offset:5120
  s_waitcnt lgkmcnt(2)
  v_mfma_f32_16x16x32_bf16 v[124:127], v[92:95], v[48:51], 0
  v_mfma_f32_16x16x32_bf16 v[128:131], v[96:99], v[48:51], 0
  s_waitcnt vmcnt(4)
  v_mfma_f32_16x16x32_bf16 v[124:127], v[64:67], v[44:47], v[124:127]
  v_cvt_pk_bf16_f32 v20, v108, v109
  v_cvt_pk_bf16_f32 v21, v110, v111
  v_mfma_f32_16x16x32_bf16 v[128:131], v[64:67], v[42:45], v[128:131]
  v_cvt_pk_bf16_f32 v22, v112, v113
  v_cvt_pk_bf16_f32 v23, v114, v115
  ds_read_b128 v[92:95], v4 offset:6144
  ds_read_b128 v[96:99], v4 offset:7168
  v_mfma_f32_16x16x32_bf16 v[172:175], a[0:3], v[20:23], v[172:175]
  v_mfma_f32_16x16x32_bf16 v[176:179], a[4:7], v[20:23], v[176:179]
  v_mfma_f32_16x16x32_bf16 v[180:183], a[8:11], v[20:23], v[180:183]
  v_mfma_f32_16x16x32_bf16 v[184:187], a[12:15], v[20:23], v[184:187]
  v_cvt_pk_bf16_f32 v28, v124, v125
  v_mfma_f32_16x16x32_bf16 v[188:191], a[16:19], v[20:23], v[188:191]
  v_cvt_pk_bf16_f32 v29, v126, v127
  v_mfma_f32_16x16x32_bf16 v[192:195], a[20:23], v[20:23], v[192:195]
  v_cvt_pk_bf16_f32 v30, v128, v129
  v_mfma_f32_16x16x32_bf16 v[196:199], a[24:27], v[20:23], v[196:199]
  v_cvt_pk_bf16_f32 v31, v130, v131
  v_mfma_f32_16x16x32_bf16 v[200:203], a[28:31], v[20:23], v[200:203]
  v_mfma_f32_16x16x32_bf16 v[204:207], a[32:35], v[20:23], v[204:207]
  v_mfma_f32_16x16x32_bf16 v[208:211], a[36:39], v[20:23], v[208:211]
  s_waitcnt lgkmcnt(2)
  v_mfma_f32_16x16x32_bf16 v[108:111], v[84:87], v[48:51], 0
  v_mfma_f32_16x16x32_bf16 v[112:115], v[88:91], v[48:51], 0
  s_waitcnt vmcnt(3)
  v_mfma_f32_16x16x32_bf16 v[108:111], v[68:71], v[44:47], v[108:111]
  v_mfma_f32_16x16x32_bf16 v[112:115], v[68:71], v[42:45], v[112:115]
  ds_read_b128 v[84:87], v4 offset:8192
  ds_read_b128 v[88:91], v4 offset:9216
  v_mfma_f32_16x16x32_bf16 v[172:175], a[40:43], v[28:31], v[172:175]
  v_mfma_f32_16x16x32_bf16 v[176:179], a[44:47], v[28:31], v[176:179]
  v_mfma_f32_16x16x32_bf16 v[180:183], a[48:51], v[28:31], v[180:183]
  v_mfma_f32_16x16x32_bf16 v[184:187], a[52:55], v[28:31], v[184:187]
  v_cvt_pk_bf16_f32 v20, v108, v109
  v_mfma_f32_16x16x32_bf16 v[188:191], a[56:59], v[28:31], v[188:191]
  v_cvt_pk_bf16_f32 v21, v110, v111
  v_mfma_f32_16x16x32_bf16 v[192:195], a[60:63], v[28:31], v[192:195]
  v_cvt_pk_bf16_f32 v22, v112, v113
  v_mfma_f32_16x16x32_bf16 v[196:199], a[64:67], v[28:31], v[196:199]
  v_cvt_pk_bf16_f32 v23, v114, v115
  v_mfma_f32_16x16x32_bf16 v[200:203], a[68:71], v[28:31], v[200:203]
  v_mfma_f32_16x16x32_bf16 v[204:207], a[72:75], v[28:31], v[204:207]
  v_mfma_f32_16x16x32_bf16 v[208:211], a[76:79], v[28:31], v[208:211]
  s_waitcnt lgkmcnt(2)
  v_mfma_f32_16x16x32_bf16 v[124:127], v[92:95], v[48:51], 0
  v_mfma_f32_16x16x32_bf16 v[128:131], v[96:99], v[48:51], 0
  s_waitcnt vmcnt(2)
  v_mfma_f32_16x16x32_bf16 v[124:127], v[72:75], v[44:47], v[124:127]
  v_mfma_f32_16x16x32_bf16 v[128:131], v[72:75], v[42:45], v[128:131]
  ds_read_b128 v[92:95], v4 offset:10240
  ds_read_b128 v[96:99], v4 offset:11264
  v_mfma_f32_16x16x32_bf16 v[172:175], a[80:83], v[20:23], v[172:175]
  v_mfma_f32_16x16x32_bf16 v[176:179], a[84:87], v[20:23], v[176:179]
  v_mfma_f32_16x16x32_bf16 v[180:183], a[88:91], v[20:23], v[180:183]
  v_mfma_f32_16x16x32_bf16 v[184:187], a[92:95], v[20:23], v[184:187]
  v_cvt_pk_bf16_f32 v28, v124, v125
  v_mfma_f32_16x16x32_bf16 v[188:191], a[96:99], v[20:23], v[188:191]
  v_cvt_pk_bf16_f32 v29, v126, v127
  v_mfma_f32_16x16x32_bf16 v[192:195], a[100:103], v[20:23], v[192:195]
  v_cvt_pk_bf16_f32 v30, v128, v129
  v_mfma_f32_16x16x32_bf16 v[196:199], a[104:107], v[20:23], v[196:199]
  v_cvt_pk_bf16_f32 v31, v130, v131
  v_mfma_f32_16x16x32_bf16 v[200:203], a[108:111], v[20:23], v[200:203]
  v_mfma_f32_16x16x32_bf16 v[204:207], a[112:115], v[20:23], v[204:207]
  v_mfma_f32_16x16x32_bf16 v[208:211], a[116:119], v[20:23], v[208:211]
  s_waitcnt lgkmcnt(2)
  v_mfma_f32_16x16x32_bf16 v[108:111], v[84:87], v[48:51], 0
  v_mfma_f32_16x16x32_bf16 v[112:115], v[88:91], v[48:51], 0
  s_waitcnt vmcnt(1)
  v_mfma_f32_16x16x32_bf16 v[108:111], v[76:79], v[44:47], v[108:111]
  v_mfma_f32_16x16x32_bf16 v[112:115], v[76:79], v[42:45], v[112:115]
  v_mfma_f32_16x16x32_bf16 v[172:175], a[120:123], v[28:31], v[172:175]
  v_mfma_f32_16x16x32_bf16 v[176:179], a[124:127], v[28:31], v[176:179]
  v_mfma_f32_16x16x32_bf16 v[180:183], a[128:131], v[28:31], v[180:183]
  v_mfma_f32_16x16x32_bf16 v[184:187], a[132:135], v[28:31], v[184:187]
  v_cvt_pk_bf16_f32 v20, v108, v109
  v_mfma_f32_16x16x32_bf16 v[188:191], a[136:139], v[28:31], v[188:191]
  v_cvt_pk_bf16_f32 v21, v110, v111
  v_mfma_f32_16x16x32_bf16 v[192:195], a[140:143], v[28:31], v[192:195]
  v_cvt_pk_bf16_f32 v22, v112, v113
  v_mfma_f32_16x16x32_bf16 v[196:199], a[144:147], v[28:31], v[196:199]
  v_cvt_pk_bf16_f32 v23, v114, v115
  v_mfma_f32_16x16x32_bf16 v[200:203], a[148:151], v[28:31], v[200:203]
  v_mfma_f32_16x16x32_bf16 v[204:207], a[152:155], v[28:31], v[204:207]
  v_mfma_f32_16x16x32_bf16 v[208:211], a[156:159], v[28:31], v[208:211]
  s_waitcnt lgkmcnt(0)
  v_mfma_f32_16x16x32_bf16 v[124:127], v[92:95], v[48:51], 0
  v_mfma_f32_16x16x32_bf16 v[128:131], v[96:99], v[48:51], 0
  s_waitcnt vmcnt(0)
  v_mfma_f32_16x16x32_bf16 v[124:127], v[80:83], v[44:47], v[124:127]
  v_mfma_f32_16x16x32_bf16 v[128:131], v[80:83], v[42:45], v[128:131]
  v_mfma_f32_16x16x32_bf16 v[172:175], a[160:163], v[20:23], v[172:175]
  v_mfma_f32_16x16x32_bf16 v[176:179], a[164:167], v[20:23], v[176:179]
  v_mfma_f32_16x16x32_bf16 v[180:183], a[168:171], v[20:23], v[180:183]
  v_mfma_f32_16x16x32_bf16 v[184:187], a[172:175], v[20:23], v[184:187]
  v_cvt_pk_bf16_f32 v28, v124, v125
  v_mfma_f32_16x16x32_bf16 v[188:191], a[176:179], v[20:23], v[188:191]
  v_cvt_pk_bf16_f32 v29, v126, v127
  v_mfma_f32_16x16x32_bf16 v[192:195], a[180:183], v[20:23], v[192:195]
  v_cvt_pk_bf16_f32 v30, v128, v129
  v_mfma_f32_16x16x32_bf16 v[196:199], a[184:187], v[20:23], v[196:199]
  v_cvt_pk_bf16_f32 v31, v130, v131
  v_mfma_f32_16x16x32_bf16 v[200:203], a[188:191], v[20:23], v[200:203]
  v_mfma_f32_16x16x32_bf16 v[204:207], a[192:195], v[20:23], v[204:207]
  v_mfma_f32_16x16x32_bf16 v[208:211], a[196:199], v[20:23], v[208:211]
  v_mfma_f32_16x16x32_bf16 v[172:175], a[200:203], v[28:31], v[172:175]
  v_mfma_f32_16x16x32_bf16 v[176:179], a[204:207], v[28:31], v[176:179]
  v_mfma_f32_16x16x32_bf16 v[180:183], a[208:211], v[28:31], v[180:183]
  v_mfma_f32_16x16x32_bf16 v[184:187], a[212:215], v[28:31], v[184:187]
  ds_write_b128 v5, v[172:175] offset:0
  v_mfma_f32_16x16x32_bf16 v[188:191], a[216:219], v[28:31], v[188:191]
  ds_write_b128 v5, v[176:179] offset:1024
  v_mfma_f32_16x16x32_bf16 v[192:195], a[220:223], v[28:31], v[192:195]
  ds_write_b128 v5, v[180:183] offset:2048
  v_mfma_f32_16x16x32_bf16 v[196:199], a[224:227], v[28:31], v[196:199]
  ds_write_b128 v5, v[184:187] offset:3072
  v_mfma_f32_16x16x32_bf16 v[200:203], a[228:231], v[28:31], v[200:203]
  ds_write_b128 v5, v[188:191] offset:4096
  v_mfma_f32_16x16x32_bf16 v[204:207], a[232:235], v[28:31], v[204:207]
  ds_write_b128 v6, v[192:195] offset:0
  v_mfma_f32_16x16x32_bf16 v[208:211], a[236:239], v[28:31], v[208:211]
  ds_write_b128 v6, v[196:199] offset:1024
  ds_write_b128 v6, v[200:203] offset:2048
  s_nop 1
  ds_write_b128 v6, v[204:207] offset:3072
  s_nop 2
  ds_write_b128 v6, v[208:211] offset:4096
  s_waitcnt lgkmcnt(0)
  s_barrier
  ds_read_b128 v[132:135], v7 offset:0
  ds_read_b128 v[136:139], v7 offset:5120
  ds_read_b128 v[140:143], v7 offset:10240
  ds_read_b128 v[144:147], v7 offset:15360
  ds_read_b128 v[148:151], v7 offset:1024
  ds_read_b128 v[152:155], v7 offset:6144
  ds_read_b128 v[156:159], v7 offset:11264
  ds_read_b128 v[160:163], v7 offset:16384
  ds_read_b128 v[164:167], v7 offset:2048
  ds_read_b128 v[168:171], v7 offset:7168
  ds_read_b128 v[172:175], v7 offset:12288
  ds_read_b128 v[176:179], v7 offset:17408
  s_waitcnt lgkmcnt(8)
  v_pk_add_f32 v[132:133], v[132:133], v[136:137]
  v_pk_add_f32 v[134:135], v[134:135], v[138:139]
  v_pk_add_f32 v[140:141], v[140:141], v[144:145]
  v_pk_add_f32 v[142:143], v[142:143], v[146:147]
  v_pk_add_f32 v[132:133], v[132:133], v[140:141]
  v_pk_add_f32 v[134:135], v[134:135], v[142:143]
  v_bfi_b32 v132, 1, s41, v132
  v_bfi_b32 v133, 1, s41, v133
  v_bfi_b32 v134, 1, s41, v134
  v_bfi_b32 v135, 1, s41, v135
  s_waitcnt lgkmcnt(4)
  v_pk_add_f32 v[148:149], v[148:149], v[152:153]
  v_pk_add_f32 v[150:151], v[150:151], v[154:155]
  v_pk_add_f32 v[156:157], v[156:157], v[160:161]
  v_pk_add_f32 v[158:159], v[158:159], v[162:163]
  v_pk_add_f32 v[148:149], v[148:149], v[156:157]
  v_pk_add_f32 v[150:151], v[150:151], v[158:159]
  v_bfi_b32 v148, 1, s41, v148
  v_bfi_b32 v149, 1, s41, v149
  v_bfi_b32 v150, 1, s41, v150
  v_bfi_b32 v151, 1, s41, v151
  s_waitcnt lgkmcnt(0)
  v_pk_add_f32 v[164:165], v[164:165], v[168:169]
  v_pk_add_f32 v[166:167], v[166:167], v[170:171]
  v_pk_add_f32 v[172:173], v[172:173], v[176:177]
  v_pk_add_f32 v[174:175], v[174:175], v[178:179]
  v_pk_add_f32 v[164:165], v[164:165], v[172:173]
  v_pk_add_f32 v[166:167], v[166:167], v[174:175]
  v_bfi_b32 v164, 1, s41, v164
  v_bfi_b32 v165, 1, s41, v165
  v_bfi_b32 v166, 1, s41, v166
  v_bfi_b32 v167, 1, s41, v167
  s_sub_u32 s3, s34, 58
  s_cmp_lt_u32 s3, 4
  s_cbranch_scc1 L37_dsl
  s_cmp_lg_u32 s97, 0
  s_cbranch_scc1 L37_dsl
  buffer_store_dwordx4 v[132:135], v8, s[8:11], s39 offen offset:0
  buffer_store_dwordx4 v[148:151], v8, s[8:11], s39 offen offset:128
  buffer_store_dwordx4 v[164:167], v8, s[8:11], s39 offen offset:256
L38_dsb:
  s_barrier
  s_mov_b32 s3, 1179648
  s_add_u32 s35, s35, s3
  s_mov_b32 s3, 294912
  s_add_u32 s36, s36, s3
  s_mov_b32 s3, 3
  s_add_u32 s45, s45, s3
  s_cmp_ge_u32 s45, s94
  s_cbranch_scc1 L36_dna
  s_cmp_lg_u32 s44, 0
  s_cbranch_scc1 L40_dsk
L41_dp:
  buffer_load_dword v12, v2, s[8:11], 0 offen sc1
  s_sub_u32 s37, s37, 1
  s_cbranch_scc1 L1_dbail
  s_waitcnt vmcnt(0)
  v_cmp_ge_u32 vcc, s45, v12
  s_cbranch_vccnz L41_dp
  v_cmp_gt_u32 vcc, 64, v12
  s_cmp_eq_u64 vcc, 0
  s_cselect_b32 s44, 1, 0
L40_dsk:
  s_add_u32 s3, s35, 33554432
  s_add_u32 s48, s35, 83886080
  s_sub_u32 s48, s48, s71
  buffer_load_dwordx4 v[36:39], v1, s[8:11], s3 offen offset:0 sc1
  buffer_load_dwordx4 v[40:43], v1, s[8:11], s3 offen offset:1024 sc1
  buffer_load_dwordx4 v[44:47], v1, s[8:11], s3 offen offset:2048 sc1
  buffer_load_dwordx4 v[48:51], v1, s[8:11], s3 offen offset:3072 sc1
  s_add_u32 s3, s35, 33558528
  s_add_u32 s48, s35, 83890176
  s_sub_u32 s48, s48, s71
  buffer_load_dwordx4 v[52:55], v1, s[8:11], s3 offen offset:0 sc1
  buffer_load_dwordx4 v[56:59], v1, s[8:11], s3 offen offset:1024 sc1
  buffer_load_dwordx4 v[60:63], v1, s[8:11], s3 offen offset:2048 sc1
  buffer_load_dwordx4 v[108:111], v1, s[8:11], s48 offen offset:2048 sc1
  buffer_load_dwordx4 v[64:67], v1, s[8:11], s3 offen offset:3072 sc1
  buffer_load_dwordx4 v[112:115], v1, s[8:11], s48 offen offset:3072 sc1
  s_add_u32 s3, s35, 33562624
  s_add_u32 s48, s35, 83894272
  s_sub_u32 s48, s48, s71
  buffer_load_dwordx4 v[68:71], v1, s[8:11], s3 offen offset:0 sc1
  buffer_load_dwordx4 v[116:119], v1, s[8:11], s48 offen offset:0 sc1
  buffer_load_dwordx4 v[72:75], v1, s[8:11], s3 offen offset:1024 sc1
  buffer_load_dwordx4 v[120:123], v1, s[8:11], s48 offen offset:1024 sc1
  buffer_load_dwordx4 v[76:79], v1, s[8:11], s3 offen offset:2048 sc1
  buffer_load_dwordx4 v[124:127], v1, s[8:11], s48 offen offset:2048 sc1
  buffer_load_dwordx4 v[80:83], v1, s[8:11], s3 offen offset:3072 sc1
  buffer_load_dwordx4 v[128:131], v1, s[8:11], s48 offen offset:3072 sc1
  s_add_u32 m0, s46, 13312
  s_add_u32 s3, s36, 49152
  buffer_load_dwordx4 v1, s[8:11], s3 offen sc1 lds
  s_add_u32 m0, s46, 15360
  s_add_u32 s3, s36, 49152
  s_add_u32 s3, s3, s49
  buffer_load_dwordx4 v1, s[8:11], s3 offen sc1 lds
  s_add_u32 s3, s35, 58720256
  s_add_u32 m0, s46, 0
  s_nop 0
  buffer_load_dwordx4 v1, s[8:11], s3 offen offset:0 sc1 lds
  buffer_load_dwordx4 v1, s[8:11], s3 offen offset:1024 sc1 lds
  buffer_load_dwordx4 v1, s[8:11], s3 offen offset:2048 sc1 lds
  buffer_load_dwordx4 v1, s[8:11], s3 offen offset:3072 sc1 lds
  s_add_u32 s3, s35, 58724352
  s_add_u32 m0, s46, 4096
  s_nop 0
  buffer_load_dwordx4 v1, s[8:11], s3 offen offset:0 sc1 lds
  buffer_load_dwordx4 v1, s[8:11], s3 offen offset:1024 sc1 lds
  buffer_load_dwordx4 v1, s[8:11], s3 offen offset:2048 sc1 lds
  buffer_load_dwordx4 v1, s[8:11], s3 offen offset:3072 sc1 lds
  s_add_u32 s3, s35, 58728448
  s_add_u32 m0, s46, 8192
  s_nop 0
  buffer_load_dwordx4 v1, s[8:11], s3 offen offset:0 sc1 lds
  buffer_load_dwordx4 v1, s[8:11], s3 offen offset:1024 sc1 lds
  buffer_load_dwordx4 v1, s[8:11], s3 offen offset:2048 sc1 lds
  buffer_load_dwordx4 v1, s[8:11], s3 offen offset:3072 sc1 lds
L36_dna:
  s_cmp_ge_u32 s6, 2
  s_cbranch_scc1 L35_dnx
  s_mov_b64 exec, s[58:59]
L39_drt:
  s_add_u32 s3, s40, 0
  buffer_load_dwordx4 v[136:139], v9, s[8:11], s3 offen offset:0 sc1
  buffer_load_dwordx4 v[140:143], v9, s[8:11], s3 offen offset:2560 sc1
  s_add_u32 s3, s40, 5120
  buffer_load_dwordx4 v[144:147], v9, s[8:11], s3 offen offset:0 sc1
  buffer_load_dwordx4 v[152:155], v9, s[8:11], s3 offen offset:2560 sc1
  s_add_u32 s3, s40, 10240
  buffer_load_dwordx4 v[156:159], v9, s[8:11], s3 offen offset:0 sc1
  buffer_load_dwordx4 v[160:163], v9, s[8:11], s3 offen offset:2560 sc1
  s_add_u32 s3, s40, 15360
  buffer_load_dwordx4 v[168:171], v9, s[8:11], s3 offen offset:0 sc1
  buffer_load_dwordx4 v[172:175], v9, s[8:11], s3 offen offset:2560 sc1
  s_sub_u32 s37, s37, 1
  s_cbranch_scc1 L1_dbail
  s_waitcnt vmcnt(8)
  v_lshlrev_b32 v184, 16, v18
  v_and_b32 v185, 0xffff0000, v18
  v_lshlrev_b32 v186, 16, v19
  v_and_b32 v187, 0xffff0000, v19
  s_waitcnt vmcnt(7)
  v_pk_add_f32 v[184:185], v[184:185], v[136:137]
  v_pk_add_f32 v[186:187], v[186:187], v[138:139]
  v_bitop3_b32 v188, v136, v137, s41 bitop3:0x7e
  v_bitop3_b32 v189, v138, v139, s41 bitop3:0x7e
  v_or_b32 v188, v188, v189
  s_waitcnt vmcnt(6)
  v_pk_add_f32 v[184:185], v[184:185], v[140:141]
  v_pk_add_f32 v[186:187], v[186:187], v[142:143]
  v_bitop3_b32 v189, v140, v141, s41 bitop3:0x7e
  v_bitop3_b32 v190, v142, v143, s41 bitop3:0x7e
  v_or3_b32 v188, v188, v189, v190
  s_waitcnt vmcnt(5)
  v_pk_add_f32 v[184:185], v[184:185], v[144:145]
  v_pk_add_f32 v[186:187], v[186:187], v[146:147]
  v_bitop3_b32 v189, v144, v145, s41 bitop3:0x7e
  v_bitop3_b32 v190, v146, v147, s41 bitop3:0x7e
  v_or3_b32 v188, v188, v189, v190
  s_waitcnt vmcnt(4)
  v_pk_add_f32 v[184:185], v[184:185], v[152:153]
  v_pk_add_f32 v[186:187], v[186:187], v[154:155]
  v_bitop3_b32 v189, v152, v153, s41 bitop3:0x7e
  v_bitop3_b32 v190, v154, v155, s41 bitop3:0x7e
  v_or3_b32 v188, v188, v189, v190
  s_waitcnt vmcnt(3)
  v_pk_add_f32 v[184:185], v[184:185], v[156:157]
  v_pk_add_f32 v[186:187], v[186:187], v[158:159]
  v_bitop3_b32 v189, v156, v157, s41 bitop3:0x7e
  v_bitop3_b32 v190, v158, v159, s41 bitop3:0x7e
  v_or3_b32 v188, v188, v189, v190
  s_waitcnt vmcnt(2)
  v_pk_add_f32 v[184:185], v[184:185], v[160:161]
  v_pk_add_f32 v[186:187], v[186:187], v[162:163]
  v_bitop3_b32 v189, v160, v161, s41 bitop3:0x7e
  v_bitop3_b32 v190, v162, v163, s41 bitop3:0x7e
  v_or3_b32 v188, v188, v189, v190
  s_waitcnt vmcnt(1)
  v_pk_add_f32 v[184:185], v[184:185], v[168:169]
  v_pk_add_f32 v[186:187], v[186:187], v[170:171]
  v_bitop3_b32 v189, v168, v169, s41 bitop3:0x7e
  v_bitop3_b32 v190, v170, v171, s41 bitop3:0x7e
  v_or3_b32 v188, v188, v189, v190
  s_waitcnt vmcnt(0)
  v_pk_add_f32 v[184:185], v[184:185], v[172:173]
  v_pk_add_f32 v[186:187], v[186:187], v[174:175]
  v_bitop3_b32 v189, v172, v173, s41 bitop3:0x7e
  v_bitop3_b32 v190, v174, v175, s41 bitop3:0x7e
  v_or3_b32 v188, v188, v189, v190
  v_and_b32 v188, 1, v188
  v_cmp_ne_u32 vcc, 0, v188
  s_cbranch_vccnz L39_drt
  v_cvt_pk_bf16_f32 v184, v184, v185
  v_cvt_pk_bf16_f32 v185, v186, v187
  s_cmp_lt_u32 s34, 62
  s_cbranch_scc1 L42_do
  buffer_store_dwordx2 v[184:185], v10, s[28:31], s43 offen
L43_do:
  s_mov_b64 exec, -1
L35_dnx:
  s_add_u32 s38, s35, 6291456
  s_mov_b32 s3, 122880
  s_add_u32 s43, s43, s3
  s_bfe_u32 s3, s39, 0x10016
  s_xor_b32 s41, s41, s3
  s_xor_b32 s39, s39, 4194304
  s_xor_b32 s40, s40, 4194304
  s_mov_b32 s34, s45
  s_cmp_lt_u32 s34, s94
  s_cbranch_scc1 L23_dtop
  s_waitcnt vmcnt(0)
L1_dbail:
  s_endpgm
L18_dsl:
  buffer_store_dwordx4 v[132:135], v8, s[8:11], s39 offen offset:0 sc1
  buffer_store_dwordx4 v[148:151], v8, s[8:11], s39 offen offset:256 sc1
  buffer_store_dwordx4 v[164:167], v8, s[8:11], s39 offen offset:512 sc1
  buffer_store_dwordx4 v[180:183], v8, s[8:11], s39 offen offset:768 sc1
  buffer_store_dwordx4 v[196:199], v8, s[8:11], s39 offen offset:1024 sc1
  s_branch L19_dsb
L29_dkr:
  s_cmp_lg_u32 s70, 0
  s_cbranch_scc1 L30_dkc
  s_waitcnt vmcnt(0)
  s_branch L26_dfp
L37_dsl:
  buffer_store_dwordx4 v[132:135], v8, s[8:11], s39 offen offset:0 sc1
  buffer_store_dwordx4 v[148:151], v8, s[8:11], s39 offen offset:128 sc1
  buffer_store_dwordx4 v[164:167], v8, s[8:11], s39 offen offset:256 sc1
  s_branch L38_dsb
L42_do:
  buffer_store_dwordx2 v[184:185], v10, s[28:31], s43 offen sc1
  s_branch L43_do
L_gemm:
  s_and_b32 s3, s2, 7
  s_sub_u32 s3, s3, 4
  s_lshl_b32 s3, s3, 5
  s_lshr_b32 s4, s2, 3
  s_add_u32 s4, s4, s3
  s_and_b32 s6, s4, 31
  v_lshrrev_b32 v20, 6, v0
  s_nop 0
  v_readfirstlane_b32 s5, v20
  s_mul_i32 s24, s6, 12288
  s_cmp_ge_u32 s4, 120
  s_cbranch_scc1 Lg_end
  s_cmp_ge_u32 s4, 96
  s_cbranch_scc1 Lg_glu
  s_cmp_ge_u32 s4, 64
  s_cbranch_scc1 Lg_q
  s_cmp_ge_u32 s4, 32
  s_cbranch_scc1 Lg_v
  s_load_dwordx2 s[8:9], s[0:1], 104
  s_load_dwordx2 s[12:13], s[0:1], 96
  s_load_dwordx2 s[16:17], s[0:1], 24
  s_mov_b32 s10, 268435456
  s_mov_b32 s11, 0x20000
  s_mov_b32 s14, 256
  s_mov_b32 s15, 0x20000
  s_mov_b32 s18, 7864320
  s_mov_b32 s19, 0x20000
  s_waitcnt lgkmcnt(0)
  s_add_u32 s24, s24, 33554432
  s_branch Lg_kq
Lg_end:
  s_load_dwordx2 s[8:9], s[0:1], 104
  s_load_dwordx2 s[12:13], s[0:1], 96
  s_mov_b32 s10, 268435456
  s_mov_b32 s11, 0x20000
  s_mov_b32 s14, 256
  s_mov_b32 s15, 0x20000
  s_waitcnt lgkmcnt(0)
  s_and_b32 s3, s2, 7
  s_sub_u32 s3, s3, 2
  s_lshl_b32 s3, s3, 2
  s_bfe_u32 vcc_lo, s2, 0x20003
  s_add_u32 s3, s3, vcc_lo
  s_lshl_b32 s3, s3, 3
  s_lshr_b32 vcc_lo, s2, 5
  s_add_u32 s3, s3, vcc_lo
  s_mul_i32 vcc_lo, s3, 8192
  s_mul_i32 s3, s3, 20480
  s_add_u32 s3, s3, 134217728
  v_lshlrev_b32 v32, 4, v0
  v_mov_b32 v28, 0
  v_mov_b32 v29, 0
  v_mov_b32 v30, 0
  v_mov_b32 v31, 0
  v_mov_b32 v28, -1
  v_mov_b32 v29, -1
  v_mov_b32 v30, -1
  v_mov_b32 v31, -1
  s_add_u32 s3, vcc_lo, 29884416
  buffer_store_dwordx4 v[28:31], v32, s[8:11], s3 offen sc1
  s_add_u32 s3, vcc_lo, 29888512
  buffer_store_dwordx4 v[28:31], v32, s[8:11], s3 offen sc1
  s_cmp_lg_u32 s5, 0
  s_waitcnt vmcnt(0)
  s_barrier
  s_cbranch_scc1 Lg_e2
  s_lshr_b32 s3, s2, 3
  s_lshl_b32 s3, 1, s3
  v_mov_b32 v28, s3
  v_mov_b32 v29, 256
  s_and_b32 s3, s2, 7
  s_lshl_b32 s3, s3, 3
  s_add_u32 s3, s3, s97
  s_mov_b64 exec, 1
  buffer_atomic_add_x2 v[28:29], off, s[12:15], s3 sc1
  s_mov_b64 exec, -1
Lg_e2:
  s_load_dwordx2 s[40:41], s[0:1], 16
  s_mov_b32 s42, 7864320
  s_mov_b32 s43, 0x20000
  s_waitcnt lgkmcnt(0)
  s_and_b32 s3, s2, 1
  s_lshl_b32 s3, s3, 5
  s_lshr_b32 vcc_lo, s2, 3
  s_add_u32 s3, s3, vcc_lo
  s_lshl_b32 s3, s3, 15
  v_lshl_add_u32 v34, v0, 7, s3
  s_lshl_b32 s3, s3, 1
  v_lshrrev_b32 v35, 2, v0
  v_lshl_add_u32 v35, v35, 10, s3
  v_and_b32 v36, 3, v0
  v_min_u32 v36, 2, v36
  v_lshl_add_u32 v35, v36, 7, v35
  s_sub_u32 s3, 256, s40
  s_and_b32 s3, s3, 1023
  buffer_load_dword v36, v35, s[40:43], s3 offen
  s_add_u32 s3, s3, 4194304
  buffer_load_dword v36, v35, s[40:43], s3 offen
  s_branch L_d2
Lg_e3:
  s_endpgm
Lg_q:
  s_load_dwordx2 s[8:9], s[0:1], 104
  s_load_dwordx2 s[12:13], s[0:1], 96
  s_load_dwordx2 s[16:17], s[0:1], 16
  s_mov_b32 s10, 268435456
  s_mov_b32 s11, 0x20000
  s_mov_b32 s14, 256
  s_mov_b32 s15, 0x20000
  s_mov_b32 s18, 7864320
  s_mov_b32 s19, 0x20000
  s_waitcnt lgkmcnt(0)
  s_add_u32 s24, s24, 83886080
Lg_kq:
  s_add_u32 s25, s24, 6144
  v_and_b32 v20, 63, v0
  v_lshrrev_b32 v21, 4, v20
  v_and_b32 v22, 15, v20
  v_lshlrev_b32 v1, 4, v20
  v_mov_b32 v2, v1
  v_mov_b32 v5, 0
  s_lshl_b32 s28, s4, 7
  s_add_u32 s28, s28, 3145728
  s_cmp_lt_u32 s4, 64
  s_cbranch_scc1 L45_gl
  buffer_store_dword v5, off, s[8:11], s28 sc1
  s_and_b32 s3, s2, 7
  s_sub_u32 s3, s3, 2
  s_lshl_b32 s3, s3, 2
  s_bfe_u32 vcc_lo, s2, 0x20003
  s_add_u32 s3, s3, vcc_lo
  s_lshl_b32 s3, s3, 3
  s_lshr_b32 vcc_lo, s2, 5
  s_add_u32 s3, s3, vcc_lo
  s_mul_i32 vcc_lo, s3, 8192
  s_mul_i32 s3, s3, 20480
  s_add_u32 s3, s3, 134217728
  v_lshlrev_b32 v32, 4, v0
  v_mov_b32 v28, 0
  v_mov_b32 v29, 0
  v_mov_b32 v30, 0
  v_mov_b32 v31, 0
  v_mov_b32 v28, -1
  v_mov_b32 v29, -1
  v_mov_b32 v30, -1
  v_mov_b32 v31, -1
  s_add_u32 s3, vcc_lo, 29884416
  buffer_store_dwordx4 v[28:31], v32, s[8:11], s3 offen sc1
  s_add_u32 s3, vcc_lo, 29888512
  buffer_store_dwordx4 v[28:31], v32, s[8:11], s3 offen sc1
  s_waitcnt vmcnt(0)
  s_barrier
  s_cmp_lg_u32 s5, 0
  s_cbranch_scc1 L47_gs
  s_lshr_b32 s3, s2, 3
  s_lshl_b32 s3, 1, s3
  v_mov_b32 v28, s3
  v_mov_b32 v29, 256
  s_and_b32 s3, s2, 7
  s_lshl_b32 s3, s3, 3
  s_add_u32 s3, s3, s97
  s_mov_b64 exec, 1
  buffer_atomic_add_x2 v[28:29], off, s[12:15], s3 sc1
  s_mov_b64 exec, -1
L47_gs:
  s_load_dwordx2 s[40:41], s[0:1], 16
  s_mov_b32 s42, 7864320
  s_mov_b32 s43, 0x20000
  s_waitcnt lgkmcnt(0)
  s_and_b32 s3, s2, 1
  s_lshl_b32 s3, s3, 5
  s_lshr_b32 vcc_lo, s2, 3
  s_add_u32 s3, s3, vcc_lo
  s_lshl_b32 s3, s3, 15
  v_lshl_add_u32 v34, v0, 7, s3
  s_lshl_b32 s3, s3, 1
  v_lshrrev_b32 v35, 2, v0
  v_lshl_add_u32 v35, v35, 10, s3
  v_and_b32 v36, 3, v0
  v_min_u32 v36, 2, v36
  v_lshl_add_u32 v35, v36, 7, v35
  s_sub_u32 s3, 256, s40
  s_and_b32 s3, s3, 1023
  buffer_load_dword v36, v35, s[40:43], s3 offen
  s_add_u32 s3, s3, 4194304
  buffer_load_dword v36, v35, s[40:43], s3 offen
  s_cmp_eq_u32 s96, 0
  s_cbranch_scc1 L48_hs
  s_barrier
L48_hs:
  v_mbcnt_lo_u32_b32 v30, -1, 0
  v_min_u32 v30, 8, v30
  v_lshlrev_b32 v30, 3, v30
L50_cen:
  buffer_load_dwordx2 v[28:29], v30, s[12:15], s97 offen sc1
  s_sub_u32 s37, s37, 1
  s_cbranch_scc1 L44_gbail
  s_waitcnt vmcnt(0)
  v_not_b32 v31, v28
  v_xor_b32 v32, 0x2000, v29
  v_or_b32 v31, v31, v32
  v_cmp_ne_u32 vcc, 0, v31
  s_and_b32 s3, vcc_lo, 0xff
  s_cbranch_scc0 L51_cok
  v_lshrrev_b32 v29, 8, v29
  s_nop 1
  v_add_u32_dpp v29, v29, v29 row_shr:1 row_mask:0xf bank_mask:0xf bound_ctrl:1
  s_nop 1
  v_add_u32_dpp v29, v29, v29 row_shr:2 row_mask:0xf bank_mask:0xf bound_ctrl:1
  s_nop 1
  v_add_u32_dpp v29, v29, v29 row_shr:4 row_mask:0xf bank_mask:0xf bound_ctrl:1
  s_nop 0
  v_readlane_b32 s3, v29, 7
  s_cmp_lt_u32 s3, 256
  s_cbranch_scc1 L50_cen
  s_branch L_restart0
L51_cok:
  s_lshl_b32 s3, s6, 7
  s_add_u32 s3, s3, 3145728
L49_hp:
  buffer_load_dword v28, off, s[8:11], s3 sc1
  s_sub_u32 s37, s37, 1
  s_cbranch_scc1 L44_gbail
  s_waitcnt vmcnt(0)
  v_cmp_gt_u32 vcc, 4, v28
  s_cbranch_vccnz L49_hp
  s_cmp_lg_u32 s96, 0
  s_cbranch_scc1 L52_hs
  s_barrier
L52_hs:
L45_gl:
  s_mul_i32 s3, s6, 384
  s_mul_i32 s29, s5, 3072
  s_mul_i32 s30, s5, 192
  v_add_u32 v23, s30, v20
  v_add_u32 v23, 0, v23
  v_mul_u32_u24 v24, 2731, v23
  v_lshrrev_b32 v24, 16, v24
  v_mul_u32_u24 v25, 24, v24
  v_sub_u32 v23, v23, v25
  v_lshl_add_u32 v23, v23, 4, s3
  v_mul_u32_u24 v24, 12288, v24
  v_add_u32 v6, v23, v24
  v_add_u32 v23, s30, v20
  v_add_u32 v23, 64, v23
  v_mul_u32_u24 v24, 2731, v23
  v_lshrrev_b32 v24, 16, v24
  v_mul_u32_u24 v25, 24, v24
  v_sub_u32 v23, v23, v25
  v_lshl_add_u32 v23, v23, 4, s3
  v_mul_u32_u24 v24, 12288, v24
  v_add_u32 v7, v23, v24
  v_add_u32 v23, s30, v20
  v_add_u32 v23, 128, v23
  v_mul_u32_u24 v24, 2731, v23
  v_lshrrev_b32 v24, 16, v24
  v_mul_u32_u24 v25, 24, v24
  v_sub_u32 v23, v23, v25
  v_lshl_add_u32 v23, v23, 4, s3
  v_mul_u32_u24 v24, 12288, v24
  v_add_u32 v8, v23, v24
  s_mov_b32 s3, 0
  s_add_u32 m0, s29, 0
  s_nop 0
  buffer_load_dwordx4 v6, s[16:19], s3 offen lds
  s_add_u32 m0, s29, 1024
  s_nop 0
  buffer_load_dwordx4 v7, s[16:19], s3 offen lds
  s_add_u32 m0, s29, 2048
  s_nop 0
  buffer_load_dwordx4 v8, s[16:19], s3 offen lds
  s_mov_b32 s3, 393216
  s_add_u32 m0, s29, 12288
  s_nop 0
  buffer_load_dwordx4 v6, s[16:19], s3 offen lds
  s_add_u32 m0, s29, 13312
  s_nop 0
  buffer_load_dwordx4 v7, s[16:19], s3 offen lds
  s_add_u32 m0, s29, 14336
  s_nop 0
  buffer_load_dwordx4 v8, s[16:19], s3 offen lds
  s_mov_b32 s3, 786432
  s_add_u32 m0, s29, 24576
  s_nop 0
  buffer_load_dwordx4 v6, s[16:19], s3 offen lds
  s_add_u32 m0, s29, 25600
  s_nop 0
  buffer_load_dwordx4 v7, s[16:19], s3 offen lds
  s_add_u32 m0, s29, 26624
  s_nop 0
  buffer_load_dwordx4 v8, s[16:19], s3 offen lds
  s_mov_b32 s3, 1179648
  s_add_u32 m0, s29, 36864
  s_nop 0
  buffer_load_dwordx4 v6, s[16:19], s3 offen lds
  s_add_u32 m0, s29, 37888
  s_nop 0
  buffer_load_dwordx4 v7, s[16:19], s3 offen lds
  s_add_u32 m0, s29, 38912
  s_nop 0
  buffer_load_dwordx4 v8, s[16:19], s3 offen lds
  s_cmp_ge_u32 s4, 64
  s_cbranch_scc1 L53_ge
  buffer_store_dword v5, off, s[8:11], s28 sc1
  s_and_b32 s3, s2, 7
  s_sub_u32 s3, s3, 2
  s_lshl_b32 s3, s3, 2
  s_bfe_u32 vcc_lo, s2, 0x20003
  s_add_u32 s3, s3, vcc_lo
  s_lshl_b32 s3, s3, 3
  s_lshr_b32 vcc_lo, s2, 5
  s_add_u32 s3, s3, vcc_lo
  s_mul_i32 vcc_lo, s3, 8192
  s_mul_i32 s3, s3, 20480
  s_add_u32 s3, s3, 134217728
  v_lshlrev_b32 v32, 4, v0
  v_mov_b32 v28, 0
  v_mov_b32 v29, 0
  v_mov_b32 v30, 0
  v_mov_b32 v31, 0
  v_mov_b32 v28, -1
  v_mov_b32 v29, -1
  v_mov_b32 v30, -1
  v_mov_b32 v31, -1
  s_add_u32 s3, vcc_lo, 29884416
  buffer_store_dwordx4 v[28:31], v32, s[8:11], s3 offen sc1
  s_add_u32 s3, vcc_lo, 29888512
  buffer_store_dwordx4 v[28:31], v32, s[8:11], s3 offen sc1
L53_ge:
  s_mov_b32 s3, 1572864
  s_add_u32 m0, s29, 49152
  s_nop 0
  buffer_load_dwordx4 v6, s[16:19], s3 offen lds
  s_add_u32 m0, s29, 50176
  s_nop 0
  buffer_load_dwordx4 v7, s[16:19], s3 offen lds
  s_add_u32 m0, s29, 51200
  s_nop 0
  buffer_load_dwordx4 v8, s[16:19], s3 offen lds
  s_mov_b32 s3, 1966080
  s_add_u32 m0, s29, 61440
  s_nop 0
  buffer_load_dwordx4 v6, s[16:19], s3 offen lds
  s_add_u32 m0, s29, 62464
  s_nop 0
  buffer_load_dwordx4 v7, s[16:19], s3 offen lds
  s_add_u32 m0, s29, 63488
  s_nop 0
  buffer_load_dwordx4 v8, s[16:19], s3 offen lds
  s_mov_b32 s3, 2359296
  s_add_u32 m0, s29, 73728
  s_nop 0
  buffer_load_dwordx4 v6, s[16:19], s3 offen lds
  s_add_u32 m0, s29, 74752
  s_nop 0
  buffer_load_dwordx4 v7, s[16:19], s3 offen lds
  s_add_u32 m0, s29, 75776
  s_nop 0
  buffer_load_dwordx4 v8, s[16:19], s3 offen lds
  s_mov_b32 s3, 2752512
  s_add_u32 m0, s29, 86016
  s_nop 0
  buffer_load_dwordx4 v6, s[16:19], s3 offen lds
  s_add_u32 m0, s29, 87040
  s_nop 0
  buffer_load_dwordx4 v7, s[16:19], s3 offen lds
  s_add_u32 m0, s29, 88064
  s_nop 0
  buffer_load_dwordx4 v8, s[16:19], s3 offen lds
  s_mov_b32 s3, 3145728
  s_add_u32 m0, s29, 98304
  s_nop 0
  buffer_load_dwordx4 v6, s[16:19], s3 offen lds
  s_add_u32 m0, s29, 99328
  s_nop 0
  buffer_load_dwordx4 v7, s[16:19], s3 offen lds
  s_add_u32 m0, s29, 100352
  s_nop 0
  buffer_load_dwordx4 v8, s[16:19], s3 offen lds
  s_mov_b32 s3, 3538944
  s_add_u32 m0, s29, 110592
  s_nop 0
  buffer_load_dwordx4 v6, s[16:19], s3 offen lds
  s_add_u32 m0, s29, 111616
  s_nop 0
  buffer_load_dwordx4 v7, s[16:19], s3 offen lds
  s_add_u32 m0, s29, 112640
  s_nop 0
  buffer_load_dwordx4 v8, s[16:19], s3 offen lds
  s_mov_b32 s3, 3932160
  s_add_u32 m0, s29, 122880
  s_nop 0
  buffer_load_dwordx4 v6, s[16:19], s3 offen lds
  s_add_u32 m0, s29, 123904
  s_nop 0
  buffer_load_dwordx4 v7, s[16:19], s3 offen lds
  s_add_u32 m0, s29, 124928
  s_nop 0
  buffer_load_dwordx4 v8, s[16:19], s3 offen lds
  s_mov_b32 s3, 4325376
  s_add_u32 m0, s29, 135168
  s_nop 0
  buffer_load_dwordx4 v6, s[16:19], s3 offen lds
  s_add_u32 m0, s29, 136192
  s_nop 0
  buffer_load_dwordx4 v7, s[16:19], s3 offen lds
  s_add_u32 m0, s29, 137216
  s_nop 0
  buffer_load_dwordx4 v8, s[16:19], s3 offen lds
  v_lshrrev_b32 v23, 2, v22
  v_lshl_add_u32 v23, v21, 3, v23
  v_mul_u32_u24 v23, 384, v23
  s_mul_i32 s3, s5, 96
  v_add_u32 v23, s3, v23
  v_and_b32 v24, 3, v22
  v_lshl_add_u32 v9, v24, 4, v23
  v_lshl_add_u32 v10, v24, 3, v23
  s_mul_i32 s3, s5, 1536
  v_add_u32 v3, s3, v1
  v_and_b32 v23, 1, v21
  v_mul_u32_u24 v23, 6144, v23
  v_lshrrev_b32 v24, 1, v21
  v_lshl_add_u32 v23, v24, 8, v23
  v_lshl_add_u32 v23, v22, 4, v23
  v_add_u32 v4, s3, v23
  s_waitcnt vmcnt(24)
  s_barrier
  s_cmp_ge_u32 s4, 64
  s_cbranch_scc1 L54_ge
  s_cmp_lg_u32 s5, 0
  s_cbranch_scc1 L55_gs
  s_lshr_b32 s3, s2, 3
  s_lshl_b32 s3, 1, s3
  v_mov_b32 v28, s3
  v_mov_b32 v29, 256
  s_and_b32 s3, s2, 7
  s_lshl_b32 s3, s3, 3
  s_add_u32 s3, s3, s97
  s_mov_b64 exec, 1
  buffer_atomic_add_x2 v[28:29], off, s[12:15], s3 sc1
  s_mov_b64 exec, -1
L55_gs:
L54_ge:
  v_add_u32 v11, 0, v9
  v_add_u32 v12, 0, v10
  ds_read_b64_tr_b16 a[0:1], v11 offset:0
  ds_read_b64_tr_b16 a[2:3], v11 offset:1536
  ds_read_b64_tr_b16 a[4:5], v11 offset:8
  ds_read_b64_tr_b16 a[6:7], v11 offset:1544
  ds_read_b64_tr_b16 a[8:9], v12 offset:64
  ds_read_b64_tr_b16 a[10:11], v12 offset:1600
  ds_read_b64_tr_b16 a[12:13], v11 offset:12288
  ds_read_b64_tr_b16 a[14:15], v11 offset:13824
  ds_read_b64_tr_b16 a[16:17], v11 offset:12296
  ds_read_b64_tr_b16 a[18:19], v11 offset:13832
  ds_read_b64_tr_b16 a[20:21], v12 offset:12352
  ds_read_b64_tr_b16 a[22:23], v12 offset:13888
  ds_read_b64_tr_b16 a[24:25], v11 offset:24576
  ds_read_b64_tr_b16 a[26:27], v11 offset:26112
  ds_read_b64_tr_b16 a[28:29], v11 offset:24584
  ds_read_b64_tr_b16 a[30:31], v11 offset:26120
  ds_read_b64_tr_b16 a[32:33], v12 offset:24640
  ds_read_b64_tr_b16 a[34:35], v12 offset:26176
  ds_read_b64_tr_b16 a[36:37], v11 offset:36864
  ds_read_b64_tr_b16 a[38:39], v11 offset:38400
  ds_read_b64_tr_b16 a[40:41], v11 offset:36872
  ds_read_b64_tr_b16 a[42:43], v11 offset:38408
  ds_read_b64_tr_b16 a[44:45], v12 offset:36928
  ds_read_b64_tr_b16 a[46:47], v12 offset:38464
  s_waitcnt lgkmcnt(0)
  s_barrier
  s_mov_b32 s3, 4718592
  s_add_u32 m0, s29, 0
  s_nop 0
  buffer_load_dwordx4 v6, s[16:19], s3 offen lds
  s_add_u32 m0, s29, 1024
  s_nop 0
  buffer_load_dwordx4 v7, s[16:19], s3 offen lds
  s_add_u32 m0, s29, 2048
  s_nop 0
  buffer_load_dwordx4 v8, s[16:19], s3 offen lds
  s_mov_b32 s3, 5111808
  s_add_u32 m0, s29, 12288
  s_nop 0
  buffer_load_dwordx4 v6, s[16:19], s3 offen lds
  s_add_u32 m0, s29, 13312
  s_nop 0
  buffer_load_dwordx4 v7, s[16:19], s3 offen lds
  s_add_u32 m0, s29, 14336
  s_nop 0
  buffer_load_dwordx4 v8, s[16:19], s3 offen lds
  s_mov_b32 s3, 5505024
  s_add_u32 m0, s29, 24576
  s_nop 0
  buffer_load_dwordx4 v6, s[16:19], s3 offen lds
  s_add_u32 m0, s29, 25600
  s_nop 0
  buffer_load_dwordx4 v7, s[16:19], s3 offen lds
  s_add_u32 m0, s29, 26624
  s_nop 0
  buffer_load_dwordx4 v8, s[16:19], s3 offen lds
  s_mov_b32 s3, 5898240
  s_add_u32 m0, s29, 36864
  s_nop 0
  buffer_load_dwordx4 v6, s[16:19], s3 offen lds
  s_add_u32 m0, s29, 37888
  s_nop 0
  buffer_load_dwordx4 v7, s[16:19], s3 offen lds
  s_add_u32 m0, s29, 38912
  s_nop 0
  buffer_load_dwordx4 v8, s[16:19], s3 offen lds
  s_waitcnt vmcnt(24)
  s_barrier
  v_add_u32 v11, 49152, v9
  v_add_u32 v12, 49152, v10
  ds_read_b64_tr_b16 a[48:49], v11 offset:0
  ds_read_b64_tr_b16 a[50:51], v11 offset:1536
  ds_read_b64_tr_b16 a[52:53], v11 offset:8
  ds_read_b64_tr_b16 a[54:55], v11 offset:1544
  ds_read_b64_tr_b16 a[56:57], v12 offset:64
  ds_read_b64_tr_b16 a[58:59], v12 offset:1600
  ds_read_b64_tr_b16 a[60:61], v11 offset:12288
  ds_read_b64_tr_b16 a[62:63], v11 offset:13824
  ds_read_b64_tr_b16 a[64:65], v11 offset:12296
  ds_read_b64_tr_b16 a[66:67], v11 offset:13832
  ds_read_b64_tr_b16 a[68:69], v12 offset:12352
  ds_read_b64_tr_b16 a[70:71], v12 offset:13888
  ds_read_b64_tr_b16 a[72:73], v11 offset:24576
  ds_read_b64_tr_b16 a[74:75], v11 offset:26112
  ds_read_b64_tr_b16 a[76:77], v11 offset:24584
  ds_read_b64_tr_b16 a[78:79], v11 offset:26120
  ds_read_b64_tr_b16 a[80:81], v12 offset:24640
  ds_read_b64_tr_b16 a[82:83], v12 offset:26176
  ds_read_b64_tr_b16 a[84:85], v11 offset:36864
  ds_read_b64_tr_b16 a[86:87], v11 offset:38400
  ds_read_b64_tr_b16 a[88:89], v11 offset:36872
  ds_read_b64_tr_b16 a[90:91], v11 offset:38408
  ds_read_b64_tr_b16 a[92:93], v12 offset:36928
  ds_read_b64_tr_b16 a[94:95], v12 offset:38464
  s_waitcnt lgkmcnt(0)
  s_barrier
  s_mov_b32 s3, 6291456
  s_add_u32 m0, s29, 49152
  s_nop 0
  buffer_load_dwordx4 v6, s[16:19], s3 offen lds
  s_add_u32 m0, s29, 50176
  s_nop 0
  buffer_load_dwordx4 v7, s[16:19], s3 offen lds
  s_add_u32 m0, s29, 51200
  s_nop 0
  buffer_load_dwordx4 v8, s[16:19], s3 offen lds
  s_mov_b32 s3, 6684672
  s_add_u32 m0, s29, 61440
  s_nop 0
  buffer_load_dwordx4 v6, s[16:19], s3 offen lds
  s_add_u32 m0, s29, 62464
  s_nop 0
  buffer_load_dwordx4 v7, s[16:19], s3 offen lds
  s_add_u32 m0, s29, 63488
  s_nop 0
  buffer_load_dwordx4 v8, s[16:19], s3 offen lds
  s_mov_b32 s3, 7077888
  s_add_u32 m0, s29, 73728
  s_nop 0
  buffer_load_dwordx4 v6, s[16:19], s3 offen lds
  s_add_u32 m0, s29, 74752
  s_nop 0
  buffer_load_dwordx4 v7, s[16:19], s3 offen lds
  s_add_u32 m0, s29, 75776
  s_nop 0
  buffer_load_dwordx4 v8, s[16:19], s3 offen lds
  s_mov_b32 s3, 7471104
  s_add_u32 m0, s29, 86016
  s_nop 0
  buffer_load_dwordx4 v6, s[16:19], s3 offen lds
  s_add_u32 m0, s29, 87040
  s_nop 0
  buffer_load_dwordx4 v7, s[16:19], s3 offen lds
  s_add_u32 m0, s29, 88064
  s_nop 0
  buffer_load_dwordx4 v8, s[16:19], s3 offen lds
  s_waitcnt vmcnt(24)
  s_barrier
  v_add_u32 v11, 98304, v9
  v_add_u32 v12, 98304, v10
  ds_read_b64_tr_b16 a[96:97], v11 offset:0
  ds_read_b64_tr_b16 a[98:99], v11 offset:1536
  ds_read_b64_tr_b16 a[100:101], v11 offset:8
  ds_read_b64_tr_b16 a[102:103], v11 offset:1544
  ds_read_b64_tr_b16 a[104:105], v12 offset:64
  ds_read_b64_tr_b16 a[106:107], v12 offset:1600
  ds_read_b64_tr_b16 a[108:109], v11 offset:12288
  ds_read_b64_tr_b16 a[110:111], v11 offset:13824
  ds_read_b64_tr_b16 a[112:113], v11 offset:12296
  ds_read_b64_tr_b16 a[114:115], v11 offset:13832
  ds_read_b64_tr_b16 a[116:117], v12 offset:12352
  ds_read_b64_tr_b16 a[118:119], v12 offset:13888
  ds_read_b64_tr_b16 a[120:121], v11 offset:24576
  ds_read_b64_tr_b16 a[122:123], v11 offset:26112
  ds_read_b64_tr_b16 a[124:125], v11 offset:24584
  ds_read_b64_tr_b16 a[126:127], v11 offset:26120
  ds_read_b64_tr_b16 a[128:129], v12 offset:24640
  ds_read_b64_tr_b16 a[130:131], v12 offset:26176
  ds_read_b64_tr_b16 a[132:133], v11 offset:36864
  ds_read_b64_tr_b16 a[134:135], v11 offset:38400
  ds_read_b64_tr_b16 a[136:137], v11 offset:36872
  ds_read_b64_tr_b16 a[138:139], v11 offset:38408
  ds_read_b64_tr_b16 a[140:141], v12 offset:36928
  ds_read_b64_tr_b16 a[142:143], v12 offset:38464
  s_waitcnt lgkmcnt(0)
  s_waitcnt vmcnt(12)
  s_barrier
  v_add_u32 v11, 0, v9
  v_add_u32 v12, 0, v10
  ds_read_b64_tr_b16 a[144:145], v11 offset:0
  ds_read_b64_tr_b16 a[146:147], v11 offset:1536
  ds_read_b64_tr_b16 a[148:149], v11 offset:8
  ds_read_b64_tr_b16 a[150:151], v11 offset:1544
  ds_read_b64_tr_b16 a[152:153], v12 offset:64
  ds_read_b64_tr_b16 a[154:155], v12 offset:1600
  ds_read_b64_tr_b16 a[156:157], v11 offset:12288
  ds_read_b64_tr_b16 a[158:159], v11 offset:13824
  ds_read_b64_tr_b16 a[160:161], v11 offset:12296
  ds_read_b64_tr_b16 a[162:163], v11 offset:13832
  ds_read_b64_tr_b16 a[164:165], v12 offset:12352
  ds_read_b64_tr_b16 a[166:167], v12 offset:13888
  ds_read_b64_tr_b16 a[168:169], v11 offset:24576
  ds_read_b64_tr_b16 a[170:171], v11 offset:26112
  ds_read_b64_tr_b16 a[172:173], v11 offset:24584
  ds_read_b64_tr_b16 a[174:175], v11 offset:26120
  ds_read_b64_tr_b16 a[176:177], v12 offset:24640
  ds_read_b64_tr_b16 a[178:179], v12 offset:26176
  ds_read_b64_tr_b16 a[180:181], v11 offset:36864
  ds_read_b64_tr_b16 a[182:183], v11 offset:38400
  ds_read_b64_tr_b16 a[184:185], v11 offset:36872
  ds_read_b64_tr_b16 a[186:187], v11 offset:38408
  ds_read_b64_tr_b16 a[188:189], v12 offset:36928
  ds_read_b64_tr_b16 a[190:191], v12 offset:38464
  s_waitcnt lgkmcnt(0)
  s_waitcnt vmcnt(0)
  s_barrier
  v_add_u32 v11, 49152, v9
  v_add_u32 v12, 49152, v10
  ds_read_b64_tr_b16 a[192:193], v11 offset:0
  ds_read_b64_tr_b16 a[194:195], v11 offset:1536
  ds_read_b64_tr_b16 a[196:197], v11 offset:8
  ds_read_b64_tr_b16 a[198:199], v11 offset:1544
  ds_read_b64_tr_b16 a[200:201], v12 offset:64
  ds_read_b64_tr_b16 a[202:203], v12 offset:1600
  ds_read_b64_tr_b16 a[204:205], v11 offset:12288
  ds_read_b64_tr_b16 a[206:207], v11 offset:13824
  ds_read_b64_tr_b16 a[208:209], v11 offset:12296
  ds_read_b64_tr_b16 a[210:211], v11 offset:13832
  ds_read_b64_tr_b16 a[212:213], v12 offset:12352
  ds_read_b64_tr_b16 a[214:215], v12 offset:13888
  ds_read_b64_tr_b16 a[216:217], v11 offset:24576
  ds_read_b64_tr_b16 a[218:219], v11 offset:26112
  ds_read_b64_tr_b16 a[220:221], v11 offset:24584
  ds_read_b64_tr_b16 a[222:223], v11 offset:26120
  ds_read_b64_tr_b16 a[224:225], v12 offset:24640
  ds_read_b64_tr_b16 a[226:227], v12 offset:26176
  ds_read_b64_tr_b16 a[228:229], v11 offset:36864
  ds_read_b64_tr_b16 a[230:231], v11 offset:38400
  ds_read_b64_tr_b16 a[232:233], v11 offset:36872
  ds_read_b64_tr_b16 a[234:235], v11 offset:38408
  ds_read_b64_tr_b16 a[236:237], v12 offset:36928
  ds_read_b64_tr_b16 a[238:239], v12 offset:38464
  s_waitcnt lgkmcnt(0)
  v_mbcnt_lo_u32_b32 v30, -1, 0
  v_min_u32 v30, 8, v30
  v_lshlrev_b32 v30, 3, v30
L56_cen:
  buffer_load_dwordx2 v[28:29], v30, s[12:15], s97 offen sc1
  s_sub_u32 s37, s37, 1
  s_cbranch_scc1 L44_gbail
  s_waitcnt vmcnt(0)
  v_not_b32 v31, v28
  v_xor_b32 v32, 0x2000, v29
  v_or_b32 v31, v31, v32
  v_cmp_ne_u32 vcc, 0, v31
  s_and_b32 s3, vcc_lo, 0xff
  s_cbranch_scc0 L57_cok
  v_lshrrev_b32 v29, 8, v29
  s_nop 1
  v_add_u32_dpp v29, v29, v29 row_shr:1 row_mask:0xf bank_mask:0xf bound_ctrl:1
  s_nop 1
  v_add_u32_dpp v29, v29, v29 row_shr:2 row_mask:0xf bank_mask:0xf bound_ctrl:1
  s_nop 1
  v_add_u32_dpp v29, v29, v29 row_shr:4 row_mask:0xf bank_mask:0xf bound_ctrl:1
  s_nop 0
  v_readlane_b32 s3, v29, 7
  s_cmp_lt_u32 s3, 256
  s_cbranch_scc1 L56_cen
  s_branch L_restart
L57_cok:
  s_barrier
  s_mul_i32 s29, s5, 10240
  s_add_u32 s26, s29, 0
  s_mov_b32 s27, 0
  s_add_u32 m0, s29, 0
  s_add_u32 s3, s26, 0
  buffer_load_dwordx4 v1, s[8:11], s3 offen offset:0 sc1 lds
  buffer_load_dwordx4 v1, s[8:11], s3 offen offset:1024 sc1 lds
  buffer_load_dwordx4 v1, s[8:11], s3 offen offset:2048 sc1 lds
  buffer_load_dwordx4 v1, s[8:11], s3 offen offset:3072 sc1 lds
  s_add_u32 m0, s29, 4096
  s_add_u32 s3, s26, 4096
  buffer_load_dwordx4 v1, s[8:11], s3 offen offset:0 sc1 lds
  buffer_load_dwordx4 v1, s[8:11], s3 offen offset:1024 sc1 lds
  buffer_load_dwordx4 v1, s[8:11], s3 offen offset:2048 sc1 lds
  buffer_load_dwordx4 v1, s[8:11], s3 offen offset:3072 sc1 lds
  s_add_u32 m0, s29, 8192
  s_add_u32 s3, s26, 8192
  buffer_load_dwordx4 v1, s[8:11], s3 offen offset:0 sc1 lds
  buffer_load_dwordx4 v1, s[8:11], s3 offen offset:1024 sc1 lds
L58_gtop:
  s_xor_b32 s29, s29, 65536
  s_add_u32 s26, s26, 40960
  s_sub_u32 s3, s27, 3
  s_cmp_lt_u32 s3, 61
  s_subb_u32 s30, s27, 0
  s_cmp_lt_u32 s3, 61
  s_cbranch_scc1 L61_glag
  s_waitcnt vmcnt(0)
L61_glag:
  s_cmp_lg_u32 s5, 0
  s_waitcnt vmcnt(3)
  s_barrier
  s_cbranch_scc1 L59_gnf
  v_mov_b32 v5, s30
  buffer_store_dword v5, off, s[8:11], s28 sc1
L59_gnf:
  s_cmp_eq_u32 s27, 64
  s_cbranch_scc1 L60_gdone
  ds_read_b128 v[56:59], v2 offset:0
  ds_read_b128 v[60:63], v2 offset:20480
  ds_read_b128 v[64:67], v2 offset:1024
  ds_read_b128 v[68:71], v2 offset:21504
  ds_read_b128 v[72:75], v2 offset:2048
  ds_read_b128 v[76:79], v2 offset:22528
  ds_read_b128 v[80:83], v2 offset:3072
  ds_read_b128 v[84:87], v2 offset:23552
  s_waitcnt lgkmcnt(7)
  v_mfma_f32_16x16x32_bf16 v[16:19], a[0:3], v[56:59], 0
  ds_read_b128 v[88:91], v2 offset:4096
  v_mfma_f32_16x16x32_bf16 v[20:23], a[4:7], v[56:59], 0
  v_mfma_f32_16x16x32_bf16 v[24:27], a[8:11], v[56:59], 0
  s_add_u32 m0, s29, 0
  s_add_u32 s3, s26, 0
  buffer_load_dwordx4 v1, s[8:11], s3 offen offset:0 sc1 lds
  s_waitcnt lgkmcnt(7)
  v_mfma_f32_16x16x32_bf16 v[28:31], a[0:3], v[60:63], 0
  ds_read_b128 v[92:95], v2 offset:24576
  v_mfma_f32_16x16x32_bf16 v[32:35], a[4:7], v[60:63], 0
  v_mfma_f32_16x16x32_bf16 v[36:39], a[8:11], v[60:63], 0
  s_waitcnt lgkmcnt(7)
  v_mfma_f32_16x16x32_bf16 v[16:19], a[12:15], v[64:67], v[16:19]
  ds_read_b128 v[56:59], v2 offset:5120
  v_mfma_f32_16x16x32_bf16 v[20:23], a[16:19], v[64:67], v[20:23]
  v_mfma_f32_16x16x32_bf16 v[24:27], a[20:23], v[64:67], v[24:27]
  buffer_load_dwordx4 v1, s[8:11], s3 offen offset:1024 sc1 lds
  s_waitcnt lgkmcnt(7)
  v_mfma_f32_16x16x32_bf16 v[28:31], a[12:15], v[68:71], v[28:31]
  ds_read_b128 v[60:63], v2 offset:25600
  v_mfma_f32_16x16x32_bf16 v[32:35], a[16:19], v[68:71], v[32:35]
  v_mfma_f32_16x16x32_bf16 v[36:39], a[20:23], v[68:71], v[36:39]
  s_waitcnt lgkmcnt(7)
  v_mfma_f32_16x16x32_bf16 v[16:19], a[24:27], v[72:75], v[16:19]
  ds_read_b128 v[64:67], v2 offset:6144
  v_mfma_f32_16x16x32_bf16 v[20:23], a[28:31], v[72:75], v[20:23]
  v_mfma_f32_16x16x32_bf16 v[24:27], a[32:35], v[72:75], v[24:27]
  buffer_load_dwordx4 v1, s[8:11], s3 offen offset:2048 sc1 lds
  s_waitcnt lgkmcnt(7)
  v_mfma_f32_16x16x32_bf16 v[28:31], a[24:27], v[76:79], v[28:31]
  ds_read_b128 v[68:71], v2 offset:26624
  v_mfma_f32_16x16x32_bf16 v[32:35], a[28:31], v[76:79], v[32:35]
  v_mfma_f32_16x16x32_bf16 v[36:39], a[32:35], v[76:79], v[36:39]
  s_waitcnt lgkmcnt(7)
  v_mfma_f32_16x16x32_bf16 v[16:19], a[36:39], v[80:83], v[16:19]
  ds_read_b128 v[72:75], v2 offset:7168
  v_mfma_f32_16x16x32_bf16 v[20:23], a[40:43], v[80:83], v[20:23]
  v_mfma_f32_16x16x32_bf16 v[24:27], a[44:47], v[80:83], v[24:27]
  buffer_load_dwordx4 v1, s[8:11], s3 offen offset:3072 sc1 lds
  s_waitcnt lgkmcnt(7)
  v_mfma_f32_16x16x32_bf16 v[28:31], a[36:39], v[84:87], v[28:31]
  ds_read_b128 v[76:79], v2 offset:27648
  v_mfma_f32_16x16x32_bf16 v[32:35], a[40:43], v[84:87], v[32:35]
  v_mfma_f32_16x16x32_bf16 v[36:39], a[44:47], v[84:87], v[36:39]
  s_waitcnt lgkmcnt(7)
  v_mfma_f32_16x16x32_bf16 v[16:19], a[48:51], v[88:91], v[16:19]
  ds_read_b128 v[80:83], v2 offset:8192
  v_mfma_f32_16x16x32_bf16 v[20:23], a[52:55], v[88:91], v[20:23]
  v_mfma_f32_16x16x32_bf16 v[24:27], a[56:59], v[88:91], v[24:27]
  s_add_u32 m0, s29, 4096
  s_add_u32 s3, s26, 4096
  buffer_load_dwordx4 v1, s[8:11], s3 offen offset:0 sc1 lds
  s_waitcnt lgkmcnt(7)
  v_mfma_f32_16x16x32_bf16 v[28:31], a[48:51], v[92:95], v[28:31]
  ds_read_b128 v[84:87], v2 offset:28672
  v_mfma_f32_16x16x32_bf16 v[32:35], a[52:55], v[92:95], v[32:35]
  v_mfma_f32_16x16x32_bf16 v[36:39], a[56:59], v[92:95], v[36:39]
  s_waitcnt lgkmcnt(7)
  v_mfma_f32_16x16x32_bf16 v[16:19], a[60:63], v[56:59], v[16:19]
  ds_read_b128 v[88:91], v2 offset:9216
  v_mfma_f32_16x16x32_bf16 v[20:23], a[64:67], v[56:59], v[20:23]
  v_mfma_f32_16x16x32_bf16 v[24:27], a[68:71], v[56:59], v[24:27]
  buffer_load_dwordx4 v1, s[8:11], s3 offen offset:1024 sc1 lds
  s_waitcnt lgkmcnt(7)
  v_mfma_f32_16x16x32_bf16 v[28:31], a[60:63], v[60:63], v[28:31]
  ds_read_b128 v[92:95], v2 offset:29696
  v_mfma_f32_16x16x32_bf16 v[32:35], a[64:67], v[60:63], v[32:35]
  v_mfma_f32_16x16x32_bf16 v[36:39], a[68:71], v[60:63], v[36:39]
  s_waitcnt lgkmcnt(7)
  v_mfma_f32_16x16x32_bf16 v[16:19], a[72:75], v[64:67], v[16:19]
  ds_read_b128 v[56:59], v2 offset:10240
  v_mfma_f32_16x16x32_bf16 v[20:23], a[76:79], v[64:67], v[20:23]
  v_mfma_f32_16x16x32_bf16 v[24:27], a[80:83], v[64:67], v[24:27]
  buffer_load_dwordx4 v1, s[8:11], s3 offen offset:2048 sc1 lds
  s_waitcnt lgkmcnt(7)
  v_mfma_f32_16x16x32_bf16 v[28:31], a[72:75], v[68:71], v[28:31]
  ds_read_b128 v[60:63], v2 offset:30720
  v_mfma_f32_16x16x32_bf16 v[32:35], a[76:79], v[68:71], v[32:35]
  v_mfma_f32_16x16x32_bf16 v[36:39], a[80:83], v[68:71], v[36:39]
  s_waitcnt lgkmcnt(7)
  v_mfma_f32_16x16x32_bf16 v[16:19], a[84:87], v[72:75], v[16:19]
  ds_read_b128 v[64:67], v2 offset:11264
  v_mfma_f32_16x16x32_bf16 v[20:23], a[88:91], v[72:75], v[20:23]
  v_mfma_f32_16x16x32_bf16 v[24:27], a[92:95], v[72:75], v[24:27]
  buffer_load_dwordx4 v1, s[8:11], s3 offen offset:3072 sc1 lds
  s_waitcnt lgkmcnt(7)
  v_mfma_f32_16x16x32_bf16 v[28:31], a[84:87], v[76:79], v[28:31]
  ds_read_b128 v[68:71], v2 offset:31744
  v_mfma_f32_16x16x32_bf16 v[32:35], a[88:91], v[76:79], v[32:35]
  v_mfma_f32_16x16x32_bf16 v[36:39], a[92:95], v[76:79], v[36:39]
  s_waitcnt lgkmcnt(7)
  v_mfma_f32_16x16x32_bf16 v[16:19], a[96:99], v[80:83], v[16:19]
  ds_read_b128 v[72:75], v2 offset:12288
  v_mfma_f32_16x16x32_bf16 v[20:23], a[100:103], v[80:83], v[20:23]
  v_mfma_f32_16x16x32_bf16 v[24:27], a[104:107], v[80:83], v[24:27]
  s_add_u32 m0, s29, 8192
  s_add_u32 s3, s26, 8192
  buffer_load_dwordx4 v1, s[8:11], s3 offen offset:0 sc1 lds
  s_waitcnt lgkmcnt(7)
  v_mfma_f32_16x16x32_bf16 v[28:31], a[96:99], v[84:87], v[28:31]
  ds_read_b128 v[76:79], v2 offset:32768
  v_mfma_f32_16x16x32_bf16 v[32:35], a[100:103], v[84:87], v[32:35]
  v_mfma_f32_16x16x32_bf16 v[36:39], a[104:107], v[84:87], v[36:39]
  s_waitcnt lgkmcnt(7)
  v_mfma_f32_16x16x32_bf16 v[16:19], a[108:111], v[88:91], v[16:19]
  ds_read_b128 v[80:83], v2 offset:13312
  v_mfma_f32_16x16x32_bf16 v[20:23], a[112:115], v[88:91], v[20:23]
  v_mfma_f32_16x16x32_bf16 v[24:27], a[116:119], v[88:91], v[24:27]
  buffer_load_dwordx4 v1, s[8:11], s3 offen offset:1024 sc1 lds
  s_waitcnt lgkmcnt(7)
  v_mfma_f32_16x16x32_bf16 v[28:31], a[108:111], v[92:95], v[28:31]
  ds_read_b128 v[84:87], v2 offset:33792
  v_mfma_f32_16x16x32_bf16 v[32:35], a[112:115], v[92:95], v[32:35]
  v_mfma_f32_16x16x32_bf16 v[36:39], a[116:119], v[92:95], v[36:39]
  s_waitcnt lgkmcnt(7)
  v_mfma_f32_16x16x32_bf16 v[16:19], a[120:123], v[56:59], v[16:19]
  ds_read_b128 v[88:91], v2 offset:14336
  v_mfma_f32_16x16x32_bf16 v[20:23], a[124:127], v[56:59], v[20:23]
  v_mfma_f32_16x16x32_bf16 v[24:27], a[128:131], v[56:59], v[24:27]
  s_waitcnt lgkmcnt(7)
  v_mfma_f32_16x16x32_bf16 v[28:31], a[120:123], v[60:63], v[28:31]
  ds_read_b128 v[92:95], v2 offset:34816
  v_mfma_f32_16x16x32_bf16 v[32:35], a[124:127], v[60:63], v[32:35]
  v_mfma_f32_16x16x32_bf16 v[36:39], a[128:131], v[60:63], v[36:39]
  s_waitcnt lgkmcnt(7)
  v_mfma_f32_16x16x32_bf16 v[16:19], a[132:135], v[64:67], v[16:19]
  ds_read_b128 v[56:59], v2 offset:15360
  v_mfma_f32_16x16x32_bf16 v[20:23], a[136:139], v[64:67], v[20:23]
  v_mfma_f32_16x16x32_bf16 v[24:27], a[140:143], v[64:67], v[24:27]
  s_waitcnt lgkmcnt(7)
  v_mfma_f32_16x16x32_bf16 v[28:31], a[132:135], v[68:71], v[28:31]
  ds_read_b128 v[60:63], v2 offset:35840
  v_mfma_f32_16x16x32_bf16 v[32:35], a[136:139], v[68:71], v[32:35]
  v_mfma_f32_16x16x32_bf16 v[36:39], a[140:143], v[68:71], v[36:39]
  s_waitcnt lgkmcnt(7)
  v_mfma_f32_16x16x32_bf16 v[16:19], a[144:147], v[72:75], v[16:19]
  ds_read_b128 v[64:67], v2 offset:16384
  v_mfma_f32_16x16x32_bf16 v[20:23], a[148:151], v[72:75], v[20:23]
  v_mfma_f32_16x16x32_bf16 v[24:27], a[152:155], v[72:75], v[24:27]
  s_waitcnt lgkmcnt(7)
  v_mfma_f32_16x16x32_bf16 v[28:31], a[144:147], v[76:79], v[28:31]
  ds_read_b128 v[68:71], v2 offset:36864
  v_mfma_f32_16x16x32_bf16 v[32:35], a[148:151], v[76:79], v[32:35]
  v_mfma_f32_16x16x32_bf16 v[36:39], a[152:155], v[76:79], v[36:39]
  s_waitcnt lgkmcnt(7)
  v_mfma_f32_16x16x32_bf16 v[16:19], a[156:159], v[80:83], v[16:19]
  ds_read_b128 v[72:75], v2 offset:17408
  v_mfma_f32_16x16x32_bf16 v[20:23], a[160:163], v[80:83], v[20:23]
  v_mfma_f32_16x16x32_bf16 v[24:27], a[164:167], v[80:83], v[24:27]
  s_waitcnt lgkmcnt(7)
  v_mfma_f32_16x16x32_bf16 v[28:31], a[156:159], v[84:87], v[28:31]
  ds_read_b128 v[76:79], v2 offset:37888
  v_mfma_f32_16x16x32_bf16 v[32:35], a[160:163], v[84:87], v[32:35]
  v_mfma_f32_16x16x32_bf16 v[36:39], a[164:167], v[84:87], v[36:39]
  s_waitcnt lgkmcnt(7)
  v_mfma_f32_16x16x32_bf16 v[16:19], a[168:171], v[88:91], v[16:19]
  ds_read_b128 v[80:83], v2 offset:18432
  v_mfma_f32_16x16x32_bf16 v[20:23], a[172:175], v[88:91], v[20:23]
  v_mfma_f32_16x16x32_bf16 v[24:27], a[176:179], v[88:91], v[24:27]
  s_waitcnt lgkmcnt(7)
  v_mfma_f32_16x16x32_bf16 v[28:31], a[168:171], v[92:95], v[28:31]
  ds_read_b128 v[84:87], v2 offset:38912
  v_mfma_f32_16x16x32_bf16 v[32:35], a[172:175], v[92:95], v[32:35]
  v_mfma_f32_16x16x32_bf16 v[36:39], a[176:179], v[92:95], v[36:39]
  s_waitcnt lgkmcnt(7)
  v_mfma_f32_16x16x32_bf16 v[16:19], a[180:183], v[56:59], v[16:19]
  ds_read_b128 v[88:91], v2 offset:19456
  v_mfma_f32_16x16x32_bf16 v[20:23], a[184:187], v[56:59], v[20:23]
  v_mfma_f32_16x16x32_bf16 v[24:27], a[188:191], v[56:59], v[24:27]
  s_waitcnt lgkmcnt(7)
  v_mfma_f32_16x16x32_bf16 v[28:31], a[180:183], v[60:63], v[28:31]
  ds_read_b128 v[92:95], v2 offset:39936
  v_mfma_f32_16x16x32_bf16 v[32:35], a[184:187], v[60:63], v[32:35]
  v_mfma_f32_16x16x32_bf16 v[36:39], a[188:191], v[60:63], v[36:39]
  s_waitcnt lgkmcnt(7)
  v_mfma_f32_16x16x32_bf16 v[16:19], a[192:195], v[64:67], v[16:19]
  v_mfma_f32_16x16x32_bf16 v[20:23], a[196:199], v[64:67], v[20:23]
  v_mfma_f32_16x16x32_bf16 v[24:27], a[200:203], v[64:67], v[24:27]
  s_waitcnt lgkmcnt(6)
  v_mfma_f32_16x16x32_bf16 v[28:31], a[192:195], v[68:71], v[28:31]
  v_mfma_f32_16x16x32_bf16 v[32:35], a[196:199], v[68:71], v[32:35]
  v_mfma_f32_16x16x32_bf16 v[36:39], a[200:203], v[68:71], v[36:39]
  s_waitcnt lgkmcnt(5)
  v_mfma_f32_16x16x32_bf16 v[16:19], a[204:207], v[72:75], v[16:19]
  v_mfma_f32_16x16x32_bf16 v[20:23], a[208:211], v[72:75], v[20:23]
  v_mfma_f32_16x16x32_bf16 v[24:27], a[212:215], v[72:75], v[24:27]
  s_waitcnt lgkmcnt(4)
  v_mfma_f32_16x16x32_bf16 v[28:31], a[204:207], v[76:79], v[28:31]
  v_mfma_f32_16x16x32_bf16 v[32:35], a[208:211], v[76:79], v[32:35]
  v_mfma_f32_16x16x32_bf16 v[36:39], a[212:215], v[76:79], v[36:39]
  s_waitcnt lgkmcnt(3)
  v_mfma_f32_16x16x32_bf16 v[16:19], a[216:219], v[80:83], v[16:19]
  v_mfma_f32_16x16x32_bf16 v[20:23], a[220:223], v[80:83], v[20:23]
  v_mfma_f32_16x16x32_bf16 v[24:27], a[224:227], v[80:83], v[24:27]
  s_waitcnt lgkmcnt(2)
  v_mfma_f32_16x16x32_bf16 v[28:31], a[216:219], v[84:87], v[28:31]
  v_mfma_f32_16x16x32_bf16 v[32:35], a[220:223], v[84:87], v[32:35]
  v_mfma_f32_16x16x32_bf16 v[36:39], a[224:227], v[84:87], v[36:39]
  s_waitcnt lgkmcnt(1)
  v_mfma_f32_16x16x32_bf16 v[16:19], a[228:231], v[88:91], v[16:19]
  v_mfma_f32_16x16x32_bf16 v[20:23], a[232:235], v[88:91], v[20:23]
  v_mfma_f32_16x16x32_bf16 v[24:27], a[236:239], v[88:91], v[24:27]
  s_waitcnt lgkmcnt(0)
  v_mfma_f32_16x16x32_bf16 v[28:31], a[228:231], v[92:95], v[28:31]
  v_mfma_f32_16x16x32_bf16 v[32:35], a[232:235], v[92:95], v[32:35]
  v_mfma_f32_16x16x32_bf16 v[36:39], a[236:239], v[92:95], v[36:39]
  v_xor_b32 v2, 65536, v2
  v_cvt_pk_bf16_f32 v40, v16, v17
  v_cvt_pk_bf16_f32 v41, v18, v19
  v_cvt_pk_bf16_f32 v42, v20, v21
  v_cvt_pk_bf16_f32 v43, v22, v23
  buffer_store_dwordx4 v[40:43], v3, s[8:11], s24 offen offset:0 sc1
  v_cvt_pk_bf16_f32 v48, v24, v25
  v_cvt_pk_bf16_f32 v49, v26, v27
  v_cvt_pk_bf16_f32 v44, v28, v29
  v_cvt_pk_bf16_f32 v45, v30, v31
  v_cvt_pk_bf16_f32 v46, v32, v33
  v_cvt_pk_bf16_f32 v47, v34, v35
  buffer_store_dwordx4 v[44:47], v3, s[8:11], s25 offen offset:0 sc1
  v_cvt_pk_bf16_f32 v50, v36, v37
  v_cvt_pk_bf16_f32 v51, v38, v39
  s_nop 0
  v_permlane16_swap_b32 v48, v50
  v_permlane16_swap_b32 v49, v51
  buffer_store_dwordx4 v[48:51], v4, s[8:11], s24 offen offset:1024 sc1
  s_add_u32 s24, s24, 393216
  s_add_u32 s25, s24, 6144
  s_add_u32 s27, s27, 1
  s_branch L58_gtop
L60_gdone:
  s_waitcnt vmcnt(0)
  s_branch L_d2
L44_gbail:
  s_endpgm
Lg_v:
  s_load_dwordx2 s[8:9], s[0:1], 104
  s_load_dwordx2 s[12:13], s[0:1], 96
  s_load_dwordx2 s[16:17], s[0:1], 32
  s_mov_b32 s10, 268435456
  s_mov_b32 s11, 0x20000
  s_mov_b32 s14, 256
  s_mov_b32 s15, 0x20000
  s_mov_b32 s18, 7864320
  s_mov_b32 s19, 0x20000
  s_waitcnt lgkmcnt(0)
  s_add_u32 s24, s24, 58720256
  v_and_b32 v20, 63, v0
  v_lshrrev_b32 v21, 4, v20
  v_and_b32 v22, 15, v20
  v_lshlrev_b32 v1, 4, v20
  v_mov_b32 v2, v1
  v_mov_b32 v5, 0
  s_lshl_b32 s28, s4, 7
  s_add_u32 s28, s28, 3145728
  s_mul_i32 s3, s6, 384
  s_mul_i32 s29, s5, 3072
  s_mul_i32 s30, s5, 192
  v_add_u32 v23, s30, v20
  v_add_u32 v23, 0, v23
  v_mul_u32_u24 v24, 2731, v23
  v_lshrrev_b32 v24, 16, v24
  v_mul_u32_u24 v25, 24, v24
  v_sub_u32 v23, v23, v25
  v_lshl_add_u32 v23, v23, 4, s3
  v_mul_u32_u24 v24, 12288, v24
  v_add_u32 v6, v23, v24
  v_add_u32 v23, s30, v20
  v_add_u32 v23, 64, v23
  v_mul_u32_u24 v24, 2731, v23
  v_lshrrev_b32 v24, 16, v24
  v_mul_u32_u24 v25, 24, v24
  v_sub_u32 v23, v23, v25
  v_lshl_add_u32 v23, v23, 4, s3
  v_mul_u32_u24 v24, 12288, v24
  v_add_u32 v7, v23, v24
  v_add_u32 v23, s30, v20
  v_add_u32 v23, 128, v23
  v_mul_u32_u24 v24, 2731, v23
  v_lshrrev_b32 v24, 16, v24
  v_mul_u32_u24 v25, 24, v24
  v_sub_u32 v23, v23, v25
  v_lshl_add_u32 v23, v23, 4, s3
  v_mul_u32_u24 v24, 12288, v24
  v_add_u32 v8, v23, v24
  s_mov_b32 s3, 0
  s_add_u32 m0, s29, 0
  s_nop 0
  buffer_load_dwordx4 v6, s[16:19], s3 offen lds
  s_add_u32 m0, s29, 1024
  s_nop 0
  buffer_load_dwordx4 v7, s[16:19], s3 offen lds
  s_add_u32 m0, s29, 2048
  s_nop 0
  buffer_load_dwordx4 v8, s[16:19], s3 offen lds
  s_mov_b32 s3, 393216
  s_add_u32 m0, s29, 12288
  s_nop 0
  buffer_load_dwordx4 v6, s[16:19], s3 offen lds
  s_add_u32 m0, s29, 13312
  s_nop 0
  buffer_load_dwordx4 v7, s[16:19], s3 offen lds
  s_add_u32 m0, s29, 14336
  s_nop 0
  buffer_load_dwordx4 v8, s[16:19], s3 offen lds
  s_mov_b32 s3, 786432
  s_add_u32 m0, s29, 24576
  s_nop 0
  buffer_load_dwordx4 v6, s[16:19], s3 offen lds
  s_add_u32 m0, s29, 25600
  s_nop 0
  buffer_load_dwordx4 v7, s[16:19], s3 offen lds
  s_add_u32 m0, s29, 26624
  s_nop 0
  buffer_load_dwordx4 v8, s[16:19], s3 offen lds
  s_mov_b32 s3, 1179648
  s_add_u32 m0, s29, 36864
  s_nop 0
  buffer_load_dwordx4 v6, s[16:19], s3 offen lds
  s_add_u32 m0, s29, 37888
  s_nop 0
  buffer_load_dwordx4 v7, s[16:19], s3 offen lds
  s_add_u32 m0, s29, 38912
  s_nop 0
  buffer_load_dwordx4 v8, s[16:19], s3 offen lds
  buffer_store_dword v5, off, s[8:11], s28 sc1
  s_and_b32 s3, s2, 7
  s_sub_u32 s3, s3, 2
  s_lshl_b32 s3, s3, 2
  s_bfe_u32 vcc_lo, s2, 0x20003
  s_add_u32 s3, s3, vcc_lo
  s_lshl_b32 s3, s3, 3
  s_lshr_b32 vcc_lo, s2, 5
  s_add_u32 s3, s3, vcc_lo
  s_mul_i32 vcc_lo, s3, 8192
  s_mul_i32 s3, s3, 20480
  s_add_u32 s3, s3, 134217728
  v_lshlrev_b32 v32, 4, v0
  v_mov_b32 v28, 0
  v_mov_b32 v29, 0
  v_mov_b32 v30, 0
  v_mov_b32 v31, 0
  v_mov_b32 v28, -1
  v_mov_b32 v29, -1
  v_mov_b32 v30, -1
  v_mov_b32 v31, -1
  s_add_u32 s3, vcc_lo, 29884416
  buffer_store_dwordx4 v[28:31], v32, s[8:11], s3 offen sc1
  s_add_u32 s3, vcc_lo, 29888512
  buffer_store_dwordx4 v[28:31], v32, s[8:11], s3 offen sc1
  s_mov_b32 s3, 1572864
  s_add_u32 m0, s29, 49152
  s_nop 0
  buffer_load_dwordx4 v6, s[16:19], s3 offen lds
  s_add_u32 m0, s29, 50176
  s_nop 0
  buffer_load_dwordx4 v7, s[16:19], s3 offen lds
  s_add_u32 m0, s29, 51200
  s_nop 0
  buffer_load_dwordx4 v8, s[16:19], s3 offen lds
  s_mov_b32 s3, 1966080
  s_add_u32 m0, s29, 61440
  s_nop 0
  buffer_load_dwordx4 v6, s[16:19], s3 offen lds
  s_add_u32 m0, s29, 62464
  s_nop 0
  buffer_load_dwordx4 v7, s[16:19], s3 offen lds
  s_add_u32 m0, s29, 63488
  s_nop 0
  buffer_load_dwordx4 v8, s[16:19], s3 offen lds
  s_mov_b32 s3, 2359296
  s_add_u32 m0, s29, 73728
  s_nop 0
  buffer_load_dwordx4 v6, s[16:19], s3 offen lds
  s_add_u32 m0, s29, 74752
  s_nop 0
  buffer_load_dwordx4 v7, s[16:19], s3 offen lds
  s_add_u32 m0, s29, 75776
  s_nop 0
  buffer_load_dwordx4 v8, s[16:19], s3 offen lds
  s_mov_b32 s3, 2752512
  s_add_u32 m0, s29, 86016
  s_nop 0
  buffer_load_dwordx4 v6, s[16:19], s3 offen lds
  s_add_u32 m0, s29, 87040
  s_nop 0
  buffer_load_dwordx4 v7, s[16:19], s3 offen lds
  s_add_u32 m0, s29, 88064
  s_nop 0
  buffer_load_dwordx4 v8, s[16:19], s3 offen lds
  s_mov_b32 s3, 3145728
  s_add_u32 m0, s29, 98304
  s_nop 0
  buffer_load_dwordx4 v6, s[16:19], s3 offen lds
  s_add_u32 m0, s29, 99328
  s_nop 0
  buffer_load_dwordx4 v7, s[16:19], s3 offen lds
  s_add_u32 m0, s29, 100352
  s_nop 0
  buffer_load_dwordx4 v8, s[16:19], s3 offen lds
  s_mov_b32 s3, 3538944
  s_add_u32 m0, s29, 110592
  s_nop 0
  buffer_load_dwordx4 v6, s[16:19], s3 offen lds
  s_add_u32 m0, s29, 111616
  s_nop 0
  buffer_load_dwordx4 v7, s[16:19], s3 offen lds
  s_add_u32 m0, s29, 112640
  s_nop 0
  buffer_load_dwordx4 v8, s[16:19], s3 offen lds
  s_mov_b32 s3, 3932160
  s_add_u32 m0, s29, 122880
  s_nop 0
  buffer_load_dwordx4 v6, s[16:19], s3 offen lds
  s_add_u32 m0, s29, 123904
  s_nop 0
  buffer_load_dwordx4 v7, s[16:19], s3 offen lds
  s_add_u32 m0, s29, 124928
  s_nop 0
  buffer_load_dwordx4 v8, s[16:19], s3 offen lds
  s_mov_b32 s3, 4325376
  s_add_u32 m0, s29, 135168
  s_nop 0
  buffer_load_dwordx4 v6, s[16:19], s3 offen lds
  s_add_u32 m0, s29, 136192
  s_nop 0
  buffer_load_dwordx4 v7, s[16:19], s3 offen lds
  s_add_u32 m0, s29, 137216
  s_nop 0
  buffer_load_dwordx4 v8, s[16:19], s3 offen lds
  v_lshrrev_b32 v23, 2, v22
  v_lshl_add_u32 v23, v21, 3, v23
  v_mul_u32_u24 v23, 384, v23
  s_mul_i32 s3, s5, 96
  v_add_u32 v23, s3, v23
  v_and_b32 v24, 3, v22
  v_lshl_add_u32 v9, v24, 4, v23
  v_lshl_add_u32 v10, v24, 3, v23
  v_add_u32 v3, s29, v1
  s_waitcnt vmcnt(24)
  s_barrier
  s_cmp_lg_u32 s5, 0
  s_cbranch_scc1 L63_gs
  s_lshr_b32 s3, s2, 3
  s_lshl_b32 s3, 1, s3
  v_mov_b32 v28, s3
  v_mov_b32 v29, 256
  s_and_b32 s3, s2, 7
  s_lshl_b32 s3, s3, 3
  s_add_u32 s3, s3, s97
  s_mov_b64 exec, 1
  buffer_atomic_add_x2 v[28:29], off, s[12:15], s3 sc1
  s_mov_b64 exec, -1
L63_gs:
  v_add_u32 v11, 0, v9
  v_add_u32 v12, 0, v10
  ds_read_b64_tr_b16 a[0:1], v12 offset:0
  ds_read_b64_tr_b16 a[2:3], v12 offset:1536
  ds_read_b64_tr_b16 a[4:5], v12 offset:32
  ds_read_b64_tr_b16 a[6:7], v12 offset:1568
  ds_read_b64_tr_b16 a[8:9], v12 offset:64
  ds_read_b64_tr_b16 a[10:11], v12 offset:1600
  ds_read_b64_tr_b16 a[12:13], v12 offset:12288
  ds_read_b64_tr_b16 a[14:15], v12 offset:13824
  ds_read_b64_tr_b16 a[16:17], v12 offset:12320
  ds_read_b64_tr_b16 a[18:19], v12 offset:13856
  ds_read_b64_tr_b16 a[20:21], v12 offset:12352
  ds_read_b64_tr_b16 a[22:23], v12 offset:13888
  ds_read_b64_tr_b16 a[24:25], v12 offset:24576
  ds_read_b64_tr_b16 a[26:27], v12 offset:26112
  ds_read_b64_tr_b16 a[28:29], v12 offset:24608
  ds_read_b64_tr_b16 a[30:31], v12 offset:26144
  ds_read_b64_tr_b16 a[32:33], v12 offset:24640
  ds_read_b64_tr_b16 a[34:35], v12 offset:26176
  ds_read_b64_tr_b16 a[36:37], v12 offset:36864
  ds_read_b64_tr_b16 a[38:39], v12 offset:38400
  ds_read_b64_tr_b16 a[40:41], v12 offset:36896
  ds_read_b64_tr_b16 a[42:43], v12 offset:38432
  ds_read_b64_tr_b16 a[44:45], v12 offset:36928
  ds_read_b64_tr_b16 a[46:47], v12 offset:38464
  s_waitcnt lgkmcnt(0)
  s_barrier
  s_mov_b32 s3, 4718592
  s_add_u32 m0, s29, 0
  s_nop 0
  buffer_load_dwordx4 v6, s[16:19], s3 offen lds
  s_add_u32 m0, s29, 1024
  s_nop 0
  buffer_load_dwordx4 v7, s[16:19], s3 offen lds
  s_add_u32 m0, s29, 2048
  s_nop 0
  buffer_load_dwordx4 v8, s[16:19], s3 offen lds
  s_mov_b32 s3, 5111808
  s_add_u32 m0, s29, 12288
  s_nop 0
  buffer_load_dwordx4 v6, s[16:19], s3 offen lds
  s_add_u32 m0, s29, 13312
  s_nop 0
  buffer_load_dwordx4 v7, s[16:19], s3 offen lds
  s_add_u32 m0, s29, 14336
  s_nop 0
  buffer_load_dwordx4 v8, s[16:19], s3 offen lds
  s_mov_b32 s3, 5505024
  s_add_u32 m0, s29, 24576
  s_nop 0
  buffer_load_dwordx4 v6, s[16:19], s3 offen lds
  s_add_u32 m0, s29, 25600
  s_nop 0
  buffer_load_dwordx4 v7, s[16:19], s3 offen lds
  s_add_u32 m0, s29, 26624
  s_nop 0
  buffer_load_dwordx4 v8, s[16:19], s3 offen lds
  s_mov_b32 s3, 5898240
  s_add_u32 m0, s29, 36864
  s_nop 0
  buffer_load_dwordx4 v6, s[16:19], s3 offen lds
  s_add_u32 m0, s29, 37888
  s_nop 0
  buffer_load_dwordx4 v7, s[16:19], s3 offen lds
  s_add_u32 m0, s29, 38912
  s_nop 0
  buffer_load_dwordx4 v8, s[16:19], s3 offen lds
  s_waitcnt vmcnt(24)
  s_barrier
  v_add_u32 v11, 49152, v9
  v_add_u32 v12, 49152, v10
  ds_read_b64_tr_b16 a[48:49], v12 offset:0
  ds_read_b64_tr_b16 a[50:51], v12 offset:1536
  ds_read_b64_tr_b16 a[52:53], v12 offset:32
  ds_read_b64_tr_b16 a[54:55], v12 offset:1568
  ds_read_b64_tr_b16 a[56:57], v12 offset:64
  ds_read_b64_tr_b16 a[58:59], v12 offset:1600
  ds_read_b64_tr_b16 a[60:61], v12 offset:12288
  ds_read_b64_tr_b16 a[62:63], v12 offset:13824
  ds_read_b64_tr_b16 a[64:65], v12 offset:12320
  ds_read_b64_tr_b16 a[66:67], v12 offset:13856
  ds_read_b64_tr_b16 a[68:69], v12 offset:12352
  ds_read_b64_tr_b16 a[70:71], v12 offset:13888
  ds_read_b64_tr_b16 a[72:73], v12 offset:24576
  ds_read_b64_tr_b16 a[74:75], v12 offset:26112
  ds_read_b64_tr_b16 a[76:77], v12 offset:24608
  ds_read_b64_tr_b16 a[78:79], v12 offset:26144
  ds_read_b64_tr_b16 a[80:81], v12 offset:24640
  ds_read_b64_tr_b16 a[82:83], v12 offset:26176
  ds_read_b64_tr_b16 a[84:85], v12 offset:36864
  ds_read_b64_tr_b16 a[86:87], v12 offset:38400
  ds_read_b64_tr_b16 a[88:89], v12 offset:36896
  ds_read_b64_tr_b16 a[90:91], v12 offset:38432
  ds_read_b64_tr_b16 a[92:93], v12 offset:36928
  ds_read_b64_tr_b16 a[94:95], v12 offset:38464
  s_waitcnt lgkmcnt(0)
  s_barrier
  s_mov_b32 s3, 6291456
  s_add_u32 m0, s29, 49152
  s_nop 0
  buffer_load_dwordx4 v6, s[16:19], s3 offen lds
  s_add_u32 m0, s29, 50176
  s_nop 0
  buffer_load_dwordx4 v7, s[16:19], s3 offen lds
  s_add_u32 m0, s29, 51200
  s_nop 0
  buffer_load_dwordx4 v8, s[16:19], s3 offen lds
  s_mov_b32 s3, 6684672
  s_add_u32 m0, s29, 61440
  s_nop 0
  buffer_load_dwordx4 v6, s[16:19], s3 offen lds
  s_add_u32 m0, s29, 62464
  s_nop 0
  buffer_load_dwordx4 v7, s[16:19], s3 offen lds
  s_add_u32 m0, s29, 63488
  s_nop 0
  buffer_load_dwordx4 v8, s[16:19], s3 offen lds
  s_mov_b32 s3, 7077888
  s_add_u32 m0, s29, 73728
  s_nop 0
  buffer_load_dwordx4 v6, s[16:19], s3 offen lds
  s_add_u32 m0, s29, 74752
  s_nop 0
  buffer_load_dwordx4 v7, s[16:19], s3 offen lds
  s_add_u32 m0, s29, 75776
  s_nop 0
  buffer_load_dwordx4 v8, s[16:19], s3 offen lds
  s_mov_b32 s3, 7471104
  s_add_u32 m0, s29, 86016
  s_nop 0
  buffer_load_dwordx4 v6, s[16:19], s3 offen lds
  s_add_u32 m0, s29, 87040
  s_nop 0
  buffer_load_dwordx4 v7, s[16:19], s3 offen lds
  s_add_u32 m0, s29, 88064
  s_nop 0
  buffer_load_dwordx4 v8, s[16:19], s3 offen lds
  s_waitcnt vmcnt(24)
  s_barrier
  v_add_u32 v11, 98304, v9
  v_add_u32 v12, 98304, v10
  ds_read_b64_tr_b16 a[96:97], v12 offset:0
  ds_read_b64_tr_b16 a[98:99], v12 offset:1536
  ds_read_b64_tr_b16 a[100:101], v12 offset:32
  ds_read_b64_tr_b16 a[102:103], v12 offset:1568
  ds_read_b64_tr_b16 a[104:105], v12 offset:64
  ds_read_b64_tr_b16 a[106:107], v12 offset:1600
  ds_read_b64_tr_b16 a[108:109], v12 offset:12288
  ds_read_b64_tr_b16 a[110:111], v12 offset:13824
  ds_read_b64_tr_b16 a[112:113], v12 offset:12320
  ds_read_b64_tr_b16 a[114:115], v12 offset:13856
  ds_read_b64_tr_b16 a[116:117], v12 offset:12352
  ds_read_b64_tr_b16 a[118:119], v12 offset:13888
  ds_read_b64_tr_b16 a[120:121], v12 offset:24576
  ds_read_b64_tr_b16 a[122:123], v12 offset:26112
  ds_read_b64_tr_b16 a[124:125], v12 offset:24608
  ds_read_b64_tr_b16 a[126:127], v12 offset:26144
  ds_read_b64_tr_b16 a[128:129], v12 offset:24640
  ds_read_b64_tr_b16 a[130:131], v12 offset:26176
  ds_read_b64_tr_b16 a[132:133], v12 offset:36864
  ds_read_b64_tr_b16 a[134:135], v12 offset:38400
  ds_read_b64_tr_b16 a[136:137], v12 offset:36896
  ds_read_b64_tr_b16 a[138:139], v12 offset:38432
  ds_read_b64_tr_b16 a[140:141], v12 offset:36928
  ds_read_b64_tr_b16 a[142:143], v12 offset:38464
  s_waitcnt lgkmcnt(0)
  s_waitcnt vmcnt(12)
  s_barrier
  v_add_u32 v11, 0, v9
  v_add_u32 v12, 0, v10
  ds_read_b64_tr_b16 a[144:145], v12 offset:0
  ds_read_b64_tr_b16 a[146:147], v12 offset:1536
  ds_read_b64_tr_b16 a[148:149], v12 offset:32
  ds_read_b64_tr_b16 a[150:151], v12 offset:1568
  ds_read_b64_tr_b16 a[152:153], v12 offset:64
  ds_read_b64_tr_b16 a[154:155], v12 offset:1600
  ds_read_b64_tr_b16 a[156:157], v12 offset:12288
  ds_read_b64_tr_b16 a[158:159], v12 offset:13824
  ds_read_b64_tr_b16 a[160:161], v12 offset:12320
  ds_read_b64_tr_b16 a[162:163], v12 offset:13856
  ds_read_b64_tr_b16 a[164:165], v12 offset:12352
  ds_read_b64_tr_b16 a[166:167], v12 offset:13888
  ds_read_b64_tr_b16 a[168:169], v12 offset:24576
  ds_read_b64_tr_b16 a[170:171], v12 offset:26112
  ds_read_b64_tr_b16 a[172:173], v12 offset:24608
  ds_read_b64_tr_b16 a[174:175], v12 offset:26144
  ds_read_b64_tr_b16 a[176:177], v12 offset:24640
  ds_read_b64_tr_b16 a[178:179], v12 offset:26176
  ds_read_b64_tr_b16 a[180:181], v12 offset:36864
  ds_read_b64_tr_b16 a[182:183], v12 offset:38400
  ds_read_b64_tr_b16 a[184:185], v12 offset:36896
  ds_read_b64_tr_b16 a[186:187], v12 offset:38432
  ds_read_b64_tr_b16 a[188:189], v12 offset:36928
  ds_read_b64_tr_b16 a[190:191], v12 offset:38464
  s_waitcnt lgkmcnt(0)
  s_waitcnt vmcnt(0)
  s_barrier
  v_add_u32 v11, 49152, v9
  v_add_u32 v12, 49152, v10
  ds_read_b64_tr_b16 a[192:193], v12 offset:0
  ds_read_b64_tr_b16 a[194:195], v12 offset:1536
  ds_read_b64_tr_b16 a[196:197], v12 offset:32
  ds_read_b64_tr_b16 a[198:199], v12 offset:1568
  ds_read_b64_tr_b16 a[200:201], v12 offset:64
  ds_read_b64_tr_b16 a[202:203], v12 offset:1600
  ds_read_b64_tr_b16 a[204:205], v12 offset:12288
  ds_read_b64_tr_b16 a[206:207], v12 offset:13824
  ds_read_b64_tr_b16 a[208:209], v12 offset:12320
  ds_read_b64_tr_b16 a[210:211], v12 offset:13856
  ds_read_b64_tr_b16 a[212:213], v12 offset:12352
  ds_read_b64_tr_b16 a[214:215], v12 offset:13888
  ds_read_b64_tr_b16 a[216:217], v12 offset:24576
  ds_read_b64_tr_b16 a[218:219], v12 offset:26112
  ds_read_b64_tr_b16 a[220:221], v12 offset:24608
  ds_read_b64_tr_b16 a[222:223], v12 offset:26144
  ds_read_b64_tr_b16 a[224:225], v12 offset:24640
  ds_read_b64_tr_b16 a[226:227], v12 offset:26176
  ds_read_b64_tr_b16 a[228:229], v12 offset:36864
  ds_read_b64_tr_b16 a[230:231], v12 offset:38400
  ds_read_b64_tr_b16 a[232:233], v12 offset:36896
  ds_read_b64_tr_b16 a[234:235], v12 offset:38432
  ds_read_b64_tr_b16 a[236:237], v12 offset:36928
  ds_read_b64_tr_b16 a[238:239], v12 offset:38464
  s_waitcnt lgkmcnt(0)
  v_mbcnt_lo_u32_b32 v30, -1, 0
  v_min_u32 v30, 8, v30
  v_lshlrev_b32 v30, 3, v30
L64_cen:
  buffer_load_dwordx2 v[28:29], v30, s[12:15], s97 offen sc1
  s_sub_u32 s37, s37, 1
  s_cbranch_scc1 L62_gbail
  s_waitcnt vmcnt(0)
  v_not_b32 v31, v28
  v_xor_b32 v32, 0x2000, v29
  v_or_b32 v31, v31, v32
  v_cmp_ne_u32 vcc, 0, v31
  s_and_b32 s3, vcc_lo, 0xff
  s_cbranch_scc0 L65_cok
  v_lshrrev_b32 v29, 8, v29
  s_nop 1
  v_add_u32_dpp v29, v29, v29 row_shr:1 row_mask:0xf bank_mask:0xf bound_ctrl:1
  s_nop 1
  v_add_u32_dpp v29, v29, v29 row_shr:2 row_mask:0xf bank_mask:0xf bound_ctrl:1
  s_nop 1
  v_add_u32_dpp v29, v29, v29 row_shr:4 row_mask:0xf bank_mask:0xf bound_ctrl:1
  s_nop 0
  v_readlane_b32 s3, v29, 7
  s_cmp_lt_u32 s3, 256
  s_cbranch_scc1 L64_cen
  s_branch L_restart
L65_cok:
  s_barrier
  s_mul_i32 s29, s5, 10240
  s_add_u32 s26, s29, 0
  s_mov_b32 s27, 0
  s_add_u32 m0, s29, 0
  s_add_u32 s3, s26, 0
  buffer_load_dwordx4 v1, s[8:11], s3 offen offset:0 sc1 lds
  buffer_load_dwordx4 v1, s[8:11], s3 offen offset:1024 sc1 lds
  buffer_load_dwordx4 v1, s[8:11], s3 offen offset:2048 sc1 lds
  buffer_load_dwordx4 v1, s[8:11], s3 offen offset:3072 sc1 lds
  s_add_u32 m0, s29, 4096
  s_add_u32 s3, s26, 4096
  buffer_load_dwordx4 v1, s[8:11], s3 offen offset:0 sc1 lds
  buffer_load_dwordx4 v1, s[8:11], s3 offen offset:1024 sc1 lds
  buffer_load_dwordx4 v1, s[8:11], s3 offen offset:2048 sc1 lds
  buffer_load_dwordx4 v1, s[8:11], s3 offen offset:3072 sc1 lds
  s_add_u32 m0, s29, 8192
  s_add_u32 s3, s26, 8192
  buffer_load_dwordx4 v1, s[8:11], s3 offen offset:0 sc1 lds
  buffer_load_dwordx4 v1, s[8:11], s3 offen offset:1024 sc1 lds
L66_gtop:
  s_xor_b32 s29, s29, 65536
  s_add_u32 s26, s26, 40960
  s_sub_u32 s3, s27, 3
  s_cmp_lt_u32 s3, 61
  s_subb_u32 s30, s27, 0
  s_cmp_lt_u32 s3, 61
  s_cbranch_scc1 L69_glag
  s_waitcnt vmcnt(0)
L69_glag:
  s_cmp_lg_u32 s5, 0
  s_waitcnt vmcnt(3)
  s_barrier
  s_cbranch_scc1 L67_gnf
  v_mov_b32 v5, s30
  buffer_store_dword v5, off, s[8:11], s28 sc1
L67_gnf:
  s_cmp_eq_u32 s27, 64
  s_cbranch_scc1 L68_gdone
  ds_read_b128 v[56:59], v2 offset:0
  ds_read_b128 v[60:63], v2 offset:20480
  ds_read_b128 v[64:67], v2 offset:1024
  ds_read_b128 v[68:71], v2 offset:21504
  ds_read_b128 v[72:75], v2 offset:2048
  ds_read_b128 v[76:79], v2 offset:22528
  ds_read_b128 v[80:83], v2 offset:3072
  ds_read_b128 v[84:87], v2 offset:23552
  s_waitcnt lgkmcnt(7)
  v_mfma_f32_16x16x32_bf16 v[16:19], v[56:59], a[0:3], 0
  ds_read_b128 v[88:91], v2 offset:4096
  v_mfma_f32_16x16x32_bf16 v[20:23], v[56:59], a[4:7], 0
  v_mfma_f32_16x16x32_bf16 v[24:27], v[56:59], a[8:11], 0
  s_add_u32 m0, s29, 0
  s_add_u32 s3, s26, 0
  buffer_load_dwordx4 v1, s[8:11], s3 offen offset:0 sc1 lds
  s_waitcnt lgkmcnt(7)
  v_mfma_f32_16x16x32_bf16 v[28:31], v[60:63], a[0:3], 0
  ds_read_b128 v[92:95], v2 offset:24576
  v_mfma_f32_16x16x32_bf16 v[32:35], v[60:63], a[4:7], 0
  v_mfma_f32_16x16x32_bf16 v[36:39], v[60:63], a[8:11], 0
  s_waitcnt lgkmcnt(7)
  v_mfma_f32_16x16x32_bf16 v[16:19], v[64:67], a[12:15], v[16:19]
  ds_read_b128 v[56:59], v2 offset:5120
  v_mfma_f32_16x16x32_bf16 v[20:23], v[64:67], a[16:19], v[20:23]
  v_mfma_f32_16x16x32_bf16 v[24:27], v[64:67], a[20:23], v[24:27]
  buffer_load_dwordx4 v1, s[8:11], s3 offen offset:1024 sc1 lds
  s_waitcnt lgkmcnt(7)
  v_mfma_f32_16x16x32_bf16 v[28:31], v[68:71], a[12:15], v[28:31]
  ds_read_b128 v[60:63], v2 offset:25600
  v_mfma_f32_16x16x32_bf16 v[32:35], v[68:71], a[16:19], v[32:35]
  v_mfma_f32_16x16x32_bf16 v[36:39], v[68:71], a[20:23], v[36:39]
  s_waitcnt lgkmcnt(7)
  v_mfma_f32_16x16x32_bf16 v[16:19], v[72:75], a[24:27], v[16:19]
  ds_read_b128 v[64:67], v2 offset:6144
  v_mfma_f32_16x16x32_bf16 v[20:23], v[72:75], a[28:31], v[20:23]
  v_mfma_f32_16x16x32_bf16 v[24:27], v[72:75], a[32:35], v[24:27]
  buffer_load_dwordx4 v1, s[8:11], s3 offen offset:2048 sc1 lds
  s_waitcnt lgkmcnt(7)
  v_mfma_f32_16x16x32_bf16 v[28:31], v[76:79], a[24:27], v[28:31]
  ds_read_b128 v[68:71], v2 offset:26624
  v_mfma_f32_16x16x32_bf16 v[32:35], v[76:79], a[28:31], v[32:35]
  v_mfma_f32_16x16x32_bf16 v[36:39], v[76:79], a[32:35], v[36:39]
  s_waitcnt lgkmcnt(7)
  v_mfma_f32_16x16x32_bf16 v[16:19], v[80:83], a[36:39], v[16:19]
  ds_read_b128 v[72:75], v2 offset:7168
  v_mfma_f32_16x16x32_bf16 v[20:23], v[80:83], a[40:43], v[20:23]
  v_mfma_f32_16x16x32_bf16 v[24:27], v[80:83], a[44:47], v[24:27]
  buffer_load_dwordx4 v1, s[8:11], s3 offen offset:3072 sc1 lds
  s_waitcnt lgkmcnt(7)
  v_mfma_f32_16x16x32_bf16 v[28:31], v[84:87], a[36:39], v[28:31]
  ds_read_b128 v[76:79], v2 offset:27648
  v_mfma_f32_16x16x32_bf16 v[32:35], v[84:87], a[40:43], v[32:35]
  v_mfma_f32_16x16x32_bf16 v[36:39], v[84:87], a[44:47], v[36:39]
  s_waitcnt lgkmcnt(7)
  v_mfma_f32_16x16x32_bf16 v[16:19], v[88:91], a[48:51], v[16:19]
  ds_read_b128 v[80:83], v2 offset:8192
  v_mfma_f32_16x16x32_bf16 v[20:23], v[88:91], a[52:55], v[20:23]
  v_mfma_f32_16x16x32_bf16 v[24:27], v[88:91], a[56:59], v[24:27]
  s_add_u32 m0, s29, 4096
  s_add_u32 s3, s26, 4096
  buffer_load_dwordx4 v1, s[8:11], s3 offen offset:0 sc1 lds
  s_waitcnt lgkmcnt(7)
  v_mfma_f32_16x16x32_bf16 v[28:31], v[92:95], a[48:51], v[28:31]
  ds_read_b128 v[84:87], v2 offset:28672
  v_mfma_f32_16x16x32_bf16 v[32:35], v[92:95], a[52:55], v[32:35]
  v_mfma_f32_16x16x32_bf16 v[36:39], v[92:95], a[56:59], v[36:39]
  s_waitcnt lgkmcnt(7)
  v_mfma_f32_16x16x32_bf16 v[16:19], v[56:59], a[60:63], v[16:19]
  ds_read_b128 v[88:91], v2 offset:9216
  v_mfma_f32_16x16x32_bf16 v[20:23], v[56:59], a[64:67], v[20:23]
  v_mfma_f32_16x16x32_bf16 v[24:27], v[56:59], a[68:71], v[24:27]
  buffer_load_dwordx4 v1, s[8:11], s3 offen offset:1024 sc1 lds
  s_waitcnt lgkmcnt(7)
  v_mfma_f32_16x16x32_bf16 v[28:31], v[60:63], a[60:63], v[28:31]
  ds_read_b128 v[92:95], v2 offset:29696
  v_mfma_f32_16x16x32_bf16 v[32:35], v[60:63], a[64:67], v[32:35]
  v_mfma_f32_16x16x32_bf16 v[36:39], v[60:63], a[68:71], v[36:39]
  s_waitcnt lgkmcnt(7)
  v_mfma_f32_16x16x32_bf16 v[16:19], v[64:67], a[72:75], v[16:19]
  ds_read_b128 v[56:59], v2 offset:10240
  v_mfma_f32_16x16x32_bf16 v[20:23], v[64:67], a[76:79], v[20:23]
  v_mfma_f32_16x16x32_bf16 v[24:27], v[64:67], a[80:83], v[24:27]
  buffer_load_dwordx4 v1, s[8:11], s3 offen offset:2048 sc1 lds
  s_waitcnt lgkmcnt(7)
  v_mfma_f32_16x16x32_bf16 v[28:31], v[68:71], a[72:75], v[28:31]
  ds_read_b128 v[60:63], v2 offset:30720
  v_mfma_f32_16x16x32_bf16 v[32:35], v[68:71], a[76:79], v[32:35]
  v_mfma_f32_16x16x32_bf16 v[36:39], v[68:71], a[80:83], v[36:39]
  s_waitcnt lgkmcnt(7)
  v_mfma_f32_16x16x32_bf16 v[16:19], v[72:75], a[84:87], v[16:19]
  ds_read_b128 v[64:67], v2 offset:11264
  v_mfma_f32_16x16x32_bf16 v[20:23], v[72:75], a[88:91], v[20:23]
  v_mfma_f32_16x16x32_bf16 v[24:27], v[72:75], a[92:95], v[24:27]
  buffer_load_dwordx4 v1, s[8:11], s3 offen offset:3072 sc1 lds
  s_waitcnt lgkmcnt(7)
  v_mfma_f32_16x16x32_bf16 v[28:31], v[76:79], a[84:87], v[28:31]
  ds_read_b128 v[68:71], v2 offset:31744
  v_mfma_f32_16x16x32_bf16 v[32:35], v[76:79], a[88:91], v[32:35]
  v_mfma_f32_16x16x32_bf16 v[36:39], v[76:79], a[92:95], v[36:39]
  s_waitcnt lgkmcnt(7)
  v_mfma_f32_16x16x32_bf16 v[16:19], v[80:83], a[96:99], v[16:19]
  ds_read_b128 v[72:75], v2 offset:12288
  v_mfma_f32_16x16x32_bf16 v[20:23], v[80:83], a[100:103], v[20:23]
  v_mfma_f32_16x16x32_bf16 v[24:27], v[80:83], a[104:107], v[24:27]
  s_add_u32 m0, s29, 8192
  s_add_u32 s3, s26, 8192
  buffer_load_dwordx4 v1, s[8:11], s3 offen offset:0 sc1 lds
  s_waitcnt lgkmcnt(7)
  v_mfma_f32_16x16x32_bf16 v[28:31], v[84:87], a[96:99], v[28:31]
  ds_read_b128 v[76:79], v2 offset:32768
  v_mfma_f32_16x16x32_bf16 v[32:35], v[84:87], a[100:103], v[32:35]
  v_mfma_f32_16x16x32_bf16 v[36:39], v[84:87], a[104:107], v[36:39]
  s_waitcnt lgkmcnt(7)
  v_mfma_f32_16x16x32_bf16 v[16:19], v[88:91], a[108:111], v[16:19]
  ds_read_b128 v[80:83], v2 offset:13312
  v_mfma_f32_16x16x32_bf16 v[20:23], v[88:91], a[112:115], v[20:23]
  v_mfma_f32_16x16x32_bf16 v[24:27], v[88:91], a[116:119], v[24:27]
  buffer_load_dwordx4 v1, s[8:11], s3 offen offset:1024 sc1 lds
  s_waitcnt lgkmcnt(7)
  v_mfma_f32_16x16x32_bf16 v[28:31], v[92:95], a[108:111], v[28:31]
  ds_read_b128 v[84:87], v2 offset:33792
  v_mfma_f32_16x16x32_bf16 v[32:35], v[92:95], a[112:115], v[32:35]
  v_mfma_f32_16x16x32_bf16 v[36:39], v[92:95], a[116:119], v[36:39]
  s_waitcnt lgkmcnt(7)
  v_mfma_f32_16x16x32_bf16 v[16:19], v[56:59], a[120:123], v[16:19]
  ds_read_b128 v[88:91], v2 offset:14336
  v_mfma_f32_16x16x32_bf16 v[20:23], v[56:59], a[124:127], v[20:23]
  v_mfma_f32_16x16x32_bf16 v[24:27], v[56:59], a[128:131], v[24:27]
  s_waitcnt lgkmcnt(7)
  v_mfma_f32_16x16x32_bf16 v[28:31], v[60:63], a[120:123], v[28:31]
  ds_read_b128 v[92:95], v2 offset:34816
  v_mfma_f32_16x16x32_bf16 v[32:35], v[60:63], a[124:127], v[32:35]
  v_mfma_f32_16x16x32_bf16 v[36:39], v[60:63], a[128:131], v[36:39]
  s_waitcnt lgkmcnt(7)
  v_mfma_f32_16x16x32_bf16 v[16:19], v[64:67], a[132:135], v[16:19]
  ds_read_b128 v[56:59], v2 offset:15360
  v_mfma_f32_16x16x32_bf16 v[20:23], v[64:67], a[136:139], v[20:23]
  v_mfma_f32_16x16x32_bf16 v[24:27], v[64:67], a[140:143], v[24:27]
  s_waitcnt lgkmcnt(7)
  v_mfma_f32_16x16x32_bf16 v[28:31], v[68:71], a[132:135], v[28:31]
  ds_read_b128 v[60:63], v2 offset:35840
  v_mfma_f32_16x16x32_bf16 v[32:35], v[68:71], a[136:139], v[32:35]
  v_mfma_f32_16x16x32_bf16 v[36:39], v[68:71], a[140:143], v[36:39]
  s_waitcnt lgkmcnt(7)
  v_mfma_f32_16x16x32_bf16 v[16:19], v[72:75], a[144:147], v[16:19]
  ds_read_b128 v[64:67], v2 offset:16384
  v_mfma_f32_16x16x32_bf16 v[20:23], v[72:75], a[148:151], v[20:23]
  v_mfma_f32_16x16x32_bf16 v[24:27], v[72:75], a[152:155], v[24:27]
  s_waitcnt lgkmcnt(7)
  v_mfma_f32_16x16x32_bf16 v[28:31], v[76:79], a[144:147], v[28:31]
  ds_read_b128 v[68:71], v2 offset:36864
  v_mfma_f32_16x16x32_bf16 v[32:35], v[76:79], a[148:151], v[32:35]
  v_mfma_f32_16x16x32_bf16 v[36:39], v[76:79], a[152:155], v[36:39]
  s_waitcnt lgkmcnt(7)
  v_mfma_f32_16x16x32_bf16 v[16:19], v[80:83], a[156:159], v[16:19]
  ds_read_b128 v[72:75], v2 offset:17408
  v_mfma_f32_16x16x32_bf16 v[20:23], v[80:83], a[160:163], v[20:23]
  v_mfma_f32_16x16x32_bf16 v[24:27], v[80:83], a[164:167], v[24:27]
  s_waitcnt lgkmcnt(7)
  v_mfma_f32_16x16x32_bf16 v[28:31], v[84:87], a[156:159], v[28:31]
  ds_read_b128 v[76:79], v2 offset:37888
  v_mfma_f32_16x16x32_bf16 v[32:35], v[84:87], a[160:163], v[32:35]
  v_mfma_f32_16x16x32_bf16 v[36:39], v[84:87], a[164:167], v[36:39]
  s_waitcnt lgkmcnt(7)
  v_mfma_f32_16x16x32_bf16 v[16:19], v[88:91], a[168:171], v[16:19]
  ds_read_b128 v[80:83], v2 offset:18432
  v_mfma_f32_16x16x32_bf16 v[20:23], v[88:91], a[172:175], v[20:23]
  v_mfma_f32_16x16x32_bf16 v[24:27], v[88:91], a[176:179], v[24:27]
  s_waitcnt lgkmcnt(7)
  v_mfma_f32_16x16x32_bf16 v[28:31], v[92:95], a[168:171], v[28:31]
  ds_read_b128 v[84:87], v2 offset:38912
  v_mfma_f32_16x16x32_bf16 v[32:35], v[92:95], a[172:175], v[32:35]
  v_mfma_f32_16x16x32_bf16 v[36:39], v[92:95], a[176:179], v[36:39]
  s_waitcnt lgkmcnt(7)
  v_mfma_f32_16x16x32_bf16 v[16:19], v[56:59], a[180:183], v[16:19]
  ds_read_b128 v[88:91], v2 offset:19456
  v_mfma_f32_16x16x32_bf16 v[20:23], v[56:59], a[184:187], v[20:23]
  v_mfma_f32_16x16x32_bf16 v[24:27], v[56:59], a[188:191], v[24:27]
  s_waitcnt lgkmcnt(7)
  v_mfma_f32_16x16x32_bf16 v[28:31], v[60:63], a[180:183], v[28:31]
  ds_read_b128 v[92:95], v2 offset:39936
  v_mfma_f32_16x16x32_bf16 v[32:35], v[60:63], a[184:187], v[32:35]
  v_mfma_f32_16x16x32_bf16 v[36:39], v[60:63], a[188:191], v[36:39]
  s_waitcnt lgkmcnt(7)
  v_mfma_f32_16x16x32_bf16 v[16:19], v[64:67], a[192:195], v[16:19]
  v_mfma_f32_16x16x32_bf16 v[20:23], v[64:67], a[196:199], v[20:23]
  v_mfma_f32_16x16x32_bf16 v[24:27], v[64:67], a[200:203], v[24:27]
  s_waitcnt lgkmcnt(6)
  v_mfma_f32_16x16x32_bf16 v[28:31], v[68:71], a[192:195], v[28:31]
  v_mfma_f32_16x16x32_bf16 v[32:35], v[68:71], a[196:199], v[32:35]
  v_mfma_f32_16x16x32_bf16 v[36:39], v[68:71], a[200:203], v[36:39]
  s_waitcnt lgkmcnt(5)
  v_mfma_f32_16x16x32_bf16 v[16:19], v[72:75], a[204:207], v[16:19]
  v_mfma_f32_16x16x32_bf16 v[20:23], v[72:75], a[208:211], v[20:23]
  v_mfma_f32_16x16x32_bf16 v[24:27], v[72:75], a[212:215], v[24:27]
  s_waitcnt lgkmcnt(4)
  v_mfma_f32_16x16x32_bf16 v[28:31], v[76:79], a[204:207], v[28:31]
  v_mfma_f32_16x16x32_bf16 v[32:35], v[76:79], a[208:211], v[32:35]
  v_mfma_f32_16x16x32_bf16 v[36:39], v[76:79], a[212:215], v[36:39]
  s_waitcnt lgkmcnt(3)
  v_mfma_f32_16x16x32_bf16 v[16:19], v[80:83], a[216:219], v[16:19]
  v_mfma_f32_16x16x32_bf16 v[20:23], v[80:83], a[220:223], v[20:23]
  v_mfma_f32_16x16x32_bf16 v[24:27], v[80:83], a[224:227], v[24:27]
  s_waitcnt lgkmcnt(2)
  v_mfma_f32_16x16x32_bf16 v[28:31], v[84:87], a[216:219], v[28:31]
  v_mfma_f32_16x16x32_bf16 v[32:35], v[84:87], a[220:223], v[32:35]
  v_mfma_f32_16x16x32_bf16 v[36:39], v[84:87], a[224:227], v[36:39]
  s_waitcnt lgkmcnt(1)
  v_mfma_f32_16x16x32_bf16 v[16:19], v[88:91], a[228:231], v[16:19]
  v_mfma_f32_16x16x32_bf16 v[20:23], v[88:91], a[232:235], v[20:23]
  v_mfma_f32_16x16x32_bf16 v[24:27], v[88:91], a[236:239], v[24:27]
  s_waitcnt lgkmcnt(0)
  v_mfma_f32_16x16x32_bf16 v[28:31], v[92:95], a[228:231], v[28:31]
  v_mfma_f32_16x16x32_bf16 v[32:35], v[92:95], a[232:235], v[32:35]
  v_mfma_f32_16x16x32_bf16 v[36:39], v[92:95], a[236:239], v[36:39]
  v_xor_b32 v2, 65536, v2
  v_cvt_pk_bf16_f32 v40, v16, v17
  v_cvt_pk_bf16_f32 v41, v18, v19
  v_cvt_pk_bf16_f32 v44, v20, v21
  v_cvt_pk_bf16_f32 v45, v22, v23
  v_cvt_pk_bf16_f32 v48, v24, v25
  v_cvt_pk_bf16_f32 v49, v26, v27
  v_cvt_pk_bf16_f32 v42, v28, v29
  v_cvt_pk_bf16_f32 v43, v30, v31
  buffer_store_dwordx4 v[40:43], v3, s[8:11], s24 offen offset:0 sc1
  v_cvt_pk_bf16_f32 v46, v32, v33
  v_cvt_pk_bf16_f32 v47, v34, v35
  buffer_store_dwordx4 v[44:47], v3, s[8:11], s24 offen offset:1024 sc1
  v_cvt_pk_bf16_f32 v50, v36, v37
  v_cvt_pk_bf16_f32 v51, v38, v39
  buffer_store_dwordx4 v[48:51], v3, s[8:11], s24 offen offset:2048 sc1
  s_add_u32 s24, s24, 393216
  s_add_u32 s25, s24, 6144
  s_add_u32 s27, s27, 1
  s_branch L66_gtop
L68_gdone:
  s_waitcnt vmcnt(0)
  s_branch L_d2
L62_gbail:
  s_endpgm
Lg_glu:
  s_load_dwordx2 s[8:9], s[0:1], 104
  s_load_dwordx2 s[12:13], s[0:1], 96
  s_load_dwordx2 s[16:17], s[0:1], 64
  s_load_dwordx2 s[20:21], s[0:1], 72
  s_mov_b32 s10, 268435456
  s_mov_b32 s11, 0x20000
  s_mov_b32 s14, 256
  s_mov_b32 s15, 0x20000
  s_mov_b32 s18, 1966080
  s_mov_b32 s19, 0x20000
  s_mov_b32 s22, 1966080
  s_mov_b32 s23, 0x20000
  s_waitcnt lgkmcnt(0)
  s_lshl_b32 s24, s6, 11
  s_add_u32 s24, s24, 109051904
  v_and_b32 v20, 63, v0
  v_lshrrev_b32 v21, 4, v20
  v_and_b32 v22, 15, v20
  v_lshlrev_b32 v1, 4, v20
  v_mov_b32 v2, v1
  v_mov_b32 v5, 0
  s_lshl_b32 s28, s4, 7
  s_add_u32 s28, s28, 3145728
  s_cmp_lt_u32 s4, 64
  s_cbranch_scc1 L71_gl
  buffer_store_dword v5, off, s[8:11], s28 sc1
  s_and_b32 s3, s2, 7
  s_sub_u32 s3, s3, 2
  s_lshl_b32 s3, s3, 2
  s_bfe_u32 vcc_lo, s2, 0x20003
  s_add_u32 s3, s3, vcc_lo
  s_lshl_b32 s3, s3, 3
  s_lshr_b32 vcc_lo, s2, 5
  s_add_u32 s3, s3, vcc_lo
  s_mul_i32 vcc_lo, s3, 8192
  s_mul_i32 s3, s3, 20480
  s_add_u32 s3, s3, 134217728
  v_lshlrev_b32 v32, 4, v0
  v_mov_b32 v28, 0
  v_mov_b32 v29, 0
  v_mov_b32 v30, 0
  v_mov_b32 v31, 0
  v_mov_b32 v28, -1
  v_mov_b32 v29, -1
  v_mov_b32 v30, -1
  v_mov_b32 v31, -1
  s_add_u32 s3, vcc_lo, 29884416
  buffer_store_dwordx4 v[28:31], v32, s[8:11], s3 offen sc1
  s_add_u32 s3, vcc_lo, 29888512
  buffer_store_dwordx4 v[28:31], v32, s[8:11], s3 offen sc1
  s_waitcnt vmcnt(0)
  s_barrier
  s_cmp_lg_u32 s5, 0
  s_cbranch_scc1 L73_gs
  s_lshr_b32 s3, s2, 3
  s_lshl_b32 s3, 1, s3
  v_mov_b32 v28, s3
  v_mov_b32 v29, 256
  s_and_b32 s3, s2, 7
  s_lshl_b32 s3, s3, 3
  s_add_u32 s3, s3, s97
  s_mov_b64 exec, 1
  buffer_atomic_add_x2 v[28:29], off, s[12:15], s3 sc1
  s_mov_b64 exec, -1
L73_gs:
  s_load_dwordx2 s[40:41], s[0:1], 16
  s_mov_b32 s42, 7864320
  s_mov_b32 s43, 0x20000
  s_waitcnt lgkmcnt(0)
  s_and_b32 s3, s2, 1
  s_lshl_b32 s3, s3, 5
  s_lshr_b32 vcc_lo, s2, 3
  s_add_u32 s3, s3, vcc_lo
  s_lshl_b32 s3, s3, 15
  v_lshl_add_u32 v34, v0, 7, s3
  s_lshl_b32 s3, s3, 1
  v_lshrrev_b32 v35, 2, v0
  v_lshl_add_u32 v35, v35, 10, s3
  v_and_b32 v36, 3, v0
  v_min_u32 v36, 2, v36
  v_lshl_add_u32 v35, v36, 7, v35
  s_sub_u32 s3, 256, s40
  s_and_b32 s3, s3, 1023
  buffer_load_dword v36, v35, s[40:43], s3 offen
  s_add_u32 s3, s3, 4194304
  buffer_load_dword v36, v35, s[40:43], s3 offen
  s_cmp_eq_u32 s96, 0
  s_cbranch_scc1 L74_hs
  s_barrier
L74_hs:
  v_mbcnt_lo_u32_b32 v30, -1, 0
  v_min_u32 v30, 8, v30
  v_lshlrev_b32 v30, 3, v30
L76_cen:
  buffer_load_dwordx2 v[28:29], v30, s[12:15], s97 offen sc1
  s_sub_u32 s37, s37, 1
  s_cbranch_scc1 L70_gbail
  s_waitcnt vmcnt(0)
  v_not_b32 v31, v28
  v_xor_b32 v32, 0x2000, v29
  v_or_b32 v31, v31, v32
  v_cmp_ne_u32 vcc, 0, v31
  s_and_b32 s3, vcc_lo, 0xff
  s_cbranch_scc0 L77_cok
  v_lshrrev_b32 v29, 8, v29
  s_nop 1
  v_add_u32_dpp v29, v29, v29 row_shr:1 row_mask:0xf bank_mask:0xf bound_ctrl:1
  s_nop 1
  v_add_u32_dpp v29, v29, v29 row_shr:2 row_mask:0xf bank_mask:0xf bound_ctrl:1
  s_nop 1
  v_add_u32_dpp v29, v29, v29 row_shr:4 row_mask:0xf bank_mask:0xf bound_ctrl:1
  s_nop 0
  v_readlane_b32 s3, v29, 7
  s_cmp_lt_u32 s3, 256
  s_cbranch_scc1 L76_cen
  s_branch L_restart0
L77_cok:
  s_lshl_b32 s3, s6, 7
  s_add_u32 s3, s3, 3145728
L75_hp:
  buffer_load_dword v28, off, s[8:11], s3 sc1
  s_sub_u32 s37, s37, 1
  s_cbranch_scc1 L70_gbail
  s_waitcnt vmcnt(0)
  v_cmp_gt_u32 vcc, 4, v28
  s_cbranch_vccnz L75_hp
  s_cmp_lg_u32 s96, 0
  s_cbranch_scc1 L78_hs
  s_barrier
L78_hs:
L71_gl:
  v_lshrrev_b32 v23, 3, v0
  v_mul_u32_u24 v23, 3072, v23
  v_and_b32 v24, 7, v0
  v_lshl_add_u32 v23, v24, 4, v23
  s_lshl_b32 s3, s6, 7
  v_add_u32 v6, s3, v23
  s_lshl_b32 s29, s5, 10
  s_mov_b32 s3, 0
  s_add_u32 m0, s29, 0
  s_nop 0
  buffer_load_dwordx4 v6, s[16:19], s3 offen lds
  s_add_u32 m0, s29, 4096
  s_nop 0
  buffer_load_dwordx4 v6, s[20:23], s3 offen lds
  s_mov_b32 s3, 98304
  s_add_u32 m0, s29, 8192
  s_nop 0
  buffer_load_dwordx4 v6, s[16:19], s3 offen lds
  s_add_u32 m0, s29, 12288
  s_nop 0
  buffer_load_dwordx4 v6, s[20:23], s3 offen lds
  s_mov_b32 s3, 196608
  s_add_u32 m0, s29, 16384
  s_nop 0
  buffer_load_dwordx4 v6, s[16:19], s3 offen lds
  s_add_u32 m0, s29, 20480
  s_nop 0
  buffer_load_dwordx4 v6, s[20:23], s3 offen lds
  s_mov_b32 s3, 294912
  s_add_u32 m0, s29, 24576
  s_nop 0
  buffer_load_dwordx4 v6, s[16:19], s3 offen lds
  s_add_u32 m0, s29, 28672
  s_nop 0
  buffer_load_dwordx4 v6, s[20:23], s3 offen lds
  s_mov_b32 s3, 393216
  s_add_u32 m0, s29, 32768
  s_nop 0
  buffer_load_dwordx4 v6, s[16:19], s3 offen lds
  s_add_u32 m0, s29, 36864
  s_nop 0
  buffer_load_dwordx4 v6, s[20:23], s3 offen lds
  s_mov_b32 s3, 491520
  s_add_u32 m0, s29, 40960
  s_nop 0
  buffer_load_dwordx4 v6, s[16:19], s3 offen lds
  s_add_u32 m0, s29, 45056
  s_nop 0
  buffer_load_dwordx4 v6, s[20:23], s3 offen lds
  s_mov_b32 s3, 589824
  s_add_u32 m0, s29, 49152
  s_nop 0
  buffer_load_dwordx4 v6, s[16:19], s3 offen lds
  s_add_u32 m0, s29, 53248
  s_nop 0
  buffer_load_dwordx4 v6, s[20:23], s3 offen lds
  s_mov_b32 s3, 688128
  s_add_u32 m0, s29, 57344
  s_nop 0
  buffer_load_dwordx4 v6, s[16:19], s3 offen lds
  s_add_u32 m0, s29, 61440
  s_nop 0
  buffer_load_dwordx4 v6, s[20:23], s3 offen lds
  s_mov_b32 s3, 786432
  s_add_u32 m0, s29, 65536
  s_nop 0
  buffer_load_dwordx4 v6, s[16:19], s3 offen lds
  s_add_u32 m0, s29, 69632
  s_nop 0
  buffer_load_dwordx4 v6, s[20:23], s3 offen lds
  s_mov_b32 s3, 884736
  s_add_u32 m0, s29, 73728
  s_nop 0
  buffer_load_dwordx4 v6, s[16:19], s3 offen lds
  s_add_u32 m0, s29, 77824
  s_nop 0
  buffer_load_dwordx4 v6, s[20:23], s3 offen lds
  s_mov_b32 s3, 983040
  s_add_u32 m0, s29, 81920
  s_nop 0
  buffer_load_dwordx4 v6, s[16:19], s3 offen lds
  s_add_u32 m0, s29, 86016
  s_nop 0
  buffer_load_dwordx4 v6, s[20:23], s3 offen lds
  s_mov_b32 s3, 1081344
  s_add_u32 m0, s29, 90112
  s_nop 0
  buffer_load_dwordx4 v6, s[16:19], s3 offen lds
  s_add_u32 m0, s29, 94208
  s_nop 0
  buffer_load_dwordx4 v6, s[20:23], s3 offen lds
  v_lshrrev_b32 v23, 2, v22
  v_lshl_add_u32 v23, v21, 3, v23
  v_mul_u32_u24 v23, 128, v23
  s_mul_i32 s3, s5, 32
  v_add_u32 v23, s3, v23
  v_and_b32 v24, 3, v22
  v_lshl_add_u32 v9, v24, 4, v23
  v_lshl_add_u32 v10, v24, 3, v23
  v_and_b32 v23, 1, v21
  v_mul_u32_u24 v23, 49152, v23
  v_lshrrev_b32 v24, 1, v21
  v_lshl_add_u32 v23, v24, 8, v23
  v_lshl_add_u32 v23, v22, 4, v23
  s_lshl_b32 s3, s5, 9
  v_add_u32 v3, s3, v23
  s_waitcnt vmcnt(16)
  s_barrier
  v_add_u32 v11, 0, v9
  v_add_u32 v12, 0, v10
  ds_read_b64_tr_b16 a[0:1], v12 offset:0
  ds_read_b64_tr_b16 a[2:3], v12 offset:512
  ds_read_b64_tr_b16 a[4:5], v12 offset:4096
  ds_read_b64_tr_b16 a[6:7], v12 offset:4608
  ds_read_b64_tr_b16 a[8:9], v12 offset:8192
  ds_read_b64_tr_b16 a[10:11], v12 offset:8704
  ds_read_b64_tr_b16 a[12:13], v12 offset:12288
  ds_read_b64_tr_b16 a[14:15], v12 offset:12800
  ds_read_b64_tr_b16 a[16:17], v12 offset:16384
  ds_read_b64_tr_b16 a[18:19], v12 offset:16896
  ds_read_b64_tr_b16 a[20:21], v12 offset:20480
  ds_read_b64_tr_b16 a[22:23], v12 offset:20992
  ds_read_b64_tr_b16 a[24:25], v12 offset:24576
  ds_read_b64_tr_b16 a[26:27], v12 offset:25088
  ds_read_b64_tr_b16 a[28:29], v12 offset:28672
  ds_read_b64_tr_b16 a[30:31], v12 offset:29184
  s_waitcnt lgkmcnt(0)
  s_barrier
  s_mov_b32 s3, 1179648
  s_add_u32 m0, s29, 0
  s_nop 0
  buffer_load_dwordx4 v6, s[16:19], s3 offen lds
  s_add_u32 m0, s29, 4096
  s_nop 0
  buffer_load_dwordx4 v6, s[20:23], s3 offen lds
  s_mov_b32 s3, 1277952
  s_add_u32 m0, s29, 8192
  s_nop 0
  buffer_load_dwordx4 v6, s[16:19], s3 offen lds
  s_add_u32 m0, s29, 12288
  s_nop 0
  buffer_load_dwordx4 v6, s[20:23], s3 offen lds
  s_mov_b32 s3, 1376256
  s_add_u32 m0, s29, 16384
  s_nop 0
  buffer_load_dwordx4 v6, s[16:19], s3 offen lds
  s_add_u32 m0, s29, 20480
  s_nop 0
  buffer_load_dwordx4 v6, s[20:23], s3 offen lds
  s_mov_b32 s3, 1474560
  s_add_u32 m0, s29, 24576
  s_nop 0
  buffer_load_dwordx4 v6, s[16:19], s3 offen lds
  s_add_u32 m0, s29, 28672
  s_nop 0
  buffer_load_dwordx4 v6, s[20:23], s3 offen lds
  s_waitcnt vmcnt(16)
  s_barrier
  v_add_u32 v11, 32768, v9
  v_add_u32 v12, 32768, v10
  ds_read_b64_tr_b16 a[32:33], v12 offset:0
  ds_read_b64_tr_b16 a[34:35], v12 offset:512
  ds_read_b64_tr_b16 a[36:37], v12 offset:4096
  ds_read_b64_tr_b16 a[38:39], v12 offset:4608
  ds_read_b64_tr_b16 a[40:41], v12 offset:8192
  ds_read_b64_tr_b16 a[42:43], v12 offset:8704
  ds_read_b64_tr_b16 a[44:45], v12 offset:12288
  ds_read_b64_tr_b16 a[46:47], v12 offset:12800
  ds_read_b64_tr_b16 a[48:49], v12 offset:16384
  ds_read_b64_tr_b16 a[50:51], v12 offset:16896
  ds_read_b64_tr_b16 a[52:53], v12 offset:20480
  ds_read_b64_tr_b16 a[54:55], v12 offset:20992
  ds_read_b64_tr_b16 a[56:57], v12 offset:24576
  ds_read_b64_tr_b16 a[58:59], v12 offset:25088
  ds_read_b64_tr_b16 a[60:61], v12 offset:28672
  ds_read_b64_tr_b16 a[62:63], v12 offset:29184
  s_waitcnt lgkmcnt(0)
  s_barrier
  s_mov_b32 s3, 1572864
  s_add_u32 m0, s29, 32768
  s_nop 0
  buffer_load_dwordx4 v6, s[16:19], s3 offen lds
  s_add_u32 m0, s29, 36864
  s_nop 0
  buffer_load_dwordx4 v6, s[20:23], s3 offen lds
  s_mov_b32 s3, 1671168
  s_add_u32 m0, s29, 40960
  s_nop 0
  buffer_load_dwordx4 v6, s[16:19], s3 offen lds
  s_add_u32 m0, s29, 45056
  s_nop 0
  buffer_load_dwordx4 v6, s[20:23], s3 offen lds
  s_mov_b32 s3, 1769472
  s_add_u32 m0, s29, 49152
  s_nop 0
  buffer_load_dwordx4 v6, s[16:19], s3 offen lds
  s_add_u32 m0, s29, 53248
  s_nop 0
  buffer_load_dwordx4 v6, s[20:23], s3 offen lds
  s_mov_b32 s3, 1867776
  s_add_u32 m0, s29, 57344
  s_nop 0
  buffer_load_dwordx4 v6, s[16:19], s3 offen lds
  s_add_u32 m0, s29, 61440
  s_nop 0
  buffer_load_dwordx4 v6, s[20:23], s3 offen lds
  s_waitcnt vmcnt(16)
  s_barrier
  v_add_u32 v11, 65536, v9
  v_add_u32 v12, 65536, v10
  ds_read_b64_tr_b16 a[64:65], v12 offset:0
  ds_read_b64_tr_b16 a[66:67], v12 offset:512
  ds_read_b64_tr_b16 a[68:69], v12 offset:4096
  ds_read_b64_tr_b16 a[70:71], v12 offset:4608
  ds_read_b64_tr_b16 a[72:73], v12 offset:8192
  ds_read_b64_tr_b16 a[74:75], v12 offset:8704
  ds_read_b64_tr_b16 a[76:77], v12 offset:12288
  ds_read_b64_tr_b16 a[78:79], v12 offset:12800
  ds_read_b64_tr_b16 a[80:81], v12 offset:16384
  ds_read_b64_tr_b16 a[82:83], v12 offset:16896
  ds_read_b64_tr_b16 a[84:85], v12 offset:20480
  ds_read_b64_tr_b16 a[86:87], v12 offset:20992
  ds_read_b64_tr_b16 a[88:89], v12 offset:24576
  ds_read_b64_tr_b16 a[90:91], v12 offset:25088
  ds_read_b64_tr_b16 a[92:93], v12 offset:28672
  ds_read_b64_tr_b16 a[94:95], v12 offset:29184
  s_waitcnt lgkmcnt(0)
  s_waitcnt vmcnt(8)
  s_barrier
  v_add_u32 v11, 0, v9
  v_add_u32 v12, 0, v10
  ds_read_b64_tr_b16 a[96:97], v12 offset:0
  ds_read_b64_tr_b16 a[98:99], v12 offset:512
  ds_read_b64_tr_b16 a[100:101], v12 offset:4096
  ds_read_b64_tr_b16 a[102:103], v12 offset:4608
  ds_read_b64_tr_b16 a[104:105], v12 offset:8192
  ds_read_b64_tr_b16 a[106:107], v12 offset:8704
  ds_read_b64_tr_b16 a[108:109], v12 offset:12288
  ds_read_b64_tr_b16 a[110:111], v12 offset:12800
  ds_read_b64_tr_b16 a[112:113], v12 offset:16384
  ds_read_b64_tr_b16 a[114:115], v12 offset:16896
  ds_read_b64_tr_b16 a[116:117], v12 offset:20480
  ds_read_b64_tr_b16 a[118:119], v12 offset:20992
  ds_read_b64_tr_b16 a[120:121], v12 offset:24576
  ds_read_b64_tr_b16 a[122:123], v12 offset:25088
  ds_read_b64_tr_b16 a[124:125], v12 offset:28672
  ds_read_b64_tr_b16 a[126:127], v12 offset:29184
  s_waitcnt lgkmcnt(0)
  s_waitcnt vmcnt(0)
  s_barrier
  v_add_u32 v11, 32768, v9
  v_add_u32 v12, 32768, v10
  ds_read_b64_tr_b16 a[128:129], v12 offset:0
  ds_read_b64_tr_b16 a[130:131], v12 offset:512
  ds_read_b64_tr_b16 a[132:133], v12 offset:4096
  ds_read_b64_tr_b16 a[134:135], v12 offset:4608
  ds_read_b64_tr_b16 a[136:137], v12 offset:8192
  ds_read_b64_tr_b16 a[138:139], v12 offset:8704
  ds_read_b64_tr_b16 a[140:141], v12 offset:12288
  ds_read_b64_tr_b16 a[142:143], v12 offset:12800
  ds_read_b64_tr_b16 a[144:145], v12 offset:16384
  ds_read_b64_tr_b16 a[146:147], v12 offset:16896
  ds_read_b64_tr_b16 a[148:149], v12 offset:20480
  ds_read_b64_tr_b16 a[150:151], v12 offset:20992
  ds_read_b64_tr_b16 a[152:153], v12 offset:24576
  ds_read_b64_tr_b16 a[154:155], v12 offset:25088
  ds_read_b64_tr_b16 a[156:157], v12 offset:28672
  ds_read_b64_tr_b16 a[158:159], v12 offset:29184
  s_waitcnt lgkmcnt(0)
  v_mbcnt_lo_u32_b32 v30, -1, 0
  v_min_u32 v30, 8, v30
  v_lshlrev_b32 v30, 3, v30
L79_cen:
  buffer_load_dwordx2 v[28:29], v30, s[12:15], s97 offen sc1
  s_sub_u32 s37, s37, 1
  s_cbranch_scc1 L70_gbail
  s_waitcnt vmcnt(0)
  v_not_b32 v31, v28
  v_xor_b32 v32, 0x2000, v29
  v_or_b32 v31, v31, v32
  v_cmp_ne_u32 vcc, 0, v31
  s_and_b32 s3, vcc_lo, 0xff
  s_cbranch_scc0 L80_cok
  v_lshrrev_b32 v29, 8, v29
  s_nop 1
  v_add_u32_dpp v29, v29, v29 row_shr:1 row_mask:0xf bank_mask:0xf bound_ctrl:1
  s_nop 1
  v_add_u32_dpp v29, v29, v29 row_shr:2 row_mask:0xf bank_mask:0xf bound_ctrl:1
  s_nop 1
  v_add_u32_dpp v29, v29, v29 row_shr:4 row_mask:0xf bank_mask:0xf bound_ctrl:1
  s_nop 0
  v_readlane_b32 s3, v29, 7
  s_cmp_lt_u32 s3, 256
  s_cbranch_scc1 L79_cen
  s_branch L_restart
L80_cok:
  s_barrier
  s_mul_i32 s29, s5, 10240
  s_add_u32 s26, s29, 0
  s_mov_b32 s27, 0
  s_add_u32 m0, s29, 0
  s_add_u32 s3, s26, 0
  buffer_load_dwordx4 v1, s[8:11], s3 offen offset:0 sc1 lds
  buffer_load_dwordx4 v1, s[8:11], s3 offen offset:1024 sc1 lds
  buffer_load_dwordx4 v1, s[8:11], s3 offen offset:2048 sc1 lds
  buffer_load_dwordx4 v1, s[8:11], s3 offen offset:3072 sc1 lds
  s_add_u32 m0, s29, 4096
  s_add_u32 s3, s26, 4096
  buffer_load_dwordx4 v1, s[8:11], s3 offen offset:0 sc1 lds
  buffer_load_dwordx4 v1, s[8:11], s3 offen offset:1024 sc1 lds
  buffer_load_dwordx4 v1, s[8:11], s3 offen offset:2048 sc1 lds
  buffer_load_dwordx4 v1, s[8:11], s3 offen offset:3072 sc1 lds
  s_add_u32 m0, s29, 8192
  s_add_u32 s3, s26, 8192
  buffer_load_dwordx4 v1, s[8:11], s3 offen offset:0 sc1 lds
  buffer_load_dwordx4 v1, s[8:11], s3 offen offset:1024 sc1 lds
L81_gtop:
  s_xor_b32 s29, s29, 65536
  s_add_u32 s26, s26, 40960
  s_sub_u32 s3, s27, 3
  s_cmp_lt_u32 s3, 61
  s_subb_u32 s30, s27, 0
  s_cmp_lt_u32 s3, 61
  s_cbranch_scc1 L84_glag
  s_waitcnt vmcnt(0)
L84_glag:
  s_cmp_lg_u32 s5, 0
  s_waitcnt vmcnt(1)
  s_barrier
  s_cbranch_scc1 L82_gnf
  v_mov_b32 v5, s30
  buffer_store_dword v5, off, s[8:11], s28 sc1
L82_gnf:
  s_cmp_eq_u32 s27, 64
  s_cbranch_scc1 L83_gdone
  ds_read_b128 v[56:59], v2 offset:0
  ds_read_b128 v[60:63], v2 offset:20480
  ds_read_b128 v[64:67], v2 offset:1024
  ds_read_b128 v[68:71], v2 offset:21504
  ds_read_b128 v[72:75], v2 offset:2048
  ds_read_b128 v[76:79], v2 offset:22528
  ds_read_b128 v[80:83], v2 offset:3072
  ds_read_b128 v[84:87], v2 offset:23552
  s_waitcnt lgkmcnt(7)
  v_mfma_f32_16x16x32_bf16 v[16:19], a[0:3], v[56:59], 0
  ds_read_b128 v[88:91], v2 offset:4096
  v_mfma_f32_16x16x32_bf16 v[20:23], a[4:7], v[56:59], 0
  s_add_u32 m0, s29, 0
  s_add_u32 s3, s26, 0
  buffer_load_dwordx4 v1, s[8:11], s3 offen offset:0 sc1 lds
  s_waitcnt lgkmcnt(7)
  v_mfma_f32_16x16x32_bf16 v[24:27], a[0:3], v[60:63], 0
  ds_read_b128 v[92:95], v2 offset:24576
  v_mfma_f32_16x16x32_bf16 v[28:31], a[4:7], v[60:63], 0
  s_waitcnt lgkmcnt(7)
  v_mfma_f32_16x16x32_bf16 v[16:19], a[8:11], v[64:67], v[16:19]
  ds_read_b128 v[56:59], v2 offset:5120
  v_mfma_f32_16x16x32_bf16 v[20:23], a[12:15], v[64:67], v[20:23]
  buffer_load_dwordx4 v1, s[8:11], s3 offen offset:1024 sc1 lds
  s_waitcnt lgkmcnt(7)
  v_mfma_f32_16x16x32_bf16 v[24:27], a[8:11], v[68:71], v[24:27]
  ds_read_b128 v[60:63], v2 offset:25600
  v_mfma_f32_16x16x32_bf16 v[28:31], a[12:15], v[68:71], v[28:31]
  s_waitcnt lgkmcnt(7)
  v_mfma_f32_16x16x32_bf16 v[16:19], a[16:19], v[72:75], v[16:19]
  ds_read_b128 v[64:67], v2 offset:6144
  v_mfma_f32_16x16x32_bf16 v[20:23], a[20:23], v[72:75], v[20:23]
  buffer_load_dwordx4 v1, s[8:11], s3 offen offset:2048 sc1 lds
  s_waitcnt lgkmcnt(7)
  v_mfma_f32_16x16x32_bf16 v[24:27], a[16:19], v[76:79], v[24:27]
  ds_read_b128 v[68:71], v2 offset:26624
  v_mfma_f32_16x16x32_bf16 v[28:31], a[20:23], v[76:79], v[28:31]
  s_waitcnt lgkmcnt(7)
  v_mfma_f32_16x16x32_bf16 v[16:19], a[24:27], v[80:83], v[16:19]
  ds_read_b128 v[72:75], v2 offset:7168
  v_mfma_f32_16x16x32_bf16 v[20:23], a[28:31], v[80:83], v[20:23]
  buffer_load_dwordx4 v1, s[8:11], s3 offen offset:3072 sc1 lds
  s_waitcnt lgkmcnt(7)
  v_mfma_f32_16x16x32_bf16 v[24:27], a[24:27], v[84:87], v[24:27]
  ds_read_b128 v[76:79], v2 offset:27648
  v_mfma_f32_16x16x32_bf16 v[28:31], a[28:31], v[84:87], v[28:31]
  s_waitcnt lgkmcnt(7)
  v_mfma_f32_16x16x32_bf16 v[16:19], a[32:35], v[88:91], v[16:19]
  ds_read_b128 v[80:83], v2 offset:8192
  v_mfma_f32_16x16x32_bf16 v[20:23], a[36:39], v[88:91], v[20:23]
  s_add_u32 m0, s29, 4096
  s_add_u32 s3, s26, 4096
  buffer_load_dwordx4 v1, s[8:11], s3 offen offset:0 sc1 lds
  s_waitcnt lgkmcnt(7)
  v_mfma_f32_16x16x32_bf16 v[24:27], a[32:35], v[92:95], v[24:27]
  ds_read_b128 v[84:87], v2 offset:28672
  v_mfma_f32_16x16x32_bf16 v[28:31], a[36:39], v[92:95], v[28:31]
  s_waitcnt lgkmcnt(7)
  v_mfma_f32_16x16x32_bf16 v[16:19], a[40:43], v[56:59], v[16:19]
  ds_read_b128 v[88:91], v2 offset:9216
  v_mfma_f32_16x16x32_bf16 v[20:23], a[44:47], v[56:59], v[20:23]
  buffer_load_dwordx4 v1, s[8:11], s3 offen offset:1024 sc1 lds
  s_waitcnt lgkmcnt(7)
  v_mfma_f32_16x16x32_bf16 v[24:27], a[40:43], v[60:63], v[24:27]
  ds_read_b128 v[92:95], v2 offset:29696
  v_mfma_f32_16x16x32_bf16 v[28:31], a[44:47], v[60:63], v[28:31]
  s_waitcnt lgkmcnt(7)
  v_mfma_f32_16x16x32_bf16 v[16:19], a[48:51], v[64:67], v[16:19]
  ds_read_b128 v[56:59], v2 offset:10240
  v_mfma_f32_16x16x32_bf16 v[20:23], a[52:55], v[64:67], v[20:23]
  buffer_load_dwordx4 v1, s[8:11], s3 offen offset:2048 sc1 lds
  s_waitcnt lgkmcnt(7)
  v_mfma_f32_16x16x32_bf16 v[24:27], a[48:51], v[68:71], v[24:27]
  ds_read_b128 v[60:63], v2 offset:30720
  v_mfma_f32_16x16x32_bf16 v[28:31], a[52:55], v[68:71], v[28:31]
  s_waitcnt lgkmcnt(7)
  v_mfma_f32_16x16x32_bf16 v[16:19], a[56:59], v[72:75], v[16:19]
  ds_read_b128 v[64:67], v2 offset:11264
  v_mfma_f32_16x16x32_bf16 v[20:23], a[60:63], v[72:75], v[20:23]
  buffer_load_dwordx4 v1, s[8:11], s3 offen offset:3072 sc1 lds
  s_waitcnt lgkmcnt(7)
  v_mfma_f32_16x16x32_bf16 v[24:27], a[56:59], v[76:79], v[24:27]
  ds_read_b128 v[68:71], v2 offset:31744
  v_mfma_f32_16x16x32_bf16 v[28:31], a[60:63], v[76:79], v[28:31]
  s_waitcnt lgkmcnt(7)
  v_mfma_f32_16x16x32_bf16 v[16:19], a[64:67], v[80:83], v[16:19]
  ds_read_b128 v[72:75], v2 offset:12288
  v_mfma_f32_16x16x32_bf16 v[20:23], a[68:71], v[80:83], v[20:23]
  s_add_u32 m0, s29, 8192
  s_add_u32 s3, s26, 8192
  buffer_load_dwordx4 v1, s[8:11], s3 offen offset:0 sc1 lds
  s_waitcnt lgkmcnt(7)
  v_mfma_f32_16x16x32_bf16 v[24:27], a[64:67], v[84:87], v[24:27]
  ds_read_b128 v[76:79], v2 offset:32768
  v_mfma_f32_16x16x32_bf16 v[28:31], a[68:71], v[84:87], v[28:31]
  s_waitcnt lgkmcnt(7)
  v_mfma_f32_16x16x32_bf16 v[16:19], a[72:75], v[88:91], v[16:19]
  ds_read_b128 v[80:83], v2 offset:13312
  v_mfma_f32_16x16x32_bf16 v[20:23], a[76:79], v[88:91], v[20:23]
  buffer_load_dwordx4 v1, s[8:11], s3 offen offset:1024 sc1 lds
  s_waitcnt lgkmcnt(7)
  v_mfma_f32_16x16x32_bf16 v[24:27], a[72:75], v[92:95], v[24:27]
  ds_read_b128 v[84:87], v2 offset:33792
  v_mfma_f32_16x16x32_bf16 v[28:31], a[76:79], v[92:95], v[28:31]
  s_waitcnt lgkmcnt(7)
  v_mfma_f32_16x16x32_bf16 v[16:19], a[80:83], v[56:59], v[16:19]
  ds_read_b128 v[88:91], v2 offset:14336
  v_mfma_f32_16x16x32_bf16 v[20:23], a[84:87], v[56:59], v[20:23]
  s_waitcnt lgkmcnt(7)
  v_mfma_f32_16x16x32_bf16 v[24:27], a[80:83], v[60:63], v[24:27]
  ds_read_b128 v[92:95], v2 offset:34816
  v_mfma_f32_16x16x32_bf16 v[28:31], a[84:87], v[60:63], v[28:31]
  s_waitcnt lgkmcnt(7)
  v_mfma_f32_16x16x32_bf16 v[16:19], a[88:91], v[64:67], v[16:19]
  ds_read_b128 v[56:59], v2 offset:15360
  v_mfma_f32_16x16x32_bf16 v[20:23], a[92:95], v[64:67], v[20:23]
  s_waitcnt lgkmcnt(7)
  v_mfma_f32_16x16x32_bf16 v[24:27], a[88:91], v[68:71], v[24:27]
  ds_read_b128 v[60:63], v2 offset:35840
  v_mfma_f32_16x16x32_bf16 v[28:31], a[92:95], v[68:71], v[28:31]
  s_waitcnt lgkmcnt(7)
  v_mfma_f32_16x16x32_bf16 v[16:19], a[96:99], v[72:75], v[16:19]
  ds_read_b128 v[64:67], v2 offset:16384
  v_mfma_f32_16x16x32_bf16 v[20:23], a[100:103], v[72:75], v[20:23]
  s_waitcnt lgkmcnt(7)
  v_mfma_f32_16x16x32_bf16 v[24:27], a[96:99], v[76:79], v[24:27]
  ds_read_b128 v[68:71], v2 offset:36864
  v_mfma_f32_16x16x32_bf16 v[28:31], a[100:103], v[76:79], v[28:31]
  s_waitcnt lgkmcnt(7)
  v_mfma_f32_16x16x32_bf16 v[16:19], a[104:107], v[80:83], v[16:19]
  ds_read_b128 v[72:75], v2 offset:17408
  v_mfma_f32_16x16x32_bf16 v[20:23], a[108:111], v[80:83], v[20:23]
  s_waitcnt lgkmcnt(7)
  v_mfma_f32_16x16x32_bf16 v[24:27], a[104:107], v[84:87], v[24:27]
  ds_read_b128 v[76:79], v2 offset:37888
  v_mfma_f32_16x16x32_bf16 v[28:31], a[108:111], v[84:87], v[28:31]
  s_waitcnt lgkmcnt(7)
  v_mfma_f32_16x16x32_bf16 v[16:19], a[112:115], v[88:91], v[16:19]
  ds_read_b128 v[80:83], v2 offset:18432
  v_mfma_f32_16x16x32_bf16 v[20:23], a[116:119], v[88:91], v[20:23]
  s_waitcnt lgkmcnt(7)
  v_mfma_f32_16x16x32_bf16 v[24:27], a[112:115], v[92:95], v[24:27]
  ds_read_b128 v[84:87], v2 offset:38912
  v_mfma_f32_16x16x32_bf16 v[28:31], a[116:119], v[92:95], v[28:31]
  s_waitcnt lgkmcnt(7)
  v_mfma_f32_16x16x32_bf16 v[16:19], a[120:123], v[56:59], v[16:19]
  ds_read_b128 v[88:91], v2 offset:19456
  v_mfma_f32_16x16x32_bf16 v[20:23], a[124:127], v[56:59], v[20:23]
  s_waitcnt lgkmcnt(7)
  v_mfma_f32_16x16x32_bf16 v[24:27], a[120:123], v[60:63], v[24:27]
  ds_read_b128 v[92:95], v2 offset:39936
  v_mfma_f32_16x16x32_bf16 v[28:31], a[124:127], v[60:63], v[28:31]
  s_waitcnt lgkmcnt(7)
  v_mfma_f32_16x16x32_bf16 v[16:19], a[128:131], v[64:67], v[16:19]
  v_mfma_f32_16x16x32_bf16 v[20:23], a[132:135], v[64:67], v[20:23]
  s_waitcnt lgkmcnt(6)
  v_mfma_f32_16x16x32_bf16 v[24:27], a[128:131], v[68:71], v[24:27]
  v_mfma_f32_16x16x32_bf16 v[28:31], a[132:135], v[68:71], v[28:31]
  s_waitcnt lgkmcnt(5)
  v_mfma_f32_16x16x32_bf16 v[16:19], a[136:139], v[72:75], v[16:19]
  v_mfma_f32_16x16x32_bf16 v[20:23], a[140:143], v[72:75], v[20:23]
  s_waitcnt lgkmcnt(4)
  v_mfma_f32_16x16x32_bf16 v[24:27], a[136:139], v[76:79], v[24:27]
  v_mfma_f32_16x16x32_bf16 v[28:31], a[140:143], v[76:79], v[28:31]
  s_waitcnt lgkmcnt(3)
  v_mfma_f32_16x16x32_bf16 v[16:19], a[144:147], v[80:83], v[16:19]
  v_mfma_f32_16x16x32_bf16 v[20:23], a[148:151], v[80:83], v[20:23]
  s_waitcnt lgkmcnt(2)
  v_mfma_f32_16x16x32_bf16 v[24:27], a[144:147], v[84:87], v[24:27]
  v_mfma_f32_16x16x32_bf16 v[28:31], a[148:151], v[84:87], v[28:31]
  s_waitcnt lgkmcnt(1)
  v_mfma_f32_16x16x32_bf16 v[16:19], a[152:155], v[88:91], v[16:19]
  v_mfma_f32_16x16x32_bf16 v[20:23], a[156:159], v[88:91], v[20:23]
  s_waitcnt lgkmcnt(0)
  v_mfma_f32_16x16x32_bf16 v[24:27], a[152:155], v[92:95], v[24:27]
  v_mfma_f32_16x16x32_bf16 v[28:31], a[156:159], v[92:95], v[28:31]
  v_xor_b32 v2, 65536, v2
  v_mul_f32 v16, v16, v20
  v_mul_f32 v17, v17, v21
  v_mul_f32 v18, v18, v22
  v_mul_f32 v19, v19, v23
  v_cvt_pk_bf16_f32 v40, v16, v17
  v_cvt_pk_bf16_f32 v41, v18, v19
  s_nop 0
  v_mul_f32 v24, v24, v28
  v_mul_f32 v25, v25, v29
  v_mul_f32 v26, v26, v30
  v_mul_f32 v27, v27, v31
  v_cvt_pk_bf16_f32 v42, v24, v25
  v_cvt_pk_bf16_f32 v43, v26, v27
  s_nop 0
  v_permlane16_swap_b32 v40, v42
  v_permlane16_swap_b32 v41, v43
  buffer_store_dwordx4 v[40:43], v3, s[8:11], s24 offen offset:0 sc1
  s_add_u32 s24, s24, 98304
  s_add_u32 s25, s24, 6144
  s_add_u32 s27, s27, 1
  s_branch L81_gtop
L83_gdone:
  s_waitcnt vmcnt(0)
  s_branch L_d2
L70_gbail:
  s_endpgm
L_rec:
  s_load_dwordx2 s[8:9], s[0:1], 104
  s_load_dwordx2 s[12:13], s[0:1], 96
  s_load_dwordx2 s[16:17], s[0:1], 16
  s_load_dwordx2 s[20:21], s[0:1], 24
  s_load_dwordx2 s[24:25], s[0:1], 32
  s_load_dwordx2 s[28:29], s[0:1], 40
  s_load_dwordx2 s[32:33], s[0:1], 8
  s_mov_b32 s10, 268435456
  s_mov_b32 s11, 0x20000
  s_mov_b32 s14, 256
  s_mov_b32 s15, 0x20000
  s_mov_b32 s18, 7864320
  s_mov_b32 s19, 0x20000
  s_mov_b32 s22, 7864320
  s_mov_b32 s23, 0x20000
  s_mov_b32 s26, 7864320
  s_mov_b32 s27, 0x20000
  s_mov_b32 s30, 7864320
  s_mov_b32 s31, 0x20000
  s_mov_b32 s34, 10240
  s_mov_b32 s35, 0x20000
  s_waitcnt lgkmcnt(0)
  s_and_b32 s4, s2, 7
  s_lshr_b32 s5, s2, 3
  s_lshr_b32 s6, s5, 1
  s_lshl_b32 s3, s4, 4
  s_add_u32 s6, s6, s3
  s_and_b32 s7, s5, 1
  s_mov_b32 s36, 0
  s_mov_b32 s38, 0
  s_mov_b32 s39, 0x3f80
  s_mov_b32 s40, 0x3f800000
  s_mov_b32 s41, 0x3dd53b95
  s_mov_b32 s42, 0xcccccccc
  s_mov_b32 s43, 0xcccccccc
  s_lshl_b32 s3, s4, 5
  s_add_u32 s3, s3, s5
  s_lshl_b32 s44, s3, 12
  s_add_u32 s44, s44, 3211264
  s_xor_b32 s45, s44, 4096
  s_mul_i32 s47, s3, 10496
  s_add_u32 s47, s47, 4194304
  s_mul_i32 s66, s3, 6144
  s_add_u32 s66, s66, 6291456
  s_lshl_b32 s67, s3, 7
  s_add_u32 s67, s67, 3178496
  s_mul_i32 s49, s4, 335872
  s_add_u32 s49, s49, 4194304
  s_add_u32 s50, s49, 83968
  s_add_u32 s51, s49, 167936
  s_add_u32 s52, s49, 251904
  s_mov_b32 s59, 1
  s_mov_b32 s60, 0
  s_lshl_b32 s3, s4, 15
  s_add_u32 s56, s3, 5570560
  s_mov_b32 s61, 1
  s_mul_i32 s57, s4, 65536
  s_xor_b32 s57, s57, 121634816
  s_xor_b32 s58, s57, 196608
  s_mov_b32 s53, 0
  s_cmp_ge_u32 s5, 8
  s_cselect_b32 s53, 2048, s53
  s_cmp_ge_u32 s5, 16
  s_cselect_b32 s53, 4096, s53
  s_cmp_ge_u32 s5, 24
  s_cselect_b32 s53, 17408, s53
  s_bitcmp1_b32 s5, 0
  s_cselect_b32 s3, 128, 0
  s_add_u32 s53, s53, s3
  s_bitcmp1_b32 s5, 1
  s_cselect_b32 s3, 256, 0
  s_add_u32 s53, s53, s3
  s_bitcmp1_b32 s5, 2
  s_cselect_b32 s3, 512, 0
  s_add_u32 s53, s53, s3
  v_lshrrev_b32 v21, 6, v0
  v_and_b32 v20, 63, v0
  v_readfirstlane_b32 s3, v21
  s_cmp_eq_u32 s3, 1
  s_cbranch_scc1 L86_recw1
  s_cmp_eq_u32 s3, 2
  s_cbranch_scc1 L87_recw2
  s_cmp_eq_u32 s3, 3
  s_cbranch_scc1 L88_recw3
L85_recw0:
  s_mul_i32 s3, s6, 384
  s_mul_i32 s100, s7, 192
  s_add_u32 s3, s3, s100
  v_add_u32 v32, 0, v20
  v_mul_u32_u24 v33, 171, v32
  v_lshrrev_b32 v33, 11, v33
  v_mul_u32_u24 v34, 12, v33
  v_sub_u32 v32, v32, v34
  v_lshl_add_u32 v32, v32, 4, s3
  v_lshrrev_b32 v34, 2, v33
  v_and_b32 v35, 3, v33
  v_lshl_add_u32 v35, v35, 4, v34
  v_mul_u32_u24 v35, 12288, v35
  v_add_u32 v21, v35, v32
  v_and_b32 v35, 1, v33
  v_lshlrev_b32 v35, 4, v35
  v_lshl_add_u32 v35, v34, 1, v35
  v_bfe_u32 v34, v33, 1, 1
  v_add_u32 v35, v35, v34
  v_mul_u32_u24 v35, 12288, v35
  v_add_u32 v24, v35, v32
  v_add_u32 v32, 64, v20
  v_mul_u32_u24 v33, 171, v32
  v_lshrrev_b32 v33, 11, v33
  v_mul_u32_u24 v34, 12, v33
  v_sub_u32 v32, v32, v34
  v_lshl_add_u32 v32, v32, 4, s3
  v_lshrrev_b32 v34, 2, v33
  v_and_b32 v35, 3, v33
  v_lshl_add_u32 v35, v35, 4, v34
  v_mul_u32_u24 v35, 12288, v35
  v_add_u32 v22, v35, v32
  v_and_b32 v35, 1, v33
  v_lshlrev_b32 v35, 4, v35
  v_lshl_add_u32 v35, v34, 1, v35
  v_bfe_u32 v34, v33, 1, 1
  v_add_u32 v35, v35, v34
  v_mul_u32_u24 v35, 12288, v35
  v_add_u32 v25, v35, v32
  v_add_u32 v32, 128, v20
  v_mul_u32_u24 v33, 171, v32
  v_lshrrev_b32 v33, 11, v33
  v_mul_u32_u24 v34, 12, v33
  v_sub_u32 v32, v32, v34
  v_lshl_add_u32 v32, v32, 4, s3
  v_lshrrev_b32 v34, 2, v33
  v_and_b32 v35, 3, v33
  v_lshl_add_u32 v35, v35, 4, v34
  v_mul_u32_u24 v35, 12288, v35
  v_add_u32 v23, v35, v32
  v_and_b32 v35, 1, v33
  v_lshlrev_b32 v35, 4, v35
  v_lshl_add_u32 v35, v34, 1, v35
  v_bfe_u32 v34, v33, 1, 1
  v_add_u32 v35, v35, v34
  v_mul_u32_u24 v35, 12288, v35
  v_add_u32 v26, v35, v32
  s_mov_b32 s3, 0
  s_mov_b32 m0, 122880
  s_nop 0
  buffer_load_dwordx4 v21, s[24:27], s3 offen lds
  s_mov_b32 m0, 123904
  s_nop 0
  buffer_load_dwordx4 v22, s[24:27], s3 offen lds
  s_mov_b32 m0, 124928
  s_nop 0
  buffer_load_dwordx4 v23, s[24:27], s3 offen lds
  s_mov_b32 s3, 786432
  s_mov_b32 m0, 135168
  s_nop 0
  buffer_load_dwordx4 v21, s[24:27], s3 offen lds
  s_mov_b32 m0, 136192
  s_nop 0
  buffer_load_dwordx4 v22, s[24:27], s3 offen lds
  s_mov_b32 m0, 137216
  s_nop 0
  buffer_load_dwordx4 v23, s[24:27], s3 offen lds
  v_and_b32 v40, 15, v20
  v_lshrrev_b32 v41, 4, v20
  v_lshlrev_b32 v0, 4, v20
  v_lshlrev_b32 v1, 2, v20
  v_add_u32 v2, 0, v0
  v_add_u32 v3, 49152, v0
  v_mov_b32 v15, v0
  v_bfe_u32 v42, v40, 2, 1
  v_lshlrev_b32 v42, 8, v42
  v_bfe_u32 v43, v40, 3, 1
  v_lshl_or_b32 v42, v43, 7, v42
  v_and_b32 v43, 3, v40
  v_lshl_or_b32 v42, v43, 5, v42
  v_lshrrev_b32 v43, 2, v40
  v_xor_b32 v43, v43, v41
  v_lshl_or_b32 v4, v43, 3, v42
  v_lshrrev_b32 v42, 1, v41
  v_lshlrev_b32 v42, 9, v42
  v_and_b32 v43, 1, v41
  v_lshl_or_b32 v42, v43, 7, v42
  v_lshrrev_b32 v44, 2, v40
  v_lshl_or_b32 v42, v44, 5, v42
  v_lshlrev_b32 v43, 1, v43
  v_and_b32 v44, 3, v40
  v_xor_b32 v43, v43, v44
  v_lshl_or_b32 v5, v43, 3, v42
  v_xor_b32 v6, 264, v5
  v_mov_b32 v42, 0x44444444
  v_mov_b32 v43, 0xeeeeeeee
  v_cndmask_b32 v13, v42, v43, s[42:43]
  v_mov_b32 v42, 0x7ffff000
  v_and_b32 v43, 1, v41
  v_lshlrev_b32 v43, 6, v43
  v_and_b32 v44, 7, v40
  v_lshl_or_b32 v43, v44, 3, v43
  v_add_u32 v8, 0, v43
  v_cndmask_b32 v7, v0, v42, s[42:43]
  v_lshrrev_b32 v42, 2, v40
  v_lshlrev_b32 v42, 8, v42
  v_lshl_or_b32 v42, v41, 6, v42
  v_and_b32 v43, 3, v40
  v_lshl_or_b32 v42, v43, 4, v42
  v_add_u32 v9, 0, v42
  v_lshrrev_b32 v42, 3, v40
  v_lshlrev_b32 v42, 8, v42
  v_lshl_or_b32 v42, v41, 6, v42
  v_and_b32 v43, 7, v40
  v_lshl_or_b32 v42, v43, 3, v42
  v_add_u32 v10, 2048, v42
  s_lshr_b32 s3, s5, 3
  s_mul_i32 s3, s3, 160
  s_and_b32 s100, s5, 7
  s_lshl_b32 s100, s100, 4
  s_add_u32 s3, s3, s100
  s_add_u32 s3, s3, 0
  v_and_b32 v43, 7, v40
  v_add_u32 v45, s3, v43
  v_lshrrev_b32 v42, 3, v40
  v_lshl_add_u32 v42, v41, 1, v42
  v_mul_u32_u24 v42, 10496, v42
  v_lshl_add_u32 v11, v45, 4, v42
  v_mov_b32 v46, 0x7ffff000
  v_lshrrev_b32 v42, 1, v45
  v_lshlrev_b32 v42, 5, v42
  v_lshl_or_b32 v42, v41, 4, v42
  v_and_b32 v43, 1, v45
  v_lshl_or_b32 v42, v43, 3, v42
  v_add_u32 v43, 12288, v42
  v_cmp_gt_u32 vcc, 4096, v42
  s_nop 1
  v_cndmask_b32 v42, v43, v42, vcc
  v_cmp_gt_u32 vcc, 8, v40
  s_nop 1
  v_cndmask_b32 v42, v46, v42, vcc
  v_cmp_gt_u32 vcc, 2, v41
  s_nop 1
  v_cndmask_b32 v12, v46, v42, vcc
  v_bfe_u32 v42, v40, 1, 1
  v_bfe_u32 v43, v40, 2, 1
  v_lshl_or_b32 v42, v42, 1, v43
  v_and_b32 v43, 1, v40
  v_lshlrev_b32 v43, 4, v43
  v_lshlrev_b32 v43, v43, s39
  v_cmp_eq_u32 vcc, 0, v42
  s_nop 1
  v_cndmask_b32 v16, 0, v43, vcc
  v_cmp_eq_u32 vcc, 1, v42
  s_nop 1
  v_cndmask_b32 v17, 0, v43, vcc
  v_cmp_eq_u32 vcc, 2, v42
  s_nop 1
  v_cndmask_b32 v18, 0, v43, vcc
  v_cmp_eq_u32 vcc, 3, v42
  s_nop 1
  v_cndmask_b32 v19, 0, v43, vcc
  v_lshrrev_b32 v42, 1, v45
  v_lshlrev_b32 v42, 5, v42
  v_and_b32 v43, 1, v41
  v_lshl_or_b32 v42, v43, 4, v42
  v_and_b32 v43, 1, v45
  v_lshl_or_b32 v42, v43, 3, v42
  v_and_b32 v57, 127, v42
  v_bfe_i32 v43, v42, 7, 1
  v_and_b32 v43, 128, v43
  v_add_u32 v57, v57, v43
  v_bfe_i32 v43, v42, 8, 1
  v_and_b32 v43, 256, v43
  v_add_u32 v57, v57, v43
  v_bfe_i32 v43, v42, 9, 1
  v_and_b32 v43, 512, v43
  v_add_u32 v57, v57, v43
  v_lshrrev_b32 v42, 10, v42
  v_lshl_add_u32 v57, v42, 10, v57
  v_add_u32 v43, 0, v57
  v_cmp_lt_u32 vcc, 1, v42
  s_nop 1
  v_cndmask_b32 v57, v57, v43, vcc
  v_add_u32 v43, 0, v57
  v_cmp_lt_u32 vcc, 3, v42
  s_nop 1
  v_cndmask_b32 v57, v57, v43, vcc
  v_add_u32 v43, 10240, v57
  v_cmp_lt_u32 vcc, 6, v42
  s_nop 1
  v_cndmask_b32 v57, v57, v43, vcc
  v_and_b32 v42, 7, v20
  v_lshlrev_b32 v42, 4, v42
  v_add_u32 v8, 0, v42
  v_bfe_i32 v43, v20, 3, 1
  v_and_b32 v43, 128, v43
  v_add_u32 v8, v8, v43
  v_bfe_i32 v43, v20, 4, 1
  v_and_b32 v43, 256, v43
  v_add_u32 v8, v8, v43
  v_bfe_i32 v43, v20, 5, 1
  v_and_b32 v43, 512, v43
  v_add_u32 v8, v8, v43
  s_lshr_b32 s3, s5, 3
  s_mul_i32 s3, s3, 160
  s_and_b32 s100, s5, 7
  s_lshl_b32 s100, s100, 4
  s_add_u32 s3, s3, s100
  s_add_u32 s3, s3, 0
  v_and_b32 v40, 7, v20
  v_add_u32 v40, s3, v40
  v_lshrrev_b32 v41, 4, v40
  v_and_b32 v48, 3, v40
  v_lshl_or_b32 v41, v41, 2, v48
  v_mul_u32_u24 v42, 205, v41
  v_lshrrev_b32 v42, 13, v42
  v_mul_u32_u24 v43, 40, v42
  v_sub_u32 v43, v41, v43
  v_lshrrev_b32 v44, 4, v43
  v_lshlrev_b32 v44, 6, v44
  v_and_b32 v48, 15, v43
  v_add_u32 v44, v44, v48
  v_add_u32 v48, v44, v48
  v_cmp_gt_u32 vcc, 32, v43
  s_nop 1
  v_cndmask_b32 v44, v48, v44, vcc
  v_cndmask_b32 v47, 2, 64, vcc
  v_mul_u32_u24 v42, 160, v42
  v_add_u32 v44, v44, v42
  v_bfe_u32 v45, v40, 2, 2
  v_bfe_u32 v48, v20, 4, 1
  v_lshl_or_b32 v45, v45, 1, v48
  v_mul_u32_u24 v45, 1280, v45
  v_lshl_add_u32 v46, v44, 1, v45
  v_add_u32 v47, v47, v46
  buffer_load_ushort v52, v46, s[32:35], 0 offen
  buffer_load_ushort v54, v46, s[32:35], 0 offen offset:32
  buffer_load_ushort v53, v47, s[32:35], 0 offen
  buffer_load_ushort v55, v47, s[32:35], 0 offen offset:32
  v_mov_b32 v132, 0
  v_mov_b32 v133, 0
  v_mov_b32 v134, 0
  v_mov_b32 v135, 0
  buffer_store_dwordx4 v[132:135], v9, s[8:11], s47 offen sc1
  buffer_store_dwordx4 v[132:135], v9, s[8:11], s47 offen offset:1024 sc1
  buffer_store_dwordx2 v[132:133], v10, s[8:11], s47 offen sc1
  buffer_store_dwordx4 v[132:135], v7, s[8:11], s44 offen sc1
  v_bfe_u32 v7, v1, 5, 1
  v_lshl_add_u32 v7, v7, 30, v57
  v_bfe_u32 v112, v1, 7, 1
  v_lshl_add_u32 v7, v112, 29, v7
  s_xor_b32 s3, s57, 0
  buffer_store_dwordx2 v[132:133], v7, s[8:11], s3 offen sc1
  s_xor_b32 s3, s57, 8192
  buffer_store_dwordx2 v[132:133], v7, s[8:11], s3 offen sc1
  s_xor_b32 s3, s57, 131072
  buffer_store_dwordx2 v[132:133], v7, s[8:11], s3 offen sc1
  s_xor_b32 s3, s57, 139264
  buffer_store_dwordx2 v[132:133], v7, s[8:11], s3 offen sc1
  s_xor_b32 s3, s56, 65536
  buffer_store_dwordx2 v[132:133], v12, s[8:11], s3 offen sc1
  s_mov_b32 s3, 1572864
  s_mov_b32 m0, 24576
  s_nop 0
  buffer_load_dwordx4 v24, s[24:27], s3 offen lds
  s_mov_b32 m0, 25600
  s_nop 0
  buffer_load_dwordx4 v25, s[24:27], s3 offen lds
  s_mov_b32 m0, 26624
  s_nop 0
  buffer_load_dwordx4 v26, s[24:27], s3 offen lds
  s_mov_b32 s3, 2064384
  s_mov_b32 m0, 36864
  s_nop 0
  buffer_load_dwordx4 v21, s[24:27], s3 offen lds
  s_mov_b32 m0, 37888
  s_nop 0
  buffer_load_dwordx4 v22, s[24:27], s3 offen lds
  s_mov_b32 m0, 38912
  s_nop 0
  buffer_load_dwordx4 v23, s[24:27], s3 offen lds
  v_bfe_u32 v32, v20, 5, 1
  v_lshlrev_b32 v32, 4, v32
  v_bfe_u32 v33, v20, 3, 1
  v_lshl_or_b32 v32, v33, 3, v32
  v_bfe_u32 v33, v20, 4, 1
  v_lshl_or_b32 v32, v33, 2, v32
  v_bfe_u32 v33, v20, 2, 1
  v_or_b32 v32, v32, v33
  v_mul_u32_u24 v32, 192, v32
  v_and_b32 v34, 3, v20
  v_lshl_add_u32 v27, v34, 3, v32
  v_add_u32 v28, 49152, v27
  v_add_u32 v29, 98304, v27
  v_bfe_u32 v32, v20, 4, 1
  v_lshlrev_b32 v32, 3, v32
  v_bfe_u32 v35, v20, 5, 1
  v_lshl_or_b32 v32, v35, 2, v32
  v_or_b32 v32, v32, v33
  v_mul_u32_u24 v32, 1280, v32
  v_bfe_u32 v33, v20, 3, 1
  v_lshl_add_u32 v32, v33, 5, v32
  v_lshl_add_u32 v30, v34, 3, v32
  v_add_u32 v31, 49152, v30
  v_add_u32 v14, 98304, v30
  s_mul_i32 s101, s6, 245760
  s_mul_i32 s100, s7, 122880
  s_add_u32 s101, s101, s100
  s_mul_i32 s65, s6, 12288
  s_mul_i32 s3, s7, 3072
  s_add_u32 s65, s65, s3
  s_add_u32 s65, s65, 33554432
  s_lshl_b32 s68, s6, 7
  s_add_u32 s68, s68, 3145728
  s_mov_b32 s69, 40960
  s_mov_b32 s62, 1
  s_waitcnt vmcnt(6)
  v_and_b32 v52, 0xfffe, v52
  v_and_b32 v53, 0xfffe, v53
  v_lshl_or_b32 v52, v54, 16, v52
  v_lshl_or_b32 v53, v55, 16, v53
  buffer_store_dwordx2 v[52:53], v12, s[8:11], s56 offen sc1
  s_mov_b32 s3, 2850816
  s_mov_b32 m0, 0
  s_nop 0
  buffer_load_dwordx4 v21, s[24:27], s3 offen lds
  s_mov_b32 m0, 1024
  s_nop 0
  buffer_load_dwordx4 v22, s[24:27], s3 offen lds
  s_mov_b32 m0, 2048
  s_nop 0
  buffer_load_dwordx4 v23, s[24:27], s3 offen lds
  s_mov_b32 s3, 3932160
  s_mov_b32 m0, 12288
  s_nop 0
  buffer_load_dwordx4 v21, s[24:27], s3 offen lds
  s_mov_b32 m0, 13312
  s_nop 0
  buffer_load_dwordx4 v22, s[24:27], s3 offen lds
  s_mov_b32 m0, 14336
  s_nop 0
  buffer_load_dwordx4 v23, s[24:27], s3 offen lds
  s_mov_b32 s3, 4718592
  s_mov_b32 m0, 49152
  s_nop 0
  buffer_load_dwordx4 v21, s[24:27], s3 offen lds
  s_mov_b32 m0, 50176
  s_nop 0
  buffer_load_dwordx4 v22, s[24:27], s3 offen lds
  s_mov_b32 m0, 51200
  s_nop 0
  buffer_load_dwordx4 v23, s[24:27], s3 offen lds
  s_mov_b32 s3, 5505024
  s_mov_b32 m0, 61440
  s_nop 0
  buffer_load_dwordx4 v24, s[24:27], s3 offen lds
  s_mov_b32 m0, 62464
  s_nop 0
  buffer_load_dwordx4 v25, s[24:27], s3 offen lds
  s_mov_b32 m0, 63488
  s_nop 0
  buffer_load_dwordx4 v26, s[24:27], s3 offen lds
  s_mov_b32 s3, 5996544
  s_mov_b32 m0, 73728
  s_nop 0
  buffer_load_dwordx4 v21, s[24:27], s3 offen lds
  s_mov_b32 m0, 74752
  s_nop 0
  buffer_load_dwordx4 v22, s[24:27], s3 offen lds
  s_mov_b32 m0, 75776
  s_nop 0
  buffer_load_dwordx4 v23, s[24:27], s3 offen lds
  s_mov_b32 s3, 6782976
  s_mov_b32 m0, 86016
  s_nop 0
  buffer_load_dwordx4 v21, s[24:27], s3 offen lds
  s_mov_b32 m0, 87040
  s_nop 0
  buffer_load_dwordx4 v22, s[24:27], s3 offen lds
  s_mov_b32 m0, 88064
  s_nop 0
  buffer_load_dwordx4 v23, s[24:27], s3 offen lds
  s_waitcnt vmcnt(24)
  s_waitcnt lgkmcnt(0)
  s_barrier
  s_mov_b32 s3, 0
  s_mov_b32 m0, 98304
  s_nop 0
  buffer_load_dwordx4 v21, s[16:19], s3 offen lds
  s_mov_b32 m0, 99328
  s_nop 0
  buffer_load_dwordx4 v22, s[16:19], s3 offen lds
  s_mov_b32 m0, 100352
  s_nop 0
  buffer_load_dwordx4 v23, s[16:19], s3 offen lds
  s_mov_b32 s3, 0
  s_mov_b32 m0, 110592
  s_nop 0
  buffer_load_dwordx4 v21, s[20:23], s3 offen lds
  s_mov_b32 m0, 111616
  s_nop 0
  buffer_load_dwordx4 v22, s[20:23], s3 offen lds
  s_mov_b32 m0, 112640
  s_nop 0
  buffer_load_dwordx4 v23, s[20:23], s3 offen lds
  ds_read_b64_tr_b16 v[96:97], v29 offset:36864
  ds_read_b64_tr_b16 v[98:99], v29 offset:37248
  ds_read_b64_tr_b16 v[100:101], v29 offset:43008
  ds_read_b64_tr_b16 v[102:103], v29 offset:43392
  ds_read_b64_tr_b16 a[8:9], v29 offset:24576
  ds_read_b64_tr_b16 a[10:11], v29 offset:24960
  ds_read_b64_tr_b16 a[12:13], v29 offset:30720
  ds_read_b64_tr_b16 a[14:15], v29 offset:31104
  ds_read_b64_tr_b16 a[240:241], v29 offset:24704
  ds_read_b64_tr_b16 a[242:243], v29 offset:25088
  ds_read_b64_tr_b16 a[244:245], v29 offset:30848
  ds_read_b64_tr_b16 a[246:247], v29 offset:31232
  ds_read_b64_tr_b16 a[248:249], v29 offset:36992
  ds_read_b64_tr_b16 a[250:251], v29 offset:37376
  ds_read_b64_tr_b16 a[252:253], v29 offset:43136
  ds_read_b64_tr_b16 a[254:255], v29 offset:43520
  s_waitcnt vmcnt(24)
  s_waitcnt lgkmcnt(0)
  s_barrier
  s_add_u32 s3, s101, 0
  s_mov_b32 m0, 122880
  s_nop 0
  buffer_load_dwordx4 v0, s[28:31], s3 offen lds
  s_add_u32 s3, s101, 1024
  s_mov_b32 m0, 123904
  s_nop 0
  buffer_load_dwordx4 v0, s[28:31], s3 offen lds
  s_add_u32 s3, s101, 2048
  s_mov_b32 m0, 124928
  s_nop 0
  buffer_load_dwordx4 v0, s[28:31], s3 offen lds
  s_add_u32 s3, s101, 3072
  s_mov_b32 m0, 125952
  s_nop 0
  buffer_load_dwordx4 v0, s[28:31], s3 offen lds
  s_add_u32 s3, s101, 4096
  s_mov_b32 m0, 126976
  s_nop 0
  buffer_load_dwordx4 v0, s[28:31], s3 offen lds
  ds_read_b64_tr_b16 v[104:105], v27 offset:24576
  ds_read_b64_tr_b16 v[106:107], v27 offset:24960
  ds_read_b64_tr_b16 v[108:109], v27 offset:30720
  ds_read_b64_tr_b16 v[110:111], v27 offset:31104
  ds_read_b64_tr_b16 a[184:185], v27 offset:36864
  ds_read_b64_tr_b16 a[186:187], v27 offset:37248
  ds_read_b64_tr_b16 a[188:189], v27 offset:43008
  ds_read_b64_tr_b16 a[190:191], v27 offset:43392
  s_waitcnt vmcnt(23)
  s_waitcnt lgkmcnt(0)
  s_barrier
  s_lshr_b32 s3, s2, 3
  s_lshl_b32 s3, 1, s3
  v_mov_b32 v252, s3
  v_mov_b32 v253, 256
  s_and_b32 s3, s2, 7
  s_lshl_b32 s3, s3, 3
  s_add_u32 s3, s3, s97
  s_mov_b64 exec, 1
  buffer_atomic_add_x2 v[252:253], off, s[12:15], s3 sc1
  s_mov_b64 exec, -1
  s_mov_b32 s3, 786432
  s_mov_b32 m0, 24576
  s_nop 0
  buffer_load_dwordx4 v21, s[16:19], s3 offen lds
  s_mov_b32 m0, 25600
  s_nop 0
  buffer_load_dwordx4 v22, s[16:19], s3 offen lds
  s_mov_b32 m0, 26624
  s_nop 0
  buffer_load_dwordx4 v23, s[16:19], s3 offen lds
  s_mov_b32 s3, 786432
  s_mov_b32 m0, 36864
  s_nop 0
  buffer_load_dwordx4 v21, s[20:23], s3 offen lds
  s_mov_b32 m0, 37888
  s_nop 0
  buffer_load_dwordx4 v22, s[20:23], s3 offen lds
  s_mov_b32 m0, 38912
  s_nop 0
  buffer_load_dwordx4 v23, s[20:23], s3 offen lds
  ds_read_b64_tr_b16 v[112:113], v27 offset:128
  ds_read_b64_tr_b16 v[114:115], v27 offset:512
  ds_read_b64_tr_b16 v[116:117], v27 offset:6272
  ds_read_b64_tr_b16 v[118:119], v27 offset:6656
  ds_read_b64_tr_b16 v[120:121], v27 offset:12416
  ds_read_b64_tr_b16 v[122:123], v27 offset:12800
  ds_read_b64_tr_b16 v[124:125], v27 offset:18560
  ds_read_b64_tr_b16 v[126:127], v27 offset:18944
  ds_read_b64_tr_b16 a[192:193], v27 offset:0
  ds_read_b64_tr_b16 a[194:195], v27 offset:384
  ds_read_b64_tr_b16 a[196:197], v27 offset:6144
  ds_read_b64_tr_b16 a[198:199], v27 offset:6528
  ds_read_b64_tr_b16 a[200:201], v27 offset:12288
  ds_read_b64_tr_b16 a[202:203], v27 offset:12672
  ds_read_b64_tr_b16 a[204:205], v27 offset:18432
  ds_read_b64_tr_b16 a[206:207], v27 offset:18816
  s_waitcnt vmcnt(23)
  s_waitcnt lgkmcnt(0)
  s_barrier
  s_mov_b32 s3, 1572864
  s_mov_b32 m0, 0
  s_nop 0
  buffer_load_dwordx4 v24, s[16:19], s3 offen lds
  s_mov_b32 m0, 1024
  s_nop 0
  buffer_load_dwordx4 v25, s[16:19], s3 offen lds
  s_mov_b32 m0, 2048
  s_nop 0
  buffer_load_dwordx4 v26, s[16:19], s3 offen lds
  s_mov_b32 s3, 1572864
  s_mov_b32 m0, 12288
  s_nop 0
  buffer_load_dwordx4 v24, s[20:23], s3 offen lds
  s_mov_b32 m0, 13312
  s_nop 0
  buffer_load_dwordx4 v25, s[20:23], s3 offen lds
  s_mov_b32 m0, 14336
  s_nop 0
  buffer_load_dwordx4 v26, s[20:23], s3 offen lds
  ds_read_b64_tr_b16 v[128:129], v28 offset:128
  ds_read_b64_tr_b16 v[130:131], v28 offset:512
  ds_read_b64_tr_b16 v[132:133], v28 offset:6272
  ds_read_b64_tr_b16 v[134:135], v28 offset:6656
  ds_read_b64_tr_b16 a[208:209], v28 offset:0
  ds_read_b64_tr_b16 a[210:211], v28 offset:384
  ds_read_b64_tr_b16 a[212:213], v28 offset:6144
  ds_read_b64_tr_b16 a[214:215], v28 offset:6528
  ds_read_b64_tr_b16 a[216:217], v28 offset:12288
  ds_read_b64_tr_b16 a[218:219], v28 offset:12672
  ds_read_b64_tr_b16 a[220:221], v28 offset:18432
  ds_read_b64_tr_b16 a[222:223], v28 offset:18816
  s_waitcnt vmcnt(23)
  s_waitcnt lgkmcnt(0)
  s_barrier
  s_add_u32 s3, s101, 10240
  s_mov_b32 m0, 49152
  s_nop 0
  buffer_load_dwordx4 v0, s[28:31], s3 offen lds
  s_add_u32 s3, s101, 11264
  s_mov_b32 m0, 50176
  s_nop 0
  buffer_load_dwordx4 v0, s[28:31], s3 offen lds
  s_add_u32 s3, s101, 12288
  s_mov_b32 m0, 51200
  s_nop 0
  buffer_load_dwordx4 v0, s[28:31], s3 offen lds
  s_add_u32 s3, s101, 13312
  s_mov_b32 m0, 52224
  s_nop 0
  buffer_load_dwordx4 v0, s[28:31], s3 offen lds
  s_add_u32 s3, s101, 14336
  s_mov_b32 m0, 53248
  s_nop 0
  buffer_load_dwordx4 v0, s[28:31], s3 offen lds
  ds_read_b64_tr_b16 a[224:225], v28 offset:24576
  ds_read_b64_tr_b16 a[226:227], v28 offset:24960
  ds_read_b64_tr_b16 a[228:229], v28 offset:30720
  ds_read_b64_tr_b16 a[230:231], v28 offset:31104
  ds_read_b64_tr_b16 a[232:233], v28 offset:36864
  ds_read_b64_tr_b16 a[234:235], v28 offset:37248
  ds_read_b64_tr_b16 a[236:237], v28 offset:43008
  ds_read_b64_tr_b16 a[238:239], v28 offset:43392
  s_waitcnt vmcnt(22)
  s_waitcnt lgkmcnt(0)
  s_barrier
  s_mov_b32 s3, 2064384
  s_mov_b32 m0, 73728
  s_nop 0
  buffer_load_dwordx4 v21, s[16:19], s3 offen lds
  s_mov_b32 m0, 74752
  s_nop 0
  buffer_load_dwordx4 v22, s[16:19], s3 offen lds
  s_mov_b32 m0, 75776
  s_nop 0
  buffer_load_dwordx4 v23, s[16:19], s3 offen lds
  s_mov_b32 s3, 2064384
  s_mov_b32 m0, 86016
  s_nop 0
  buffer_load_dwordx4 v21, s[20:23], s3 offen lds
  s_mov_b32 m0, 87040
  s_nop 0
  buffer_load_dwordx4 v22, s[20:23], s3 offen lds
  s_mov_b32 m0, 88064
  s_nop 0
  buffer_load_dwordx4 v23, s[20:23], s3 offen lds
  ds_read_b64_tr_b16 v[32:33], v29 offset:0
  ds_read_b64_tr_b16 v[34:35], v29 offset:384
  ds_read_b64_tr_b16 v[36:37], v29 offset:6144
  ds_read_b64_tr_b16 v[38:39], v29 offset:6528
  ds_read_b64_tr_b16 v[40:41], v29 offset:32
  ds_read_b64_tr_b16 v[42:43], v29 offset:416
  ds_read_b64_tr_b16 v[44:45], v29 offset:6176
  ds_read_b64_tr_b16 v[46:47], v29 offset:6560
  ds_read_b64_tr_b16 v[48:49], v29 offset:64
  ds_read_b64_tr_b16 v[50:51], v29 offset:448
  ds_read_b64_tr_b16 v[52:53], v29 offset:6208
  ds_read_b64_tr_b16 v[54:55], v29 offset:6592
  s_waitcnt vmcnt(23)
  s_waitcnt lgkmcnt(0)
  s_barrier
  s_mov_b32 s3, 2850816
  s_mov_b32 m0, 98304
  s_nop 0
  buffer_load_dwordx4 v21, s[16:19], s3 offen lds
  s_mov_b32 m0, 99328
  s_nop 0
  buffer_load_dwordx4 v22, s[16:19], s3 offen lds
  s_mov_b32 m0, 100352
  s_nop 0
  buffer_load_dwordx4 v23, s[16:19], s3 offen lds
  s_mov_b32 s3, 2850816
  s_mov_b32 m0, 110592
  s_nop 0
  buffer_load_dwordx4 v21, s[20:23], s3 offen lds
  s_mov_b32 m0, 111616
  s_nop 0
  buffer_load_dwordx4 v22, s[20:23], s3 offen lds
  s_mov_b32 m0, 112640
  s_nop 0
  buffer_load_dwordx4 v23, s[20:23], s3 offen lds
  ds_read_b64_tr_b16 v[136:137], v14 offset:24576
  ds_read_b64_tr_b16 v[138:139], v14 offset:27136
  ds_read_b64_tr_b16 v[144:145], v14 offset:24640
  ds_read_b64_tr_b16 v[146:147], v14 offset:27200
  ds_read_b64_tr_b16 v[152:153], v14 offset:24704
  ds_read_b64_tr_b16 v[154:155], v14 offset:27264
  ds_read_b64_tr_b16 v[160:161], v14 offset:24768
  ds_read_b64_tr_b16 v[162:163], v14 offset:27328
  ds_read_b64_tr_b16 v[168:169], v14 offset:24832
  ds_read_b64_tr_b16 v[170:171], v14 offset:27392
  s_waitcnt vmcnt(23)
  s_waitcnt lgkmcnt(0)
  s_barrier
  s_add_u32 s3, s101, 40960
  s_mov_b32 m0, 122880
  s_nop 0
  buffer_load_dwordx4 v0, s[28:31], s3 offen lds
  s_add_u32 s3, s101, 41984
  s_mov_b32 m0, 123904
  s_nop 0
  buffer_load_dwordx4 v0, s[28:31], s3 offen lds
  s_add_u32 s3, s101, 43008
  s_mov_b32 m0, 124928
  s_nop 0
  buffer_load_dwordx4 v0, s[28:31], s3 offen lds
  s_add_u32 s3, s101, 44032
  s_mov_b32 m0, 125952
  s_nop 0
  buffer_load_dwordx4 v0, s[28:31], s3 offen lds
  s_add_u32 s3, s101, 45056
  s_mov_b32 m0, 126976
  s_nop 0
  buffer_load_dwordx4 v0, s[28:31], s3 offen lds
  ds_read_b64_tr_b16 v[56:57], v27 offset:24576
  ds_read_b64_tr_b16 v[58:59], v27 offset:24960
  ds_read_b64_tr_b16 v[60:61], v27 offset:30720
  ds_read_b64_tr_b16 v[62:63], v27 offset:31104
  ds_read_b64_tr_b16 v[64:65], v27 offset:24608
  ds_read_b64_tr_b16 v[66:67], v27 offset:24992
  ds_read_b64_tr_b16 v[68:69], v27 offset:30752
  ds_read_b64_tr_b16 v[70:71], v27 offset:31136
  ds_read_b64_tr_b16 a[0:1], v27 offset:24640
  ds_read_b64_tr_b16 a[2:3], v27 offset:25024
  ds_read_b64_tr_b16 a[4:5], v27 offset:30784
  ds_read_b64_tr_b16 a[6:7], v27 offset:31168
  s_waitcnt vmcnt(22)
  s_waitcnt lgkmcnt(0)
  s_barrier
  s_mov_b32 s3, 3932160
  s_mov_b32 m0, 24576
  s_nop 0
  buffer_load_dwordx4 v21, s[16:19], s3 offen lds
  s_mov_b32 m0, 25600
  s_nop 0
  buffer_load_dwordx4 v22, s[16:19], s3 offen lds
  s_mov_b32 m0, 26624
  s_nop 0
  buffer_load_dwordx4 v23, s[16:19], s3 offen lds
  s_mov_b32 s3, 3932160
  s_mov_b32 m0, 36864
  s_nop 0
  buffer_load_dwordx4 v21, s[20:23], s3 offen lds
  s_mov_b32 m0, 37888
  s_nop 0
  buffer_load_dwordx4 v22, s[20:23], s3 offen lds
  s_mov_b32 m0, 38912
  s_nop 0
  buffer_load_dwordx4 v23, s[20:23], s3 offen lds
  ds_read_b64_tr_b16 a[16:17], v27 offset:0
  ds_read_b64_tr_b16 a[18:19], v27 offset:384
  ds_read_b64_tr_b16 a[20:21], v27 offset:6144
  ds_read_b64_tr_b16 a[22:23], v27 offset:6528
  ds_read_b64_tr_b16 a[24:25], v27 offset:32
  ds_read_b64_tr_b16 a[26:27], v27 offset:416
  ds_read_b64_tr_b16 a[28:29], v27 offset:6176
  ds_read_b64_tr_b16 a[30:31], v27 offset:6560
  ds_read_b64_tr_b16 a[32:33], v27 offset:64
  ds_read_b64_tr_b16 a[34:35], v27 offset:448
  ds_read_b64_tr_b16 a[36:37], v27 offset:6208
  ds_read_b64_tr_b16 a[38:39], v27 offset:6592
  s_waitcnt vmcnt(23)
  s_waitcnt lgkmcnt(0)
  s_barrier
  s_mov_b32 s3, 4718592
  s_mov_b32 m0, 0
  s_nop 0
  buffer_load_dwordx4 v21, s[16:19], s3 offen lds
  s_mov_b32 m0, 1024
  s_nop 0
  buffer_load_dwordx4 v22, s[16:19], s3 offen lds
  s_mov_b32 m0, 2048
  s_nop 0
  buffer_load_dwordx4 v23, s[16:19], s3 offen lds
  s_mov_b32 s3, 4718592
  s_mov_b32 m0, 12288
  s_nop 0
  buffer_load_dwordx4 v21, s[20:23], s3 offen lds
  s_mov_b32 m0, 13312
  s_nop 0
  buffer_load_dwordx4 v22, s[20:23], s3 offen lds
  s_mov_b32 m0, 14336
  s_nop 0
  buffer_load_dwordx4 v23, s[20:23], s3 offen lds
  ds_read_b64_tr_b16 v[140:141], v31 offset:0
  ds_read_b64_tr_b16 v[142:143], v31 offset:2560
  ds_read_b64_tr_b16 v[148:149], v31 offset:64
  ds_read_b64_tr_b16 v[150:151], v31 offset:2624
  ds_read_b64_tr_b16 v[156:157], v31 offset:128
  ds_read_b64_tr_b16 v[158:159], v31 offset:2688
  ds_read_b64_tr_b16 v[164:165], v31 offset:192
  ds_read_b64_tr_b16 v[166:167], v31 offset:2752
  ds_read_b64_tr_b16 v[172:173], v31 offset:256
  ds_read_b64_tr_b16 v[174:175], v31 offset:2816
  s_waitcnt vmcnt(23)
  s_waitcnt lgkmcnt(0)
  s_barrier
  s_add_u32 s3, s101, 51200
  s_mov_b32 m0, 49152
  s_nop 0
  buffer_load_dwordx4 v0, s[28:31], s3 offen lds
  s_add_u32 s3, s101, 52224
  s_mov_b32 m0, 50176
  s_nop 0
  buffer_load_dwordx4 v0, s[28:31], s3 offen lds
  s_add_u32 s3, s101, 53248
  s_mov_b32 m0, 51200
  s_nop 0
  buffer_load_dwordx4 v0, s[28:31], s3 offen lds
  s_add_u32 s3, s101, 54272
  s_mov_b32 m0, 52224
  s_nop 0
  buffer_load_dwordx4 v0, s[28:31], s3 offen lds
  s_add_u32 s3, s101, 55296
  s_mov_b32 m0, 53248
  s_nop 0
  buffer_load_dwordx4 v0, s[28:31], s3 offen lds
  ds_read_b64_tr_b16 a[40:41], v28 offset:24576
  ds_read_b64_tr_b16 a[42:43], v28 offset:24960
  ds_read_b64_tr_b16 a[44:45], v28 offset:30720
  ds_read_b64_tr_b16 a[46:47], v28 offset:31104
  ds_read_b64_tr_b16 a[48:49], v28 offset:24608
  ds_read_b64_tr_b16 a[50:51], v28 offset:24992
  ds_read_b64_tr_b16 a[52:53], v28 offset:30752
  ds_read_b64_tr_b16 a[54:55], v28 offset:31136
  ds_read_b64_tr_b16 a[56:57], v28 offset:24640
  ds_read_b64_tr_b16 a[58:59], v28 offset:25024
  ds_read_b64_tr_b16 a[60:61], v28 offset:30784
  ds_read_b64_tr_b16 a[62:63], v28 offset:31168
  s_waitcnt vmcnt(22)
  s_waitcnt lgkmcnt(0)
  s_barrier
  s_mov_b32 s3, 5505024
  s_mov_b32 m0, 73728
  s_nop 0
  buffer_load_dwordx4 v24, s[16:19], s3 offen lds
  s_mov_b32 m0, 74752
  s_nop 0
  buffer_load_dwordx4 v25, s[16:19], s3 offen lds
  s_mov_b32 m0, 75776
  s_nop 0
  buffer_load_dwordx4 v26, s[16:19], s3 offen lds
  s_mov_b32 s3, 5505024
  s_mov_b32 m0, 86016
  s_nop 0
  buffer_load_dwordx4 v24, s[20:23], s3 offen lds
  s_mov_b32 m0, 87040
  s_nop 0
  buffer_load_dwordx4 v25, s[20:23], s3 offen lds
  s_mov_b32 m0, 88064
  s_nop 0
  buffer_load_dwordx4 v26, s[20:23], s3 offen lds
  ds_read_b64_tr_b16 a[64:65], v29 offset:0
  ds_read_b64_tr_b16 a[66:67], v29 offset:384
  ds_read_b64_tr_b16 a[68:69], v29 offset:6144
  ds_read_b64_tr_b16 a[70:71], v29 offset:6528
  ds_read_b64_tr_b16 a[72:73], v29 offset:32
  ds_read_b64_tr_b16 a[74:75], v29 offset:416
  ds_read_b64_tr_b16 a[76:77], v29 offset:6176
  ds_read_b64_tr_b16 a[78:79], v29 offset:6560
  ds_read_b64_tr_b16 a[80:81], v29 offset:64
  ds_read_b64_tr_b16 a[82:83], v29 offset:448
  ds_read_b64_tr_b16 a[84:85], v29 offset:6208
  ds_read_b64_tr_b16 a[86:87], v29 offset:6592
  s_waitcnt vmcnt(23)
  s_waitcnt lgkmcnt(0)
  s_barrier
  s_mov_b32 s3, 5996544
  s_mov_b32 m0, 98304
  s_nop 0
  buffer_load_dwordx4 v21, s[16:19], s3 offen lds
  s_mov_b32 m0, 99328
  s_nop 0
  buffer_load_dwordx4 v22, s[16:19], s3 offen lds
  s_mov_b32 m0, 100352
  s_nop 0
  buffer_load_dwordx4 v23, s[16:19], s3 offen lds
  s_mov_b32 s3, 5996544
  s_mov_b32 m0, 110592
  s_nop 0
  buffer_load_dwordx4 v21, s[20:23], s3 offen lds
  s_mov_b32 m0, 111616
  s_nop 0
  buffer_load_dwordx4 v22, s[20:23], s3 offen lds
  s_mov_b32 m0, 112640
  s_nop 0
  buffer_load_dwordx4 v23, s[20:23], s3 offen lds
  ds_read_b64_tr_b16 v[176:177], v14 offset:24576
  ds_read_b64_tr_b16 v[178:179], v14 offset:27136
  ds_read_b64_tr_b16 v[184:185], v14 offset:24640
  ds_read_b64_tr_b16 v[186:187], v14 offset:27200
  ds_read_b64_tr_b16 v[192:193], v14 offset:24704
  ds_read_b64_tr_b16 v[194:195], v14 offset:27264
  ds_read_b64_tr_b16 v[200:201], v14 offset:24768
  ds_read_b64_tr_b16 v[202:203], v14 offset:27328
  ds_read_b64_tr_b16 v[208:209], v14 offset:24832
  ds_read_b64_tr_b16 v[210:211], v14 offset:27392
  s_waitcnt vmcnt(23)
  s_waitcnt lgkmcnt(0)
  s_barrier
  v_min_u32 v254, 8, v20
  v_lshlrev_b32 v254, 3, v254
  buffer_load_dwordx2 v[252:253], v254, s[12:15], s97 offen sc1
  s_mov_b32 s3, 6782976
  s_mov_b32 m0, 122880
  s_nop 0
  buffer_load_dwordx4 v21, s[16:19], s3 offen lds
  s_mov_b32 m0, 123904
  s_nop 0
  buffer_load_dwordx4 v22, s[16:19], s3 offen lds
  s_mov_b32 m0, 124928
  s_nop 0
  buffer_load_dwordx4 v23, s[16:19], s3 offen lds
  s_mov_b32 s3, 6782976
  s_mov_b32 m0, 135168
  s_nop 0
  buffer_load_dwordx4 v21, s[20:23], s3 offen lds
  s_mov_b32 m0, 136192
  s_nop 0
  buffer_load_dwordx4 v22, s[20:23], s3 offen lds
  s_mov_b32 m0, 137216
  s_nop 0
  buffer_load_dwordx4 v23, s[20:23], s3 offen lds
  ds_read_b64_tr_b16 a[88:89], v27 offset:24576
  ds_read_b64_tr_b16 a[90:91], v27 offset:24960
  ds_read_b64_tr_b16 a[92:93], v27 offset:30720
  ds_read_b64_tr_b16 a[94:95], v27 offset:31104
  ds_read_b64_tr_b16 a[96:97], v27 offset:24608
  ds_read_b64_tr_b16 a[98:99], v27 offset:24992
  ds_read_b64_tr_b16 a[100:101], v27 offset:30752
  ds_read_b64_tr_b16 a[102:103], v27 offset:31136
  ds_read_b64_tr_b16 a[104:105], v27 offset:24640
  ds_read_b64_tr_b16 a[106:107], v27 offset:25024
  ds_read_b64_tr_b16 a[108:109], v27 offset:30784
  ds_read_b64_tr_b16 a[110:111], v27 offset:31168
  s_waitcnt vmcnt(24)
  s_waitcnt lgkmcnt(0)
  s_barrier
  s_add_u32 s3, s101, 81920
  s_mov_b32 m0, 24576
  s_nop 0
  buffer_load_dwordx4 v0, s[28:31], s3 offen lds
  s_add_u32 s3, s101, 82944
  s_mov_b32 m0, 25600
  s_nop 0
  buffer_load_dwordx4 v0, s[28:31], s3 offen lds
  s_add_u32 s3, s101, 83968
  s_mov_b32 m0, 26624
  s_nop 0
  buffer_load_dwordx4 v0, s[28:31], s3 offen lds
  s_add_u32 s3, s101, 84992
  s_mov_b32 m0, 27648
  s_nop 0
  buffer_load_dwordx4 v0, s[28:31], s3 offen lds
  s_add_u32 s3, s101, 86016
  s_mov_b32 m0, 28672
  s_nop 0
  buffer_load_dwordx4 v0, s[28:31], s3 offen lds
  ds_read_b64_tr_b16 a[112:113], v27 offset:0
  ds_read_b64_tr_b16 a[114:115], v27 offset:384
  ds_read_b64_tr_b16 a[116:117], v27 offset:6144
  ds_read_b64_tr_b16 a[118:119], v27 offset:6528
  ds_read_b64_tr_b16 a[120:121], v27 offset:32
  ds_read_b64_tr_b16 a[122:123], v27 offset:416
  ds_read_b64_tr_b16 a[124:125], v27 offset:6176
  ds_read_b64_tr_b16 a[126:127], v27 offset:6560
  ds_read_b64_tr_b16 a[152:153], v27 offset:64
  ds_read_b64_tr_b16 a[154:155], v27 offset:448
  ds_read_b64_tr_b16 a[156:157], v27 offset:6208
  ds_read_b64_tr_b16 a[158:159], v27 offset:6592
  s_waitcnt vmcnt(24)
  s_waitcnt lgkmcnt(0)
  s_barrier
  s_add_u32 s3, s101, 92160
  s_mov_b32 m0, 0
  s_nop 0
  buffer_load_dwordx4 v0, s[28:31], s3 offen lds
  s_add_u32 s3, s101, 93184
  s_mov_b32 m0, 1024
  s_nop 0
  buffer_load_dwordx4 v0, s[28:31], s3 offen lds
  s_add_u32 s3, s101, 94208
  s_mov_b32 m0, 2048
  s_nop 0
  buffer_load_dwordx4 v0, s[28:31], s3 offen lds
  s_add_u32 s3, s101, 95232
  s_mov_b32 m0, 3072
  s_nop 0
  buffer_load_dwordx4 v0, s[28:31], s3 offen lds
  s_add_u32 s3, s101, 96256
  s_mov_b32 m0, 4096
  s_nop 0
  buffer_load_dwordx4 v0, s[28:31], s3 offen lds
  ds_read_b64_tr_b16 v[180:181], v31 offset:0
  ds_read_b64_tr_b16 v[182:183], v31 offset:2560
  ds_read_b64_tr_b16 v[188:189], v31 offset:64
  ds_read_b64_tr_b16 v[190:191], v31 offset:2624
  ds_read_b64_tr_b16 v[196:197], v31 offset:128
  ds_read_b64_tr_b16 v[198:199], v31 offset:2688
  ds_read_b64_tr_b16 v[204:205], v31 offset:192
  ds_read_b64_tr_b16 v[206:207], v31 offset:2752
  ds_read_b64_tr_b16 v[212:213], v31 offset:256
  ds_read_b64_tr_b16 v[214:215], v31 offset:2816
  s_waitcnt vmcnt(23)
  s_waitcnt lgkmcnt(0)
  s_barrier
  ds_read_b64_tr_b16 v[72:73], v28 offset:24576
  ds_read_b64_tr_b16 v[74:75], v28 offset:24960
  ds_read_b64_tr_b16 v[76:77], v28 offset:30720
  ds_read_b64_tr_b16 v[78:79], v28 offset:31104
  ds_read_b64_tr_b16 a[128:129], v28 offset:24608
  ds_read_b64_tr_b16 a[130:131], v28 offset:24992
  ds_read_b64_tr_b16 a[132:133], v28 offset:30752
  ds_read_b64_tr_b16 a[134:135], v28 offset:31136
  ds_read_b64_tr_b16 a[160:161], v28 offset:24640
  ds_read_b64_tr_b16 a[162:163], v28 offset:25024
  ds_read_b64_tr_b16 a[164:165], v28 offset:30784
  ds_read_b64_tr_b16 a[166:167], v28 offset:31168
  s_waitcnt vmcnt(17)
  s_waitcnt lgkmcnt(0)
  s_barrier
  ds_read_b64_tr_b16 v[80:81], v29 offset:0
  ds_read_b64_tr_b16 v[82:83], v29 offset:384
  ds_read_b64_tr_b16 v[84:85], v29 offset:6144
  ds_read_b64_tr_b16 v[86:87], v29 offset:6528
  ds_read_b64_tr_b16 a[136:137], v29 offset:32
  ds_read_b64_tr_b16 a[138:139], v29 offset:416
  ds_read_b64_tr_b16 a[140:141], v29 offset:6176
  ds_read_b64_tr_b16 a[142:143], v29 offset:6560
  ds_read_b64_tr_b16 a[168:169], v29 offset:64
  ds_read_b64_tr_b16 a[170:171], v29 offset:448
  ds_read_b64_tr_b16 a[172:173], v29 offset:6208
  ds_read_b64_tr_b16 a[174:175], v29 offset:6592
  s_waitcnt vmcnt(10)
  s_waitcnt lgkmcnt(0)
  s_barrier
  ds_read_b64_tr_b16 v[88:89], v29 offset:24576
  ds_read_b64_tr_b16 v[90:91], v29 offset:24960
  ds_read_b64_tr_b16 v[92:93], v29 offset:30720
  ds_read_b64_tr_b16 v[94:95], v29 offset:31104
  ds_read_b64_tr_b16 a[144:145], v29 offset:24608
  ds_read_b64_tr_b16 a[146:147], v29 offset:24992
  ds_read_b64_tr_b16 a[148:149], v29 offset:30752
  ds_read_b64_tr_b16 a[150:151], v29 offset:31136
  ds_read_b64_tr_b16 a[176:177], v29 offset:24640
  ds_read_b64_tr_b16 a[178:179], v29 offset:25024
  ds_read_b64_tr_b16 a[180:181], v29 offset:30784
  ds_read_b64_tr_b16 a[182:183], v29 offset:31168
  s_waitcnt vmcnt(5)
  s_waitcnt lgkmcnt(0)
  s_barrier
  s_waitcnt vmcnt(16)
  buffer_load_dword v22, off, s[8:11], s68 sc1
  v_not_b32 v254, v252
  v_xor_b32 v255, 0x2000, v253
  v_or_b32 v254, v254, v255
  v_cmp_ne_u32 vcc, 0, v254
  v_readlane_b32 s64, v252, 8
  s_and_b32 s3, vcc_lo, 0xff
  s_cselect_b32 s63, 0, -1
  s_cmp_eq_u32 s64, 0
  s_cselect_b32 s63, 0, s63
  ds_read_b64_tr_b16 v[216:217], v30 offset:24576
  ds_read_b64_tr_b16 v[218:219], v30 offset:27136
  ds_read_b64_tr_b16 v[224:225], v30 offset:24640
  ds_read_b64_tr_b16 v[226:227], v30 offset:27200
  ds_read_b64_tr_b16 v[232:233], v30 offset:24704
  ds_read_b64_tr_b16 v[234:235], v30 offset:27264
  ds_read_b64_tr_b16 v[240:241], v30 offset:24768
  ds_read_b64_tr_b16 v[242:243], v30 offset:27328
  ds_read_b64_tr_b16 v[248:249], v30 offset:24832
  ds_read_b64_tr_b16 v[250:251], v30 offset:27392
  ds_write_b128 v3, v[32:35] offset:0
  ds_write_b128 v3, v[36:39] offset:1024
  ds_write_b128 v3, v[40:43] offset:2048
  ds_write_b128 v3, v[44:47] offset:3072
  ds_write_b128 v3, v[48:51] offset:4096
  ds_write_b128 v3, v[52:55] offset:5120
  ds_write_b128 v3, v[56:59] offset:6144
  ds_write_b128 v3, v[60:63] offset:7168
  ds_write_b128 v3, v[64:67] offset:8192
  ds_write_b128 v3, v[68:71] offset:9216
  ds_write_b128 v3, v[72:75] offset:10240
  ds_write_b128 v3, v[76:79] offset:11264
  ds_write_b128 v3, v[80:83] offset:12288
  ds_write_b128 v3, v[84:87] offset:13312
  ds_write_b128 v3, v[88:91] offset:14336
  ds_write_b128 v3, v[92:95] offset:15360
  ds_write_b128 v3, v[96:99] offset:16384
  ds_write_b128 v3, v[100:103] offset:17408
  ds_write_b128 v3, v[104:107] offset:18432
  ds_write_b128 v3, v[108:111] offset:19456
  ds_write_b128 v3, v[112:115] offset:20480
  ds_write_b128 v3, v[116:119] offset:21504
  ds_write_b128 v3, v[120:123] offset:22528
  ds_write_b128 v3, v[124:127] offset:23552
  ds_write_b128 v3, v[128:131] offset:24576
  ds_write_b128 v3, v[132:135] offset:25600
  s_waitcnt vmcnt(0)
  s_waitcnt lgkmcnt(0)
  s_barrier
  v_readfirstlane_b32 s38, v22
  s_and_b32 s38, s38, s63
  s_cbranch_scc0 L90_cslow
L91_cback:
  s_mov_b32 m0, s69
  s_nop 0
  buffer_load_dwordx4 v0, s[8:11], s65 offen offset:0 sc1 lds
  buffer_load_dwordx4 v0, s[8:11], s65 offen offset:1024 sc1 lds
  buffer_load_dwordx4 v0, s[8:11], s65 offen offset:2048 sc1 lds
  ds_read_b64_tr_b16 v[220:221], v30 offset:0
  ds_read_b64_tr_b16 v[222:223], v30 offset:2560
  ds_read_b64_tr_b16 v[228:229], v30 offset:64
  ds_read_b64_tr_b16 v[230:231], v30 offset:2624
  ds_read_b64_tr_b16 v[236:237], v30 offset:128
  ds_read_b64_tr_b16 v[238:239], v30 offset:2688
  ds_read_b64_tr_b16 v[244:245], v30 offset:192
  ds_read_b64_tr_b16 v[246:247], v30 offset:2752
  ds_read_b64_tr_b16 v[252:253], v30 offset:256
  ds_read_b64_tr_b16 v[254:255], v30 offset:2816
  s_and_b32 s64, s64, 8192
  s_add_u32 s57, s57, s64
  s_add_u32 s58, s58, s64
  s_add_u32 s65, s65, 393216
  s_waitcnt vmcnt(0) lgkmcnt(0)
  v_mov_b32 v14, s38
  s_barrier
  ds_read_b128 v[60:63], v3 offset:0
  ds_read_b128 v[64:67], v3 offset:1024
  ds_read_b128 v[68:71], v3 offset:2048
  ds_read_b128 v[72:75], v3 offset:3072
  ds_read_b128 v[76:79], v3 offset:4096
  ds_read_b128 v[80:83], v3 offset:5120
  ds_read_b128 v[84:87], v3 offset:6144
  ds_read_b128 v[88:91], v3 offset:7168
  ds_read_b128 v[92:95], v3 offset:8192
  ds_read_b128 v[96:99], v3 offset:9216
  ds_read_b128 v[100:103], v0 offset:40960
  ds_read_b128 v[104:107], v0 offset:41984
  ds_read_b128 v[108:111], v0 offset:43008
  v_mov_b32 v112, 0
  v_mov_b32 v113, 0
  v_mov_b32 v114, 0
  v_mov_b32 v115, 0
  v_mov_b32 v116, 0
  v_mov_b32 v117, 0
  v_mov_b32 v118, 0
  v_mov_b32 v119, 0
  v_mov_b32 v120, 0
  v_mov_b32 v121, 0
  v_mov_b32 v122, 0
  v_mov_b32 v123, 0
  v_mov_b32 v124, 0
  v_mov_b32 v125, 0
  v_mov_b32 v126, 0
  v_mov_b32 v127, 0
  v_mov_b32 v128, 0
  v_mov_b32 v129, 0
  v_mov_b32 v130, 0
  v_mov_b32 v131, 0
  s_cmp_eq_u32 s97, 0
  s_cbranch_scc1 L92_fast
  s_branch L93_slow
L90_cslow:
  v_mbcnt_lo_u32_b32 v24, -1, 0
  v_min_u32 v24, 8, v24
  v_lshlrev_b32 v24, 3, v24
L100001_cen:
  buffer_load_dwordx2 v[22:23], v24, s[12:15], s97 offen sc1
  s_sub_u32 s37, s37, 1
  s_cbranch_scc1 L89_bail
  s_waitcnt vmcnt(0)
  v_not_b32 v25, v22
  v_xor_b32 v26, 0x2000, v23
  v_or_b32 v25, v25, v26
  v_cmp_ne_u32 vcc, 0, v25
  s_and_b32 s3, vcc_lo, 0xff
  s_cbranch_scc0 L100002_cok
  v_lshrrev_b32 v23, 8, v23
  s_nop 1
  v_add_u32_dpp v23, v23, v23 row_shr:1 row_mask:0xf bank_mask:0xf bound_ctrl:1
  s_nop 1
  v_add_u32_dpp v23, v23, v23 row_shr:2 row_mask:0xf bank_mask:0xf bound_ctrl:1
  s_nop 1
  v_add_u32_dpp v23, v23, v23 row_shr:4 row_mask:0xf bank_mask:0xf bound_ctrl:1
  s_nop 0
  v_readlane_b32 s3, v23, 7
  s_cmp_lt_u32 s3, 256
  s_cbranch_scc1 L100001_cen
  s_branch L_restart
L100002_cok:
  v_readlane_b32 s64, v22, 8
  s_cmp_eq_u32 s64, 0
  s_cbranch_scc1 L100001_cen
  s_cmp_lt_u32 s38, s62
  s_cbranch_scc1 L100003_pw
L100004_pwb:
  s_branch L91_cback
L100003_pw:
  buffer_load_dword v14, off, s[8:11], s68 sc1
  s_sub_u32 s37, s37, 1
  s_cbranch_scc1 L89_bail
  s_waitcnt vmcnt(0)
  v_readfirstlane_b32 s38, v14
  s_cmp_lt_u32 s38, s62
  s_cbranch_scc1 L100003_pw
  s_branch L100004_pwb
L92_fast:
L94_top:
  v_bfe_u32 v46, v1, 2, 1
  v_lshlrev_b32 v46, 4, v46
  v_lshlrev_b32 v46, v46, s39
  v_cndmask_b32 v44, v46, 0, s[42:43]
  v_cndmask_b32 v45, 0, v46, s[42:43]
  buffer_load_dwordx4 v[28:31], v2, s[8:11], s56 offen offset:0 sc1
  buffer_load_dwordx4 v[32:35], v2, s[8:11], s56 offen offset:1024 sc1
  s_add_u32 s62, s36, 2
  s_min_u32 s62, s62, 64
  v_readfirstlane_b32 s38, v14
  s_mov_b32 m0, s69
  s_cmp_lt_u32 s38, s62
  s_cbranch_scc1 L97_pw
L98_pwb:
  s_waitcnt vmcnt(1)
  v_bitop3_b32 v132, v28, v30, s60 bitop3:0x7e
  s_waitcnt vmcnt(0)
  v_bitop3_b32 v133, v32, v34, s60 bitop3:0x7e
  v_bitop3_b32 v132, v132, v133, 1 bitop3:0xa8
  v_cmp_ne_u32 vcc, 0, v132
  s_cbranch_vccnz L99_f1
L100_b1:
  buffer_load_dwordx4 v[20:23], v8, s[8:11], s58 offen offset:0 sc1
  buffer_load_dwordx4 v[24:27], v8, s[8:11], s58 offen offset:1024 sc1
L103_b3:
L102_b2:
  v_mfma_f32_4x4x4_16b_bf16 v[36:39], v[44:45], v[28:29], 0
  v_mfma_f32_4x4x4_16b_bf16 v[48:51], v[44:45], v[30:31], 0
  v_mfma_f32_4x4x4_16b_bf16 v[40:43], v[44:45], v[32:33], 0
  v_mfma_f32_4x4x4_16b_bf16 v[52:55], v[44:45], v[34:35], 0
  s_waitcnt lgkmcnt(0)
  s_waitcnt vmcnt(1)
  v_mfma_f32_4x4x4_16b_bf16 v[36:39], v[44:45], v[20:21], v[36:39]
  v_mfma_f32_4x4x4_16b_bf16 v[48:51], v[44:45], v[22:23], v[48:51]
  v_bitop3_b32 v132, v20, v22, s60 bitop3:0x7e
  s_waitcnt vmcnt(0)
  v_mfma_f32_4x4x4_16b_bf16 v[40:43], v[44:45], v[24:25], v[40:43]
  v_mfma_f32_4x4x4_16b_bf16 v[52:55], v[44:45], v[26:27], v[52:55]
  v_bitop3_b32 v133, v24, v26, s60 bitop3:0x7e
  v_bitop3_b32 v132, v132, v133, 1 bitop3:0xa8
  v_cmp_ne_u32 vcc, 0, v132
  v_cvt_pk_bf16_f32 v20, v36, v37
  v_cvt_pk_bf16_f32 v21, v38, v39
  v_cvt_pk_bf16_f32 v22, v48, v49
  v_cvt_pk_bf16_f32 v23, v50, v51
  ds_write_b128 v0, v[20:23] offset:0
  v_cvt_pk_bf16_f32 v24, v40, v41
  v_cvt_pk_bf16_f32 v25, v42, v43
  s_cbranch_vccnz L101_f2
  v_cvt_pk_bf16_f32 v26, v52, v53
  v_cvt_pk_bf16_f32 v27, v54, v55
  ds_write_b128 v0, v[24:27] offset:1024
L96_rl:
  v_smfmac_f32_16x16x64_bf16 v[112:115], v[20:23], v[60:67], v13
  v_smfmac_f32_16x16x64_bf16 v[116:119], v[20:23], v[68:75], v13
  v_smfmac_f32_16x16x64_bf16 v[120:123], v[20:23], v[76:83], v13
  s_waitcnt lgkmcnt(0)
  s_barrier
  ds_read_b128 v[28:31], v0 offset:2048
  ds_read_b128 v[32:35], v0 offset:3072
  v_smfmac_f32_16x16x64_bf16 v[112:115], v[24:27], v[84:91], v13
  ds_read_b128 v[36:39], v0 offset:4096
  buffer_load_dwordx4 v0, s[8:11], s65 offen offset:0 sc1 lds
  v_smfmac_f32_16x16x64_bf16 v[116:119], v[24:27], v[92:99], v13
  ds_read_b128 v[40:43], v0 offset:5120
  v_smfmac_f32_16x16x64_bf16 v[120:123], v[24:27], a[0:7], v13
  ds_read_b128 v[44:47], v0 offset:6144
  buffer_load_dwordx4 v0, s[8:11], s65 offen offset:1024 sc1 lds
  v_smfmac_f32_16x16x64_bf16 v[124:127], v[20:23], a[8:15], v13
  ds_read_b128 v[48:51], v0 offset:7168
  s_waitcnt lgkmcnt(5)
  v_smfmac_f32_16x16x64_bf16 v[112:115], v[28:31], a[16:23], v13
  ds_read_b128 v[52:55], v0 offset:8192
  buffer_load_dwordx4 v0, s[8:11], s65 offen offset:2048 sc1 lds
  v_smfmac_f32_16x16x64_bf16 v[116:119], v[28:31], a[24:31], v13
  ds_read_b128 v[56:59], v0 offset:9216
  v_smfmac_f32_16x16x64_bf16 v[120:123], v[28:31], a[32:39], v13
  ds_read_b128 v[60:63], v3 offset:10240
  buffer_load_dword v14, off, s[8:11], s68 sc1
  s_waitcnt lgkmcnt(7)
  v_smfmac_f32_16x16x64_bf16 v[112:115], v[32:35], a[40:47], v13
  ds_read_b128 v[64:67], v3 offset:11264
  v_smfmac_f32_16x16x64_bf16 v[116:119], v[32:35], a[48:55], v13
  ds_read_b128 v[68:71], v3 offset:12288
  v_not_b32 v132, s61
  v_not_b32 v133, s61
  v_smfmac_f32_16x16x64_bf16 v[120:123], v[32:35], a[56:63], v13
  ds_read_b128 v[72:75], v3 offset:13312
  s_waitcnt lgkmcnt(9)
  v_smfmac_f32_16x16x64_bf16 v[112:115], v[36:39], a[64:71], v13
  ds_read_b128 v[76:79], v3 offset:14336
  buffer_store_dwordx2 v[132:133], v7, s[8:11], s57 offen sc1
  v_smfmac_f32_16x16x64_bf16 v[116:119], v[36:39], a[72:79], v13
  ds_read_b128 v[80:83], v3 offset:15360
  v_smfmac_f32_16x16x64_bf16 v[120:123], v[36:39], a[80:87], v13
  ds_read_b128 v[84:87], v3 offset:16384
  s_waitcnt lgkmcnt(11)
  v_smfmac_f32_16x16x64_bf16 v[112:115], v[40:43], a[88:95], v13
  ds_read_b128 v[88:91], v3 offset:17408
  v_smfmac_f32_16x16x64_bf16 v[116:119], v[40:43], a[96:103], v13
  ds_read_b128 v[92:95], v3 offset:18432
  v_smfmac_f32_16x16x64_bf16 v[120:123], v[40:43], a[104:111], v13
  ds_read_b128 v[96:99], v3 offset:19456
  s_waitcnt lgkmcnt(13)
  v_smfmac_f32_16x16x64_bf16 v[112:115], v[44:47], a[112:119], v13
  s_waitcnt lgkmcnt(12)
  s_waitcnt lgkmcnt(8)
  v_smfmac_f32_16x16x64_bf16 v[112:115], v[48:51], v[60:67], v13
  ds_read_b128 v[60:63], v3 offset:20480
  s_waitcnt lgkmcnt(7)
  v_smfmac_f32_16x16x64_bf16 v[112:115], v[52:55], v[68:75], v13
  ds_read_b128 v[64:67], v3 offset:21504
  s_waitcnt lgkmcnt(6)
  v_smfmac_f32_16x16x64_bf16 v[112:115], v[56:59], v[76:83], v13
  ds_read_b128 v[68:71], v3 offset:22528
  v_smfmac_f32_16x16x64_bf16 v[116:119], v[44:47], a[120:127], v13
  ds_read_b128 v[72:75], v3 offset:23552
  v_smfmac_f32_16x16x64_bf16 v[116:119], v[48:51], a[128:135], v13
  ds_read_b128 v[76:79], v3 offset:24576
  v_add_f32 v112, v112, v114
  v_smfmac_f32_16x16x64_bf16 v[116:119], v[52:55], a[136:143], v13
  ds_read_b128 v[80:83], v3 offset:25600
  v_add_f32 v113, v113, v115
  v_smfmac_f32_16x16x64_bf16 v[116:119], v[56:59], a[144:151], v13
  v_cvt_pk_bf16_f32 v114, v112, v113
  v_smfmac_f32_16x16x64_bf16 v[120:123], v[44:47], a[152:159], v13
  v_cvt_pk_bf16_f32 v115, v112, v113
  ds_write_b64 v4, v[114:115] offset:10240
  v_smfmac_f32_16x16x64_bf16 v[120:123], v[48:51], a[160:167], v13
  v_add_f32 v116, v116, v118
  v_smfmac_f32_16x16x64_bf16 v[120:123], v[52:55], a[168:175], v13
  v_add_f32 v117, v117, v119
  v_smfmac_f32_16x16x64_bf16 v[120:123], v[56:59], a[176:183], v13
  v_cvt_pk_bf16_f32 v118, v116, v117
  s_waitcnt lgkmcnt(9)
  v_smfmac_f32_16x16x64_bf16 v[124:127], v[24:27], v[84:91], v13
  v_cvt_pk_bf16_f32 v119, v116, v117
  ds_write_b64 v4, v[118:119] offset:10752
  s_waitcnt lgkmcnt(8)
  v_smfmac_f32_16x16x64_bf16 v[124:127], v[28:31], v[92:99], v13
  v_add_f32 v120, v120, v122
  v_add_f32 v121, v121, v123
  v_cvt_pk_bf16_f32 v122, v120, v121
  v_cvt_pk_bf16_f32 v123, v120, v121
  ds_write_b64 v4, v[122:123] offset:11264
  v_smfmac_f32_16x16x64_bf16 v[124:127], v[32:35], a[184:191], v13
  v_smfmac_f32_16x16x64_bf16 v[124:127], v[36:39], a[192:199], v13
  s_waitcnt lgkmcnt(0)
  s_barrier
  ds_read_b64_tr_b16 v[112:113], v5 offset:10240
  ds_read_b64_tr_b16 v[114:115], v6 offset:10240
  ds_read_b64_tr_b16 v[116:117], v5 offset:11264
  ds_read_b64_tr_b16 v[118:119], v6 offset:11264
  ds_read_b64_tr_b16 v[120:121], v5 offset:12288
  ds_read_b64_tr_b16 v[122:123], v6 offset:12288
  v_smfmac_f32_16x16x64_bf16 v[124:127], v[40:43], a[200:207], v13
  v_smfmac_f32_16x16x64_bf16 v[124:127], v[44:47], a[208:215], v13
  v_smfmac_f32_16x16x64_bf16 v[124:127], v[48:51], a[216:223], v13
  v_smfmac_f32_16x16x64_bf16 v[124:127], v[52:55], a[224:231], v13
  s_waitcnt lgkmcnt(4)
  v_mfma_f32_16x16x32_bf16 v[132:135], v[100:103], v[112:115], 0
  s_waitcnt lgkmcnt(2)
  v_mfma_f32_16x16x32_bf16 v[132:135], v[104:107], v[116:119], v[132:135]
  s_waitcnt lgkmcnt(0)
  v_mfma_f32_16x16x32_bf16 v[132:135], v[108:111], v[120:123], v[132:135]
  v_smfmac_f32_16x16x64_bf16 v[124:127], v[56:59], a[232:239], v13
  s_nop 3
  v_bfi_b32 v132, 1, s59, v132
  s_not_b64 exec, s[42:43]
  buffer_store_dwordx4 v[132:135], v0, s[8:11], s44 offen
  ds_write_b128 v0, v[132:135] offset:19456
  s_mov_b64 exec, -1
  v_smfmac_f32_16x16x64_bf16 v[128:131], v[20:23], a[240:247], v13
  v_smfmac_f32_16x16x64_bf16 v[128:131], v[24:27], a[248:255], v13
  v_cvt_pk_bf16_f32 v124, v124, v125
  v_cvt_pk_bf16_f32 v125, v126, v127
  v_smfmac_f32_16x16x64_bf16 v[128:131], v[36:39], v[60:67], v13
  v_smfmac_f32_16x16x64_bf16 v[128:131], v[40:43], v[68:75], v13
  v_smfmac_f32_16x16x64_bf16 v[128:131], v[44:47], v[76:83], v13
  ds_write_b64 v0, v[124:125] offset:16384
  v_mov_b32 v112, 0
  v_mov_b32 v113, 0
  v_mov_b32 v114, 0
  v_mov_b32 v115, 0
  v_mov_b32 v116, 0
  v_mov_b32 v117, 0
  s_nop 0
  v_add_f32 v128, v128, v130
  v_add_f32 v129, v129, v131
  v_cvt_pk_bf16_f32 v128, v128, v129
  ds_write_b32 v0, v128 offset:18432
  v_mov_b32 v118, 0
  v_mov_b32 v119, 0
  v_mov_b32 v120, 0
  v_mov_b32 v121, 0
  v_mov_b32 v122, 0
  v_mov_b32 v123, 0
  s_cmp_eq_u32 s36, 63
  s_waitcnt lgkmcnt(0)
  s_barrier
  s_cbranch_scc1 L106_fin
  buffer_load_dwordx4 v[84:87], v0, s[8:11], s45 offen sc1
  buffer_load_dword v88, v1, s[8:11], s45 offen offset:1024 sc1
  ds_read_b128 v[90:93], v0 offset:19456
  ds_read_b32 v94, v1 offset:20480
  ds_read_b128 v[20:23], v15 offset:24576
  ds_read_b128 v[24:27], v15 offset:25600
  ds_read_b128 v[28:31], v15 offset:26624
  ds_read_b128 v[32:35], v15 offset:27648
  ds_read_b128 v[36:39], v15 offset:28672
  ds_read_b128 v[40:43], v15 offset:29696
  ds_read_b128 v[44:47], v0 offset:16384
  ds_read_b128 v[48:51], v0 offset:17408
  ds_read_b128 v[52:55], v0 offset:18432
  v_mov_b32 v95, 1.0
  v_mov_b32 v134, 0
  v_mov_b32 v135, 0
  v_mov_b32 v124, 0
  v_mov_b32 v125, 0
  v_mov_b32 v126, 0
  v_mov_b32 v127, 0
  v_mov_b32 v128, 0
  v_mov_b32 v129, 0
  v_mov_b32 v130, 0
  v_mov_b32 v131, 0
  buffer_load_dwordx4 v[72:75], v0, s[8:11], s45 offen sc1
  buffer_load_dword v76, v1, s[8:11], s45 offen offset:1024 sc1
  s_waitcnt vmcnt(2) lgkmcnt(9)
L107_rb:
  v_add_f32 v60, v90, v84
  v_add_f32 v61, v91, v85
  v_add_f32 v62, v92, v86
  v_add_f32 v63, v93, v87
  v_add_f32 v64, v94, v88
  v_max3_f32 v66, v60, v61, v62
  v_max3_f32 v66, v66, v63, v64
  v_bitop3_b32 v71, v84, v88, s59 bitop3:0x7e
  v_and_b32 v71, 1, v71
  v_max_f32_dpp v67, v66, v66 quad_perm:[2,3,0,1] row_mask:0xf bank_mask:0xf
  v_max_f32_dpp v66, v66, v66 quad_perm:[2,3,0,1] row_mask:0xf bank_mask:0xf
  v_cmp_ne_u32 vcc, 0, v71
  s_nop 0
  v_permlane16_swap_b32 v66, v67
  v_max_f32 v68, v66, v67
  v_max_f32 v66, v66, v67
  s_cbranch_vccnz L108_fb
  s_nop 0
  v_permlane32_swap_b32 v66, v68
  v_max_f32 v66, v66, v68
  v_mul_f32 v66, s41, v66
  v_fma_f32 v60, v60, s41, -v66
  v_fma_f32 v61, v61, s41, -v66
  v_fma_f32 v62, v62, s41, -v66
  v_fma_f32 v63, v63, s41, -v66
  v_fma_f32 v64, v64, s41, -v66
  v_exp_f32 v60, v60
  v_exp_f32 v61, v61
  v_exp_f32 v62, v62
  v_exp_f32 v63, v63
  v_exp_f32 v64, v64
  v_cvt_pk_bf16_f32 v69, v60, v61
  v_cvt_pk_bf16_f32 v70, v62, v63
  v_add_f32 v89, v60, v61
  v_mov_b32_dpp v56, v69 quad_perm:[0,1,0,1] row_mask:0xf bank_mask:0xf
  v_mov_b32_dpp v57, v70 quad_perm:[0,1,0,1] row_mask:0xf bank_mask:0xf
  v_mov_b32_dpp v58, v69 quad_perm:[2,3,2,3] row_mask:0xf bank_mask:0xf
  v_mov_b32_dpp v59, v70 quad_perm:[2,3,2,3] row_mask:0xf bank_mask:0xf
  v_mov_b32_dpp v66, v64 quad_perm:[0,1,0,1] row_mask:0xf bank_mask:0xf
  v_mov_b32_dpp v67, v64 quad_perm:[2,3,2,3] row_mask:0xf bank_mask:0xf
  s_waitcnt vmcnt(0) lgkmcnt(0)
  v_mfma_f32_16x16x32_bf16 v[80:83], v[20:23], v[56:59], 0
  v_add_f32 v89, v89, v62
  v_cvt_pk_bf16_f32 v132, v66, v67
  v_mfma_f32_16x16x32_bf16 v[76:79], v[24:27], v[56:59], 0
  v_add_f32 v89, v89, v63
  v_cvt_pk_bf16_f32 v133, v66, v67
  v_mfma_f32_16x16x32_bf16 v[72:75], v[28:31], v[56:59], 0
  v_add_f32 v89, v89, v64
  v_mfma_f32_16x16x32_bf16 v[80:83], v[44:47], v[132:135], v[80:83]
  v_mfma_f32_16x16x32_bf16 v[76:79], v[44:47], v[130:133], v[76:79]
  v_add_f32_dpp v89, v89, v89 quad_perm:[2,3,0,1] row_mask:0xf bank_mask:0xf
  v_mfma_f32_16x16x32_bf16 v[68:71], v[32:35], v[56:59], 0
  v_mfma_f32_16x16x32_bf16 v[72:75], v[48:51], v[132:135], v[72:75]
  v_mfma_f32_16x16x4_f32 v[96:99], v89, v95, 0
  v_cvt_pk_bf16_f32 v84, v80, v81
  v_cvt_pk_bf16_f32 v85, v82, v83
  v_cvt_pk_bf16_f32 v86, v76, v77
  v_cvt_pk_bf16_f32 v87, v78, v79
  v_mfma_f32_16x16x32_bf16 v[68:71], v[48:51], v[130:133], v[68:71]
  v_cvt_pk_bf16_f32 v88, v72, v73
  v_cvt_pk_bf16_f32 v89, v74, v75
  v_mfma_f32_16x16x32_bf16 v[64:67], v[36:39], v[56:59], 0
  v_mfma_f32_16x16x32_bf16 v[60:63], v[40:43], v[56:59], 0
  v_cvt_pk_bf16_f32 v90, v68, v69
  v_cvt_pk_bf16_f32 v91, v70, v71
  v_mfma_f32_16x16x32_bf16 v[64:67], v[52:55], v[132:135], v[64:67]
  v_rcp_f32 v96, v96
  v_mfma_f32_16x16x32_bf16 v[60:63], v[52:55], v[130:133], v[60:63]
  v_rcp_f32 v97, v97
  v_smfmac_f32_16x16x64_bf16 v[112:115], v[84:87], v[136:143], v13
  v_cvt_pk_bf16_f32 v92, v64, v65
  v_cvt_pk_bf16_f32 v93, v66, v67
  v_smfmac_f32_16x16x64_bf16 v[116:119], v[84:87], v[144:151], v13
  v_cvt_pk_bf16_f32 v94, v60, v61
  v_cvt_pk_bf16_f32 v95, v62, v63
  v_smfmac_f32_16x16x64_bf16 v[112:115], v[88:91], v[176:183], v13
  v_smfmac_f32_16x16x64_bf16 v[116:119], v[88:91], v[184:191], v13
  v_smfmac_f32_16x16x64_bf16 v[112:115], v[92:95], v[216:223], v13
  v_smfmac_f32_16x16x64_bf16 v[116:119], v[92:95], v[224:231], v13
  v_smfmac_f32_16x16x64_bf16 v[120:123], v[84:87], v[152:159], v13
  v_mul_f32 v112, v96, v112
  v_mul_f32 v114, v96, v114
  v_smfmac_f32_16x16x64_bf16 v[124:127], v[84:87], v[160:167], v13
  v_mul_f32 v113, v97, v113
  v_mul_f32 v115, v97, v115
  v_smfmac_f32_16x16x64_bf16 v[120:123], v[88:91], v[192:199], v13
  v_cvt_pk_bf16_f32 v20, v112, v114
  v_cvt_pk_bf16_f32 v21, v113, v115
  v_smfmac_f32_16x16x64_bf16 v[124:127], v[88:91], v[200:207], v13
  v_bfi_b32 v20, 1, s59, v20
  v_mul_f32 v116, v96, v116
  v_mul_f32 v118, v96, v118
  v_smfmac_f32_16x16x64_bf16 v[120:123], v[92:95], v[232:239], v13
  v_mul_f32 v117, v97, v117
  v_mul_f32 v119, v97, v119
  v_cvt_pk_bf16_f32 v22, v116, v118
  v_smfmac_f32_16x16x64_bf16 v[124:127], v[92:95], v[240:247], v13
  v_cvt_pk_bf16_f32 v23, v117, v119
  buffer_store_dwordx4 v[20:23], v9, s[8:11], s47 offen
  v_smfmac_f32_16x16x64_bf16 v[128:131], v[84:87], v[168:175], v13
  v_mul_f32 v120, v96, v120
  v_mul_f32 v122, v96, v122
  v_smfmac_f32_16x16x64_bf16 v[128:131], v[88:91], v[208:215], v13
  v_mul_f32 v121, v97, v121
  v_mul_f32 v123, v97, v123
  v_smfmac_f32_16x16x64_bf16 v[128:131], v[92:95], v[248:255], v13
  v_cvt_pk_bf16_f32 v24, v120, v122
  v_cvt_pk_bf16_f32 v25, v121, v123
  v_bfi_b32 v24, 1, s59, v24
  v_mul_f32 v124, v96, v124
  v_mul_f32 v126, v96, v126
  v_mul_f32 v125, v97, v125
  v_mul_f32 v127, v97, v127
  v_cvt_pk_bf16_f32 v26, v124, v126
  v_cvt_pk_bf16_f32 v27, v125, v127
  buffer_store_dwordx4 v[24:27], v9, s[8:11], s47 offen offset:1024
  v_mul_f32 v128, v96, v128
  v_mul_f32 v130, v96, v130
  v_mul_f32 v129, v97, v129
  v_mul_f32 v131, v97, v131
  v_cvt_pk_bf16_f32 v28, v128, v130
  v_cvt_pk_bf16_f32 v29, v129, v131
  v_bfi_b32 v28, 1, s59, v28
  buffer_store_dwordx2 v[28:29], v10, s[8:11], s47 offen
  ds_read_b128 v[60:63], v3 offset:0
  ds_read_b128 v[64:67], v3 offset:1024
  ds_read_b128 v[68:71], v3 offset:2048
  ds_read_b128 v[72:75], v3 offset:3072
  ds_read_b128 v[76:79], v3 offset:4096
  ds_read_b128 v[80:83], v3 offset:5120
  ds_read_b128 v[84:87], v3 offset:6144
  ds_read_b128 v[88:91], v3 offset:7168
  ds_read_b128 v[92:95], v3 offset:8192
  ds_read_b128 v[96:99], v3 offset:9216
  ds_read_b128 v[100:103], v0 offset:40960
  ds_read_b128 v[104:107], v0 offset:41984
  ds_read_b128 v[108:111], v0 offset:43008
  v_mov_b32 v112, 0
  v_mov_b32 v113, 0
  v_mov_b32 v114, 0
  v_mov_b32 v115, 0
  v_mov_b32 v116, 0
  v_mov_b32 v117, 0
  v_mov_b32 v118, 0
  v_mov_b32 v119, 0
  v_mov_b32 v120, 0
  v_mov_b32 v121, 0
  v_mov_b32 v122, 0
  v_mov_b32 v123, 0
  v_mov_b32 v124, 0
  v_mov_b32 v125, 0
  v_mov_b32 v126, 0
  v_mov_b32 v127, 0
  v_mov_b32 v128, 0
  v_mov_b32 v129, 0
  v_mov_b32 v130, 0
  v_mov_b32 v131, 0
  s_xor_b32 s56, s56, 65536
  s_xor_b32 s58, s58, 131072
  s_add_u32 s65, s65, 393216
  v_xor_b32 v15, 8192, v15
  s_add_u32 s36, s36, 1
  s_waitcnt vmcnt(1)
  buffer_load_dwordx4 v[32:35], v11, s[8:11], s49 offen sc1
  buffer_load_dwordx4 v[36:39], v11, s[8:11], s50 offen sc1
  buffer_load_dwordx4 v[40:43], v11, s[8:11], s51 offen sc1
  buffer_load_dwordx4 v[44:47], v11, s[8:11], s52 offen sc1
L110_rc:
  s_waitcnt vmcnt(3)
  v_mfma_f32_16x16x32_bf16 v[48:51], v[16:19], v[32:35], 0
  v_bitop3_b32 v132, v32, v32, s59 bitop3:0x7e
  s_waitcnt vmcnt(2)
  v_mfma_f32_16x16x32_bf16 v[48:51], v[16:19], v[36:39], v[48:51]
  v_bitop3_b32 v133, v36, v36, s59 bitop3:0x7e
  v_or_b32 v132, v132, v133
  s_waitcnt vmcnt(1)
  v_mfma_f32_16x16x32_bf16 v[48:51], v[16:19], v[40:43], v[48:51]
  v_bitop3_b32 v133, v40, v40, s59 bitop3:0x7e
  v_or_b32 v132, v132, v133
  s_waitcnt vmcnt(0)
  v_mfma_f32_16x16x32_bf16 v[48:51], v[16:19], v[44:47], v[48:51]
  v_bitop3_b32 v133, v44, v44, s59 bitop3:0x7e
  v_bitop3_b32 v132, v132, v133, 1 bitop3:0xa8
  v_cmp_ne_u32 vcc, 0, v132
  s_cbranch_vccnz L111_fc
  s_nop 3
  v_add_f32_dpp v48, v48, v48 row_ror:8 row_mask:0xf bank_mask:0xf
  v_add_f32_dpp v49, v49, v49 row_ror:8 row_mask:0xf bank_mask:0xf
  v_add_f32_dpp v50, v50, v50 row_ror:8 row_mask:0xf bank_mask:0xf
  v_add_f32_dpp v51, v51, v51 row_ror:8 row_mask:0xf bank_mask:0xf
  v_cvt_pk_bf16_f32 v24, v48, v49
  v_cvt_pk_bf16_f32 v25, v50, v51
  v_bfi_b32 v24, 1, s61, v24
  buffer_store_dwordx2 v[24:25], v12, s[8:11], s56 offen
  s_barrier
  buffer_store_dwordx2 v[24:25], v7, s[8:11], s57 offen sc1
  s_xor_b32 s59, s59, 1
  s_mov_b32 s60, s61
  s_xor_b32 s61, s61, s59
  s_xor_b32 s57, s57, 131072
  s_waitcnt vmcnt(1)
  s_barrier
  s_branch L94_top
L106_fin:
  s_barrier
  s_waitcnt vmcnt(0)
  s_endpgm
L97_pw:
  buffer_load_dword v14, off, s[8:11], s68 sc1
  s_sub_u32 s37, s37, 1
  s_cbranch_scc1 L89_bail
  s_waitcnt vmcnt(0)
  v_readfirstlane_b32 s38, v14
  s_cmp_lt_u32 s38, s62
  s_cbranch_scc1 L97_pw
  s_branch L98_pwb
L99_f1:
  s_mov_b64 exec, vcc
  buffer_load_dwordx4 v[28:31], v2, s[8:11], s56 offen offset:0 sc1
  buffer_load_dwordx4 v[32:35], v2, s[8:11], s56 offen offset:1024 sc1
  s_mov_b64 exec, -1
  buffer_load_dwordx4 v[20:23], v8, s[8:11], s58 offen offset:0 sc1
  buffer_load_dwordx4 v[24:27], v8, s[8:11], s58 offen offset:1024 sc1
  s_waitcnt vmcnt(2)
  v_bitop3_b32 v132, v28, v30, s60 bitop3:0x7e
  v_bitop3_b32 v133, v32, v34, s60 bitop3:0x7e
  v_bitop3_b32 v132, v132, v133, 1 bitop3:0xa8
  v_cmp_ne_u32 vcc, 0, v132
  s_cbranch_vccz L103_b3
L104_f3:
L105_ag:
  s_mov_b64 exec, vcc
  s_xor_b32 s3, s58, 0
  buffer_load_dwordx4 v[28:31], v2, s[8:11], s56 offen offset:0 sc1
  buffer_load_dwordx4 v[32:35], v2, s[8:11], s56 offen offset:1024 sc1
  s_sub_u32 s37, s37, 1
  s_cbranch_scc1 L89_bail
  s_waitcnt vmcnt(0)
  v_bitop3_b32 v132, v28, v30, s60 bitop3:0x7e
  v_bitop3_b32 v133, v32, v34, s60 bitop3:0x7e
  v_bitop3_b32 v132, v132, v133, 1 bitop3:0xa8
  v_cmp_ne_u32 vcc, 0, v132
  s_mov_b64 exec, -1
  s_cbranch_vccnz L105_ag
  s_branch L103_b3
L101_f2:
  s_xor_b32 s3, s58, 0
  s_sub_u32 s37, s37, 1
  s_cbranch_scc1 L89_bail
  buffer_load_dwordx4 v[20:23], v8, s[8:11], s3 offen offset:0 sc1
  buffer_load_dwordx4 v[24:27], v8, s[8:11], s3 offen offset:1024 sc1
  s_branch L102_b2
L95_fL:
  s_mov_b64 exec, vcc
  buffer_load_dwordx4 v[20:23], v2, s[8:11], s56 offen offset:0 sc1
  buffer_load_dwordx4 v[24:27], v2, s[8:11], s56 offen offset:1024 sc1
  s_mov_b64 exec, -1
  s_sub_u32 s37, s37, 1
  s_cbranch_scc1 L89_bail
  s_branch L96_rl
L108_fb:
  s_waitcnt vmcnt(0)
  v_bitop3_b32 v71, v72, v76, s59 bitop3:0x7e
  v_and_b32 v71, 1, v71
  v_cmp_ne_u32 vcc, 0, v71
  v_mov_b32 v84, v72
  v_mov_b32 v85, v73
  v_mov_b32 v86, v74
  v_mov_b32 v87, v75
  v_mov_b32 v88, v76
  s_cbranch_vccz L107_rb
L109_fb2:
  s_sub_u32 s37, s37, 1
  s_cbranch_scc1 L89_bail
  buffer_load_dwordx4 v[84:87], v0, s[8:11], s45 offen sc1
  buffer_load_dword v88, v1, s[8:11], s45 offen offset:1024 sc1
  s_waitcnt vmcnt(0)
  v_bitop3_b32 v71, v84, v88, s59 bitop3:0x7e
  v_and_b32 v71, 1, v71
  v_cmp_ne_u32 vcc, 0, v71
  s_cbranch_vccz L107_rb
  s_branch L109_fb2
L111_fc:
  s_mov_b64 exec, vcc
  buffer_load_dwordx4 v[32:35], v11, s[8:11], s49 offen sc1
  buffer_load_dwordx4 v[36:39], v11, s[8:11], s50 offen sc1
  buffer_load_dwordx4 v[40:43], v11, s[8:11], s51 offen sc1
  buffer_load_dwordx4 v[44:47], v11, s[8:11], s52 offen sc1
  s_mov_b64 exec, -1
  s_sub_u32 s37, s37, 1
  s_cbranch_scc1 L89_bail
  s_branch L110_rc
L93_slow:
L112_top:
  v_bfe_u32 v46, v1, 2, 1
  v_lshlrev_b32 v46, 4, v46
  v_lshlrev_b32 v46, v46, s39
  v_cndmask_b32 v44, v46, 0, s[42:43]
  v_cndmask_b32 v45, 0, v46, s[42:43]
  buffer_load_dwordx4 v[28:31], v2, s[8:11], s56 offen offset:0 sc1
  buffer_load_dwordx4 v[32:35], v2, s[8:11], s56 offen offset:1024 sc1
  s_add_u32 s62, s36, 2
  s_min_u32 s62, s62, 64
  v_readfirstlane_b32 s38, v14
  s_mov_b32 m0, s69
  s_cmp_lt_u32 s38, s62
  s_cbranch_scc1 L115_pw
L116_pwb:
  s_waitcnt vmcnt(1)
  v_bitop3_b32 v132, v28, v30, s60 bitop3:0x7e
  s_waitcnt vmcnt(0)
  v_bitop3_b32 v133, v32, v34, s60 bitop3:0x7e
  v_bitop3_b32 v132, v132, v133, 1 bitop3:0xa8
  v_cmp_ne_u32 vcc, 0, v132
  s_cbranch_vccnz L117_f1
L118_b1:
  buffer_load_dwordx4 v[20:23], v8, s[8:11], s58 offen offset:0 sc1
  buffer_load_dwordx4 v[24:27], v8, s[8:11], s58 offen offset:1024 sc1
L121_b3:
L120_b2:
  v_mfma_f32_4x4x4_16b_bf16 v[36:39], v[44:45], v[28:29], 0
  v_mfma_f32_4x4x4_16b_bf16 v[48:51], v[44:45], v[30:31], 0
  v_mfma_f32_4x4x4_16b_bf16 v[40:43], v[44:45], v[32:33], 0
  v_mfma_f32_4x4x4_16b_bf16 v[52:55], v[44:45], v[34:35], 0
  s_waitcnt lgkmcnt(0)
  s_waitcnt vmcnt(1)
  v_mfma_f32_4x4x4_16b_bf16 v[36:39], v[44:45], v[20:21], v[36:39]
  v_mfma_f32_4x4x4_16b_bf16 v[48:51], v[44:45], v[22:23], v[48:51]
  v_bitop3_b32 v132, v20, v22, s60 bitop3:0x7e
  s_waitcnt vmcnt(0)
  v_mfma_f32_4x4x4_16b_bf16 v[40:43], v[44:45], v[24:25], v[40:43]
  v_mfma_f32_4x4x4_16b_bf16 v[52:55], v[44:45], v[26:27], v[52:55]
  v_bitop3_b32 v133, v24, v26, s60 bitop3:0x7e
  v_bitop3_b32 v132, v132, v133, 1 bitop3:0xa8
  v_cmp_ne_u32 vcc, 0, v132
  v_cvt_pk_bf16_f32 v20, v36, v37
  v_cvt_pk_bf16_f32 v21, v38, v39
  v_cvt_pk_bf16_f32 v22, v48, v49
  v_cvt_pk_bf16_f32 v23, v50, v51
  ds_write_b128 v0, v[20:23] offset:0
  v_cvt_pk_bf16_f32 v24, v40, v41
  v_cvt_pk_bf16_f32 v25, v42, v43
  s_cbranch_vccnz L119_f2
  v_cvt_pk_bf16_f32 v26, v52, v53
  v_cvt_pk_bf16_f32 v27, v54, v55
  ds_write_b128 v0, v[24:27] offset:1024
L114_rl:
  v_smfmac_f32_16x16x64_bf16 v[112:115], v[20:23], v[60:67], v13
  v_smfmac_f32_16x16x64_bf16 v[116:119], v[20:23], v[68:75], v13
  v_smfmac_f32_16x16x64_bf16 v[120:123], v[20:23], v[76:83], v13
  s_waitcnt lgkmcnt(0)
  s_barrier
  ds_read_b128 v[28:31], v0 offset:2048
  ds_read_b128 v[32:35], v0 offset:3072
  v_smfmac_f32_16x16x64_bf16 v[112:115], v[24:27], v[84:91], v13
  ds_read_b128 v[36:39], v0 offset:4096
  buffer_load_dwordx4 v0, s[8:11], s65 offen offset:0 sc1 lds
  v_smfmac_f32_16x16x64_bf16 v[116:119], v[24:27], v[92:99], v13
  ds_read_b128 v[40:43], v0 offset:5120
  v_smfmac_f32_16x16x64_bf16 v[120:123], v[24:27], a[0:7], v13
  ds_read_b128 v[44:47], v0 offset:6144
  buffer_load_dwordx4 v0, s[8:11], s65 offen offset:1024 sc1 lds
  v_smfmac_f32_16x16x64_bf16 v[124:127], v[20:23], a[8:15], v13
  ds_read_b128 v[48:51], v0 offset:7168
  s_waitcnt lgkmcnt(5)
  v_smfmac_f32_16x16x64_bf16 v[112:115], v[28:31], a[16:23], v13
  ds_read_b128 v[52:55], v0 offset:8192
  buffer_load_dwordx4 v0, s[8:11], s65 offen offset:2048 sc1 lds
  v_smfmac_f32_16x16x64_bf16 v[116:119], v[28:31], a[24:31], v13
  ds_read_b128 v[56:59], v0 offset:9216
  v_smfmac_f32_16x16x64_bf16 v[120:123], v[28:31], a[32:39], v13
  ds_read_b128 v[60:63], v3 offset:10240
  buffer_load_dword v14, off, s[8:11], s68 sc1
  s_waitcnt lgkmcnt(7)
  v_smfmac_f32_16x16x64_bf16 v[112:115], v[32:35], a[40:47], v13
  ds_read_b128 v[64:67], v3 offset:11264
  v_smfmac_f32_16x16x64_bf16 v[116:119], v[32:35], a[48:55], v13
  ds_read_b128 v[68:71], v3 offset:12288
  v_not_b32 v132, s61
  v_not_b32 v133, s61
  v_smfmac_f32_16x16x64_bf16 v[120:123], v[32:35], a[56:63], v13
  ds_read_b128 v[72:75], v3 offset:13312
  s_waitcnt lgkmcnt(9)
  v_smfmac_f32_16x16x64_bf16 v[112:115], v[36:39], a[64:71], v13
  ds_read_b128 v[76:79], v3 offset:14336
  buffer_store_dwordx2 v[132:133], v7, s[8:11], s57 offen sc1
  v_smfmac_f32_16x16x64_bf16 v[116:119], v[36:39], a[72:79], v13
  ds_read_b128 v[80:83], v3 offset:15360
  v_smfmac_f32_16x16x64_bf16 v[120:123], v[36:39], a[80:87], v13
  ds_read_b128 v[84:87], v3 offset:16384
  s_waitcnt lgkmcnt(11)
  v_smfmac_f32_16x16x64_bf16 v[112:115], v[40:43], a[88:95], v13
  ds_read_b128 v[88:91], v3 offset:17408
  v_smfmac_f32_16x16x64_bf16 v[116:119], v[40:43], a[96:103], v13
  ds_read_b128 v[92:95], v3 offset:18432
  v_smfmac_f32_16x16x64_bf16 v[120:123], v[40:43], a[104:111], v13
  ds_read_b128 v[96:99], v3 offset:19456
  s_waitcnt lgkmcnt(13)
  v_smfmac_f32_16x16x64_bf16 v[112:115], v[44:47], a[112:119], v13
  s_waitcnt lgkmcnt(12)
  s_waitcnt lgkmcnt(8)
  v_smfmac_f32_16x16x64_bf16 v[112:115], v[48:51], v[60:67], v13
  ds_read_b128 v[60:63], v3 offset:20480
  s_waitcnt lgkmcnt(7)
  v_smfmac_f32_16x16x64_bf16 v[112:115], v[52:55], v[68:75], v13
  ds_read_b128 v[64:67], v3 offset:21504
  s_waitcnt lgkmcnt(6)
  v_smfmac_f32_16x16x64_bf16 v[112:115], v[56:59], v[76:83], v13
  ds_read_b128 v[68:71], v3 offset:22528
  v_smfmac_f32_16x16x64_bf16 v[116:119], v[44:47], a[120:127], v13
  ds_read_b128 v[72:75], v3 offset:23552
  v_smfmac_f32_16x16x64_bf16 v[116:119], v[48:51], a[128:135], v13
  ds_read_b128 v[76:79], v3 offset:24576
  v_add_f32 v112, v112, v114
  v_smfmac_f32_16x16x64_bf16 v[116:119], v[52:55], a[136:143], v13
  ds_read_b128 v[80:83], v3 offset:25600
  v_add_f32 v113, v113, v115
  v_smfmac_f32_16x16x64_bf16 v[116:119], v[56:59], a[144:151], v13
  v_cvt_pk_bf16_f32 v114, v112, v113
  v_smfmac_f32_16x16x64_bf16 v[120:123], v[44:47], a[152:159], v13
  v_cvt_pk_bf16_f32 v115, v112, v113
  ds_write_b64 v4, v[114:115] offset:10240
  v_smfmac_f32_16x16x64_bf16 v[120:123], v[48:51], a[160:167], v13
  v_add_f32 v116, v116, v118
  v_smfmac_f32_16x16x64_bf16 v[120:123], v[52:55], a[168:175], v13
  v_add_f32 v117, v117, v119
  v_smfmac_f32_16x16x64_bf16 v[120:123], v[56:59], a[176:183], v13
  v_cvt_pk_bf16_f32 v118, v116, v117
  s_waitcnt lgkmcnt(9)
  v_smfmac_f32_16x16x64_bf16 v[124:127], v[24:27], v[84:91], v13
  v_cvt_pk_bf16_f32 v119, v116, v117
  ds_write_b64 v4, v[118:119] offset:10752
  s_waitcnt lgkmcnt(8)
  v_smfmac_f32_16x16x64_bf16 v[124:127], v[28:31], v[92:99], v13
  v_add_f32 v120, v120, v122
  v_add_f32 v121, v121, v123
  v_cvt_pk_bf16_f32 v122, v120, v121
  v_cvt_pk_bf16_f32 v123, v120, v121
  ds_write_b64 v4, v[122:123] offset:11264
  v_smfmac_f32_16x16x64_bf16 v[124:127], v[32:35], a[184:191], v13
  v_smfmac_f32_16x16x64_bf16 v[124:127], v[36:39], a[192:199], v13
  s_waitcnt lgkmcnt(0)
  s_barrier
  ds_read_b64_tr_b16 v[112:113], v5 offset:10240
  ds_read_b64_tr_b16 v[114:115], v6 offset:10240
  ds_read_b64_tr_b16 v[116:117], v5 offset:11264
  ds_read_b64_tr_b16 v[118:119], v6 offset:11264
  ds_read_b64_tr_b16 v[120:121], v5 offset:12288
  ds_read_b64_tr_b16 v[122:123], v6 offset:12288
  v_smfmac_f32_16x16x64_bf16 v[124:127], v[40:43], a[200:207], v13
  v_smfmac_f32_16x16x64_bf16 v[124:127], v[44:47], a[208:215], v13
  v_smfmac_f32_16x16x64_bf16 v[124:127], v[48:51], a[216:223], v13
  v_smfmac_f32_16x16x64_bf16 v[124:127], v[52:55], a[224:231], v13
  s_waitcnt lgkmcnt(4)
  v_mfma_f32_16x16x32_bf16 v[132:135], v[100:103], v[112:115], 0
  s_waitcnt lgkmcnt(2)
  v_mfma_f32_16x16x32_bf16 v[132:135], v[104:107], v[116:119], v[132:135]
  s_waitcnt lgkmcnt(0)
  v_mfma_f32_16x16x32_bf16 v[132:135], v[108:111], v[120:123], v[132:135]
  v_smfmac_f32_16x16x64_bf16 v[124:127], v[56:59], a[232:239], v13
  s_nop 3
  v_bfi_b32 v132, 1, s59, v132
  s_not_b64 exec, s[42:43]
  buffer_store_dwordx4 v[132:135], v0, s[8:11], s44 offen sc1
  ds_write_b128 v0, v[132:135] offset:19456
  s_mov_b64 exec, -1
  v_smfmac_f32_16x16x64_bf16 v[128:131], v[20:23], a[240:247], v13
  v_smfmac_f32_16x16x64_bf16 v[128:131], v[24:27], a[248:255], v13
  v_cvt_pk_bf16_f32 v124, v124, v125
  v_cvt_pk_bf16_f32 v125, v126, v127
  v_smfmac_f32_16x16x64_bf16 v[128:131], v[36:39], v[60:67], v13
  v_smfmac_f32_16x16x64_bf16 v[128:131], v[40:43], v[68:75], v13
  v_smfmac_f32_16x16x64_bf16 v[128:131], v[44:47], v[76:83], v13
  ds_write_b64 v0, v[124:125] offset:16384
  v_mov_b32 v112, 0
  v_mov_b32 v113, 0
  v_mov_b32 v114, 0
  v_mov_b32 v115, 0
  v_mov_b32 v116, 0
  v_mov_b32 v117, 0
  s_nop 0
  v_add_f32 v128, v128, v130
  v_add_f32 v129, v129, v131
  v_cvt_pk_bf16_f32 v128, v128, v129
  ds_write_b32 v0, v128 offset:18432
  v_mov_b32 v118, 0
  v_mov_b32 v119, 0
  v_mov_b32 v120, 0
  v_mov_b32 v121, 0
  v_mov_b32 v122, 0
  v_mov_b32 v123, 0
  s_cmp_eq_u32 s36, 63
  s_waitcnt lgkmcnt(0)
  s_barrier
  s_cbranch_scc1 L124_fin
  buffer_load_dwordx4 v[84:87], v0, s[8:11], s45 offen sc1
  buffer_load_dword v88, v1, s[8:11], s45 offen offset:1024 sc1
  ds_read_b128 v[90:93], v0 offset:19456
  ds_read_b32 v94, v1 offset:20480
  ds_read_b128 v[20:23], v15 offset:24576
  ds_read_b128 v[24:27], v15 offset:25600
  ds_read_b128 v[28:31], v15 offset:26624
  ds_read_b128 v[32:35], v15 offset:27648
  ds_read_b128 v[36:39], v15 offset:28672
  ds_read_b128 v[40:43], v15 offset:29696
  ds_read_b128 v[44:47], v0 offset:16384
  ds_read_b128 v[48:51], v0 offset:17408
  ds_read_b128 v[52:55], v0 offset:18432
  v_mov_b32 v95, 1.0
  v_mov_b32 v134, 0
  v_mov_b32 v135, 0
  v_mov_b32 v124, 0
  v_mov_b32 v125, 0
  v_mov_b32 v126, 0
  v_mov_b32 v127, 0
  v_mov_b32 v128, 0
  v_mov_b32 v129, 0
  v_mov_b32 v130, 0
  v_mov_b32 v131, 0
  buffer_load_dwordx4 v[72:75], v0, s[8:11], s45 offen sc1
  buffer_load_dword v76, v1, s[8:11], s45 offen offset:1024 sc1
  s_waitcnt vmcnt(2) lgkmcnt(9)
L125_rb:
  v_add_f32 v60, v90, v84
  v_add_f32 v61, v91, v85
  v_add_f32 v62, v92, v86
  v_add_f32 v63, v93, v87
  v_add_f32 v64, v94, v88
  v_max3_f32 v66, v60, v61, v62
  v_max3_f32 v66, v66, v63, v64
  v_bitop3_b32 v71, v84, v88, s59 bitop3:0x7e
  v_and_b32 v71, 1, v71
  v_max_f32_dpp v67, v66, v66 quad_perm:[2,3,0,1] row_mask:0xf bank_mask:0xf
  v_max_f32_dpp v66, v66, v66 quad_perm:[2,3,0,1] row_mask:0xf bank_mask:0xf
  v_cmp_ne_u32 vcc, 0, v71
  s_nop 0
  v_permlane16_swap_b32 v66, v67
  v_max_f32 v68, v66, v67
  v_max_f32 v66, v66, v67
  s_cbranch_vccnz L126_fb
  s_nop 0
  v_permlane32_swap_b32 v66, v68
  v_max_f32 v66, v66, v68
  v_mul_f32 v66, s41, v66
  v_fma_f32 v60, v60, s41, -v66
  v_fma_f32 v61, v61, s41, -v66
  v_fma_f32 v62, v62, s41, -v66
  v_fma_f32 v63, v63, s41, -v66
  v_fma_f32 v64, v64, s41, -v66
  v_exp_f32 v60, v60
  v_exp_f32 v61, v61
  v_exp_f32 v62, v62
  v_exp_f32 v63, v63
  v_exp_f32 v64, v64
  v_cvt_pk_bf16_f32 v69, v60, v61
  v_cvt_pk_bf16_f32 v70, v62, v63
  v_add_f32 v89, v60, v61
  v_mov_b32_dpp v56, v69 quad_perm:[0,1,0,1] row_mask:0xf bank_mask:0xf
  v_mov_b32_dpp v57, v70 quad_perm:[0,1,0,1] row_mask:0xf bank_mask:0xf
  v_mov_b32_dpp v58, v69 quad_perm:[2,3,2,3] row_mask:0xf bank_mask:0xf
  v_mov_b32_dpp v59, v70 quad_perm:[2,3,2,3] row_mask:0xf bank_mask:0xf
  v_mov_b32_dpp v66, v64 quad_perm:[0,1,0,1] row_mask:0xf bank_mask:0xf
  v_mov_b32_dpp v67, v64 quad_perm:[2,3,2,3] row_mask:0xf bank_mask:0xf
  s_waitcnt vmcnt(0) lgkmcnt(0)
  v_mfma_f32_16x16x32_bf16 v[80:83], v[20:23], v[56:59], 0
  v_add_f32 v89, v89, v62
  v_cvt_pk_bf16_f32 v132, v66, v67
  v_mfma_f32_16x16x32_bf16 v[76:79], v[24:27], v[56:59], 0
  v_add_f32 v89, v89, v63
  v_cvt_pk_bf16_f32 v133, v66, v67
  v_mfma_f32_16x16x32_bf16 v[72:75], v[28:31], v[56:59], 0
  v_add_f32 v89, v89, v64
  v_mfma_f32_16x16x32_bf16 v[80:83], v[44:47], v[132:135], v[80:83]
  v_mfma_f32_16x16x32_bf16 v[76:79], v[44:47], v[130:133], v[76:79]
  v_add_f32_dpp v89, v89, v89 quad_perm:[2,3,0,1] row_mask:0xf bank_mask:0xf
  v_mfma_f32_16x16x32_bf16 v[68:71], v[32:35], v[56:59], 0
  v_mfma_f32_16x16x32_bf16 v[72:75], v[48:51], v[132:135], v[72:75]
  v_mfma_f32_16x16x4_f32 v[96:99], v89, v95, 0
  v_cvt_pk_bf16_f32 v84, v80, v81
  v_cvt_pk_bf16_f32 v85, v82, v83
  v_cvt_pk_bf16_f32 v86, v76, v77
  v_cvt_pk_bf16_f32 v87, v78, v79
  v_mfma_f32_16x16x32_bf16 v[68:71], v[48:51], v[130:133], v[68:71]
  v_cvt_pk_bf16_f32 v88, v72, v73
  v_cvt_pk_bf16_f32 v89, v74, v75
  v_mfma_f32_16x16x32_bf16 v[64:67], v[36:39], v[56:59], 0
  v_mfma_f32_16x16x32_bf16 v[60:63], v[40:43], v[56:59], 0
  v_cvt_pk_bf16_f32 v90, v68, v69
  v_cvt_pk_bf16_f32 v91, v70, v71
  v_mfma_f32_16x16x32_bf16 v[64:67], v[52:55], v[132:135], v[64:67]
  v_rcp_f32 v96, v96
  v_mfma_f32_16x16x32_bf16 v[60:63], v[52:55], v[130:133], v[60:63]
  v_rcp_f32 v97, v97
  v_smfmac_f32_16x16x64_bf16 v[112:115], v[84:87], v[136:143], v13
  v_cvt_pk_bf16_f32 v92, v64, v65
  v_cvt_pk_bf16_f32 v93, v66, v67
  v_smfmac_f32_16x16x64_bf16 v[116:119], v[84:87], v[144:151], v13
  v_cvt_pk_bf16_f32 v94, v60, v61
  v_cvt_pk_bf16_f32 v95, v62, v63
  v_smfmac_f32_16x16x64_bf16 v[112:115], v[88:91], v[176:183], v13
  v_smfmac_f32_16x16x64_bf16 v[116:119], v[88:91], v[184:191], v13
  v_smfmac_f32_16x16x64_bf16 v[112:115], v[92:95], v[216:223], v13
  v_smfmac_f32_16x16x64_bf16 v[116:119], v[92:95], v[224:231], v13
  v_smfmac_f32_16x16x64_bf16 v[120:123], v[84:87], v[152:159], v13
  v_mul_f32 v112, v96, v112
  v_mul_f32 v114, v96, v114
  v_smfmac_f32_16x16x64_bf16 v[124:127], v[84:87], v[160:167], v13
  v_mul_f32 v113, v97, v113
  v_mul_f32 v115, v97, v115
  v_smfmac_f32_16x16x64_bf16 v[120:123], v[88:91], v[192:199], v13
  v_cvt_pk_bf16_f32 v20, v112, v114
  v_cvt_pk_bf16_f32 v21, v113, v115
  v_smfmac_f32_16x16x64_bf16 v[124:127], v[88:91], v[200:207], v13
  v_bfi_b32 v20, 1, s59, v20
  v_mul_f32 v116, v96, v116
  v_mul_f32 v118, v96, v118
  v_smfmac_f32_16x16x64_bf16 v[120:123], v[92:95], v[232:239], v13
  v_mul_f32 v117, v97, v117
  v_mul_f32 v119, v97, v119
  v_cvt_pk_bf16_f32 v22, v116, v118
  v_smfmac_f32_16x16x64_bf16 v[124:127], v[92:95], v[240:247], v13
  v_cvt_pk_bf16_f32 v23, v117, v119
  buffer_store_dwordx4 v[20:23], v9, s[8:11], s47 offen sc1
  v_smfmac_f32_16x16x64_bf16 v[128:131], v[84:87], v[168:175], v13
  v_mul_f32 v120, v96, v120
  v_mul_f32 v122, v96, v122
  v_smfmac_f32_16x16x64_bf16 v[128:131], v[88:91], v[208:215], v13
  v_mul_f32 v121, v97, v121
  v_mul_f32 v123, v97, v123
  v_smfmac_f32_16x16x64_bf16 v[128:131], v[92:95], v[248:255], v13
  v_cvt_pk_bf16_f32 v24, v120, v122
  v_cvt_pk_bf16_f32 v25, v121, v123
  v_bfi_b32 v24, 1, s59, v24
  v_mul_f32 v124, v96, v124
  v_mul_f32 v126, v96, v126
  v_mul_f32 v125, v97, v125
  v_mul_f32 v127, v97, v127
  v_cvt_pk_bf16_f32 v26, v124, v126
  v_cvt_pk_bf16_f32 v27, v125, v127
  buffer_store_dwordx4 v[24:27], v9, s[8:11], s47 offen offset:1024 sc1
  v_mul_f32 v128, v96, v128
  v_mul_f32 v130, v96, v130
  v_mul_f32 v129, v97, v129
  v_mul_f32 v131, v97, v131
  v_cvt_pk_bf16_f32 v28, v128, v130
  v_cvt_pk_bf16_f32 v29, v129, v131
  v_bfi_b32 v28, 1, s59, v28
  buffer_store_dwordx2 v[28:29], v10, s[8:11], s47 offen sc1
  ds_read_b128 v[60:63], v3 offset:0
  ds_read_b128 v[64:67], v3 offset:1024
  ds_read_b128 v[68:71], v3 offset:2048
  ds_read_b128 v[72:75], v3 offset:3072
  ds_read_b128 v[76:79], v3 offset:4096
  ds_read_b128 v[80:83], v3 offset:5120
  ds_read_b128 v[84:87], v3 offset:6144
  ds_read_b128 v[88:91], v3 offset:7168
  ds_read_b128 v[92:95], v3 offset:8192
  ds_read_b128 v[96:99], v3 offset:9216
  ds_read_b128 v[100:103], v0 offset:40960
  ds_read_b128 v[104:107], v0 offset:41984
  ds_read_b128 v[108:111], v0 offset:43008
  v_mov_b32 v112, 0
  v_mov_b32 v113, 0
  v_mov_b32 v114, 0
  v_mov_b32 v115, 0
  v_mov_b32 v116, 0
  v_mov_b32 v117, 0
  v_mov_b32 v118, 0
  v_mov_b32 v119, 0
  v_mov_b32 v120, 0
  v_mov_b32 v121, 0
  v_mov_b32 v122, 0
  v_mov_b32 v123, 0
  v_mov_b32 v124, 0
  v_mov_b32 v125, 0
  v_mov_b32 v126, 0
  v_mov_b32 v127, 0
  v_mov_b32 v128, 0
  v_mov_b32 v129, 0
  v_mov_b32 v130, 0
  v_mov_b32 v131, 0
  s_xor_b32 s56, s56, 65536
  s_xor_b32 s58, s58, 131072
  s_add_u32 s65, s65, 393216
  v_xor_b32 v15, 8192, v15
  s_add_u32 s36, s36, 1
  s_waitcnt vmcnt(1)
  buffer_load_dwordx4 v[32:35], v11, s[8:11], s49 offen sc1
  buffer_load_dwordx4 v[36:39], v11, s[8:11], s50 offen sc1
  buffer_load_dwordx4 v[40:43], v11, s[8:11], s51 offen sc1
  buffer_load_dwordx4 v[44:47], v11, s[8:11], s52 offen sc1
L128_rc:
  s_waitcnt vmcnt(3)
  v_mfma_f32_16x16x32_bf16 v[48:51], v[16:19], v[32:35], 0
  v_bitop3_b32 v132, v32, v32, s59 bitop3:0x7e
  s_waitcnt vmcnt(2)
  v_mfma_f32_16x16x32_bf16 v[48:51], v[16:19], v[36:39], v[48:51]
  v_bitop3_b32 v133, v36, v36, s59 bitop3:0x7e
  v_or_b32 v132, v132, v133
  s_waitcnt vmcnt(1)
  v_mfma_f32_16x16x32_bf16 v[48:51], v[16:19], v[40:43], v[48:51]
  v_bitop3_b32 v133, v40, v40, s59 bitop3:0x7e
  v_or_b32 v132, v132, v133
  s_waitcnt vmcnt(0)
  v_mfma_f32_16x16x32_bf16 v[48:51], v[16:19], v[44:47], v[48:51]
  v_bitop3_b32 v133, v44, v44, s59 bitop3:0x7e
  v_bitop3_b32 v132, v132, v133, 1 bitop3:0xa8
  v_cmp_ne_u32 vcc, 0, v132
  s_cbranch_vccnz L129_fc
  s_nop 3
  v_add_f32_dpp v48, v48, v48 row_ror:8 row_mask:0xf bank_mask:0xf
  v_add_f32_dpp v49, v49, v49 row_ror:8 row_mask:0xf bank_mask:0xf
  v_add_f32_dpp v50, v50, v50 row_ror:8 row_mask:0xf bank_mask:0xf
  v_add_f32_dpp v51, v51, v51 row_ror:8 row_mask:0xf bank_mask:0xf
  v_cvt_pk_bf16_f32 v24, v48, v49
  v_cvt_pk_bf16_f32 v25, v50, v51
  v_bfi_b32 v24, 1, s61, v24
  buffer_store_dwordx2 v[24:25], v12, s[8:11], s56 offen sc1
  s_barrier
  buffer_store_dwordx2 v[24:25], v7, s[8:11], s57 offen sc1
  s_xor_b32 s59, s59, 1
  s_mov_b32 s60, s61
  s_xor_b32 s61, s61, s59
  s_xor_b32 s57, s57, 131072
  s_waitcnt vmcnt(1)
  s_barrier
  s_branch L112_top
L124_fin:
  s_barrier
  s_waitcnt vmcnt(0)
  s_endpgm
L115_pw:
  buffer_load_dword v14, off, s[8:11], s68 sc1
  s_sub_u32 s37, s37, 1
  s_cbranch_scc1 L89_bail
  s_waitcnt vmcnt(0)
  v_readfirstlane_b32 s38, v14
  s_cmp_lt_u32 s38, s62
  s_cbranch_scc1 L115_pw
  s_branch L116_pwb
L117_f1:
  s_mov_b64 exec, vcc
  buffer_load_dwordx4 v[28:31], v2, s[8:11], s56 offen offset:0 sc1
  buffer_load_dwordx4 v[32:35], v2, s[8:11], s56 offen offset:1024 sc1
  s_mov_b64 exec, -1
  buffer_load_dwordx4 v[20:23], v8, s[8:11], s58 offen offset:0 sc1
  buffer_load_dwordx4 v[24:27], v8, s[8:11], s58 offen offset:1024 sc1
  s_waitcnt vmcnt(2)
  v_bitop3_b32 v132, v28, v30, s60 bitop3:0x7e
  v_bitop3_b32 v133, v32, v34, s60 bitop3:0x7e
  v_bitop3_b32 v132, v132, v133, 1 bitop3:0xa8
  v_cmp_ne_u32 vcc, 0, v132
  s_cbranch_vccz L121_b3
L122_f3:
L123_ag:
  s_mov_b64 exec, vcc
  s_xor_b32 s3, s58, 0
  buffer_load_dwordx4 v[28:31], v2, s[8:11], s56 offen offset:0 sc1
  buffer_load_dwordx4 v[32:35], v2, s[8:11], s56 offen offset:1024 sc1
  s_sub_u32 s37, s37, 1
  s_cbranch_scc1 L89_bail
  s_waitcnt vmcnt(0)
  v_bitop3_b32 v132, v28, v30, s60 bitop3:0x7e
  v_bitop3_b32 v133, v32, v34, s60 bitop3:0x7e
  v_bitop3_b32 v132, v132, v133, 1 bitop3:0xa8
  v_cmp_ne_u32 vcc, 0, v132
  s_mov_b64 exec, -1
  s_cbranch_vccnz L123_ag
  s_branch L121_b3
L119_f2:
  s_xor_b32 s3, s58, 0
  s_sub_u32 s37, s37, 1
  s_cbranch_scc1 L89_bail
  buffer_load_dwordx4 v[20:23], v8, s[8:11], s3 offen offset:0 sc1
  buffer_load_dwordx4 v[24:27], v8, s[8:11], s3 offen offset:1024 sc1
  s_branch L120_b2
L113_fL:
  s_mov_b64 exec, vcc
  buffer_load_dwordx4 v[20:23], v2, s[8:11], s56 offen offset:0 sc1
  buffer_load_dwordx4 v[24:27], v2, s[8:11], s56 offen offset:1024 sc1
  s_mov_b64 exec, -1
  s_sub_u32 s37, s37, 1
  s_cbranch_scc1 L89_bail
  s_branch L114_rl
L126_fb:
  s_waitcnt vmcnt(0)
  v_bitop3_b32 v71, v72, v76, s59 bitop3:0x7e
  v_and_b32 v71, 1, v71
  v_cmp_ne_u32 vcc, 0, v71
  v_mov_b32 v84, v72
  v_mov_b32 v85, v73
  v_mov_b32 v86, v74
  v_mov_b32 v87, v75
  v_mov_b32 v88, v76
  s_cbranch_vccz L125_rb
L127_fb2:
  s_sub_u32 s37, s37, 1
  s_cbranch_scc1 L89_bail
  buffer_load_dwordx4 v[84:87], v0, s[8:11], s45 offen sc1
  buffer_load_dword v88, v1, s[8:11], s45 offen offset:1024 sc1
  s_waitcnt vmcnt(0)
  v_bitop3_b32 v71, v84, v88, s59 bitop3:0x7e
  v_and_b32 v71, 1, v71
  v_cmp_ne_u32 vcc, 0, v71
  s_cbranch_vccz L125_rb
  s_branch L127_fb2
L129_fc:
  s_mov_b64 exec, vcc
  buffer_load_dwordx4 v[32:35], v11, s[8:11], s49 offen sc1
  buffer_load_dwordx4 v[36:39], v11, s[8:11], s50 offen sc1
  buffer_load_dwordx4 v[40:43], v11, s[8:11], s51 offen sc1
  buffer_load_dwordx4 v[44:47], v11, s[8:11], s52 offen sc1
  s_mov_b64 exec, -1
  s_sub_u32 s37, s37, 1
  s_cbranch_scc1 L89_bail
  s_branch L128_rc
L89_bail:
  s_endpgm
L86_recw1:
  s_mul_i32 s3, s6, 384
  s_mul_i32 s100, s7, 192
  s_add_u32 s3, s3, s100
  v_add_u32 v32, 0, v20
  v_mul_u32_u24 v33, 171, v32
  v_lshrrev_b32 v33, 11, v33
  v_mul_u32_u24 v34, 12, v33
  v_sub_u32 v32, v32, v34
  v_lshl_add_u32 v32, v32, 4, s3
  v_lshrrev_b32 v34, 2, v33
  v_and_b32 v35, 3, v33
  v_lshl_add_u32 v35, v35, 4, v34
  v_mul_u32_u24 v35, 12288, v35
  v_add_u32 v21, v35, v32
  v_and_b32 v35, 1, v33
  v_lshlrev_b32 v35, 4, v35
  v_lshl_add_u32 v35, v34, 1, v35
  v_bfe_u32 v34, v33, 1, 1
  v_add_u32 v35, v35, v34
  v_mul_u32_u24 v35, 12288, v35
  v_add_u32 v24, v35, v32
  v_add_u32 v32, 64, v20
  v_mul_u32_u24 v33, 171, v32
  v_lshrrev_b32 v33, 11, v33
  v_mul_u32_u24 v34, 12, v33
  v_sub_u32 v32, v32, v34
  v_lshl_add_u32 v32, v32, 4, s3
  v_lshrrev_b32 v34, 2, v33
  v_and_b32 v35, 3, v33
  v_lshl_add_u32 v35, v35, 4, v34
  v_mul_u32_u24 v35, 12288, v35
  v_add_u32 v22, v35, v32
  v_and_b32 v35, 1, v33
  v_lshlrev_b32 v35, 4, v35
  v_lshl_add_u32 v35, v34, 1, v35
  v_bfe_u32 v34, v33, 1, 1
  v_add_u32 v35, v35, v34
  v_mul_u32_u24 v35, 12288, v35
  v_add_u32 v25, v35, v32
  v_add_u32 v32, 128, v20
  v_mul_u32_u24 v33, 171, v32
  v_lshrrev_b32 v33, 11, v33
  v_mul_u32_u24 v34, 12, v33
  v_sub_u32 v32, v32, v34
  v_lshl_add_u32 v32, v32, 4, s3
  v_lshrrev_b32 v34, 2, v33
  v_and_b32 v35, 3, v33
  v_lshl_add_u32 v35, v35, 4, v34
  v_mul_u32_u24 v35, 12288, v35
  v_add_u32 v23, v35, v32
  v_and_b32 v35, 1, v33
  v_lshlrev_b32 v35, 4, v35
  v_lshl_add_u32 v35, v34, 1, v35
  v_bfe_u32 v34, v33, 1, 1
  v_add_u32 v35, v35, v34
  v_mul_u32_u24 v35, 12288, v35
  v_add_u32 v26, v35, v32
  s_mov_b32 s3, 49152
  s_mov_b32 m0, 125952
  s_nop 0
  buffer_load_dwordx4 v21, s[24:27], s3 offen lds
  s_mov_b32 m0, 126976
  s_nop 0
  buffer_load_dwordx4 v22, s[24:27], s3 offen lds
  s_mov_b32 m0, 128000
  s_nop 0
  buffer_load_dwordx4 v23, s[24:27], s3 offen lds
  s_mov_b32 s3, 835584
  s_mov_b32 m0, 138240
  s_nop 0
  buffer_load_dwordx4 v21, s[24:27], s3 offen lds
  s_mov_b32 m0, 139264
  s_nop 0
  buffer_load_dwordx4 v22, s[24:27], s3 offen lds
  s_mov_b32 m0, 140288
  s_nop 0
  buffer_load_dwordx4 v23, s[24:27], s3 offen lds
  v_and_b32 v40, 15, v20
  v_lshrrev_b32 v41, 4, v20
  v_lshlrev_b32 v0, 4, v20
  v_lshlrev_b32 v1, 2, v20
  v_add_u32 v2, 2048, v0
  v_add_u32 v3, 75776, v0
  v_mov_b32 v15, v0
  v_bfe_u32 v42, v40, 2, 1
  v_lshlrev_b32 v42, 8, v42
  v_bfe_u32 v43, v40, 3, 1
  v_lshl_or_b32 v42, v43, 7, v42
  v_and_b32 v43, 3, v40
  v_lshl_or_b32 v42, v43, 5, v42
  v_lshrrev_b32 v43, 2, v40
  v_xor_b32 v43, v43, v41
  v_lshl_or_b32 v4, v43, 3, v42
  v_lshrrev_b32 v42, 1, v41
  v_lshlrev_b32 v42, 9, v42
  v_and_b32 v43, 1, v41
  v_lshl_or_b32 v42, v43, 7, v42
  v_lshrrev_b32 v44, 2, v40
  v_lshl_or_b32 v42, v44, 5, v42
  v_lshlrev_b32 v43, 1, v43
  v_and_b32 v44, 3, v40
  v_xor_b32 v43, v43, v44
  v_lshl_or_b32 v5, v43, 3, v42
  v_xor_b32 v6, 264, v5
  v_mov_b32 v42, 0x44444444
  v_mov_b32 v43, 0xeeeeeeee
  v_cndmask_b32 v13, v42, v43, s[42:43]
  v_mov_b32 v42, 0x7ffff000
  v_and_b32 v43, 1, v41
  v_lshlrev_b32 v43, 6, v43
  v_and_b32 v44, 7, v40
  v_lshl_or_b32 v43, v44, 3, v43
  v_add_u32 v8, 256, v43
  v_cndmask_b32 v7, v42, v0, s[42:43]
  v_lshrrev_b32 v42, 2, v40
  v_lshlrev_b32 v42, 8, v42
  v_lshl_or_b32 v42, v41, 6, v42
  v_and_b32 v43, 3, v40
  v_lshl_or_b32 v42, v43, 4, v42
  v_add_u32 v9, 2560, v42
  v_lshrrev_b32 v42, 3, v40
  v_lshlrev_b32 v42, 8, v42
  v_lshl_or_b32 v42, v41, 6, v42
  v_and_b32 v43, 7, v40
  v_lshl_or_b32 v42, v43, 3, v42
  v_add_u32 v10, 4608, v42
  s_lshr_b32 s3, s5, 3
  s_mul_i32 s3, s3, 160
  s_and_b32 s100, s5, 7
  s_lshl_b32 s100, s100, 4
  s_add_u32 s3, s3, s100
  s_add_u32 s3, s3, 8
  v_and_b32 v43, 7, v40
  v_add_u32 v45, s3, v43
  v_lshrrev_b32 v42, 3, v40
  v_lshl_add_u32 v42, v41, 1, v42
  v_mul_u32_u24 v42, 10496, v42
  v_lshl_add_u32 v11, v45, 4, v42
  v_mov_b32 v46, 0x7ffff000
  v_lshrrev_b32 v42, 1, v45
  v_lshlrev_b32 v42, 5, v42
  v_lshl_or_b32 v42, v41, 4, v42
  v_and_b32 v43, 1, v45
  v_lshl_or_b32 v42, v43, 3, v42
  v_add_u32 v43, 12288, v42
  v_cmp_gt_u32 vcc, 4096, v42
  s_nop 1
  v_cndmask_b32 v42, v43, v42, vcc
  v_cmp_gt_u32 vcc, 8, v40
  s_nop 1
  v_cndmask_b32 v42, v46, v42, vcc
  v_cmp_gt_u32 vcc, 2, v41
  s_nop 1
  v_cndmask_b32 v12, v46, v42, vcc
  v_bfe_u32 v42, v40, 1, 1
  v_bfe_u32 v43, v40, 2, 1
  v_lshl_or_b32 v42, v42, 1, v43
  v_and_b32 v43, 1, v40
  v_lshlrev_b32 v43, 4, v43
  v_lshlrev_b32 v43, v43, s39
  v_cmp_eq_u32 vcc, 0, v42
  s_nop 1
  v_cndmask_b32 v16, 0, v43, vcc
  v_cmp_eq_u32 vcc, 1, v42
  s_nop 1
  v_cndmask_b32 v17, 0, v43, vcc
  v_cmp_eq_u32 vcc, 2, v42
  s_nop 1
  v_cndmask_b32 v18, 0, v43, vcc
  v_cmp_eq_u32 vcc, 3, v42
  s_nop 1
  v_cndmask_b32 v19, 0, v43, vcc
  v_lshrrev_b32 v42, 1, v45
  v_lshlrev_b32 v42, 5, v42
  v_and_b32 v43, 1, v41
  v_lshl_or_b32 v42, v43, 4, v42
  v_and_b32 v43, 1, v45
  v_lshl_or_b32 v42, v43, 3, v42
  v_and_b32 v57, 127, v42
  v_bfe_i32 v43, v42, 7, 1
  v_and_b32 v43, 128, v43
  v_add_u32 v57, v57, v43
  v_bfe_i32 v43, v42, 8, 1
  v_and_b32 v43, 256, v43
  v_add_u32 v57, v57, v43
  v_bfe_i32 v43, v42, 9, 1
  v_and_b32 v43, 512, v43
  v_add_u32 v57, v57, v43
  v_lshrrev_b32 v42, 10, v42
  v_lshl_add_u32 v57, v42, 10, v57
  v_add_u32 v43, 0, v57
  v_cmp_lt_u32 vcc, 1, v42
  s_nop 1
  v_cndmask_b32 v57, v57, v43, vcc
  v_add_u32 v43, 0, v57
  v_cmp_lt_u32 vcc, 3, v42
  s_nop 1
  v_cndmask_b32 v57, v57, v43, vcc
  v_add_u32 v43, 10240, v57
  v_cmp_lt_u32 vcc, 6, v42
  s_nop 1
  v_cndmask_b32 v57, v57, v43, vcc
  v_and_b32 v42, 7, v20
  v_lshlrev_b32 v42, 4, v42
  v_add_u32 v8, 2048, v42
  v_bfe_i32 v43, v20, 3, 1
  v_and_b32 v43, 128, v43
  v_add_u32 v8, v8, v43
  v_bfe_i32 v43, v20, 4, 1
  v_and_b32 v43, 256, v43
  v_add_u32 v8, v8, v43
  v_bfe_i32 v43, v20, 5, 1
  v_and_b32 v43, 512, v43
  v_add_u32 v8, v8, v43
  s_lshr_b32 s3, s5, 3
  s_mul_i32 s3, s3, 160
  s_and_b32 s100, s5, 7
  s_lshl_b32 s100, s100, 4
  s_add_u32 s3, s3, s100
  s_add_u32 s3, s3, 8
  v_and_b32 v40, 7, v20
  v_add_u32 v40, s3, v40
  v_lshrrev_b32 v41, 4, v40
  v_and_b32 v48, 3, v40
  v_lshl_or_b32 v41, v41, 2, v48
  v_mul_u32_u24 v42, 205, v41
  v_lshrrev_b32 v42, 13, v42
  v_mul_u32_u24 v43, 40, v42
  v_sub_u32 v43, v41, v43
  v_lshrrev_b32 v44, 4, v43
  v_lshlrev_b32 v44, 6, v44
  v_and_b32 v48, 15, v43
  v_add_u32 v44, v44, v48
  v_add_u32 v48, v44, v48
  v_cmp_gt_u32 vcc, 32, v43
  s_nop 1
  v_cndmask_b32 v44, v48, v44, vcc
  v_cndmask_b32 v47, 2, 64, vcc
  v_mul_u32_u24 v42, 160, v42
  v_add_u32 v44, v44, v42
  v_bfe_u32 v45, v40, 2, 2
  v_bfe_u32 v48, v20, 4, 1
  v_lshl_or_b32 v45, v45, 1, v48
  v_mul_u32_u24 v45, 1280, v45
  v_lshl_add_u32 v46, v44, 1, v45
  v_add_u32 v47, v47, v46
  buffer_load_ushort v52, v46, s[32:35], 0 offen
  buffer_load_ushort v54, v46, s[32:35], 0 offen offset:32
  buffer_load_ushort v53, v47, s[32:35], 0 offen
  buffer_load_ushort v55, v47, s[32:35], 0 offen offset:32
  v_mov_b32 v132, 0
  v_mov_b32 v133, 0
  v_mov_b32 v134, 0
  v_mov_b32 v135, 0
  buffer_store_dwordx4 v[132:135], v9, s[8:11], s47 offen sc1
  buffer_store_dwordx4 v[132:135], v9, s[8:11], s47 offen offset:1024 sc1
  buffer_store_dwordx2 v[132:133], v10, s[8:11], s47 offen sc1
  buffer_store_dwordx4 v[132:135], v7, s[8:11], s44 offen sc1
  v_bfe_u32 v7, v1, 5, 1
  v_lshl_add_u32 v7, v7, 30, v57
  v_bfe_u32 v112, v1, 7, 1
  v_lshl_add_u32 v7, v112, 29, v7
  s_xor_b32 s3, s57, 0
  buffer_store_dwordx2 v[132:133], v7, s[8:11], s3 offen sc1
  s_xor_b32 s3, s57, 8192
  buffer_store_dwordx2 v[132:133], v7, s[8:11], s3 offen sc1
  s_xor_b32 s3, s57, 131072
  buffer_store_dwordx2 v[132:133], v7, s[8:11], s3 offen sc1
  s_xor_b32 s3, s57, 139264
  buffer_store_dwordx2 v[132:133], v7, s[8:11], s3 offen sc1
  s_xor_b32 s3, s56, 65536
  buffer_store_dwordx2 v[132:133], v12, s[8:11], s3 offen sc1
  s_mov_b32 s3, 1671168
  s_mov_b32 m0, 27648
  s_nop 0
  buffer_load_dwordx4 v24, s[24:27], s3 offen lds
  s_mov_b32 m0, 28672
  s_nop 0
  buffer_load_dwordx4 v25, s[24:27], s3 offen lds
  s_mov_b32 m0, 29696
  s_nop 0
  buffer_load_dwordx4 v26, s[24:27], s3 offen lds
  s_mov_b32 s3, 2113536
  s_mov_b32 m0, 39936
  s_nop 0
  buffer_load_dwordx4 v21, s[24:27], s3 offen lds
  s_mov_b32 m0, 40960
  s_nop 0
  buffer_load_dwordx4 v22, s[24:27], s3 offen lds
  s_mov_b32 m0, 41984
  s_nop 0
  buffer_load_dwordx4 v23, s[24:27], s3 offen lds
  v_bfe_u32 v32, v20, 5, 1
  v_lshlrev_b32 v32, 4, v32
  v_bfe_u32 v33, v20, 3, 1
  v_lshl_or_b32 v32, v33, 3, v32
  v_bfe_u32 v33, v20, 4, 1
  v_lshl_or_b32 v32, v33, 2, v32
  v_bfe_u32 v33, v20, 2, 1
  v_or_b32 v32, v32, v33
  v_mul_u32_u24 v32, 192, v32
  v_and_b32 v34, 3, v20
  v_lshl_add_u32 v27, v34, 3, v32
  v_add_u32 v28, 49152, v27
  v_add_u32 v29, 98304, v27
  v_bfe_u32 v32, v20, 4, 1
  v_lshlrev_b32 v32, 3, v32
  v_bfe_u32 v35, v20, 5, 1
  v_lshl_or_b32 v32, v35, 2, v32
  v_or_b32 v32, v32, v33
  v_mul_u32_u24 v32, 1280, v32
  v_bfe_u32 v33, v20, 3, 1
  v_lshl_add_u32 v32, v33, 5, v32
  v_lshl_add_u32 v30, v34, 3, v32
  v_add_u32 v31, 49152, v30
  v_add_u32 v14, 98304, v30
  s_mul_i32 s101, s6, 245760
  s_mul_i32 s100, s7, 122880
  s_add_u32 s101, s101, s100
  s_mul_i32 s65, s6, 12288
  s_mul_i32 s3, s7, 3072
  s_add_u32 s65, s65, s3
  s_add_u32 s65, s65, 33560576
  s_lshl_b32 s68, s6, 7
  s_add_u32 s68, s68, 3145728
  s_mov_b32 s69, 44032
  s_mov_b32 s62, 1
  s_waitcnt vmcnt(6)
  v_and_b32 v52, 0xfffe, v52
  v_and_b32 v53, 0xfffe, v53
  v_lshl_or_b32 v52, v54, 16, v52
  v_lshl_or_b32 v53, v55, 16, v53
  buffer_store_dwordx2 v[52:53], v12, s[8:11], s56 offen sc1
  s_mov_b32 s3, 2899968
  s_mov_b32 m0, 3072
  s_nop 0
  buffer_load_dwordx4 v21, s[24:27], s3 offen lds
  s_mov_b32 m0, 4096
  s_nop 0
  buffer_load_dwordx4 v22, s[24:27], s3 offen lds
  s_mov_b32 m0, 5120
  s_nop 0
  buffer_load_dwordx4 v23, s[24:27], s3 offen lds
  s_mov_b32 s3, 3981312
  s_mov_b32 m0, 15360
  s_nop 0
  buffer_load_dwordx4 v21, s[24:27], s3 offen lds
  s_mov_b32 m0, 16384
  s_nop 0
  buffer_load_dwordx4 v22, s[24:27], s3 offen lds
  s_mov_b32 m0, 17408
  s_nop 0
  buffer_load_dwordx4 v23, s[24:27], s3 offen lds
  s_mov_b32 s3, 4767744
  s_mov_b32 m0, 52224
  s_nop 0
  buffer_load_dwordx4 v21, s[24:27], s3 offen lds
  s_mov_b32 m0, 53248
  s_nop 0
  buffer_load_dwordx4 v22, s[24:27], s3 offen lds
  s_mov_b32 m0, 54272
  s_nop 0
  buffer_load_dwordx4 v23, s[24:27], s3 offen lds
  s_mov_b32 s3, 5603328
  s_mov_b32 m0, 64512
  s_nop 0
  buffer_load_dwordx4 v24, s[24:27], s3 offen lds
  s_mov_b32 m0, 65536
  s_nop 0
  buffer_load_dwordx4 v25, s[24:27], s3 offen lds
  s_mov_b32 m0, 66560
  s_nop 0
  buffer_load_dwordx4 v26, s[24:27], s3 offen lds
  s_mov_b32 s3, 6045696
  s_mov_b32 m0, 76800
  s_nop 0
  buffer_load_dwordx4 v21, s[24:27], s3 offen lds
  s_mov_b32 m0, 77824
  s_nop 0
  buffer_load_dwordx4 v22, s[24:27], s3 offen lds
  s_mov_b32 m0, 78848
  s_nop 0
  buffer_load_dwordx4 v23, s[24:27], s3 offen lds
  s_mov_b32 s3, 6832128
  s_mov_b32 m0, 89088
  s_nop 0
  buffer_load_dwordx4 v21, s[24:27], s3 offen lds
  s_mov_b32 m0, 90112
  s_nop 0
  buffer_load_dwordx4 v22, s[24:27], s3 offen lds
  s_mov_b32 m0, 91136
  s_nop 0
  buffer_load_dwordx4 v23, s[24:27], s3 offen lds
  s_waitcnt vmcnt(24)
  s_waitcnt lgkmcnt(0)
  s_barrier
  s_mov_b32 s3, 49152
  s_mov_b32 m0, 101376
  s_nop 0
  buffer_load_dwordx4 v21, s[16:19], s3 offen lds
  s_mov_b32 m0, 102400
  s_nop 0
  buffer_load_dwordx4 v22, s[16:19], s3 offen lds
  s_mov_b32 m0, 103424
  s_nop 0
  buffer_load_dwordx4 v23, s[16:19], s3 offen lds
  s_mov_b32 s3, 49152
  s_mov_b32 m0, 113664
  s_nop 0
  buffer_load_dwordx4 v21, s[20:23], s3 offen lds
  s_mov_b32 m0, 114688
  s_nop 0
  buffer_load_dwordx4 v22, s[20:23], s3 offen lds
  s_mov_b32 m0, 115712
  s_nop 0
  buffer_load_dwordx4 v23, s[20:23], s3 offen lds
  ds_read_b64_tr_b16 v[96:97], v29 offset:24608
  ds_read_b64_tr_b16 v[98:99], v29 offset:24992
  ds_read_b64_tr_b16 v[100:101], v29 offset:30752
  ds_read_b64_tr_b16 v[102:103], v29 offset:31136
  ds_read_b64_tr_b16 v[104:105], v29 offset:36896
  ds_read_b64_tr_b16 v[106:107], v29 offset:37280
  ds_read_b64_tr_b16 v[108:109], v29 offset:43040
  ds_read_b64_tr_b16 v[110:111], v29 offset:43424
  s_waitcnt vmcnt(24)
  s_waitcnt lgkmcnt(0)
  s_barrier
  s_add_u32 s3, s101, 5120
  s_mov_b32 m0, 128000
  s_nop 0
  buffer_load_dwordx4 v0, s[28:31], s3 offen lds
  s_add_u32 s3, s101, 6144
  s_mov_b32 m0, 129024
  s_nop 0
  buffer_load_dwordx4 v0, s[28:31], s3 offen lds
  s_add_u32 s3, s101, 7168
  s_mov_b32 m0, 130048
  s_nop 0
  buffer_load_dwordx4 v0, s[28:31], s3 offen lds
  s_add_u32 s3, s101, 8192
  s_mov_b32 m0, 131072
  s_nop 0
  buffer_load_dwordx4 v0, s[28:31], s3 offen lds
  s_add_u32 s3, s101, 9216
  s_mov_b32 m0, 132096
  s_nop 0
  buffer_load_dwordx4 v0, s[28:31], s3 offen lds
  ds_read_b64_tr_b16 a[8:9], v27 offset:24608
  ds_read_b64_tr_b16 a[10:11], v27 offset:24992
  ds_read_b64_tr_b16 a[12:13], v27 offset:30752
  ds_read_b64_tr_b16 a[14:15], v27 offset:31136
  ds_read_b64_tr_b16 a[184:185], v27 offset:36896
  ds_read_b64_tr_b16 a[186:187], v27 offset:37280
  ds_read_b64_tr_b16 a[188:189], v27 offset:43040
  ds_read_b64_tr_b16 a[190:191], v27 offset:43424
  ds_read_b64_tr_b16 a[240:241], v27 offset:24704
  ds_read_b64_tr_b16 a[242:243], v27 offset:25088
  ds_read_b64_tr_b16 a[244:245], v27 offset:30848
  ds_read_b64_tr_b16 a[246:247], v27 offset:31232
  ds_read_b64_tr_b16 a[248:249], v27 offset:36992
  ds_read_b64_tr_b16 a[250:251], v27 offset:37376
  ds_read_b64_tr_b16 a[252:253], v27 offset:43136
  ds_read_b64_tr_b16 a[254:255], v27 offset:43520
  s_waitcnt vmcnt(23)
  s_waitcnt lgkmcnt(0)
  s_barrier
  s_mov_b32 s3, 835584
  s_mov_b32 m0, 27648
  s_nop 0
  buffer_load_dwordx4 v21, s[16:19], s3 offen lds
  s_mov_b32 m0, 28672
  s_nop 0
  buffer_load_dwordx4 v22, s[16:19], s3 offen lds
  s_mov_b32 m0, 29696
  s_nop 0
  buffer_load_dwordx4 v23, s[16:19], s3 offen lds
  s_mov_b32 s3, 835584
  s_mov_b32 m0, 39936
  s_nop 0
  buffer_load_dwordx4 v21, s[20:23], s3 offen lds
  s_mov_b32 m0, 40960
  s_nop 0
  buffer_load_dwordx4 v22, s[20:23], s3 offen lds
  s_mov_b32 m0, 41984
  s_nop 0
  buffer_load_dwordx4 v23, s[20:23], s3 offen lds
  ds_read_b64_tr_b16 a[192:193], v27 offset:32
  ds_read_b64_tr_b16 a[194:195], v27 offset:416
  ds_read_b64_tr_b16 a[196:197], v27 offset:6176
  ds_read_b64_tr_b16 a[198:199], v27 offset:6560
  ds_read_b64_tr_b16 a[200:201], v27 offset:12320
  ds_read_b64_tr_b16 a[202:203], v27 offset:12704
  ds_read_b64_tr_b16 a[204:205], v27 offset:18464
  ds_read_b64_tr_b16 a[206:207], v27 offset:18848
  s_waitcnt vmcnt(23)
  s_waitcnt lgkmcnt(0)
  s_barrier
  s_mov_b32 s3, 1671168
  s_mov_b32 m0, 3072
  s_nop 0
  buffer_load_dwordx4 v24, s[16:19], s3 offen lds
  s_mov_b32 m0, 4096
  s_nop 0
  buffer_load_dwordx4 v25, s[16:19], s3 offen lds
  s_mov_b32 m0, 5120
  s_nop 0
  buffer_load_dwordx4 v26, s[16:19], s3 offen lds
  s_mov_b32 s3, 1671168
  s_mov_b32 m0, 15360
  s_nop 0
  buffer_load_dwordx4 v24, s[20:23], s3 offen lds
  s_mov_b32 m0, 16384
  s_nop 0
  buffer_load_dwordx4 v25, s[20:23], s3 offen lds
  s_mov_b32 m0, 17408
  s_nop 0
  buffer_load_dwordx4 v26, s[20:23], s3 offen lds
  ds_read_b64_tr_b16 v[112:113], v28 offset:12416
  ds_read_b64_tr_b16 v[114:115], v28 offset:12800
  ds_read_b64_tr_b16 v[116:117], v28 offset:18560
  ds_read_b64_tr_b16 v[118:119], v28 offset:18944
  ds_read_b64_tr_b16 a[208:209], v28 offset:32
  ds_read_b64_tr_b16 a[210:211], v28 offset:416
  ds_read_b64_tr_b16 a[212:213], v28 offset:6176
  ds_read_b64_tr_b16 a[214:215], v28 offset:6560
  ds_read_b64_tr_b16 a[216:217], v28 offset:12320
  ds_read_b64_tr_b16 a[218:219], v28 offset:12704
  ds_read_b64_tr_b16 a[220:221], v28 offset:18464
  ds_read_b64_tr_b16 a[222:223], v28 offset:18848
  s_waitcnt vmcnt(23)
  s_waitcnt lgkmcnt(0)
  s_barrier
  s_add_u32 s3, s101, 15360
  s_mov_b32 m0, 54272
  s_nop 0
  buffer_load_dwordx4 v0, s[28:31], s3 offen lds
  s_add_u32 s3, s101, 16384
  s_mov_b32 m0, 55296
  s_nop 0
  buffer_load_dwordx4 v0, s[28:31], s3 offen lds
  s_add_u32 s3, s101, 17408
  s_mov_b32 m0, 56320
  s_nop 0
  buffer_load_dwordx4 v0, s[28:31], s3 offen lds
  s_add_u32 s3, s101, 18432
  s_mov_b32 m0, 57344
  s_nop 0
  buffer_load_dwordx4 v0, s[28:31], s3 offen lds
  s_add_u32 s3, s101, 19456
  s_mov_b32 m0, 58368
  s_nop 0
  buffer_load_dwordx4 v0, s[28:31], s3 offen lds
  ds_read_b64_tr_b16 v[120:121], v28 offset:24704
  ds_read_b64_tr_b16 v[122:123], v28 offset:25088
  ds_read_b64_tr_b16 v[124:125], v28 offset:30848
  ds_read_b64_tr_b16 v[126:127], v28 offset:31232
  ds_read_b64_tr_b16 v[128:129], v28 offset:36992
  ds_read_b64_tr_b16 v[130:131], v28 offset:37376
  ds_read_b64_tr_b16 v[132:133], v28 offset:43136
  ds_read_b64_tr_b16 v[134:135], v28 offset:43520
  ds_read_b64_tr_b16 a[224:225], v28 offset:24608
  ds_read_b64_tr_b16 a[226:227], v28 offset:24992
  ds_read_b64_tr_b16 a[228:229], v28 offset:30752
  ds_read_b64_tr_b16 a[230:231], v28 offset:31136
  ds_read_b64_tr_b16 a[232:233], v28 offset:36896
  ds_read_b64_tr_b16 a[234:235], v28 offset:37280
  ds_read_b64_tr_b16 a[236:237], v28 offset:43040
  ds_read_b64_tr_b16 a[238:239], v28 offset:43424
  s_waitcnt vmcnt(22)
  s_waitcnt lgkmcnt(0)
  s_barrier
  s_mov_b32 s3, 2113536
  s_mov_b32 m0, 76800
  s_nop 0
  buffer_load_dwordx4 v21, s[16:19], s3 offen lds
  s_mov_b32 m0, 77824
  s_nop 0
  buffer_load_dwordx4 v22, s[16:19], s3 offen lds
  s_mov_b32 m0, 78848
  s_nop 0
  buffer_load_dwordx4 v23, s[16:19], s3 offen lds
  s_mov_b32 s3, 2113536
  s_mov_b32 m0, 89088
  s_nop 0
  buffer_load_dwordx4 v21, s[20:23], s3 offen lds
  s_mov_b32 m0, 90112
  s_nop 0
  buffer_load_dwordx4 v22, s[20:23], s3 offen lds
  s_mov_b32 m0, 91136
  s_nop 0
  buffer_load_dwordx4 v23, s[20:23], s3 offen lds
  ds_read_b64_tr_b16 a[16:17], v29 offset:96
  ds_read_b64_tr_b16 a[18:19], v29 offset:480
  ds_read_b64_tr_b16 a[20:21], v29 offset:6240
  ds_read_b64_tr_b16 a[22:23], v29 offset:6624
  ds_read_b64_tr_b16 a[24:25], v29 offset:128
  ds_read_b64_tr_b16 a[26:27], v29 offset:512
  ds_read_b64_tr_b16 a[28:29], v29 offset:6272
  ds_read_b64_tr_b16 a[30:31], v29 offset:6656
  ds_read_b64_tr_b16 a[32:33], v29 offset:160
  ds_read_b64_tr_b16 a[34:35], v29 offset:544
  ds_read_b64_tr_b16 a[36:37], v29 offset:6304
  ds_read_b64_tr_b16 a[38:39], v29 offset:6688
  s_waitcnt vmcnt(23)
  s_waitcnt lgkmcnt(0)
  s_barrier
  s_mov_b32 s3, 2899968
  s_mov_b32 m0, 101376
  s_nop 0
  buffer_load_dwordx4 v21, s[16:19], s3 offen lds
  s_mov_b32 m0, 102400
  s_nop 0
  buffer_load_dwordx4 v22, s[16:19], s3 offen lds
  s_mov_b32 m0, 103424
  s_nop 0
  buffer_load_dwordx4 v23, s[16:19], s3 offen lds
  s_mov_b32 s3, 2899968
  s_mov_b32 m0, 113664
  s_nop 0
  buffer_load_dwordx4 v21, s[20:23], s3 offen lds
  s_mov_b32 m0, 114688
  s_nop 0
  buffer_load_dwordx4 v22, s[20:23], s3 offen lds
  s_mov_b32 m0, 115712
  s_nop 0
  buffer_load_dwordx4 v23, s[20:23], s3 offen lds
  ds_read_b64_tr_b16 v[136:137], v14 offset:24896
  ds_read_b64_tr_b16 v[138:139], v14 offset:27456
  ds_read_b64_tr_b16 v[144:145], v14 offset:24960
  ds_read_b64_tr_b16 v[146:147], v14 offset:27520
  ds_read_b64_tr_b16 v[152:153], v14 offset:25024
  ds_read_b64_tr_b16 v[154:155], v14 offset:27584
  ds_read_b64_tr_b16 v[160:161], v14 offset:25088
  ds_read_b64_tr_b16 v[162:163], v14 offset:27648
  ds_read_b64_tr_b16 v[168:169], v14 offset:25152
  ds_read_b64_tr_b16 v[170:171], v14 offset:27712
  s_waitcnt vmcnt(23)
  s_waitcnt lgkmcnt(0)
  s_barrier
  s_add_u32 s3, s101, 46080
  s_mov_b32 m0, 128000
  s_nop 0
  buffer_load_dwordx4 v0, s[28:31], s3 offen lds
  s_add_u32 s3, s101, 47104
  s_mov_b32 m0, 129024
  s_nop 0
  buffer_load_dwordx4 v0, s[28:31], s3 offen lds
  s_add_u32 s3, s101, 48128
  s_mov_b32 m0, 130048
  s_nop 0
  buffer_load_dwordx4 v0, s[28:31], s3 offen lds
  s_add_u32 s3, s101, 49152
  s_mov_b32 m0, 131072
  s_nop 0
  buffer_load_dwordx4 v0, s[28:31], s3 offen lds
  s_add_u32 s3, s101, 50176
  s_mov_b32 m0, 132096
  s_nop 0
  buffer_load_dwordx4 v0, s[28:31], s3 offen lds
  ds_read_b64_tr_b16 a[40:41], v27 offset:24672
  ds_read_b64_tr_b16 a[42:43], v27 offset:25056
  ds_read_b64_tr_b16 a[44:45], v27 offset:30816
  ds_read_b64_tr_b16 a[46:47], v27 offset:31200
  ds_read_b64_tr_b16 a[48:49], v27 offset:24704
  ds_read_b64_tr_b16 a[50:51], v27 offset:25088
  ds_read_b64_tr_b16 a[52:53], v27 offset:30848
  ds_read_b64_tr_b16 a[54:55], v27 offset:31232
  ds_read_b64_tr_b16 a[56:57], v27 offset:24736
  ds_read_b64_tr_b16 a[58:59], v27 offset:25120
  ds_read_b64_tr_b16 a[60:61], v27 offset:30880
  ds_read_b64_tr_b16 a[62:63], v27 offset:31264
  s_waitcnt vmcnt(22)
  s_waitcnt lgkmcnt(0)
  s_barrier
  s_mov_b32 s3, 3981312
  s_mov_b32 m0, 27648
  s_nop 0
  buffer_load_dwordx4 v21, s[16:19], s3 offen lds
  s_mov_b32 m0, 28672
  s_nop 0
  buffer_load_dwordx4 v22, s[16:19], s3 offen lds
  s_mov_b32 m0, 29696
  s_nop 0
  buffer_load_dwordx4 v23, s[16:19], s3 offen lds
  s_mov_b32 s3, 3981312
  s_mov_b32 m0, 39936
  s_nop 0
  buffer_load_dwordx4 v21, s[20:23], s3 offen lds
  s_mov_b32 m0, 40960
  s_nop 0
  buffer_load_dwordx4 v22, s[20:23], s3 offen lds
  s_mov_b32 m0, 41984
  s_nop 0
  buffer_load_dwordx4 v23, s[20:23], s3 offen lds
  ds_read_b64_tr_b16 v[32:33], v27 offset:96
  ds_read_b64_tr_b16 v[34:35], v27 offset:480
  ds_read_b64_tr_b16 v[36:37], v27 offset:6240
  ds_read_b64_tr_b16 v[38:39], v27 offset:6624
  ds_read_b64_tr_b16 v[40:41], v27 offset:128
  ds_read_b64_tr_b16 v[42:43], v27 offset:512
  ds_read_b64_tr_b16 v[44:45], v27 offset:6272
  ds_read_b64_tr_b16 v[46:47], v27 offset:6656
  ds_read_b64_tr_b16 v[48:49], v27 offset:160
  ds_read_b64_tr_b16 v[50:51], v27 offset:544
  ds_read_b64_tr_b16 v[52:53], v27 offset:6304
  ds_read_b64_tr_b16 v[54:55], v27 offset:6688
  s_waitcnt vmcnt(23)
  s_waitcnt lgkmcnt(0)
  s_barrier
  s_mov_b32 s3, 4767744
  s_mov_b32 m0, 3072
  s_nop 0
  buffer_load_dwordx4 v21, s[16:19], s3 offen lds
  s_mov_b32 m0, 4096
  s_nop 0
  buffer_load_dwordx4 v22, s[16:19], s3 offen lds
  s_mov_b32 m0, 5120
  s_nop 0
  buffer_load_dwordx4 v23, s[16:19], s3 offen lds
  s_mov_b32 s3, 4767744
  s_mov_b32 m0, 15360
  s_nop 0
  buffer_load_dwordx4 v21, s[20:23], s3 offen lds
  s_mov_b32 m0, 16384
  s_nop 0
  buffer_load_dwordx4 v22, s[20:23], s3 offen lds
  s_mov_b32 m0, 17408
  s_nop 0
  buffer_load_dwordx4 v23, s[20:23], s3 offen lds
  ds_read_b64_tr_b16 v[140:141], v31 offset:320
  ds_read_b64_tr_b16 v[142:143], v31 offset:2880
  ds_read_b64_tr_b16 v[148:149], v31 offset:384
  ds_read_b64_tr_b16 v[150:151], v31 offset:2944
  ds_read_b64_tr_b16 v[156:157], v31 offset:448
  ds_read_b64_tr_b16 v[158:159], v31 offset:3008
  ds_read_b64_tr_b16 v[164:165], v31 offset:512
  ds_read_b64_tr_b16 v[166:167], v31 offset:3072
  ds_read_b64_tr_b16 v[172:173], v31 offset:576
  ds_read_b64_tr_b16 v[174:175], v31 offset:3136
  s_waitcnt vmcnt(23)
  s_waitcnt lgkmcnt(0)
  s_barrier
  s_add_u32 s3, s101, 56320
  s_mov_b32 m0, 54272
  s_nop 0
  buffer_load_dwordx4 v0, s[28:31], s3 offen lds
  s_add_u32 s3, s101, 57344
  s_mov_b32 m0, 55296
  s_nop 0
  buffer_load_dwordx4 v0, s[28:31], s3 offen lds
  s_add_u32 s3, s101, 58368
  s_mov_b32 m0, 56320
  s_nop 0
  buffer_load_dwordx4 v0, s[28:31], s3 offen lds
  s_add_u32 s3, s101, 59392
  s_mov_b32 m0, 57344
  s_nop 0
  buffer_load_dwordx4 v0, s[28:31], s3 offen lds
  s_add_u32 s3, s101, 60416
  s_mov_b32 m0, 58368
  s_nop 0
  buffer_load_dwordx4 v0, s[28:31], s3 offen lds
  ds_read_b64_tr_b16 v[56:57], v28 offset:24672
  ds_read_b64_tr_b16 v[58:59], v28 offset:25056
  ds_read_b64_tr_b16 v[60:61], v28 offset:30816
  ds_read_b64_tr_b16 v[62:63], v28 offset:31200
  ds_read_b64_tr_b16 v[64:65], v28 offset:24704
  ds_read_b64_tr_b16 v[66:67], v28 offset:25088
  ds_read_b64_tr_b16 v[68:69], v28 offset:30848
  ds_read_b64_tr_b16 v[70:71], v28 offset:31232
  ds_read_b64_tr_b16 a[0:1], v28 offset:24736
  ds_read_b64_tr_b16 a[2:3], v28 offset:25120
  ds_read_b64_tr_b16 a[4:5], v28 offset:30880
  ds_read_b64_tr_b16 a[6:7], v28 offset:31264
  s_waitcnt vmcnt(22)
  s_waitcnt lgkmcnt(0)
  s_barrier
  s_mov_b32 s3, 5603328
  s_mov_b32 m0, 76800
  s_nop 0
  buffer_load_dwordx4 v24, s[16:19], s3 offen lds
  s_mov_b32 m0, 77824
  s_nop 0
  buffer_load_dwordx4 v25, s[16:19], s3 offen lds
  s_mov_b32 m0, 78848
  s_nop 0
  buffer_load_dwordx4 v26, s[16:19], s3 offen lds
  s_mov_b32 s3, 5603328
  s_mov_b32 m0, 89088
  s_nop 0
  buffer_load_dwordx4 v24, s[20:23], s3 offen lds
  s_mov_b32 m0, 90112
  s_nop 0
  buffer_load_dwordx4 v25, s[20:23], s3 offen lds
  s_mov_b32 m0, 91136
  s_nop 0
  buffer_load_dwordx4 v26, s[20:23], s3 offen lds
  ds_read_b64_tr_b16 a[64:65], v29 offset:96
  ds_read_b64_tr_b16 a[66:67], v29 offset:480
  ds_read_b64_tr_b16 a[68:69], v29 offset:6240
  ds_read_b64_tr_b16 a[70:71], v29 offset:6624
  ds_read_b64_tr_b16 a[72:73], v29 offset:128
  ds_read_b64_tr_b16 a[74:75], v29 offset:512
  ds_read_b64_tr_b16 a[76:77], v29 offset:6272
  ds_read_b64_tr_b16 a[78:79], v29 offset:6656
  ds_read_b64_tr_b16 a[80:81], v29 offset:160
  ds_read_b64_tr_b16 a[82:83], v29 offset:544
  ds_read_b64_tr_b16 a[84:85], v29 offset:6304
  ds_read_b64_tr_b16 a[86:87], v29 offset:6688
  s_waitcnt vmcnt(23)
  s_waitcnt lgkmcnt(0)
  s_barrier
  s_mov_b32 s3, 6045696
  s_mov_b32 m0, 101376
  s_nop 0
  buffer_load_dwordx4 v21, s[16:19], s3 offen lds
  s_mov_b32 m0, 102400
  s_nop 0
  buffer_load_dwordx4 v22, s[16:19], s3 offen lds
  s_mov_b32 m0, 103424
  s_nop 0
  buffer_load_dwordx4 v23, s[16:19], s3 offen lds
  s_mov_b32 s3, 6045696
  s_mov_b32 m0, 113664
  s_nop 0
  buffer_load_dwordx4 v21, s[20:23], s3 offen lds
  s_mov_b32 m0, 114688
  s_nop 0
  buffer_load_dwordx4 v22, s[20:23], s3 offen lds
  s_mov_b32 m0, 115712
  s_nop 0
  buffer_load_dwordx4 v23, s[20:23], s3 offen lds
  ds_read_b64_tr_b16 v[176:177], v14 offset:24896
  ds_read_b64_tr_b16 v[178:179], v14 offset:27456
  ds_read_b64_tr_b16 v[184:185], v14 offset:24960
  ds_read_b64_tr_b16 v[186:187], v14 offset:27520
  ds_read_b64_tr_b16 v[192:193], v14 offset:25024
  ds_read_b64_tr_b16 v[194:195], v14 offset:27584
  ds_read_b64_tr_b16 v[200:201], v14 offset:25088
  ds_read_b64_tr_b16 v[202:203], v14 offset:27648
  ds_read_b64_tr_b16 v[208:209], v14 offset:25152
  ds_read_b64_tr_b16 v[210:211], v14 offset:27712
  s_waitcnt vmcnt(23)
  s_waitcnt lgkmcnt(0)
  s_barrier
  v_min_u32 v254, 8, v20
  v_lshlrev_b32 v254, 3, v254
  buffer_load_dwordx2 v[252:253], v254, s[12:15], s97 offen sc1
  s_mov_b32 s3, 6832128
  s_mov_b32 m0, 125952
  s_nop 0
  buffer_load_dwordx4 v21, s[16:19], s3 offen lds
  s_mov_b32 m0, 126976
  s_nop 0
  buffer_load_dwordx4 v22, s[16:19], s3 offen lds
  s_mov_b32 m0, 128000
  s_nop 0
  buffer_load_dwordx4 v23, s[16:19], s3 offen lds
  s_mov_b32 s3, 6832128
  s_mov_b32 m0, 138240
  s_nop 0
  buffer_load_dwordx4 v21, s[20:23], s3 offen lds
  s_mov_b32 m0, 139264
  s_nop 0
  buffer_load_dwordx4 v22, s[20:23], s3 offen lds
  s_mov_b32 m0, 140288
  s_nop 0
  buffer_load_dwordx4 v23, s[20:23], s3 offen lds
  ds_read_b64_tr_b16 a[88:89], v27 offset:24672
  ds_read_b64_tr_b16 a[90:91], v27 offset:25056
  ds_read_b64_tr_b16 a[92:93], v27 offset:30816
  ds_read_b64_tr_b16 a[94:95], v27 offset:31200
  ds_read_b64_tr_b16 a[96:97], v27 offset:24704
  ds_read_b64_tr_b16 a[98:99], v27 offset:25088
  ds_read_b64_tr_b16 a[100:101], v27 offset:30848
  ds_read_b64_tr_b16 a[102:103], v27 offset:31232
  ds_read_b64_tr_b16 a[104:105], v27 offset:24736
  ds_read_b64_tr_b16 a[106:107], v27 offset:25120
  ds_read_b64_tr_b16 a[108:109], v27 offset:30880
  ds_read_b64_tr_b16 a[110:111], v27 offset:31264
  s_waitcnt vmcnt(24)
  s_waitcnt lgkmcnt(0)
  s_barrier
  s_add_u32 s3, s101, 87040
  s_mov_b32 m0, 29696
  s_nop 0
  buffer_load_dwordx4 v0, s[28:31], s3 offen lds
  s_add_u32 s3, s101, 88064
  s_mov_b32 m0, 30720
  s_nop 0
  buffer_load_dwordx4 v0, s[28:31], s3 offen lds
  s_add_u32 s3, s101, 89088
  s_mov_b32 m0, 31744
  s_nop 0
  buffer_load_dwordx4 v0, s[28:31], s3 offen lds
  s_add_u32 s3, s101, 90112
  s_mov_b32 m0, 32768
  s_nop 0
  buffer_load_dwordx4 v0, s[28:31], s3 offen lds
  s_add_u32 s3, s101, 91136
  s_mov_b32 m0, 33792
  s_nop 0
  buffer_load_dwordx4 v0, s[28:31], s3 offen lds
  ds_read_b64_tr_b16 a[112:113], v27 offset:96
  ds_read_b64_tr_b16 a[114:115], v27 offset:480
  ds_read_b64_tr_b16 a[116:117], v27 offset:6240
  ds_read_b64_tr_b16 a[118:119], v27 offset:6624
  ds_read_b64_tr_b16 a[120:121], v27 offset:128
  ds_read_b64_tr_b16 a[122:123], v27 offset:512
  ds_read_b64_tr_b16 a[124:125], v27 offset:6272
  ds_read_b64_tr_b16 a[126:127], v27 offset:6656
  ds_read_b64_tr_b16 a[152:153], v27 offset:160
  ds_read_b64_tr_b16 a[154:155], v27 offset:544
  ds_read_b64_tr_b16 a[156:157], v27 offset:6304
  ds_read_b64_tr_b16 a[158:159], v27 offset:6688
  s_waitcnt vmcnt(24)
  s_waitcnt lgkmcnt(0)
  s_barrier
  s_add_u32 s3, s101, 97280
  s_mov_b32 m0, 5120
  s_nop 0
  buffer_load_dwordx4 v0, s[28:31], s3 offen lds
  s_add_u32 s3, s101, 98304
  s_mov_b32 m0, 6144
  s_nop 0
  buffer_load_dwordx4 v0, s[28:31], s3 offen lds
  s_add_u32 s3, s101, 99328
  s_mov_b32 m0, 7168
  s_nop 0
  buffer_load_dwordx4 v0, s[28:31], s3 offen lds
  s_add_u32 s3, s101, 100352
  s_mov_b32 m0, 8192
  s_nop 0
  buffer_load_dwordx4 v0, s[28:31], s3 offen lds
  s_add_u32 s3, s101, 101376
  s_mov_b32 m0, 9216
  s_nop 0
  buffer_load_dwordx4 v0, s[28:31], s3 offen lds
  ds_read_b64_tr_b16 v[180:181], v31 offset:320
  ds_read_b64_tr_b16 v[182:183], v31 offset:2880
  ds_read_b64_tr_b16 v[188:189], v31 offset:384
  ds_read_b64_tr_b16 v[190:191], v31 offset:2944
  ds_read_b64_tr_b16 v[196:197], v31 offset:448
  ds_read_b64_tr_b16 v[198:199], v31 offset:3008
  ds_read_b64_tr_b16 v[204:205], v31 offset:512
  ds_read_b64_tr_b16 v[206:207], v31 offset:3072
  ds_read_b64_tr_b16 v[212:213], v31 offset:576
  ds_read_b64_tr_b16 v[214:215], v31 offset:3136
  s_waitcnt vmcnt(23)
  s_waitcnt lgkmcnt(0)
  s_barrier
  ds_read_b64_tr_b16 v[72:73], v28 offset:24672
  ds_read_b64_tr_b16 v[74:75], v28 offset:25056
  ds_read_b64_tr_b16 v[76:77], v28 offset:30816
  ds_read_b64_tr_b16 v[78:79], v28 offset:31200
  ds_read_b64_tr_b16 a[128:129], v28 offset:24704
  ds_read_b64_tr_b16 a[130:131], v28 offset:25088
  ds_read_b64_tr_b16 a[132:133], v28 offset:30848
  ds_read_b64_tr_b16 a[134:135], v28 offset:31232
  ds_read_b64_tr_b16 a[160:161], v28 offset:24736
  ds_read_b64_tr_b16 a[162:163], v28 offset:25120
  ds_read_b64_tr_b16 a[164:165], v28 offset:30880
  ds_read_b64_tr_b16 a[166:167], v28 offset:31264
  s_waitcnt vmcnt(17)
  s_waitcnt lgkmcnt(0)
  s_barrier
  ds_read_b64_tr_b16 v[80:81], v29 offset:96
  ds_read_b64_tr_b16 v[82:83], v29 offset:480
  ds_read_b64_tr_b16 v[84:85], v29 offset:6240
  ds_read_b64_tr_b16 v[86:87], v29 offset:6624
  ds_read_b64_tr_b16 a[136:137], v29 offset:128
  ds_read_b64_tr_b16 a[138:139], v29 offset:512
  ds_read_b64_tr_b16 a[140:141], v29 offset:6272
  ds_read_b64_tr_b16 a[142:143], v29 offset:6656
  ds_read_b64_tr_b16 a[168:169], v29 offset:160
  ds_read_b64_tr_b16 a[170:171], v29 offset:544
  ds_read_b64_tr_b16 a[172:173], v29 offset:6304
  ds_read_b64_tr_b16 a[174:175], v29 offset:6688
  s_waitcnt vmcnt(10)
  s_waitcnt lgkmcnt(0)
  s_barrier
  ds_read_b64_tr_b16 v[88:89], v29 offset:24672
  ds_read_b64_tr_b16 v[90:91], v29 offset:25056
  ds_read_b64_tr_b16 v[92:93], v29 offset:30816
  ds_read_b64_tr_b16 v[94:95], v29 offset:31200
  ds_read_b64_tr_b16 a[144:145], v29 offset:24704
  ds_read_b64_tr_b16 a[146:147], v29 offset:25088
  ds_read_b64_tr_b16 a[148:149], v29 offset:30848
  ds_read_b64_tr_b16 a[150:151], v29 offset:31232
  ds_read_b64_tr_b16 a[176:177], v29 offset:24736
  ds_read_b64_tr_b16 a[178:179], v29 offset:25120
  ds_read_b64_tr_b16 a[180:181], v29 offset:30880
  ds_read_b64_tr_b16 a[182:183], v29 offset:31264
  s_waitcnt vmcnt(5)
  s_waitcnt lgkmcnt(0)
  s_barrier
  s_waitcnt vmcnt(16)
  buffer_load_dword v22, off, s[8:11], s68 sc1
  v_not_b32 v254, v252
  v_xor_b32 v255, 0x2000, v253
  v_or_b32 v254, v254, v255
  v_cmp_ne_u32 vcc, 0, v254
  v_readlane_b32 s64, v252, 8
  s_and_b32 s3, vcc_lo, 0xff
  s_cselect_b32 s63, 0, -1
  s_cmp_eq_u32 s64, 0
  s_cselect_b32 s63, 0, s63
  ds_read_b64_tr_b16 v[216:217], v30 offset:24896
  ds_read_b64_tr_b16 v[218:219], v30 offset:27456
  ds_read_b64_tr_b16 v[224:225], v30 offset:24960
  ds_read_b64_tr_b16 v[226:227], v30 offset:27520
  ds_read_b64_tr_b16 v[232:233], v30 offset:25024
  ds_read_b64_tr_b16 v[234:235], v30 offset:27584
  ds_read_b64_tr_b16 v[240:241], v30 offset:25088
  ds_read_b64_tr_b16 v[242:243], v30 offset:27648
  ds_read_b64_tr_b16 v[248:249], v30 offset:25152
  ds_read_b64_tr_b16 v[250:251], v30 offset:27712
  ds_write_b128 v3, v[32:35] offset:0
  ds_write_b128 v3, v[36:39] offset:1024
  ds_write_b128 v3, v[40:43] offset:2048
  ds_write_b128 v3, v[44:47] offset:3072
  ds_write_b128 v3, v[48:51] offset:4096
  ds_write_b128 v3, v[52:55] offset:5120
  ds_write_b128 v3, v[56:59] offset:6144
  ds_write_b128 v3, v[60:63] offset:7168
  ds_write_b128 v3, v[64:67] offset:8192
  ds_write_b128 v3, v[68:71] offset:9216
  ds_write_b128 v3, v[72:75] offset:10240
  ds_write_b128 v3, v[76:79] offset:11264
  ds_write_b128 v3, v[80:83] offset:12288
  ds_write_b128 v3, v[84:87] offset:13312
  ds_write_b128 v3, v[88:91] offset:14336
  ds_write_b128 v3, v[92:95] offset:15360
  ds_write_b128 v3, v[96:99] offset:16384
  ds_write_b128 v3, v[100:103] offset:17408
  ds_write_b128 v3, v[104:107] offset:18432
  ds_write_b128 v3, v[108:111] offset:19456
  ds_write_b128 v3, v[112:115] offset:20480
  ds_write_b128 v3, v[116:119] offset:21504
  ds_write_b128 v3, v[120:123] offset:22528
  ds_write_b128 v3, v[124:127] offset:23552
  ds_write_b128 v3, v[128:131] offset:24576
  ds_write_b128 v3, v[132:135] offset:25600
  s_waitcnt vmcnt(0)
  s_waitcnt lgkmcnt(0)
  s_barrier
  v_readfirstlane_b32 s38, v22
  s_and_b32 s38, s38, s63
  s_cbranch_scc0 L131_cslow
L132_cback:
  s_mov_b32 m0, s69
  s_nop 0
  buffer_load_dwordx4 v0, s[8:11], s65 offen offset:0 sc1 lds
  buffer_load_dwordx4 v0, s[8:11], s65 offen offset:1024 sc1 lds
  buffer_load_dwordx4 v0, s[8:11], s65 offen offset:2048 sc1 lds
  ds_read_b64_tr_b16 v[220:221], v30 offset:320
  ds_read_b64_tr_b16 v[222:223], v30 offset:2880
  ds_read_b64_tr_b16 v[228:229], v30 offset:384
  ds_read_b64_tr_b16 v[230:231], v30 offset:2944
  ds_read_b64_tr_b16 v[236:237], v30 offset:448
  ds_read_b64_tr_b16 v[238:239], v30 offset:3008
  ds_read_b64_tr_b16 v[244:245], v30 offset:512
  ds_read_b64_tr_b16 v[246:247], v30 offset:3072
  ds_read_b64_tr_b16 v[252:253], v30 offset:576
  ds_read_b64_tr_b16 v[254:255], v30 offset:3136
  s_and_b32 s64, s64, 8192
  s_add_u32 s57, s57, s64
  s_add_u32 s58, s58, s64
  s_add_u32 s65, s65, 393216
  s_waitcnt vmcnt(0) lgkmcnt(0)
  v_mov_b32 v14, s38
  s_barrier
  ds_read_b128 v[60:63], v3 offset:0
  ds_read_b128 v[64:67], v3 offset:1024
  ds_read_b128 v[68:71], v3 offset:2048
  ds_read_b128 v[72:75], v3 offset:3072
  ds_read_b128 v[76:79], v3 offset:4096
  ds_read_b128 v[80:83], v3 offset:5120
  ds_read_b128 v[84:87], v3 offset:6144
  ds_read_b128 v[88:91], v3 offset:7168
  ds_read_b128 v[92:95], v3 offset:8192
  ds_read_b128 v[96:99], v3 offset:9216
  ds_read_b128 v[100:103], v0 offset:44032
  ds_read_b128 v[104:107], v0 offset:45056
  ds_read_b128 v[108:111], v0 offset:46080
  v_mov_b32 v112, 0
  v_mov_b32 v113, 0
  v_mov_b32 v114, 0
  v_mov_b32 v115, 0
  v_mov_b32 v116, 0
  v_mov_b32 v117, 0
  v_mov_b32 v118, 0
  v_mov_b32 v119, 0
  v_mov_b32 v120, 0
  v_mov_b32 v121, 0
  v_mov_b32 v122, 0
  v_mov_b32 v123, 0
  v_mov_b32 v124, 0
  v_mov_b32 v125, 0
  v_mov_b32 v126, 0
  v_mov_b32 v127, 0
  v_mov_b32 v128, 0
  v_mov_b32 v129, 0
  v_mov_b32 v130, 0
  v_mov_b32 v131, 0
  s_cmp_eq_u32 s97, 0
  s_cbranch_scc1 L133_fast
  s_branch L134_slow
L131_cslow:
  v_mbcnt_lo_u32_b32 v24, -1, 0
  v_min_u32 v24, 8, v24
  v_lshlrev_b32 v24, 3, v24
L200001_cen:
  buffer_load_dwordx2 v[22:23], v24, s[12:15], s97 offen sc1
  s_sub_u32 s37, s37, 1
  s_cbranch_scc1 L130_bail
  s_waitcnt vmcnt(0)
  v_not_b32 v25, v22
  v_xor_b32 v26, 0x2000, v23
  v_or_b32 v25, v25, v26
  v_cmp_ne_u32 vcc, 0, v25
  s_and_b32 s3, vcc_lo, 0xff
  s_cbranch_scc0 L200002_cok
  v_lshrrev_b32 v23, 8, v23
  s_nop 1
  v_add_u32_dpp v23, v23, v23 row_shr:1 row_mask:0xf bank_mask:0xf bound_ctrl:1
  s_nop 1
  v_add_u32_dpp v23, v23, v23 row_shr:2 row_mask:0xf bank_mask:0xf bound_ctrl:1
  s_nop 1
  v_add_u32_dpp v23, v23, v23 row_shr:4 row_mask:0xf bank_mask:0xf bound_ctrl:1
  s_nop 0
  v_readlane_b32 s3, v23, 7
  s_cmp_lt_u32 s3, 256
  s_cbranch_scc1 L200001_cen
  s_branch L_restart
L200002_cok:
  v_readlane_b32 s64, v22, 8
  s_cmp_eq_u32 s64, 0
  s_cbranch_scc1 L200001_cen
  s_cmp_lt_u32 s38, s62
  s_cbranch_scc1 L200003_pw
L200004_pwb:
  s_branch L132_cback
L200003_pw:
  buffer_load_dword v14, off, s[8:11], s68 sc1
  s_sub_u32 s37, s37, 1
  s_cbranch_scc1 L130_bail
  s_waitcnt vmcnt(0)
  v_readfirstlane_b32 s38, v14
  s_cmp_lt_u32 s38, s62
  s_cbranch_scc1 L200003_pw
  s_branch L200004_pwb
L133_fast:
L135_top:
  v_bfe_u32 v46, v1, 2, 1
  v_lshlrev_b32 v46, 4, v46
  v_lshlrev_b32 v46, v46, s39
  v_cndmask_b32 v44, v46, 0, s[42:43]
  v_cndmask_b32 v45, 0, v46, s[42:43]
  buffer_load_dwordx4 v[20:23], v2, s[8:11], s56 offen offset:0 sc1
  buffer_load_dwordx4 v[24:27], v2, s[8:11], s56 offen offset:1024 sc1
  s_add_u32 s62, s36, 2
  s_min_u32 s62, s62, 64
  v_readfirstlane_b32 s38, v14
  s_mov_b32 m0, s69
  s_cmp_lt_u32 s38, s62
  s_cbranch_scc1 L138_pw
L139_pwb:
  s_waitcnt vmcnt(1)
  v_bitop3_b32 v132, v20, v22, s60 bitop3:0x7e
  s_waitcnt vmcnt(0)
  v_bitop3_b32 v133, v24, v26, s60 bitop3:0x7e
  v_bitop3_b32 v132, v132, v133, 1 bitop3:0xa8
  v_cmp_ne_u32 vcc, 0, v132
  s_cbranch_vccnz L140_f1
L141_b1:
  buffer_load_dwordx4 v[28:31], v8, s[8:11], s58 offen offset:0 sc1
  buffer_load_dwordx4 v[32:35], v8, s[8:11], s58 offen offset:1024 sc1
L144_b3:
L143_b2:
  v_mfma_f32_4x4x4_16b_bf16 v[36:39], v[44:45], v[20:21], 0
  v_mfma_f32_4x4x4_16b_bf16 v[48:51], v[44:45], v[22:23], 0
  v_mfma_f32_4x4x4_16b_bf16 v[40:43], v[44:45], v[24:25], 0
  v_mfma_f32_4x4x4_16b_bf16 v[52:55], v[44:45], v[26:27], 0
  s_waitcnt lgkmcnt(0)
  s_waitcnt vmcnt(1)
  v_mfma_f32_4x4x4_16b_bf16 v[36:39], v[44:45], v[28:29], v[36:39]
  v_mfma_f32_4x4x4_16b_bf16 v[48:51], v[44:45], v[30:31], v[48:51]
  v_bitop3_b32 v132, v28, v30, s60 bitop3:0x7e
  s_waitcnt vmcnt(0)
  v_mfma_f32_4x4x4_16b_bf16 v[40:43], v[44:45], v[32:33], v[40:43]
  v_mfma_f32_4x4x4_16b_bf16 v[52:55], v[44:45], v[34:35], v[52:55]
  v_bitop3_b32 v133, v32, v34, s60 bitop3:0x7e
  v_bitop3_b32 v132, v132, v133, 1 bitop3:0xa8
  v_cmp_ne_u32 vcc, 0, v132
  v_cvt_pk_bf16_f32 v28, v36, v37
  v_cvt_pk_bf16_f32 v29, v38, v39
  v_cvt_pk_bf16_f32 v30, v48, v49
  v_cvt_pk_bf16_f32 v31, v50, v51
  ds_write_b128 v0, v[28:31] offset:2048
  v_cvt_pk_bf16_f32 v32, v40, v41
  v_cvt_pk_bf16_f32 v33, v42, v43
  s_cbranch_vccnz L142_f2
  v_cvt_pk_bf16_f32 v34, v52, v53
  v_cvt_pk_bf16_f32 v35, v54, v55
  ds_write_b128 v0, v[32:35] offset:3072
L137_rl:
  v_smfmac_f32_16x16x64_bf16 v[112:115], v[28:31], v[60:67], v13
  v_smfmac_f32_16x16x64_bf16 v[116:119], v[28:31], v[68:75], v13
  v_smfmac_f32_16x16x64_bf16 v[120:123], v[28:31], v[76:83], v13
  s_waitcnt lgkmcnt(0)
  s_barrier
  ds_read_b128 v[20:23], v0 offset:0
  ds_read_b128 v[24:27], v0 offset:1024
  v_smfmac_f32_16x16x64_bf16 v[112:115], v[32:35], v[84:91], v13
  ds_read_b128 v[36:39], v0 offset:4096
  buffer_load_dwordx4 v0, s[8:11], s65 offen offset:0 sc1 lds
  v_smfmac_f32_16x16x64_bf16 v[116:119], v[32:35], v[92:99], v13
  ds_read_b128 v[40:43], v0 offset:5120
  v_smfmac_f32_16x16x64_bf16 v[120:123], v[32:35], a[0:7], v13
  ds_read_b128 v[44:47], v0 offset:6144
  buffer_load_dwordx4 v0, s[8:11], s65 offen offset:1024 sc1 lds
  v_smfmac_f32_16x16x64_bf16 v[124:127], v[28:31], a[8:15], v13
  ds_read_b128 v[48:51], v0 offset:7168
  s_waitcnt lgkmcnt(5)
  v_smfmac_f32_16x16x64_bf16 v[112:115], v[20:23], a[16:23], v13
  ds_read_b128 v[52:55], v0 offset:8192
  buffer_load_dwordx4 v0, s[8:11], s65 offen offset:2048 sc1 lds
  v_smfmac_f32_16x16x64_bf16 v[116:119], v[20:23], a[24:31], v13
  ds_read_b128 v[56:59], v0 offset:9216
  v_smfmac_f32_16x16x64_bf16 v[120:123], v[20:23], a[32:39], v13
  ds_read_b128 v[60:63], v3 offset:10240
  buffer_load_dword v14, off, s[8:11], s68 sc1
  s_waitcnt lgkmcnt(7)
  v_smfmac_f32_16x16x64_bf16 v[112:115], v[24:27], a[40:47], v13
  ds_read_b128 v[64:67], v3 offset:11264
  v_smfmac_f32_16x16x64_bf16 v[116:119], v[24:27], a[48:55], v13
  ds_read_b128 v[68:71], v3 offset:12288
  v_not_b32 v132, s61
  v_not_b32 v133, s61
  v_smfmac_f32_16x16x64_bf16 v[120:123], v[24:27], a[56:63], v13
  ds_read_b128 v[72:75], v3 offset:13312
  s_waitcnt lgkmcnt(9)
  v_smfmac_f32_16x16x64_bf16 v[112:115], v[36:39], a[64:71], v13
  ds_read_b128 v[76:79], v3 offset:14336
  buffer_store_dwordx2 v[132:133], v7, s[8:11], s57 offen sc1
  v_smfmac_f32_16x16x64_bf16 v[116:119], v[36:39], a[72:79], v13
  ds_read_b128 v[80:83], v3 offset:15360
  v_smfmac_f32_16x16x64_bf16 v[120:123], v[36:39], a[80:87], v13
  ds_read_b128 v[84:87], v3 offset:16384
  s_waitcnt lgkmcnt(11)
  v_smfmac_f32_16x16x64_bf16 v[112:115], v[40:43], a[88:95], v13
  ds_read_b128 v[88:91], v3 offset:17408
  v_smfmac_f32_16x16x64_bf16 v[116:119], v[40:43], a[96:103], v13
  ds_read_b128 v[92:95], v3 offset:18432
  v_smfmac_f32_16x16x64_bf16 v[120:123], v[40:43], a[104:111], v13
  ds_read_b128 v[96:99], v3 offset:19456
  s_waitcnt lgkmcnt(13)
  v_smfmac_f32_16x16x64_bf16 v[112:115], v[44:47], a[112:119], v13
  s_waitcnt lgkmcnt(12)
  s_waitcnt lgkmcnt(8)
  v_smfmac_f32_16x16x64_bf16 v[112:115], v[48:51], v[60:67], v13
  ds_read_b128 v[60:63], v3 offset:20480
  s_waitcnt lgkmcnt(7)
  v_smfmac_f32_16x16x64_bf16 v[112:115], v[52:55], v[68:75], v13
  ds_read_b128 v[64:67], v3 offset:21504
  s_waitcnt lgkmcnt(6)
  v_smfmac_f32_16x16x64_bf16 v[112:115], v[56:59], v[76:83], v13
  ds_read_b128 v[68:71], v3 offset:22528
  v_smfmac_f32_16x16x64_bf16 v[116:119], v[44:47], a[120:127], v13
  ds_read_b128 v[72:75], v3 offset:23552
  v_smfmac_f32_16x16x64_bf16 v[116:119], v[48:51], a[128:135], v13
  ds_read_b128 v[76:79], v3 offset:24576
  v_add_f32 v112, v112, v114
  v_smfmac_f32_16x16x64_bf16 v[116:119], v[52:55], a[136:143], v13
  ds_read_b128 v[80:83], v3 offset:25600
  v_add_f32 v113, v113, v115
  v_smfmac_f32_16x16x64_bf16 v[116:119], v[56:59], a[144:151], v13
  v_cvt_pk_bf16_f32 v114, v112, v113
  v_smfmac_f32_16x16x64_bf16 v[120:123], v[44:47], a[152:159], v13
  v_cvt_pk_bf16_f32 v115, v112, v113
  ds_write_b64 v4, v[114:115] offset:11776
  v_smfmac_f32_16x16x64_bf16 v[120:123], v[48:51], a[160:167], v13
  v_add_f32 v116, v116, v118
  v_smfmac_f32_16x16x64_bf16 v[120:123], v[52:55], a[168:175], v13
  v_add_f32 v117, v117, v119
  v_smfmac_f32_16x16x64_bf16 v[120:123], v[56:59], a[176:183], v13
  v_cvt_pk_bf16_f32 v118, v116, v117
  s_waitcnt lgkmcnt(9)
  v_smfmac_f32_16x16x64_bf16 v[124:127], v[20:23], v[84:91], v13
  v_cvt_pk_bf16_f32 v119, v116, v117
  ds_write_b64 v4, v[118:119] offset:12288
  s_waitcnt lgkmcnt(8)
  v_smfmac_f32_16x16x64_bf16 v[124:127], v[24:27], v[92:99], v13
  v_add_f32 v120, v120, v122
  v_add_f32 v121, v121, v123
  v_cvt_pk_bf16_f32 v122, v120, v121
  v_cvt_pk_bf16_f32 v123, v120, v121
  ds_write_b64 v4, v[122:123] offset:12800
  v_smfmac_f32_16x16x64_bf16 v[124:127], v[32:35], a[184:191], v13
  v_smfmac_f32_16x16x64_bf16 v[124:127], v[36:39], a[192:199], v13
  s_waitcnt lgkmcnt(0)
  s_barrier
  ds_read_b64_tr_b16 v[112:113], v5 offset:10240
  ds_read_b64_tr_b16 v[114:115], v6 offset:10240
  ds_read_b64_tr_b16 v[116:117], v5 offset:11264
  ds_read_b64_tr_b16 v[118:119], v6 offset:11264
  ds_read_b64_tr_b16 v[120:121], v5 offset:12288
  ds_read_b64_tr_b16 v[122:123], v6 offset:12288
  v_smfmac_f32_16x16x64_bf16 v[124:127], v[40:43], a[200:207], v13
  v_smfmac_f32_16x16x64_bf16 v[124:127], v[44:47], a[208:215], v13
  v_smfmac_f32_16x16x64_bf16 v[124:127], v[48:51], a[216:223], v13
  v_smfmac_f32_16x16x64_bf16 v[124:127], v[52:55], a[224:231], v13
  s_waitcnt lgkmcnt(4)
  v_mfma_f32_16x16x32_bf16 v[132:135], v[100:103], v[112:115], 0
  s_waitcnt lgkmcnt(2)
  v_mfma_f32_16x16x32_bf16 v[132:135], v[104:107], v[116:119], v[132:135]
  s_waitcnt lgkmcnt(0)
  v_mfma_f32_16x16x32_bf16 v[132:135], v[108:111], v[120:123], v[132:135]
  v_smfmac_f32_16x16x64_bf16 v[124:127], v[56:59], a[232:239], v13
  s_nop 3
  v_bfi_b32 v132, 1, s59, v132
  s_mov_b64 exec, s[42:43]
  buffer_store_dwordx4 v[132:135], v0, s[8:11], s44 offen
  ds_write_b128 v0, v[132:135] offset:19456
  s_mov_b64 exec, -1
  v_smfmac_f32_16x16x64_bf16 v[128:131], v[28:31], a[240:247], v13
  v_smfmac_f32_16x16x64_bf16 v[128:131], v[32:35], a[248:255], v13
  v_cvt_pk_bf16_f32 v124, v124, v125
  v_cvt_pk_bf16_f32 v125, v126, v127
  v_smfmac_f32_16x16x64_bf16 v[128:131], v[48:51], v[60:67], v13
  v_smfmac_f32_16x16x64_bf16 v[128:131], v[52:55], v[68:75], v13
  v_smfmac_f32_16x16x64_bf16 v[128:131], v[56:59], v[76:83], v13
  ds_write_b64 v0, v[124:125] offset:16392
  v_mov_b32 v112, 0
  v_mov_b32 v113, 0
  v_mov_b32 v114, 0
  v_mov_b32 v115, 0
  v_mov_b32 v116, 0
  v_mov_b32 v117, 0
  s_nop 0
  v_add_f32 v128, v128, v130
  v_add_f32 v129, v129, v131
  v_cvt_pk_bf16_f32 v128, v128, v129
  ds_write_b32 v0, v128 offset:18436
  v_mov_b32 v118, 0
  v_mov_b32 v119, 0
  v_mov_b32 v120, 0
  v_mov_b32 v121, 0
  v_mov_b32 v122, 0
  v_mov_b32 v123, 0
  s_cmp_eq_u32 s36, 63
  s_waitcnt lgkmcnt(0)
  s_barrier
  s_cbranch_scc1 L147_fin
  buffer_load_dwordx4 v[84:87], v0, s[8:11], s45 offen sc1
  buffer_load_dword v88, v1, s[8:11], s45 offen offset:1024 sc1
  ds_read_b128 v[90:93], v0 offset:19456
  ds_read_b32 v94, v1 offset:20480
  ds_read_b128 v[20:23], v15 offset:24576
  ds_read_b128 v[24:27], v15 offset:25600
  ds_read_b128 v[28:31], v15 offset:26624
  ds_read_b128 v[32:35], v15 offset:27648
  ds_read_b128 v[36:39], v15 offset:28672
  ds_read_b128 v[40:43], v15 offset:29696
  ds_read_b128 v[44:47], v0 offset:16384
  ds_read_b128 v[48:51], v0 offset:17408
  ds_read_b128 v[52:55], v0 offset:18432
  v_mov_b32 v95, 1.0
  v_mov_b32 v134, 0
  v_mov_b32 v135, 0
  v_mov_b32 v124, 0
  v_mov_b32 v125, 0
  v_mov_b32 v126, 0
  v_mov_b32 v127, 0
  v_mov_b32 v128, 0
  v_mov_b32 v129, 0
  v_mov_b32 v130, 0
  v_mov_b32 v131, 0
  buffer_load_dwordx4 v[72:75], v0, s[8:11], s45 offen sc1
  buffer_load_dword v76, v1, s[8:11], s45 offen offset:1024 sc1
  s_waitcnt vmcnt(2) lgkmcnt(9)
L148_rb:
  v_add_f32 v60, v90, v84
  v_add_f32 v61, v91, v85
  v_add_f32 v62, v92, v86
  v_add_f32 v63, v93, v87
  v_add_f32 v64, v94, v88
  v_max3_f32 v66, v60, v61, v62
  v_max3_f32 v66, v66, v63, v64
  v_bitop3_b32 v71, v84, v88, s59 bitop3:0x7e
  v_and_b32 v71, 1, v71
  v_max_f32_dpp v67, v66, v66 quad_perm:[2,3,0,1] row_mask:0xf bank_mask:0xf
  v_max_f32_dpp v66, v66, v66 quad_perm:[2,3,0,1] row_mask:0xf bank_mask:0xf
  v_cmp_ne_u32 vcc, 0, v71
  s_nop 0
  v_permlane16_swap_b32 v66, v67
  v_max_f32 v68, v66, v67
  v_max_f32 v66, v66, v67
  s_cbranch_vccnz L149_fb
  s_nop 0
  v_permlane32_swap_b32 v66, v68
  v_max_f32 v66, v66, v68
  v_mul_f32 v66, s41, v66
  v_fma_f32 v60, v60, s41, -v66
  v_fma_f32 v61, v61, s41, -v66
  v_fma_f32 v62, v62, s41, -v66
  v_fma_f32 v63, v63, s41, -v66
  v_fma_f32 v64, v64, s41, -v66
  v_exp_f32 v60, v60
  v_exp_f32 v61, v61
  v_exp_f32 v62, v62
  v_exp_f32 v63, v63
  v_exp_f32 v64, v64
  v_cvt_pk_bf16_f32 v69, v60, v61
  v_cvt_pk_bf16_f32 v70, v62, v63
  v_add_f32 v89, v60, v61
  v_mov_b32_dpp v56, v69 quad_perm:[0,1,0,1] row_mask:0xf bank_mask:0xf
  v_mov_b32_dpp v57, v70 quad_perm:[0,1,0,1] row_mask:0xf bank_mask:0xf
  v_mov_b32_dpp v58, v69 quad_perm:[2,3,2,3] row_mask:0xf bank_mask:0xf
  v_mov_b32_dpp v59, v70 quad_perm:[2,3,2,3] row_mask:0xf bank_mask:0xf
  v_mov_b32_dpp v66, v64 quad_perm:[0,1,0,1] row_mask:0xf bank_mask:0xf
  v_mov_b32_dpp v67, v64 quad_perm:[2,3,2,3] row_mask:0xf bank_mask:0xf
  s_waitcnt vmcnt(0) lgkmcnt(0)
  v_mfma_f32_16x16x32_bf16 v[80:83], v[20:23], v[56:59], 0
  v_add_f32 v89, v89, v62
  v_cvt_pk_bf16_f32 v132, v66, v67
  v_mfma_f32_16x16x32_bf16 v[76:79], v[24:27], v[56:59], 0
  v_add_f32 v89, v89, v63
  v_cvt_pk_bf16_f32 v133, v66, v67
  v_mfma_f32_16x16x32_bf16 v[72:75], v[28:31], v[56:59], 0
  v_add_f32 v89, v89, v64
  v_mfma_f32_16x16x32_bf16 v[80:83], v[44:47], v[132:135], v[80:83]
  v_mfma_f32_16x16x32_bf16 v[76:79], v[44:47], v[130:133], v[76:79]
  v_add_f32_dpp v89, v89, v89 quad_perm:[2,3,0,1] row_mask:0xf bank_mask:0xf
  v_mfma_f32_16x16x32_bf16 v[68:71], v[32:35], v[56:59], 0
  v_mfma_f32_16x16x32_bf16 v[72:75], v[48:51], v[132:135], v[72:75]
  v_mfma_f32_16x16x4_f32 v[96:99], v89, v95, 0
  v_cvt_pk_bf16_f32 v84, v80, v81
  v_cvt_pk_bf16_f32 v85, v82, v83
  v_cvt_pk_bf16_f32 v86, v76, v77
  v_cvt_pk_bf16_f32 v87, v78, v79
  v_mfma_f32_16x16x32_bf16 v[68:71], v[48:51], v[130:133], v[68:71]
  v_cvt_pk_bf16_f32 v88, v72, v73
  v_cvt_pk_bf16_f32 v89, v74, v75
  v_mfma_f32_16x16x32_bf16 v[64:67], v[36:39], v[56:59], 0
  v_mfma_f32_16x16x32_bf16 v[60:63], v[40:43], v[56:59], 0
  v_cvt_pk_bf16_f32 v90, v68, v69
  v_cvt_pk_bf16_f32 v91, v70, v71
  v_mfma_f32_16x16x32_bf16 v[64:67], v[52:55], v[132:135], v[64:67]
  v_rcp_f32 v96, v96
  v_mfma_f32_16x16x32_bf16 v[60:63], v[52:55], v[130:133], v[60:63]
  v_rcp_f32 v97, v97
  v_smfmac_f32_16x16x64_bf16 v[112:115], v[84:87], v[136:143], v13
  v_cvt_pk_bf16_f32 v92, v64, v65
  v_cvt_pk_bf16_f32 v93, v66, v67
  v_smfmac_f32_16x16x64_bf16 v[116:119], v[84:87], v[144:151], v13
  v_cvt_pk_bf16_f32 v94, v60, v61
  v_cvt_pk_bf16_f32 v95, v62, v63
  v_smfmac_f32_16x16x64_bf16 v[112:115], v[88:91], v[176:183], v13
  v_smfmac_f32_16x16x64_bf16 v[116:119], v[88:91], v[184:191], v13
  v_smfmac_f32_16x16x64_bf16 v[112:115], v[92:95], v[216:223], v13
  v_smfmac_f32_16x16x64_bf16 v[116:119], v[92:95], v[224:231], v13
  v_smfmac_f32_16x16x64_bf16 v[120:123], v[84:87], v[152:159], v13
  v_mul_f32 v112, v96, v112
  v_mul_f32 v114, v96, v114
  v_smfmac_f32_16x16x64_bf16 v[124:127], v[84:87], v[160:167], v13
  v_mul_f32 v113, v97, v113
  v_mul_f32 v115, v97, v115
  v_smfmac_f32_16x16x64_bf16 v[120:123], v[88:91], v[192:199], v13
  v_cvt_pk_bf16_f32 v20, v112, v114
  v_cvt_pk_bf16_f32 v21, v113, v115
  v_smfmac_f32_16x16x64_bf16 v[124:127], v[88:91], v[200:207], v13
  v_bfi_b32 v20, 1, s59, v20
  v_mul_f32 v116, v96, v116
  v_mul_f32 v118, v96, v118
  v_smfmac_f32_16x16x64_bf16 v[120:123], v[92:95], v[232:239], v13
  v_mul_f32 v117, v97, v117
  v_mul_f32 v119, v97, v119
  v_cvt_pk_bf16_f32 v22, v116, v118
  v_smfmac_f32_16x16x64_bf16 v[124:127], v[92:95], v[240:247], v13
  v_cvt_pk_bf16_f32 v23, v117, v119
  buffer_store_dwordx4 v[20:23], v9, s[8:11], s47 offen
  v_smfmac_f32_16x16x64_bf16 v[128:131], v[84:87], v[168:175], v13
  v_mul_f32 v120, v96, v120
  v_mul_f32 v122, v96, v122
  v_smfmac_f32_16x16x64_bf16 v[128:131], v[88:91], v[208:215], v13
  v_mul_f32 v121, v97, v121
  v_mul_f32 v123, v97, v123
  v_smfmac_f32_16x16x64_bf16 v[128:131], v[92:95], v[248:255], v13
  v_cvt_pk_bf16_f32 v24, v120, v122
  v_cvt_pk_bf16_f32 v25, v121, v123
  v_bfi_b32 v24, 1, s59, v24
  v_mul_f32 v124, v96, v124
  v_mul_f32 v126, v96, v126
  v_mul_f32 v125, v97, v125
  v_mul_f32 v127, v97, v127
  v_cvt_pk_bf16_f32 v26, v124, v126
  v_cvt_pk_bf16_f32 v27, v125, v127
  buffer_store_dwordx4 v[24:27], v9, s[8:11], s47 offen offset:1024
  v_mul_f32 v128, v96, v128
  v_mul_f32 v130, v96, v130
  v_mul_f32 v129, v97, v129
  v_mul_f32 v131, v97, v131
  v_cvt_pk_bf16_f32 v28, v128, v130
  v_cvt_pk_bf16_f32 v29, v129, v131
  v_bfi_b32 v28, 1, s59, v28
  buffer_store_dwordx2 v[28:29], v10, s[8:11], s47 offen
  ds_read_b128 v[60:63], v3 offset:0
  ds_read_b128 v[64:67], v3 offset:1024
  ds_read_b128 v[68:71], v3 offset:2048
  ds_read_b128 v[72:75], v3 offset:3072
  ds_read_b128 v[76:79], v3 offset:4096
  ds_read_b128 v[80:83], v3 offset:5120
  ds_read_b128 v[84:87], v3 offset:6144
  ds_read_b128 v[88:91], v3 offset:7168
  ds_read_b128 v[92:95], v3 offset:8192
  ds_read_b128 v[96:99], v3 offset:9216
  ds_read_b128 v[100:103], v0 offset:44032
  ds_read_b128 v[104:107], v0 offset:45056
  ds_read_b128 v[108:111], v0 offset:46080
  v_mov_b32 v112, 0
  v_mov_b32 v113, 0
  v_mov_b32 v114, 0
  v_mov_b32 v115, 0
  v_mov_b32 v116, 0
  v_mov_b32 v117, 0
  v_mov_b32 v118, 0
  v_mov_b32 v119, 0
  v_mov_b32 v120, 0
  v_mov_b32 v121, 0
  v_mov_b32 v122, 0
  v_mov_b32 v123, 0
  v_mov_b32 v124, 0
  v_mov_b32 v125, 0
  v_mov_b32 v126, 0
  v_mov_b32 v127, 0
  v_mov_b32 v128, 0
  v_mov_b32 v129, 0
  v_mov_b32 v130, 0
  v_mov_b32 v131, 0
  s_xor_b32 s56, s56, 65536
  s_xor_b32 s58, s58, 131072
  s_add_u32 s65, s65, 393216
  v_xor_b32 v15, 8192, v15
  s_add_u32 s36, s36, 1
  s_waitcnt vmcnt(1)
  buffer_load_dwordx4 v[32:35], v11, s[8:11], s49 offen sc1
  buffer_load_dwordx4 v[36:39], v11, s[8:11], s50 offen sc1
  buffer_load_dwordx4 v[40:43], v11, s[8:11], s51 offen sc1
  buffer_load_dwordx4 v[44:47], v11, s[8:11], s52 offen sc1
L151_rc:
  s_waitcnt vmcnt(3)
  v_mfma_f32_16x16x32_bf16 v[48:51], v[16:19], v[32:35], 0
  v_bitop3_b32 v132, v32, v32, s59 bitop3:0x7e
  s_waitcnt vmcnt(2)
  v_mfma_f32_16x16x32_bf16 v[48:51], v[16:19], v[36:39], v[48:51]
  v_bitop3_b32 v133, v36, v36, s59 bitop3:0x7e
  v_or_b32 v132, v132, v133
  s_waitcnt vmcnt(1)
  v_mfma_f32_16x16x32_bf16 v[48:51], v[16:19], v[40:43], v[48:51]
  v_bitop3_b32 v133, v40, v40, s59 bitop3:0x7e
  v_or_b32 v132, v132, v133
  s_waitcnt vmcnt(0)
  v_mfma_f32_16x16x32_bf16 v[48:51], v[16:19], v[44:47], v[48:51]
  v_bitop3_b32 v133, v44, v44, s59 bitop3:0x7e
  v_bitop3_b32 v132, v132, v133, 1 bitop3:0xa8
  v_cmp_ne_u32 vcc, 0, v132
  s_cbranch_vccnz L152_fc
  s_nop 3
  v_add_f32_dpp v48, v48, v48 row_ror:8 row_mask:0xf bank_mask:0xf
  v_add_f32_dpp v49, v49, v49 row_ror:8 row_mask:0xf bank_mask:0xf
  v_add_f32_dpp v50, v50, v50 row_ror:8 row_mask:0xf bank_mask:0xf
  v_add_f32_dpp v51, v51, v51 row_ror:8 row_mask:0xf bank_mask:0xf
  v_cvt_pk_bf16_f32 v24, v48, v49
  v_cvt_pk_bf16_f32 v25, v50, v51
  v_bfi_b32 v24, 1, s61, v24
  buffer_store_dwordx2 v[24:25], v12, s[8:11], s56 offen
  s_barrier
  buffer_store_dwordx2 v[24:25], v7, s[8:11], s57 offen sc1
  s_xor_b32 s59, s59, 1
  s_mov_b32 s60, s61
  s_xor_b32 s61, s61, s59
  s_xor_b32 s57, s57, 131072
  s_waitcnt vmcnt(1)
  s_barrier
  s_branch L135_top
L147_fin:
  s_barrier
  s_waitcnt vmcnt(0)
  s_endpgm
L138_pw:
  buffer_load_dword v14, off, s[8:11], s68 sc1
  s_sub_u32 s37, s37, 1
  s_cbranch_scc1 L130_bail
  s_waitcnt vmcnt(0)
  v_readfirstlane_b32 s38, v14
  s_cmp_lt_u32 s38, s62
  s_cbranch_scc1 L138_pw
  s_branch L139_pwb
L140_f1:
  s_mov_b64 exec, vcc
  buffer_load_dwordx4 v[20:23], v2, s[8:11], s56 offen offset:0 sc1
  buffer_load_dwordx4 v[24:27], v2, s[8:11], s56 offen offset:1024 sc1
  s_mov_b64 exec, -1
  buffer_load_dwordx4 v[28:31], v8, s[8:11], s58 offen offset:0 sc1
  buffer_load_dwordx4 v[32:35], v8, s[8:11], s58 offen offset:1024 sc1
  s_waitcnt vmcnt(2)
  v_bitop3_b32 v132, v20, v22, s60 bitop3:0x7e
  v_bitop3_b32 v133, v24, v26, s60 bitop3:0x7e
  v_bitop3_b32 v132, v132, v133, 1 bitop3:0xa8
  v_cmp_ne_u32 vcc, 0, v132
  s_cbranch_vccz L144_b3
L145_f3:
L146_ag:
  s_mov_b64 exec, vcc
  s_xor_b32 s3, s58, 0
  buffer_load_dwordx4 v[20:23], v2, s[8:11], s56 offen offset:0 sc1
  buffer_load_dwordx4 v[24:27], v2, s[8:11], s56 offen offset:1024 sc1
  s_sub_u32 s37, s37, 1
  s_cbranch_scc1 L130_bail
  s_waitcnt vmcnt(0)
  v_bitop3_b32 v132, v20, v22, s60 bitop3:0x7e
  v_bitop3_b32 v133, v24, v26, s60 bitop3:0x7e
  v_bitop3_b32 v132, v132, v133, 1 bitop3:0xa8
  v_cmp_ne_u32 vcc, 0, v132
  s_mov_b64 exec, -1
  s_cbranch_vccnz L146_ag
  s_branch L144_b3
L142_f2:
  s_xor_b32 s3, s58, 0
  s_sub_u32 s37, s37, 1
  s_cbranch_scc1 L130_bail
  buffer_load_dwordx4 v[28:31], v8, s[8:11], s3 offen offset:0 sc1
  buffer_load_dwordx4 v[32:35], v8, s[8:11], s3 offen offset:1024 sc1
  s_branch L143_b2
L136_fL:
  s_mov_b64 exec, vcc
  buffer_load_dwordx4 v[28:31], v2, s[8:11], s56 offen offset:0 sc1
  buffer_load_dwordx4 v[32:35], v2, s[8:11], s56 offen offset:1024 sc1
  s_mov_b64 exec, -1
  s_sub_u32 s37, s37, 1
  s_cbranch_scc1 L130_bail
  s_branch L137_rl
L149_fb:
  s_waitcnt vmcnt(0)
  v_bitop3_b32 v71, v72, v76, s59 bitop3:0x7e
  v_and_b32 v71, 1, v71
  v_cmp_ne_u32 vcc, 0, v71
  v_mov_b32 v84, v72
  v_mov_b32 v85, v73
  v_mov_b32 v86, v74
  v_mov_b32 v87, v75
  v_mov_b32 v88, v76
  s_cbranch_vccz L148_rb
L150_fb2:
  s_sub_u32 s37, s37, 1
  s_cbranch_scc1 L130_bail
  buffer_load_dwordx4 v[84:87], v0, s[8:11], s45 offen sc1
  buffer_load_dword v88, v1, s[8:11], s45 offen offset:1024 sc1
  s_waitcnt vmcnt(0)
  v_bitop3_b32 v71, v84, v88, s59 bitop3:0x7e
  v_and_b32 v71, 1, v71
  v_cmp_ne_u32 vcc, 0, v71
  s_cbranch_vccz L148_rb
  s_branch L150_fb2
L152_fc:
  s_mov_b64 exec, vcc
  buffer_load_dwordx4 v[32:35], v11, s[8:11], s49 offen sc1
  buffer_load_dwordx4 v[36:39], v11, s[8:11], s50 offen sc1
  buffer_load_dwordx4 v[40:43], v11, s[8:11], s51 offen sc1
  buffer_load_dwordx4 v[44:47], v11, s[8:11], s52 offen sc1
  s_mov_b64 exec, -1
  s_sub_u32 s37, s37, 1
  s_cbranch_scc1 L130_bail
  s_branch L151_rc
L134_slow:
L153_top:
  v_bfe_u32 v46, v1, 2, 1
  v_lshlrev_b32 v46, 4, v46
  v_lshlrev_b32 v46, v46, s39
  v_cndmask_b32 v44, v46, 0, s[42:43]
  v_cndmask_b32 v45, 0, v46, s[42:43]
  buffer_load_dwordx4 v[20:23], v2, s[8:11], s56 offen offset:0 sc1
  buffer_load_dwordx4 v[24:27], v2, s[8:11], s56 offen offset:1024 sc1
  s_add_u32 s62, s36, 2
  s_min_u32 s62, s62, 64
  v_readfirstlane_b32 s38, v14
  s_mov_b32 m0, s69
  s_cmp_lt_u32 s38, s62
  s_cbranch_scc1 L156_pw
L157_pwb:
  s_waitcnt vmcnt(1)
  v_bitop3_b32 v132, v20, v22, s60 bitop3:0x7e
  s_waitcnt vmcnt(0)
  v_bitop3_b32 v133, v24, v26, s60 bitop3:0x7e
  v_bitop3_b32 v132, v132, v133, 1 bitop3:0xa8
  v_cmp_ne_u32 vcc, 0, v132
  s_cbranch_vccnz L158_f1
L159_b1:
  buffer_load_dwordx4 v[28:31], v8, s[8:11], s58 offen offset:0 sc1
  buffer_load_dwordx4 v[32:35], v8, s[8:11], s58 offen offset:1024 sc1
L162_b3:
L161_b2:
  v_mfma_f32_4x4x4_16b_bf16 v[36:39], v[44:45], v[20:21], 0
  v_mfma_f32_4x4x4_16b_bf16 v[48:51], v[44:45], v[22:23], 0
  v_mfma_f32_4x4x4_16b_bf16 v[40:43], v[44:45], v[24:25], 0
  v_mfma_f32_4x4x4_16b_bf16 v[52:55], v[44:45], v[26:27], 0
  s_waitcnt lgkmcnt(0)
  s_waitcnt vmcnt(1)
  v_mfma_f32_4x4x4_16b_bf16 v[36:39], v[44:45], v[28:29], v[36:39]
  v_mfma_f32_4x4x4_16b_bf16 v[48:51], v[44:45], v[30:31], v[48:51]
  v_bitop3_b32 v132, v28, v30, s60 bitop3:0x7e
  s_waitcnt vmcnt(0)
  v_mfma_f32_4x4x4_16b_bf16 v[40:43], v[44:45], v[32:33], v[40:43]
  v_mfma_f32_4x4x4_16b_bf16 v[52:55], v[44:45], v[34:35], v[52:55]
  v_bitop3_b32 v133, v32, v34, s60 bitop3:0x7e
  v_bitop3_b32 v132, v132, v133, 1 bitop3:0xa8
  v_cmp_ne_u32 vcc, 0, v132
  v_cvt_pk_bf16_f32 v28, v36, v37
  v_cvt_pk_bf16_f32 v29, v38, v39
  v_cvt_pk_bf16_f32 v30, v48, v49
  v_cvt_pk_bf16_f32 v31, v50, v51
  ds_write_b128 v0, v[28:31] offset:2048
  v_cvt_pk_bf16_f32 v32, v40, v41
  v_cvt_pk_bf16_f32 v33, v42, v43
  s_cbranch_vccnz L160_f2
  v_cvt_pk_bf16_f32 v34, v52, v53
  v_cvt_pk_bf16_f32 v35, v54, v55
  ds_write_b128 v0, v[32:35] offset:3072
L155_rl:
  v_smfmac_f32_16x16x64_bf16 v[112:115], v[28:31], v[60:67], v13
  v_smfmac_f32_16x16x64_bf16 v[116:119], v[28:31], v[68:75], v13
  v_smfmac_f32_16x16x64_bf16 v[120:123], v[28:31], v[76:83], v13
  s_waitcnt lgkmcnt(0)
  s_barrier
  ds_read_b128 v[20:23], v0 offset:0
  ds_read_b128 v[24:27], v0 offset:1024
  v_smfmac_f32_16x16x64_bf16 v[112:115], v[32:35], v[84:91], v13
  ds_read_b128 v[36:39], v0 offset:4096
  buffer_load_dwordx4 v0, s[8:11], s65 offen offset:0 sc1 lds
  v_smfmac_f32_16x16x64_bf16 v[116:119], v[32:35], v[92:99], v13
  ds_read_b128 v[40:43], v0 offset:5120
  v_smfmac_f32_16x16x64_bf16 v[120:123], v[32:35], a[0:7], v13
  ds_read_b128 v[44:47], v0 offset:6144
  buffer_load_dwordx4 v0, s[8:11], s65 offen offset:1024 sc1 lds
  v_smfmac_f32_16x16x64_bf16 v[124:127], v[28:31], a[8:15], v13
  ds_read_b128 v[48:51], v0 offset:7168
  s_waitcnt lgkmcnt(5)
  v_smfmac_f32_16x16x64_bf16 v[112:115], v[20:23], a[16:23], v13
  ds_read_b128 v[52:55], v0 offset:8192
  buffer_load_dwordx4 v0, s[8:11], s65 offen offset:2048 sc1 lds
  v_smfmac_f32_16x16x64_bf16 v[116:119], v[20:23], a[24:31], v13
  ds_read_b128 v[56:59], v0 offset:9216
  v_smfmac_f32_16x16x64_bf16 v[120:123], v[20:23], a[32:39], v13
  ds_read_b128 v[60:63], v3 offset:10240
  buffer_load_dword v14, off, s[8:11], s68 sc1
  s_waitcnt lgkmcnt(7)
  v_smfmac_f32_16x16x64_bf16 v[112:115], v[24:27], a[40:47], v13
  ds_read_b128 v[64:67], v3 offset:11264
  v_smfmac_f32_16x16x64_bf16 v[116:119], v[24:27], a[48:55], v13
  ds_read_b128 v[68:71], v3 offset:12288
  v_not_b32 v132, s61
  v_not_b32 v133, s61
  v_smfmac_f32_16x16x64_bf16 v[120:123], v[24:27], a[56:63], v13
  ds_read_b128 v[72:75], v3 offset:13312
  s_waitcnt lgkmcnt(9)
  v_smfmac_f32_16x16x64_bf16 v[112:115], v[36:39], a[64:71], v13
  ds_read_b128 v[76:79], v3 offset:14336
  buffer_store_dwordx2 v[132:133], v7, s[8:11], s57 offen sc1
  v_smfmac_f32_16x16x64_bf16 v[116:119], v[36:39], a[72:79], v13
  ds_read_b128 v[80:83], v3 offset:15360
  v_smfmac_f32_16x16x64_bf16 v[120:123], v[36:39], a[80:87], v13
  ds_read_b128 v[84:87], v3 offset:16384
  s_waitcnt lgkmcnt(11)
  v_smfmac_f32_16x16x64_bf16 v[112:115], v[40:43], a[88:95], v13
  ds_read_b128 v[88:91], v3 offset:17408
  v_smfmac_f32_16x16x64_bf16 v[116:119], v[40:43], a[96:103], v13
  ds_read_b128 v[92:95], v3 offset:18432
  v_smfmac_f32_16x16x64_bf16 v[120:123], v[40:43], a[104:111], v13
  ds_read_b128 v[96:99], v3 offset:19456
  s_waitcnt lgkmcnt(13)
  v_smfmac_f32_16x16x64_bf16 v[112:115], v[44:47], a[112:119], v13
  s_waitcnt lgkmcnt(12)
  s_waitcnt lgkmcnt(8)
  v_smfmac_f32_16x16x64_bf16 v[112:115], v[48:51], v[60:67], v13
  ds_read_b128 v[60:63], v3 offset:20480
  s_waitcnt lgkmcnt(7)
  v_smfmac_f32_16x16x64_bf16 v[112:115], v[52:55], v[68:75], v13
  ds_read_b128 v[64:67], v3 offset:21504
  s_waitcnt lgkmcnt(6)
  v_smfmac_f32_16x16x64_bf16 v[112:115], v[56:59], v[76:83], v13
  ds_read_b128 v[68:71], v3 offset:22528
  v_smfmac_f32_16x16x64_bf16 v[116:119], v[44:47], a[120:127], v13
  ds_read_b128 v[72:75], v3 offset:23552
  v_smfmac_f32_16x16x64_bf16 v[116:119], v[48:51], a[128:135], v13
  ds_read_b128 v[76:79], v3 offset:24576
  v_add_f32 v112, v112, v114
  v_smfmac_f32_16x16x64_bf16 v[116:119], v[52:55], a[136:143], v13
  ds_read_b128 v[80:83], v3 offset:25600
  v_add_f32 v113, v113, v115
  v_smfmac_f32_16x16x64_bf16 v[116:119], v[56:59], a[144:151], v13
  v_cvt_pk_bf16_f32 v114, v112, v113
  v_smfmac_f32_16x16x64_bf16 v[120:123], v[44:47], a[152:159], v13
  v_cvt_pk_bf16_f32 v115, v112, v113
  ds_write_b64 v4, v[114:115] offset:11776
  v_smfmac_f32_16x16x64_bf16 v[120:123], v[48:51], a[160:167], v13
  v_add_f32 v116, v116, v118
  v_smfmac_f32_16x16x64_bf16 v[120:123], v[52:55], a[168:175], v13
  v_add_f32 v117, v117, v119
  v_smfmac_f32_16x16x64_bf16 v[120:123], v[56:59], a[176:183], v13
  v_cvt_pk_bf16_f32 v118, v116, v117
  s_waitcnt lgkmcnt(9)
  v_smfmac_f32_16x16x64_bf16 v[124:127], v[20:23], v[84:91], v13
  v_cvt_pk_bf16_f32 v119, v116, v117
  ds_write_b64 v4, v[118:119] offset:12288
  s_waitcnt lgkmcnt(8)
  v_smfmac_f32_16x16x64_bf16 v[124:127], v[24:27], v[92:99], v13
  v_add_f32 v120, v120, v122
  v_add_f32 v121, v121, v123
  v_cvt_pk_bf16_f32 v122, v120, v121
  v_cvt_pk_bf16_f32 v123, v120, v121
  ds_write_b64 v4, v[122:123] offset:12800
  v_smfmac_f32_16x16x64_bf16 v[124:127], v[32:35], a[184:191], v13
  v_smfmac_f32_16x16x64_bf16 v[124:127], v[36:39], a[192:199], v13
  s_waitcnt lgkmcnt(0)
  s_barrier
  ds_read_b64_tr_b16 v[112:113], v5 offset:10240
  ds_read_b64_tr_b16 v[114:115], v6 offset:10240
  ds_read_b64_tr_b16 v[116:117], v5 offset:11264
  ds_read_b64_tr_b16 v[118:119], v6 offset:11264
  ds_read_b64_tr_b16 v[120:121], v5 offset:12288
  ds_read_b64_tr_b16 v[122:123], v6 offset:12288
  v_smfmac_f32_16x16x64_bf16 v[124:127], v[40:43], a[200:207], v13
  v_smfmac_f32_16x16x64_bf16 v[124:127], v[44:47], a[208:215], v13
  v_smfmac_f32_16x16x64_bf16 v[124:127], v[48:51], a[216:223], v13
  v_smfmac_f32_16x16x64_bf16 v[124:127], v[52:55], a[224:231], v13
  s_waitcnt lgkmcnt(4)
  v_mfma_f32_16x16x32_bf16 v[132:135], v[100:103], v[112:115], 0
  s_waitcnt lgkmcnt(2)
  v_mfma_f32_16x16x32_bf16 v[132:135], v[104:107], v[116:119], v[132:135]
  s_waitcnt lgkmcnt(0)
  v_mfma_f32_16x16x32_bf16 v[132:135], v[108:111], v[120:123], v[132:135]
  v_smfmac_f32_16x16x64_bf16 v[124:127], v[56:59], a[232:239], v13
  s_nop 3
  v_bfi_b32 v132, 1, s59, v132
  s_mov_b64 exec, s[42:43]
  buffer_store_dwordx4 v[132:135], v0, s[8:11], s44 offen sc1
  ds_write_b128 v0, v[132:135] offset:19456
  s_mov_b64 exec, -1
  v_smfmac_f32_16x16x64_bf16 v[128:131], v[28:31], a[240:247], v13
  v_smfmac_f32_16x16x64_bf16 v[128:131], v[32:35], a[248:255], v13
  v_cvt_pk_bf16_f32 v124, v124, v125
  v_cvt_pk_bf16_f32 v125, v126, v127
  v_smfmac_f32_16x16x64_bf16 v[128:131], v[48:51], v[60:67], v13
  v_smfmac_f32_16x16x64_bf16 v[128:131], v[52:55], v[68:75], v13
  v_smfmac_f32_16x16x64_bf16 v[128:131], v[56:59], v[76:83], v13
  ds_write_b64 v0, v[124:125] offset:16392
  v_mov_b32 v112, 0
  v_mov_b32 v113, 0
  v_mov_b32 v114, 0
  v_mov_b32 v115, 0
  v_mov_b32 v116, 0
  v_mov_b32 v117, 0
  s_nop 0
  v_add_f32 v128, v128, v130
  v_add_f32 v129, v129, v131
  v_cvt_pk_bf16_f32 v128, v128, v129
  ds_write_b32 v0, v128 offset:18436
  v_mov_b32 v118, 0
  v_mov_b32 v119, 0
  v_mov_b32 v120, 0
  v_mov_b32 v121, 0
  v_mov_b32 v122, 0
  v_mov_b32 v123, 0
  s_cmp_eq_u32 s36, 63
  s_waitcnt lgkmcnt(0)
  s_barrier
  s_cbranch_scc1 L165_fin
  buffer_load_dwordx4 v[84:87], v0, s[8:11], s45 offen sc1
  buffer_load_dword v88, v1, s[8:11], s45 offen offset:1024 sc1
  ds_read_b128 v[90:93], v0 offset:19456
  ds_read_b32 v94, v1 offset:20480
  ds_read_b128 v[20:23], v15 offset:24576
  ds_read_b128 v[24:27], v15 offset:25600
  ds_read_b128 v[28:31], v15 offset:26624
  ds_read_b128 v[32:35], v15 offset:27648
  ds_read_b128 v[36:39], v15 offset:28672
  ds_read_b128 v[40:43], v15 offset:29696
  ds_read_b128 v[44:47], v0 offset:16384
  ds_read_b128 v[48:51], v0 offset:17408
  ds_read_b128 v[52:55], v0 offset:18432
  v_mov_b32 v95, 1.0
  v_mov_b32 v134, 0
  v_mov_b32 v135, 0
  v_mov_b32 v124, 0
  v_mov_b32 v125, 0
  v_mov_b32 v126, 0
  v_mov_b32 v127, 0
  v_mov_b32 v128, 0
  v_mov_b32 v129, 0
  v_mov_b32 v130, 0
  v_mov_b32 v131, 0
  buffer_load_dwordx4 v[72:75], v0, s[8:11], s45 offen sc1
  buffer_load_dword v76, v1, s[8:11], s45 offen offset:1024 sc1
  s_waitcnt vmcnt(2) lgkmcnt(9)
L166_rb:
  v_add_f32 v60, v90, v84
  v_add_f32 v61, v91, v85
  v_add_f32 v62, v92, v86
  v_add_f32 v63, v93, v87
  v_add_f32 v64, v94, v88
  v_max3_f32 v66, v60, v61, v62
  v_max3_f32 v66, v66, v63, v64
  v_bitop3_b32 v71, v84, v88, s59 bitop3:0x7e
  v_and_b32 v71, 1, v71
  v_max_f32_dpp v67, v66, v66 quad_perm:[2,3,0,1] row_mask:0xf bank_mask:0xf
  v_max_f32_dpp v66, v66, v66 quad_perm:[2,3,0,1] row_mask:0xf bank_mask:0xf
  v_cmp_ne_u32 vcc, 0, v71
  s_nop 0
  v_permlane16_swap_b32 v66, v67
  v_max_f32 v68, v66, v67
  v_max_f32 v66, v66, v67
  s_cbranch_vccnz L167_fb
  s_nop 0
  v_permlane32_swap_b32 v66, v68
  v_max_f32 v66, v66, v68
  v_mul_f32 v66, s41, v66
  v_fma_f32 v60, v60, s41, -v66
  v_fma_f32 v61, v61, s41, -v66
  v_fma_f32 v62, v62, s41, -v66
  v_fma_f32 v63, v63, s41, -v66
  v_fma_f32 v64, v64, s41, -v66
  v_exp_f32 v60, v60
  v_exp_f32 v61, v61
  v_exp_f32 v62, v62
  v_exp_f32 v63, v63
  v_exp_f32 v64, v64
  v_cvt_pk_bf16_f32 v69, v60, v61
  v_cvt_pk_bf16_f32 v70, v62, v63
  v_add_f32 v89, v60, v61
  v_mov_b32_dpp v56, v69 quad_perm:[0,1,0,1] row_mask:0xf bank_mask:0xf
  v_mov_b32_dpp v57, v70 quad_perm:[0,1,0,1] row_mask:0xf bank_mask:0xf
  v_mov_b32_dpp v58, v69 quad_perm:[2,3,2,3] row_mask:0xf bank_mask:0xf
  v_mov_b32_dpp v59, v70 quad_perm:[2,3,2,3] row_mask:0xf bank_mask:0xf
  v_mov_b32_dpp v66, v64 quad_perm:[0,1,0,1] row_mask:0xf bank_mask:0xf
  v_mov_b32_dpp v67, v64 quad_perm:[2,3,2,3] row_mask:0xf bank_mask:0xf
  s_waitcnt vmcnt(0) lgkmcnt(0)
  v_mfma_f32_16x16x32_bf16 v[80:83], v[20:23], v[56:59], 0
  v_add_f32 v89, v89, v62
  v_cvt_pk_bf16_f32 v132, v66, v67
  v_mfma_f32_16x16x32_bf16 v[76:79], v[24:27], v[56:59], 0
  v_add_f32 v89, v89, v63
  v_cvt_pk_bf16_f32 v133, v66, v67
  v_mfma_f32_16x16x32_bf16 v[72:75], v[28:31], v[56:59], 0
  v_add_f32 v89, v89, v64
  v_mfma_f32_16x16x32_bf16 v[80:83], v[44:47], v[132:135], v[80:83]
  v_mfma_f32_16x16x32_bf16 v[76:79], v[44:47], v[130:133], v[76:79]
  v_add_f32_dpp v89, v89, v89 quad_perm:[2,3,0,1] row_mask:0xf bank_mask:0xf
  v_mfma_f32_16x16x32_bf16 v[68:71], v[32:35], v[56:59], 0
  v_mfma_f32_16x16x32_bf16 v[72:75], v[48:51], v[132:135], v[72:75]
  v_mfma_f32_16x16x4_f32 v[96:99], v89, v95, 0
  v_cvt_pk_bf16_f32 v84, v80, v81
  v_cvt_pk_bf16_f32 v85, v82, v83
  v_cvt_pk_bf16_f32 v86, v76, v77
  v_cvt_pk_bf16_f32 v87, v78, v79
  v_mfma_f32_16x16x32_bf16 v[68:71], v[48:51], v[130:133], v[68:71]
  v_cvt_pk_bf16_f32 v88, v72, v73
  v_cvt_pk_bf16_f32 v89, v74, v75
  v_mfma_f32_16x16x32_bf16 v[64:67], v[36:39], v[56:59], 0
  v_mfma_f32_16x16x32_bf16 v[60:63], v[40:43], v[56:59], 0
  v_cvt_pk_bf16_f32 v90, v68, v69
  v_cvt_pk_bf16_f32 v91, v70, v71
  v_mfma_f32_16x16x32_bf16 v[64:67], v[52:55], v[132:135], v[64:67]
  v_rcp_f32 v96, v96
  v_mfma_f32_16x16x32_bf16 v[60:63], v[52:55], v[130:133], v[60:63]
  v_rcp_f32 v97, v97
  v_smfmac_f32_16x16x64_bf16 v[112:115], v[84:87], v[136:143], v13
  v_cvt_pk_bf16_f32 v92, v64, v65
  v_cvt_pk_bf16_f32 v93, v66, v67
  v_smfmac_f32_16x16x64_bf16 v[116:119], v[84:87], v[144:151], v13
  v_cvt_pk_bf16_f32 v94, v60, v61
  v_cvt_pk_bf16_f32 v95, v62, v63
  v_smfmac_f32_16x16x64_bf16 v[112:115], v[88:91], v[176:183], v13
  v_smfmac_f32_16x16x64_bf16 v[116:119], v[88:91], v[184:191], v13
  v_smfmac_f32_16x16x64_bf16 v[112:115], v[92:95], v[216:223], v13
  v_smfmac_f32_16x16x64_bf16 v[116:119], v[92:95], v[224:231], v13
  v_smfmac_f32_16x16x64_bf16 v[120:123], v[84:87], v[152:159], v13
  v_mul_f32 v112, v96, v112
  v_mul_f32 v114, v96, v114
  v_smfmac_f32_16x16x64_bf16 v[124:127], v[84:87], v[160:167], v13
  v_mul_f32 v113, v97, v113
  v_mul_f32 v115, v97, v115
  v_smfmac_f32_16x16x64_bf16 v[120:123], v[88:91], v[192:199], v13
  v_cvt_pk_bf16_f32 v20, v112, v114
  v_cvt_pk_bf16_f32 v21, v113, v115
  v_smfmac_f32_16x16x64_bf16 v[124:127], v[88:91], v[200:207], v13
  v_bfi_b32 v20, 1, s59, v20
  v_mul_f32 v116, v96, v116
  v_mul_f32 v118, v96, v118
  v_smfmac_f32_16x16x64_bf16 v[120:123], v[92:95], v[232:239], v13
  v_mul_f32 v117, v97, v117
  v_mul_f32 v119, v97, v119
  v_cvt_pk_bf16_f32 v22, v116, v118
  v_smfmac_f32_16x16x64_bf16 v[124:127], v[92:95], v[240:247], v13
  v_cvt_pk_bf16_f32 v23, v117, v119
  buffer_store_dwordx4 v[20:23], v9, s[8:11], s47 offen sc1
  v_smfmac_f32_16x16x64_bf16 v[128:131], v[84:87], v[168:175], v13
  v_mul_f32 v120, v96, v120
  v_mul_f32 v122, v96, v122
  v_smfmac_f32_16x16x64_bf16 v[128:131], v[88:91], v[208:215], v13
  v_mul_f32 v121, v97, v121
  v_mul_f32 v123, v97, v123
  v_smfmac_f32_16x16x64_bf16 v[128:131], v[92:95], v[248:255], v13
  v_cvt_pk_bf16_f32 v24, v120, v122
  v_cvt_pk_bf16_f32 v25, v121, v123
  v_bfi_b32 v24, 1, s59, v24
  v_mul_f32 v124, v96, v124
  v_mul_f32 v126, v96, v126
  v_mul_f32 v125, v97, v125
  v_mul_f32 v127, v97, v127
  v_cvt_pk_bf16_f32 v26, v124, v126
  v_cvt_pk_bf16_f32 v27, v125, v127
  buffer_store_dwordx4 v[24:27], v9, s[8:11], s47 offen offset:1024 sc1
  v_mul_f32 v128, v96, v128
  v_mul_f32 v130, v96, v130
  v_mul_f32 v129, v97, v129
  v_mul_f32 v131, v97, v131
  v_cvt_pk_bf16_f32 v28, v128, v130
  v_cvt_pk_bf16_f32 v29, v129, v131
  v_bfi_b32 v28, 1, s59, v28
  buffer_store_dwordx2 v[28:29], v10, s[8:11], s47 offen sc1
  ds_read_b128 v[60:63], v3 offset:0
  ds_read_b128 v[64:67], v3 offset:1024
  ds_read_b128 v[68:71], v3 offset:2048
  ds_read_b128 v[72:75], v3 offset:3072
  ds_read_b128 v[76:79], v3 offset:4096
  ds_read_b128 v[80:83], v3 offset:5120
  ds_read_b128 v[84:87], v3 offset:6144
  ds_read_b128 v[88:91], v3 offset:7168
  ds_read_b128 v[92:95], v3 offset:8192
  ds_read_b128 v[96:99], v3 offset:9216
  ds_read_b128 v[100:103], v0 offset:44032
  ds_read_b128 v[104:107], v0 offset:45056
  ds_read_b128 v[108:111], v0 offset:46080
  v_mov_b32 v112, 0
  v_mov_b32 v113, 0
  v_mov_b32 v114, 0
  v_mov_b32 v115, 0
  v_mov_b32 v116, 0
  v_mov_b32 v117, 0
  v_mov_b32 v118, 0
  v_mov_b32 v119, 0
  v_mov_b32 v120, 0
  v_mov_b32 v121, 0
  v_mov_b32 v122, 0
  v_mov_b32 v123, 0
  v_mov_b32 v124, 0
  v_mov_b32 v125, 0
  v_mov_b32 v126, 0
  v_mov_b32 v127, 0
  v_mov_b32 v128, 0
  v_mov_b32 v129, 0
  v_mov_b32 v130, 0
  v_mov_b32 v131, 0
  s_xor_b32 s56, s56, 65536
  s_xor_b32 s58, s58, 131072
  s_add_u32 s65, s65, 393216
  v_xor_b32 v15, 8192, v15
  s_add_u32 s36, s36, 1
  s_waitcnt vmcnt(1)
  buffer_load_dwordx4 v[32:35], v11, s[8:11], s49 offen sc1
  buffer_load_dwordx4 v[36:39], v11, s[8:11], s50 offen sc1
  buffer_load_dwordx4 v[40:43], v11, s[8:11], s51 offen sc1
  buffer_load_dwordx4 v[44:47], v11, s[8:11], s52 offen sc1
L169_rc:
  s_waitcnt vmcnt(3)
  v_mfma_f32_16x16x32_bf16 v[48:51], v[16:19], v[32:35], 0
  v_bitop3_b32 v132, v32, v32, s59 bitop3:0x7e
  s_waitcnt vmcnt(2)
  v_mfma_f32_16x16x32_bf16 v[48:51], v[16:19], v[36:39], v[48:51]
  v_bitop3_b32 v133, v36, v36, s59 bitop3:0x7e
  v_or_b32 v132, v132, v133
  s_waitcnt vmcnt(1)
  v_mfma_f32_16x16x32_bf16 v[48:51], v[16:19], v[40:43], v[48:51]
  v_bitop3_b32 v133, v40, v40, s59 bitop3:0x7e
  v_or_b32 v132, v132, v133
  s_waitcnt vmcnt(0)
  v_mfma_f32_16x16x32_bf16 v[48:51], v[16:19], v[44:47], v[48:51]
  v_bitop3_b32 v133, v44, v44, s59 bitop3:0x7e
  v_bitop3_b32 v132, v132, v133, 1 bitop3:0xa8
  v_cmp_ne_u32 vcc, 0, v132
  s_cbranch_vccnz L170_fc
  s_nop 3
  v_add_f32_dpp v48, v48, v48 row_ror:8 row_mask:0xf bank_mask:0xf
  v_add_f32_dpp v49, v49, v49 row_ror:8 row_mask:0xf bank_mask:0xf
  v_add_f32_dpp v50, v50, v50 row_ror:8 row_mask:0xf bank_mask:0xf
  v_add_f32_dpp v51, v51, v51 row_ror:8 row_mask:0xf bank_mask:0xf
  v_cvt_pk_bf16_f32 v24, v48, v49
  v_cvt_pk_bf16_f32 v25, v50, v51
  v_bfi_b32 v24, 1, s61, v24
  buffer_store_dwordx2 v[24:25], v12, s[8:11], s56 offen sc1
  s_barrier
  buffer_store_dwordx2 v[24:25], v7, s[8:11], s57 offen sc1
  s_xor_b32 s59, s59, 1
  s_mov_b32 s60, s61
  s_xor_b32 s61, s61, s59
  s_xor_b32 s57, s57, 131072
  s_waitcnt vmcnt(1)
  s_barrier
  s_branch L153_top
L165_fin:
  s_barrier
  s_waitcnt vmcnt(0)
  s_endpgm
L156_pw:
  buffer_load_dword v14, off, s[8:11], s68 sc1
  s_sub_u32 s37, s37, 1
  s_cbranch_scc1 L130_bail
  s_waitcnt vmcnt(0)
  v_readfirstlane_b32 s38, v14
  s_cmp_lt_u32 s38, s62
  s_cbranch_scc1 L156_pw
  s_branch L157_pwb
L158_f1:
  s_mov_b64 exec, vcc
  buffer_load_dwordx4 v[20:23], v2, s[8:11], s56 offen offset:0 sc1
  buffer_load_dwordx4 v[24:27], v2, s[8:11], s56 offen offset:1024 sc1
  s_mov_b64 exec, -1
  buffer_load_dwordx4 v[28:31], v8, s[8:11], s58 offen offset:0 sc1
  buffer_load_dwordx4 v[32:35], v8, s[8:11], s58 offen offset:1024 sc1
  s_waitcnt vmcnt(2)
  v_bitop3_b32 v132, v20, v22, s60 bitop3:0x7e
  v_bitop3_b32 v133, v24, v26, s60 bitop3:0x7e
  v_bitop3_b32 v132, v132, v133, 1 bitop3:0xa8
  v_cmp_ne_u32 vcc, 0, v132
  s_cbranch_vccz L162_b3
L163_f3:
L164_ag:
  s_mov_b64 exec, vcc
  s_xor_b32 s3, s58, 0
  buffer_load_dwordx4 v[20:23], v2, s[8:11], s56 offen offset:0 sc1
  buffer_load_dwordx4 v[24:27], v2, s[8:11], s56 offen offset:1024 sc1
  s_sub_u32 s37, s37, 1
  s_cbranch_scc1 L130_bail
  s_waitcnt vmcnt(0)
  v_bitop3_b32 v132, v20, v22, s60 bitop3:0x7e
  v_bitop3_b32 v133, v24, v26, s60 bitop3:0x7e
  v_bitop3_b32 v132, v132, v133, 1 bitop3:0xa8
  v_cmp_ne_u32 vcc, 0, v132
  s_mov_b64 exec, -1
  s_cbranch_vccnz L164_ag
  s_branch L162_b3
L160_f2:
  s_xor_b32 s3, s58, 0
  s_sub_u32 s37, s37, 1
  s_cbranch_scc1 L130_bail
  buffer_load_dwordx4 v[28:31], v8, s[8:11], s3 offen offset:0 sc1
  buffer_load_dwordx4 v[32:35], v8, s[8:11], s3 offen offset:1024 sc1
  s_branch L161_b2
L154_fL:
  s_mov_b64 exec, vcc
  buffer_load_dwordx4 v[28:31], v2, s[8:11], s56 offen offset:0 sc1
  buffer_load_dwordx4 v[32:35], v2, s[8:11], s56 offen offset:1024 sc1
  s_mov_b64 exec, -1
  s_sub_u32 s37, s37, 1
  s_cbranch_scc1 L130_bail
  s_branch L155_rl
L167_fb:
  s_waitcnt vmcnt(0)
  v_bitop3_b32 v71, v72, v76, s59 bitop3:0x7e
  v_and_b32 v71, 1, v71
  v_cmp_ne_u32 vcc, 0, v71
  v_mov_b32 v84, v72
  v_mov_b32 v85, v73
  v_mov_b32 v86, v74
  v_mov_b32 v87, v75
  v_mov_b32 v88, v76
  s_cbranch_vccz L166_rb
L168_fb2:
  s_sub_u32 s37, s37, 1
  s_cbranch_scc1 L130_bail
  buffer_load_dwordx4 v[84:87], v0, s[8:11], s45 offen sc1
  buffer_load_dword v88, v1, s[8:11], s45 offen offset:1024 sc1
  s_waitcnt vmcnt(0)
  v_bitop3_b32 v71, v84, v88, s59 bitop3:0x7e
  v_and_b32 v71, 1, v71
  v_cmp_ne_u32 vcc, 0, v71
  s_cbranch_vccz L166_rb
  s_branch L168_fb2
L170_fc:
  s_mov_b64 exec, vcc
  buffer_load_dwordx4 v[32:35], v11, s[8:11], s49 offen sc1
  buffer_load_dwordx4 v[36:39], v11, s[8:11], s50 offen sc1
  buffer_load_dwordx4 v[40:43], v11, s[8:11], s51 offen sc1
  buffer_load_dwordx4 v[44:47], v11, s[8:11], s52 offen sc1
  s_mov_b64 exec, -1
  s_sub_u32 s37, s37, 1
  s_cbranch_scc1 L130_bail
  s_branch L169_rc
L130_bail:
  s_endpgm
L87_recw2:
  s_add_u32 s66, s66, -393216
  s_mul_i32 s3, s6, 384
  s_mul_i32 s100, s7, 192
  s_add_u32 s3, s3, s100
  v_add_u32 v32, 0, v20
  v_mul_u32_u24 v33, 171, v32
  v_lshrrev_b32 v33, 11, v33
  v_mul_u32_u24 v34, 12, v33
  v_sub_u32 v32, v32, v34
  v_lshl_add_u32 v32, v32, 4, s3
  v_lshrrev_b32 v34, 2, v33
  v_and_b32 v35, 3, v33
  v_lshl_add_u32 v35, v35, 4, v34
  v_mul_u32_u24 v35, 12288, v35
  v_add_u32 v21, v35, v32
  v_and_b32 v35, 1, v33
  v_lshlrev_b32 v35, 4, v35
  v_lshl_add_u32 v35, v34, 1, v35
  v_bfe_u32 v34, v33, 1, 1
  v_add_u32 v35, v35, v34
  v_mul_u32_u24 v35, 12288, v35
  v_add_u32 v24, v35, v32
  v_add_u32 v32, 64, v20
  v_mul_u32_u24 v33, 171, v32
  v_lshrrev_b32 v33, 11, v33
  v_mul_u32_u24 v34, 12, v33
  v_sub_u32 v32, v32, v34
  v_lshl_add_u32 v32, v32, 4, s3
  v_lshrrev_b32 v34, 2, v33
  v_and_b32 v35, 3, v33
  v_lshl_add_u32 v35, v35, 4, v34
  v_mul_u32_u24 v35, 12288, v35
  v_add_u32 v22, v35, v32
  v_and_b32 v35, 1, v33
  v_lshlrev_b32 v35, 4, v35
  v_lshl_add_u32 v35, v34, 1, v35
  v_bfe_u32 v34, v33, 1, 1
  v_add_u32 v35, v35, v34
  v_mul_u32_u24 v35, 12288, v35
  v_add_u32 v25, v35, v32
  v_add_u32 v32, 128, v20
  v_mul_u32_u24 v33, 171, v32
  v_lshrrev_b32 v33, 11, v33
  v_mul_u32_u24 v34, 12, v33
  v_sub_u32 v32, v32, v34
  v_lshl_add_u32 v32, v32, 4, s3
  v_lshrrev_b32 v34, 2, v33
  v_and_b32 v35, 3, v33
  v_lshl_add_u32 v35, v35, 4, v34
  v_mul_u32_u24 v35, 12288, v35
  v_add_u32 v23, v35, v32
  v_and_b32 v35, 1, v33
  v_lshlrev_b32 v35, 4, v35
  v_lshl_add_u32 v35, v34, 1, v35
  v_bfe_u32 v34, v33, 1, 1
  v_add_u32 v35, v35, v34
  v_mul_u32_u24 v35, 12288, v35
  v_add_u32 v26, v35, v32
  s_mov_b32 s3, 98304
  s_mov_b32 m0, 129024
  s_nop 0
  buffer_load_dwordx4 v21, s[24:27], s3 offen lds
  s_mov_b32 m0, 130048
  s_nop 0
  buffer_load_dwordx4 v22, s[24:27], s3 offen lds
  s_mov_b32 m0, 131072
  s_nop 0
  buffer_load_dwordx4 v23, s[24:27], s3 offen lds
  s_mov_b32 s3, 884736
  s_mov_b32 m0, 141312
  s_nop 0
  buffer_load_dwordx4 v21, s[24:27], s3 offen lds
  s_mov_b32 m0, 142336
  s_nop 0
  buffer_load_dwordx4 v22, s[24:27], s3 offen lds
  s_mov_b32 m0, 143360
  s_nop 0
  buffer_load_dwordx4 v23, s[24:27], s3 offen lds
  v_and_b32 v40, 15, v20
  v_lshrrev_b32 v41, 4, v20
  v_lshlrev_b32 v0, 4, v20
  v_lshlrev_b32 v1, 2, v20
  v_add_u32 v2, 16384, v0
  v_add_u32 v3, 102400, v0
  v_mov_b32 v15, v0
  v_bfe_u32 v42, v40, 2, 1
  v_lshlrev_b32 v42, 8, v42
  v_bfe_u32 v43, v40, 3, 1
  v_lshl_or_b32 v42, v43, 7, v42
  v_and_b32 v43, 3, v40
  v_lshl_or_b32 v42, v43, 5, v42
  v_lshrrev_b32 v43, 2, v40
  v_xor_b32 v43, v43, v41
  v_lshl_or_b32 v4, v43, 3, v42
  v_lshrrev_b32 v42, 1, v41
  v_lshlrev_b32 v42, 9, v42
  v_and_b32 v43, 1, v41
  v_lshl_or_b32 v42, v43, 7, v42
  v_lshrrev_b32 v44, 2, v40
  v_lshl_or_b32 v42, v44, 5, v42
  v_lshlrev_b32 v43, 1, v43
  v_and_b32 v44, 3, v40
  v_xor_b32 v43, v43, v44
  v_lshl_or_b32 v5, v43, 3, v42
  v_xor_b32 v6, 264, v5
  v_mov_b32 v42, 0x44444444
  v_mov_b32 v43, 0xeeeeeeee
  v_cndmask_b32 v13, v42, v43, s[42:43]
  v_mov_b32 v42, 0x7ffff000
  v_and_b32 v43, 1, v41
  v_lshlrev_b32 v43, 5, v43
  v_and_b32 v44, 3, v40
  v_lshl_or_b32 v43, v44, 3, v43
  v_add_u32 v8, 512, v43
  v_cndmask_b32 v7, v42, v0, s[42:43]
  v_lshrrev_b32 v42, 2, v40
  v_lshlrev_b32 v42, 8, v42
  v_lshl_or_b32 v42, v41, 6, v42
  v_and_b32 v43, 3, v40
  v_lshl_or_b32 v42, v43, 4, v42
  v_add_u32 v9, 5120, v42
  v_lshrrev_b32 v42, 3, v40
  v_lshlrev_b32 v42, 8, v42
  v_lshl_or_b32 v42, v41, 6, v42
  v_and_b32 v43, 7, v40
  v_lshl_or_b32 v42, v43, 3, v42
  v_add_u32 v10, 7168, v42
  s_lshr_b32 s3, s5, 3
  s_mul_i32 s3, s3, 160
  s_and_b32 s100, s5, 7
  s_lshl_b32 s100, s100, 2
  s_add_u32 s3, s3, s100
  s_add_u32 s3, s3, 128
  v_and_b32 v43, 3, v40
  v_add_u32 v45, s3, v43
  v_lshrrev_b32 v42, 2, v40
  v_lshl_add_u32 v42, v41, 2, v42
  v_mul_u32_u24 v42, 10496, v42
  v_lshl_add_u32 v11, v45, 4, v42
  v_mov_b32 v46, 0x7ffff000
  v_lshrrev_b32 v42, 1, v45
  v_lshlrev_b32 v42, 5, v42
  v_lshl_or_b32 v42, v41, 4, v42
  v_and_b32 v43, 1, v45
  v_lshl_or_b32 v42, v43, 3, v42
  v_add_u32 v43, 12288, v42
  v_cmp_gt_u32 vcc, 4096, v42
  s_nop 1
  v_cndmask_b32 v42, v43, v42, vcc
  v_cmp_gt_u32 vcc, 4, v40
  s_nop 1
  v_cndmask_b32 v42, v46, v42, vcc
  v_cmp_gt_u32 vcc, 2, v41
  s_nop 1
  v_cndmask_b32 v12, v46, v42, vcc
  v_bfe_u32 v42, v40, 1, 1
  v_bfe_u32 v43, v40, 2, 1
  v_lshl_or_b32 v42, v42, 1, v43
  v_and_b32 v43, 1, v40
  v_lshlrev_b32 v43, 4, v43
  v_lshlrev_b32 v43, v43, s39
  v_cmp_eq_u32 vcc, 0, v42
  s_nop 1
  v_cndmask_b32 v16, 0, v43, vcc
  v_cmp_eq_u32 vcc, 1, v42
  s_nop 1
  v_cndmask_b32 v17, 0, v43, vcc
  v_cmp_eq_u32 vcc, 2, v42
  s_nop 1
  v_cndmask_b32 v18, 0, v43, vcc
  v_cmp_eq_u32 vcc, 3, v42
  s_nop 1
  v_cndmask_b32 v19, 0, v43, vcc
  v_lshrrev_b32 v42, 1, v45
  v_lshlrev_b32 v42, 5, v42
  v_and_b32 v43, 1, v41
  v_lshl_or_b32 v42, v43, 4, v42
  v_and_b32 v43, 1, v45
  v_lshl_or_b32 v42, v43, 3, v42
  v_and_b32 v57, 127, v42
  v_bfe_i32 v43, v42, 7, 1
  v_and_b32 v43, 128, v43
  v_add_u32 v57, v57, v43
  v_bfe_i32 v43, v42, 8, 1
  v_and_b32 v43, 256, v43
  v_add_u32 v57, v57, v43
  v_bfe_i32 v43, v42, 9, 1
  v_and_b32 v43, 512, v43
  v_add_u32 v57, v57, v43
  v_lshrrev_b32 v42, 10, v42
  v_lshl_add_u32 v57, v42, 10, v57
  v_add_u32 v43, 0, v57
  v_cmp_lt_u32 vcc, 1, v42
  s_nop 1
  v_cndmask_b32 v57, v57, v43, vcc
  v_add_u32 v43, 0, v57
  v_cmp_lt_u32 vcc, 3, v42
  s_nop 1
  v_cndmask_b32 v57, v57, v43, vcc
  v_add_u32 v43, 10240, v57
  v_cmp_lt_u32 vcc, 6, v42
  s_nop 1
  v_cndmask_b32 v57, v57, v43, vcc
  v_and_b32 v42, 7, v20
  v_lshlrev_b32 v42, 4, v42
  v_add_u32 v8, 4096, v42
  v_bfe_i32 v43, v20, 3, 1
  v_and_b32 v43, 128, v43
  v_add_u32 v8, v8, v43
  v_bfe_i32 v43, v20, 4, 1
  v_and_b32 v43, 256, v43
  v_add_u32 v8, v8, v43
  v_bfe_i32 v43, v20, 5, 1
  v_and_b32 v43, 512, v43
  v_add_u32 v8, v8, v43
  s_lshr_b32 s3, s5, 3
  s_mul_i32 s3, s3, 160
  s_and_b32 s100, s5, 7
  s_lshl_b32 s100, s100, 2
  s_add_u32 s3, s3, s100
  s_add_u32 s3, s3, 128
  v_and_b32 v40, 3, v20
  v_add_u32 v40, s3, v40
  v_lshrrev_b32 v41, 4, v40
  v_and_b32 v48, 3, v40
  v_lshl_or_b32 v41, v41, 2, v48
  v_mul_u32_u24 v42, 205, v41
  v_lshrrev_b32 v42, 13, v42
  v_mul_u32_u24 v43, 40, v42
  v_sub_u32 v43, v41, v43
  v_lshrrev_b32 v44, 4, v43
  v_lshlrev_b32 v44, 6, v44
  v_and_b32 v48, 15, v43
  v_add_u32 v44, v44, v48
  v_add_u32 v48, v44, v48
  v_cmp_gt_u32 vcc, 32, v43
  s_nop 1
  v_cndmask_b32 v44, v48, v44, vcc
  v_cndmask_b32 v47, 2, 64, vcc
  v_mul_u32_u24 v42, 160, v42
  v_add_u32 v44, v44, v42
  v_bfe_u32 v45, v40, 2, 2
  v_bfe_u32 v48, v20, 4, 1
  v_lshl_or_b32 v45, v45, 1, v48
  v_mul_u32_u24 v45, 1280, v45
  v_lshl_add_u32 v46, v44, 1, v45
  v_add_u32 v47, v47, v46
  buffer_load_ushort v52, v46, s[32:35], 0 offen
  buffer_load_ushort v54, v46, s[32:35], 0 offen offset:32
  buffer_load_ushort v53, v47, s[32:35], 0 offen
  buffer_load_ushort v55, v47, s[32:35], 0 offen offset:32
  v_mov_b32 v132, 0
  v_mov_b32 v133, 0
  v_mov_b32 v134, 0
  v_mov_b32 v135, 0
  buffer_store_dwordx4 v[132:135], v9, s[8:11], s47 offen sc1
  buffer_store_dwordx4 v[132:135], v9, s[8:11], s47 offen offset:1024 sc1
  buffer_store_dwordx2 v[132:133], v10, s[8:11], s47 offen sc1
  buffer_store_dword v132, v1, s[8:11], s44 offen offset:1024 sc1
  v_bfe_u32 v7, v1, 5, 1
  v_lshl_add_u32 v7, v7, 30, v57
  v_bfe_u32 v112, v1, 7, 1
  v_lshl_add_u32 v7, v112, 29, v7
  s_xor_b32 s3, s57, 0
  buffer_store_dwordx2 v[132:133], v7, s[8:11], s3 offen sc1
  s_xor_b32 s3, s57, 8192
  buffer_store_dwordx2 v[132:133], v7, s[8:11], s3 offen sc1
  s_xor_b32 s3, s57, 131072
  buffer_store_dwordx2 v[132:133], v7, s[8:11], s3 offen sc1
  s_xor_b32 s3, s57, 139264
  buffer_store_dwordx2 v[132:133], v7, s[8:11], s3 offen sc1
  s_xor_b32 s3, s56, 65536
  buffer_store_dwordx2 v[132:133], v12, s[8:11], s3 offen sc1
  s_mov_b32 s3, 1966080
  s_mov_b32 m0, 30720
  s_nop 0
  buffer_load_dwordx4 v21, s[24:27], s3 offen lds
  s_mov_b32 m0, 31744
  s_nop 0
  buffer_load_dwordx4 v22, s[24:27], s3 offen lds
  s_mov_b32 m0, 32768
  s_nop 0
  buffer_load_dwordx4 v23, s[24:27], s3 offen lds
  s_mov_b32 s3, 2752512
  s_mov_b32 m0, 43008
  s_nop 0
  buffer_load_dwordx4 v21, s[24:27], s3 offen lds
  s_mov_b32 m0, 44032
  s_nop 0
  buffer_load_dwordx4 v22, s[24:27], s3 offen lds
  s_mov_b32 m0, 45056
  s_nop 0
  buffer_load_dwordx4 v23, s[24:27], s3 offen lds
  v_bfe_u32 v32, v20, 5, 1
  v_lshlrev_b32 v32, 4, v32
  v_bfe_u32 v33, v20, 3, 1
  v_lshl_or_b32 v32, v33, 3, v32
  v_bfe_u32 v33, v20, 4, 1
  v_lshl_or_b32 v32, v33, 2, v32
  v_bfe_u32 v33, v20, 2, 1
  v_or_b32 v32, v32, v33
  v_mul_u32_u24 v32, 192, v32
  v_and_b32 v34, 3, v20
  v_lshl_add_u32 v27, v34, 3, v32
  v_add_u32 v28, 49152, v27
  v_add_u32 v29, 98304, v27
  v_bfe_u32 v32, v20, 4, 1
  v_lshlrev_b32 v32, 3, v32
  v_bfe_u32 v35, v20, 5, 1
  v_lshl_or_b32 v32, v35, 2, v32
  v_or_b32 v32, v32, v33
  v_mul_u32_u24 v32, 1280, v32
  v_bfe_u32 v33, v20, 3, 1
  v_lshl_add_u32 v32, v33, 5, v32
  v_lshl_add_u32 v30, v34, 3, v32
  v_add_u32 v31, 49152, v30
  v_add_u32 v14, 98304, v30
  s_mul_i32 s101, s6, 245760
  s_mul_i32 s100, s7, 122880
  s_add_u32 s101, s101, s100
  s_mul_i32 s65, s6, 12288
  s_mul_i32 s3, s7, 6144
  s_add_u32 s65, s65, s3
  s_add_u32 s65, s65, 58720256
  s_lshl_b32 s68, s6, 7
  s_add_u32 s68, s68, 3149824
  s_mov_b32 s69, 24576
  s_mov_b32 s62, 1
  s_waitcnt vmcnt(6)
  v_and_b32 v52, 0xfffe, v52
  v_and_b32 v53, 0xfffe, v53
  v_lshl_or_b32 v52, v54, 16, v52
  v_lshl_or_b32 v53, v55, 16, v53
  buffer_store_dwordx2 v[52:53], v12, s[8:11], s56 offen sc1
  s_mov_b32 s3, 3538944
  s_mov_b32 m0, 6144
  s_nop 0
  buffer_load_dwordx4 v24, s[24:27], s3 offen lds
  s_mov_b32 m0, 7168
  s_nop 0
  buffer_load_dwordx4 v25, s[24:27], s3 offen lds
  s_mov_b32 m0, 8192
  s_nop 0
  buffer_load_dwordx4 v26, s[24:27], s3 offen lds
  s_mov_b32 s3, 4030464
  s_mov_b32 m0, 18432
  s_nop 0
  buffer_load_dwordx4 v21, s[24:27], s3 offen lds
  s_mov_b32 m0, 19456
  s_nop 0
  buffer_load_dwordx4 v22, s[24:27], s3 offen lds
  s_mov_b32 m0, 20480
  s_nop 0
  buffer_load_dwordx4 v23, s[24:27], s3 offen lds
  s_mov_b32 s3, 4816896
  s_mov_b32 m0, 55296
  s_nop 0
  buffer_load_dwordx4 v21, s[24:27], s3 offen lds
  s_mov_b32 m0, 56320
  s_nop 0
  buffer_load_dwordx4 v22, s[24:27], s3 offen lds
  s_mov_b32 m0, 57344
  s_nop 0
  buffer_load_dwordx4 v23, s[24:27], s3 offen lds
  s_mov_b32 s3, 5898240
  s_mov_b32 m0, 67584
  s_nop 0
  buffer_load_dwordx4 v21, s[24:27], s3 offen lds
  s_mov_b32 m0, 68608
  s_nop 0
  buffer_load_dwordx4 v22, s[24:27], s3 offen lds
  s_mov_b32 m0, 69632
  s_nop 0
  buffer_load_dwordx4 v23, s[24:27], s3 offen lds
  s_mov_b32 s3, 6684672
  s_mov_b32 m0, 79872
  s_nop 0
  buffer_load_dwordx4 v21, s[24:27], s3 offen lds
  s_mov_b32 m0, 80896
  s_nop 0
  buffer_load_dwordx4 v22, s[24:27], s3 offen lds
  s_mov_b32 m0, 81920
  s_nop 0
  buffer_load_dwordx4 v23, s[24:27], s3 offen lds
  s_mov_b32 s3, 7471104
  s_mov_b32 m0, 92160
  s_nop 0
  buffer_load_dwordx4 v24, s[24:27], s3 offen lds
  s_mov_b32 m0, 93184
  s_nop 0
  buffer_load_dwordx4 v25, s[24:27], s3 offen lds
  s_mov_b32 m0, 94208
  s_nop 0
  buffer_load_dwordx4 v26, s[24:27], s3 offen lds
  s_waitcnt vmcnt(24)
  s_waitcnt lgkmcnt(0)
  s_barrier
  s_mov_b32 s3, 98304
  s_mov_b32 m0, 104448
  s_nop 0
  buffer_load_dwordx4 v21, s[16:19], s3 offen lds
  s_mov_b32 m0, 105472
  s_nop 0
  buffer_load_dwordx4 v22, s[16:19], s3 offen lds
  s_mov_b32 m0, 106496
  s_nop 0
  buffer_load_dwordx4 v23, s[16:19], s3 offen lds
  s_mov_b32 s3, 98304
  s_mov_b32 m0, 116736
  s_nop 0
  buffer_load_dwordx4 v21, s[20:23], s3 offen lds
  s_mov_b32 m0, 117760
  s_nop 0
  buffer_load_dwordx4 v22, s[20:23], s3 offen lds
  s_mov_b32 m0, 118784
  s_nop 0
  buffer_load_dwordx4 v23, s[20:23], s3 offen lds
  ds_read_b64_tr_b16 v[96:97], v29 offset:24640
  ds_read_b64_tr_b16 v[98:99], v29 offset:25024
  ds_read_b64_tr_b16 v[100:101], v29 offset:30784
  ds_read_b64_tr_b16 v[102:103], v29 offset:31168
  ds_read_b64_tr_b16 v[104:105], v29 offset:36928
  ds_read_b64_tr_b16 v[106:107], v29 offset:37312
  ds_read_b64_tr_b16 v[108:109], v29 offset:43072
  ds_read_b64_tr_b16 v[110:111], v29 offset:43456
  ds_read_b64_tr_b16 v[120:121], v29 offset:24736
  ds_read_b64_tr_b16 v[122:123], v29 offset:25120
  ds_read_b64_tr_b16 v[124:125], v29 offset:30880
  ds_read_b64_tr_b16 v[126:127], v29 offset:31264
  ds_read_b64_tr_b16 v[128:129], v29 offset:37024
  ds_read_b64_tr_b16 v[130:131], v29 offset:37408
  ds_read_b64_tr_b16 v[132:133], v29 offset:43168
  ds_read_b64_tr_b16 v[134:135], v29 offset:43552
  s_waitcnt vmcnt(24)
  s_waitcnt lgkmcnt(0)
  s_barrier
  s_add_u32 s3, s101, 20480
  s_mov_b32 m0, 133120
  s_nop 0
  buffer_load_dwordx4 v0, s[28:31], s3 offen lds
  s_add_u32 s3, s101, 21504
  s_mov_b32 m0, 134144
  s_nop 0
  buffer_load_dwordx4 v0, s[28:31], s3 offen lds
  s_add_u32 s3, s101, 22528
  s_mov_b32 m0, 135168
  s_nop 0
  buffer_load_dwordx4 v0, s[28:31], s3 offen lds
  s_add_u32 s3, s101, 23552
  s_mov_b32 m0, 136192
  s_nop 0
  buffer_load_dwordx4 v0, s[28:31], s3 offen lds
  s_add_u32 s3, s101, 24576
  s_mov_b32 m0, 137216
  s_nop 0
  buffer_load_dwordx4 v0, s[28:31], s3 offen lds
  ds_read_b64_tr_b16 a[176:177], v27 offset:24640
  ds_read_b64_tr_b16 a[178:179], v27 offset:25024
  ds_read_b64_tr_b16 a[180:181], v27 offset:30784
  ds_read_b64_tr_b16 a[182:183], v27 offset:31168
  ds_read_b64_tr_b16 a[184:185], v27 offset:36928
  ds_read_b64_tr_b16 a[186:187], v27 offset:37312
  ds_read_b64_tr_b16 a[188:189], v27 offset:43072
  ds_read_b64_tr_b16 a[190:191], v27 offset:43456
  s_waitcnt vmcnt(23)
  s_waitcnt lgkmcnt(0)
  s_barrier
  s_mov_b32 s3, 884736
  s_mov_b32 m0, 30720
  s_nop 0
  buffer_load_dwordx4 v21, s[16:19], s3 offen lds
  s_mov_b32 m0, 31744
  s_nop 0
  buffer_load_dwordx4 v22, s[16:19], s3 offen lds
  s_mov_b32 m0, 32768
  s_nop 0
  buffer_load_dwordx4 v23, s[16:19], s3 offen lds
  s_mov_b32 s3, 884736
  s_mov_b32 m0, 43008
  s_nop 0
  buffer_load_dwordx4 v21, s[20:23], s3 offen lds
  s_mov_b32 m0, 44032
  s_nop 0
  buffer_load_dwordx4 v22, s[20:23], s3 offen lds
  s_mov_b32 m0, 45056
  s_nop 0
  buffer_load_dwordx4 v23, s[20:23], s3 offen lds
  ds_read_b64_tr_b16 a[192:193], v27 offset:64
  ds_read_b64_tr_b16 a[194:195], v27 offset:448
  ds_read_b64_tr_b16 a[196:197], v27 offset:6208
  ds_read_b64_tr_b16 a[198:199], v27 offset:6592
  ds_read_b64_tr_b16 a[200:201], v27 offset:12352
  ds_read_b64_tr_b16 a[202:203], v27 offset:12736
  ds_read_b64_tr_b16 a[204:205], v27 offset:18496
  ds_read_b64_tr_b16 a[206:207], v27 offset:18880
  ds_read_b64_tr_b16 a[240:241], v27 offset:160
  ds_read_b64_tr_b16 a[242:243], v27 offset:544
  ds_read_b64_tr_b16 a[244:245], v27 offset:6304
  ds_read_b64_tr_b16 a[246:247], v27 offset:6688
  ds_read_b64_tr_b16 a[248:249], v27 offset:12448
  ds_read_b64_tr_b16 a[250:251], v27 offset:12832
  ds_read_b64_tr_b16 a[252:253], v27 offset:18592
  ds_read_b64_tr_b16 a[254:255], v27 offset:18976
  s_waitcnt vmcnt(23)
  s_waitcnt lgkmcnt(0)
  s_barrier
  s_mov_b32 s3, 1966080
  s_mov_b32 m0, 6144
  s_nop 0
  buffer_load_dwordx4 v21, s[16:19], s3 offen lds
  s_mov_b32 m0, 7168
  s_nop 0
  buffer_load_dwordx4 v22, s[16:19], s3 offen lds
  s_mov_b32 m0, 8192
  s_nop 0
  buffer_load_dwordx4 v23, s[16:19], s3 offen lds
  s_mov_b32 s3, 1966080
  s_mov_b32 m0, 18432
  s_nop 0
  buffer_load_dwordx4 v21, s[20:23], s3 offen lds
  s_mov_b32 m0, 19456
  s_nop 0
  buffer_load_dwordx4 v22, s[20:23], s3 offen lds
  s_mov_b32 m0, 20480
  s_nop 0
  buffer_load_dwordx4 v23, s[20:23], s3 offen lds
  ds_read_b64_tr_b16 v[112:113], v28 offset:160
  ds_read_b64_tr_b16 v[114:115], v28 offset:544
  ds_read_b64_tr_b16 v[116:117], v28 offset:6304
  ds_read_b64_tr_b16 v[118:119], v28 offset:6688
  ds_read_b64_tr_b16 a[208:209], v28 offset:64
  ds_read_b64_tr_b16 a[210:211], v28 offset:448
  ds_read_b64_tr_b16 a[212:213], v28 offset:6208
  ds_read_b64_tr_b16 a[214:215], v28 offset:6592
  ds_read_b64_tr_b16 a[216:217], v28 offset:12352
  ds_read_b64_tr_b16 a[218:219], v28 offset:12736
  ds_read_b64_tr_b16 a[220:221], v28 offset:18496
  ds_read_b64_tr_b16 a[222:223], v28 offset:18880
  s_waitcnt vmcnt(23)
  s_waitcnt lgkmcnt(0)
  s_barrier
  s_add_u32 s3, s101, 30720
  s_mov_b32 m0, 59392
  s_nop 0
  buffer_load_dwordx4 v0, s[28:31], s3 offen lds
  s_add_u32 s3, s101, 31744
  s_mov_b32 m0, 60416
  s_nop 0
  buffer_load_dwordx4 v0, s[28:31], s3 offen lds
  s_add_u32 s3, s101, 32768
  s_mov_b32 m0, 61440
  s_nop 0
  buffer_load_dwordx4 v0, s[28:31], s3 offen lds
  s_add_u32 s3, s101, 33792
  s_mov_b32 m0, 62464
  s_nop 0
  buffer_load_dwordx4 v0, s[28:31], s3 offen lds
  s_add_u32 s3, s101, 34816
  s_mov_b32 m0, 63488
  s_nop 0
  buffer_load_dwordx4 v0, s[28:31], s3 offen lds
  ds_read_b64_tr_b16 a[224:225], v28 offset:24640
  ds_read_b64_tr_b16 a[226:227], v28 offset:25024
  ds_read_b64_tr_b16 a[228:229], v28 offset:30784
  ds_read_b64_tr_b16 a[230:231], v28 offset:31168
  ds_read_b64_tr_b16 a[232:233], v28 offset:36928
  ds_read_b64_tr_b16 a[234:235], v28 offset:37312
  ds_read_b64_tr_b16 a[236:237], v28 offset:43072
  ds_read_b64_tr_b16 a[238:239], v28 offset:43456
  s_waitcnt vmcnt(22)
  s_waitcnt lgkmcnt(0)
  s_barrier
  s_mov_b32 s3, 2752512
  s_mov_b32 m0, 79872
  s_nop 0
  buffer_load_dwordx4 v21, s[16:19], s3 offen lds
  s_mov_b32 m0, 80896
  s_nop 0
  buffer_load_dwordx4 v22, s[16:19], s3 offen lds
  s_mov_b32 m0, 81920
  s_nop 0
  buffer_load_dwordx4 v23, s[16:19], s3 offen lds
  s_mov_b32 s3, 2752512
  s_mov_b32 m0, 92160
  s_nop 0
  buffer_load_dwordx4 v21, s[20:23], s3 offen lds
  s_mov_b32 m0, 93184
  s_nop 0
  buffer_load_dwordx4 v22, s[20:23], s3 offen lds
  s_mov_b32 m0, 94208
  s_nop 0
  buffer_load_dwordx4 v23, s[20:23], s3 offen lds
  ds_read_b64_tr_b16 a[32:33], v29 offset:12288
  ds_read_b64_tr_b16 a[34:35], v29 offset:12672
  ds_read_b64_tr_b16 a[36:37], v29 offset:18432
  ds_read_b64_tr_b16 a[38:39], v29 offset:18816
  ds_read_b64_tr_b16 a[40:41], v29 offset:12320
  ds_read_b64_tr_b16 a[42:43], v29 offset:12704
  ds_read_b64_tr_b16 a[44:45], v29 offset:18464
  ds_read_b64_tr_b16 a[46:47], v29 offset:18848
  ds_read_b64_tr_b16 a[48:49], v29 offset:12352
  ds_read_b64_tr_b16 a[50:51], v29 offset:12736
  ds_read_b64_tr_b16 a[52:53], v29 offset:18496
  ds_read_b64_tr_b16 a[54:55], v29 offset:18880
  s_waitcnt vmcnt(23)
  s_waitcnt lgkmcnt(0)
  s_barrier
  s_mov_b32 s3, 3538944
  s_mov_b32 m0, 104448
  s_nop 0
  buffer_load_dwordx4 v24, s[16:19], s3 offen lds
  s_mov_b32 m0, 105472
  s_nop 0
  buffer_load_dwordx4 v25, s[16:19], s3 offen lds
  s_mov_b32 m0, 106496
  s_nop 0
  buffer_load_dwordx4 v26, s[16:19], s3 offen lds
  s_mov_b32 s3, 3538944
  s_mov_b32 m0, 116736
  s_nop 0
  buffer_load_dwordx4 v24, s[20:23], s3 offen lds
  s_mov_b32 m0, 117760
  s_nop 0
  buffer_load_dwordx4 v25, s[20:23], s3 offen lds
  s_mov_b32 m0, 118784
  s_nop 0
  buffer_load_dwordx4 v26, s[20:23], s3 offen lds
  ds_read_b64_tr_b16 v[136:137], v14 offset:25216
  ds_read_b64_tr_b16 v[138:139], v14 offset:27776
  ds_read_b64_tr_b16 v[144:145], v14 offset:25280
  ds_read_b64_tr_b16 v[146:147], v14 offset:27840
  ds_read_b64_tr_b16 v[152:153], v14 offset:25344
  ds_read_b64_tr_b16 v[154:155], v14 offset:27904
  ds_read_b64_tr_b16 v[160:161], v14 offset:25408
  ds_read_b64_tr_b16 v[162:163], v14 offset:27968
  ds_read_b64_tr_b16 v[168:169], v14 offset:25472
  ds_read_b64_tr_b16 v[170:171], v14 offset:28032
  s_waitcnt vmcnt(23)
  s_waitcnt lgkmcnt(0)
  s_barrier
  s_add_u32 s3, s101, 61440
  s_mov_b32 m0, 133120
  s_nop 0
  buffer_load_dwordx4 v0, s[28:31], s3 offen lds
  s_add_u32 s3, s101, 62464
  s_mov_b32 m0, 134144
  s_nop 0
  buffer_load_dwordx4 v0, s[28:31], s3 offen lds
  s_add_u32 s3, s101, 63488
  s_mov_b32 m0, 135168
  s_nop 0
  buffer_load_dwordx4 v0, s[28:31], s3 offen lds
  s_add_u32 s3, s101, 64512
  s_mov_b32 m0, 136192
  s_nop 0
  buffer_load_dwordx4 v0, s[28:31], s3 offen lds
  s_add_u32 s3, s101, 65536
  s_mov_b32 m0, 137216
  s_nop 0
  buffer_load_dwordx4 v0, s[28:31], s3 offen lds
  ds_read_b64_tr_b16 a[56:57], v27 offset:36864
  ds_read_b64_tr_b16 a[58:59], v27 offset:37248
  ds_read_b64_tr_b16 a[60:61], v27 offset:43008
  ds_read_b64_tr_b16 a[62:63], v27 offset:43392
  ds_read_b64_tr_b16 a[64:65], v27 offset:36896
  ds_read_b64_tr_b16 a[66:67], v27 offset:37280
  ds_read_b64_tr_b16 a[68:69], v27 offset:43040
  ds_read_b64_tr_b16 a[70:71], v27 offset:43424
  ds_read_b64_tr_b16 a[72:73], v27 offset:36928
  ds_read_b64_tr_b16 a[74:75], v27 offset:37312
  ds_read_b64_tr_b16 a[76:77], v27 offset:43072
  ds_read_b64_tr_b16 a[78:79], v27 offset:43456
  s_waitcnt vmcnt(22)
  s_waitcnt lgkmcnt(0)
  s_barrier
  s_mov_b32 s3, 4030464
  s_mov_b32 m0, 30720
  s_nop 0
  buffer_load_dwordx4 v21, s[16:19], s3 offen lds
  s_mov_b32 m0, 31744
  s_nop 0
  buffer_load_dwordx4 v22, s[16:19], s3 offen lds
  s_mov_b32 m0, 32768
  s_nop 0
  buffer_load_dwordx4 v23, s[16:19], s3 offen lds
  s_mov_b32 s3, 4030464
  s_mov_b32 m0, 43008
  s_nop 0
  buffer_load_dwordx4 v21, s[20:23], s3 offen lds
  s_mov_b32 m0, 44032
  s_nop 0
  buffer_load_dwordx4 v22, s[20:23], s3 offen lds
  s_mov_b32 m0, 45056
  s_nop 0
  buffer_load_dwordx4 v23, s[20:23], s3 offen lds
  ds_read_b64_tr_b16 a[80:81], v27 offset:12288
  ds_read_b64_tr_b16 a[82:83], v27 offset:12672
  ds_read_b64_tr_b16 a[84:85], v27 offset:18432
  ds_read_b64_tr_b16 a[86:87], v27 offset:18816
  ds_read_b64_tr_b16 a[88:89], v27 offset:12320
  ds_read_b64_tr_b16 a[90:91], v27 offset:12704
  ds_read_b64_tr_b16 a[92:93], v27 offset:18464
  ds_read_b64_tr_b16 a[94:95], v27 offset:18848
  ds_read_b64_tr_b16 a[96:97], v27 offset:12352
  ds_read_b64_tr_b16 a[98:99], v27 offset:12736
  ds_read_b64_tr_b16 a[100:101], v27 offset:18496
  ds_read_b64_tr_b16 a[102:103], v27 offset:18880
  s_waitcnt vmcnt(23)
  s_waitcnt lgkmcnt(0)
  s_barrier
  s_mov_b32 s3, 4816896
  s_mov_b32 m0, 6144
  s_nop 0
  buffer_load_dwordx4 v21, s[16:19], s3 offen lds
  s_mov_b32 m0, 7168
  s_nop 0
  buffer_load_dwordx4 v22, s[16:19], s3 offen lds
  s_mov_b32 m0, 8192
  s_nop 0
  buffer_load_dwordx4 v23, s[16:19], s3 offen lds
  s_mov_b32 s3, 4816896
  s_mov_b32 m0, 18432
  s_nop 0
  buffer_load_dwordx4 v21, s[20:23], s3 offen lds
  s_mov_b32 m0, 19456
  s_nop 0
  buffer_load_dwordx4 v22, s[20:23], s3 offen lds
  s_mov_b32 m0, 20480
  s_nop 0
  buffer_load_dwordx4 v23, s[20:23], s3 offen lds
  ds_read_b64_tr_b16 v[140:141], v31 offset:640
  ds_read_b64_tr_b16 v[142:143], v31 offset:3200
  ds_read_b64_tr_b16 v[148:149], v31 offset:704
  ds_read_b64_tr_b16 v[150:151], v31 offset:3264
  ds_read_b64_tr_b16 v[156:157], v31 offset:768
  ds_read_b64_tr_b16 v[158:159], v31 offset:3328
  ds_read_b64_tr_b16 v[164:165], v31 offset:832
  ds_read_b64_tr_b16 v[166:167], v31 offset:3392
  ds_read_b64_tr_b16 v[172:173], v31 offset:896
  ds_read_b64_tr_b16 v[174:175], v31 offset:3456
  s_waitcnt vmcnt(23)
  s_waitcnt lgkmcnt(0)
  s_barrier
  s_add_u32 s3, s101, 71680
  s_mov_b32 m0, 59392
  s_nop 0
  buffer_load_dwordx4 v0, s[28:31], s3 offen lds
  s_add_u32 s3, s101, 72704
  s_mov_b32 m0, 60416
  s_nop 0
  buffer_load_dwordx4 v0, s[28:31], s3 offen lds
  s_add_u32 s3, s101, 73728
  s_mov_b32 m0, 61440
  s_nop 0
  buffer_load_dwordx4 v0, s[28:31], s3 offen lds
  s_add_u32 s3, s101, 74752
  s_mov_b32 m0, 62464
  s_nop 0
  buffer_load_dwordx4 v0, s[28:31], s3 offen lds
  s_add_u32 s3, s101, 75776
  s_mov_b32 m0, 63488
  s_nop 0
  buffer_load_dwordx4 v0, s[28:31], s3 offen lds
  ds_read_b64_tr_b16 a[104:105], v28 offset:36864
  ds_read_b64_tr_b16 a[106:107], v28 offset:37248
  ds_read_b64_tr_b16 a[108:109], v28 offset:43008
  ds_read_b64_tr_b16 a[110:111], v28 offset:43392
  ds_read_b64_tr_b16 a[112:113], v28 offset:36896
  ds_read_b64_tr_b16 a[114:115], v28 offset:37280
  ds_read_b64_tr_b16 a[116:117], v28 offset:43040
  ds_read_b64_tr_b16 a[118:119], v28 offset:43424
  ds_read_b64_tr_b16 a[144:145], v28 offset:36928
  ds_read_b64_tr_b16 a[146:147], v28 offset:37312
  ds_read_b64_tr_b16 a[148:149], v28 offset:43072
  ds_read_b64_tr_b16 a[150:151], v28 offset:43456
  s_waitcnt vmcnt(22)
  s_waitcnt lgkmcnt(0)
  s_barrier
  s_mov_b32 s3, 5898240
  s_mov_b32 m0, 79872
  s_nop 0
  buffer_load_dwordx4 v21, s[16:19], s3 offen lds
  s_mov_b32 m0, 80896
  s_nop 0
  buffer_load_dwordx4 v22, s[16:19], s3 offen lds
  s_mov_b32 m0, 81920
  s_nop 0
  buffer_load_dwordx4 v23, s[16:19], s3 offen lds
  s_mov_b32 s3, 5898240
  s_mov_b32 m0, 92160
  s_nop 0
  buffer_load_dwordx4 v21, s[20:23], s3 offen lds
  s_mov_b32 m0, 93184
  s_nop 0
  buffer_load_dwordx4 v22, s[20:23], s3 offen lds
  s_mov_b32 m0, 94208
  s_nop 0
  buffer_load_dwordx4 v23, s[20:23], s3 offen lds
  ds_read_b64_tr_b16 v[32:33], v29 offset:12288
  ds_read_b64_tr_b16 v[34:35], v29 offset:12672
  ds_read_b64_tr_b16 v[36:37], v29 offset:18432
  ds_read_b64_tr_b16 v[38:39], v29 offset:18816
  ds_read_b64_tr_b16 v[40:41], v29 offset:12320
  ds_read_b64_tr_b16 v[42:43], v29 offset:12704
  ds_read_b64_tr_b16 v[44:45], v29 offset:18464
  ds_read_b64_tr_b16 v[46:47], v29 offset:18848
  ds_read_b64_tr_b16 v[48:49], v29 offset:12352
  ds_read_b64_tr_b16 v[50:51], v29 offset:12736
  ds_read_b64_tr_b16 v[52:53], v29 offset:18496
  ds_read_b64_tr_b16 v[54:55], v29 offset:18880
  s_waitcnt vmcnt(23)
  s_waitcnt lgkmcnt(0)
  s_barrier
  s_mov_b32 s3, 6684672
  s_mov_b32 m0, 104448
  s_nop 0
  buffer_load_dwordx4 v21, s[16:19], s3 offen lds
  s_mov_b32 m0, 105472
  s_nop 0
  buffer_load_dwordx4 v22, s[16:19], s3 offen lds
  s_mov_b32 m0, 106496
  s_nop 0
  buffer_load_dwordx4 v23, s[16:19], s3 offen lds
  s_mov_b32 s3, 6684672
  s_mov_b32 m0, 116736
  s_nop 0
  buffer_load_dwordx4 v21, s[20:23], s3 offen lds
  s_mov_b32 m0, 117760
  s_nop 0
  buffer_load_dwordx4 v22, s[20:23], s3 offen lds
  s_mov_b32 m0, 118784
  s_nop 0
  buffer_load_dwordx4 v23, s[20:23], s3 offen lds
  ds_read_b64_tr_b16 v[176:177], v14 offset:25216
  ds_read_b64_tr_b16 v[178:179], v14 offset:27776
  ds_read_b64_tr_b16 v[184:185], v14 offset:25280
  ds_read_b64_tr_b16 v[186:187], v14 offset:27840
  ds_read_b64_tr_b16 v[192:193], v14 offset:25344
  ds_read_b64_tr_b16 v[194:195], v14 offset:27904
  ds_read_b64_tr_b16 v[200:201], v14 offset:25408
  ds_read_b64_tr_b16 v[202:203], v14 offset:27968
  ds_read_b64_tr_b16 v[208:209], v14 offset:25472
  ds_read_b64_tr_b16 v[210:211], v14 offset:28032
  s_waitcnt vmcnt(23)
  s_waitcnt lgkmcnt(0)
  s_barrier
  v_min_u32 v254, 8, v20
  v_lshlrev_b32 v254, 3, v254
  buffer_load_dwordx2 v[252:253], v254, s[12:15], s97 offen sc1
  s_mov_b32 s3, 7471104
  s_mov_b32 m0, 129024
  s_nop 0
  buffer_load_dwordx4 v24, s[16:19], s3 offen lds
  s_mov_b32 m0, 130048
  s_nop 0
  buffer_load_dwordx4 v25, s[16:19], s3 offen lds
  s_mov_b32 m0, 131072
  s_nop 0
  buffer_load_dwordx4 v26, s[16:19], s3 offen lds
  s_mov_b32 s3, 7471104
  s_mov_b32 m0, 141312
  s_nop 0
  buffer_load_dwordx4 v24, s[20:23], s3 offen lds
  s_mov_b32 m0, 142336
  s_nop 0
  buffer_load_dwordx4 v25, s[20:23], s3 offen lds
  s_mov_b32 m0, 143360
  s_nop 0
  buffer_load_dwordx4 v26, s[20:23], s3 offen lds
  ds_read_b64_tr_b16 v[56:57], v27 offset:36864
  ds_read_b64_tr_b16 v[58:59], v27 offset:37248
  ds_read_b64_tr_b16 v[60:61], v27 offset:43008
  ds_read_b64_tr_b16 v[62:63], v27 offset:43392
  ds_read_b64_tr_b16 v[64:65], v27 offset:36896
  ds_read_b64_tr_b16 v[66:67], v27 offset:37280
  ds_read_b64_tr_b16 v[68:69], v27 offset:43040
  ds_read_b64_tr_b16 v[70:71], v27 offset:43424
  ds_read_b64_tr_b16 a[0:1], v27 offset:36928
  ds_read_b64_tr_b16 a[2:3], v27 offset:37312
  ds_read_b64_tr_b16 a[4:5], v27 offset:43072
  ds_read_b64_tr_b16 a[6:7], v27 offset:43456
  s_waitcnt vmcnt(24)
  s_waitcnt lgkmcnt(0)
  s_barrier
  s_add_u32 s3, s101, 102400
  s_mov_b32 m0, 34816
  s_nop 0
  buffer_load_dwordx4 v0, s[28:31], s3 offen lds
  s_add_u32 s3, s101, 103424
  s_mov_b32 m0, 35840
  s_nop 0
  buffer_load_dwordx4 v0, s[28:31], s3 offen lds
  s_add_u32 s3, s101, 104448
  s_mov_b32 m0, 36864
  s_nop 0
  buffer_load_dwordx4 v0, s[28:31], s3 offen lds
  s_add_u32 s3, s101, 105472
  s_mov_b32 m0, 37888
  s_nop 0
  buffer_load_dwordx4 v0, s[28:31], s3 offen lds
  s_add_u32 s3, s101, 106496
  s_mov_b32 m0, 38912
  s_nop 0
  buffer_load_dwordx4 v0, s[28:31], s3 offen lds
  ds_read_b64_tr_b16 a[8:9], v27 offset:12288
  ds_read_b64_tr_b16 a[10:11], v27 offset:12672
  ds_read_b64_tr_b16 a[12:13], v27 offset:18432
  ds_read_b64_tr_b16 a[14:15], v27 offset:18816
  ds_read_b64_tr_b16 a[16:17], v27 offset:12320
  ds_read_b64_tr_b16 a[18:19], v27 offset:12704
  ds_read_b64_tr_b16 a[20:21], v27 offset:18464
  ds_read_b64_tr_b16 a[22:23], v27 offset:18848
  ds_read_b64_tr_b16 a[24:25], v27 offset:12352
  ds_read_b64_tr_b16 a[26:27], v27 offset:12736
  ds_read_b64_tr_b16 a[28:29], v27 offset:18496
  ds_read_b64_tr_b16 a[30:31], v27 offset:18880
  s_waitcnt vmcnt(24)
  s_waitcnt lgkmcnt(0)
  s_barrier
  s_add_u32 s3, s101, 112640
  s_mov_b32 m0, 10240
  s_nop 0
  buffer_load_dwordx4 v0, s[28:31], s3 offen lds
  s_add_u32 s3, s101, 113664
  s_mov_b32 m0, 11264
  s_nop 0
  buffer_load_dwordx4 v0, s[28:31], s3 offen lds
  s_add_u32 s3, s101, 114688
  s_mov_b32 m0, 12288
  s_nop 0
  buffer_load_dwordx4 v0, s[28:31], s3 offen lds
  s_add_u32 s3, s101, 115712
  s_mov_b32 m0, 13312
  s_nop 0
  buffer_load_dwordx4 v0, s[28:31], s3 offen lds
  s_add_u32 s3, s101, 116736
  s_mov_b32 m0, 14336
  s_nop 0
  buffer_load_dwordx4 v0, s[28:31], s3 offen lds
  ds_read_b64_tr_b16 v[180:181], v31 offset:640
  ds_read_b64_tr_b16 v[182:183], v31 offset:3200
  ds_read_b64_tr_b16 v[188:189], v31 offset:704
  ds_read_b64_tr_b16 v[190:191], v31 offset:3264
  ds_read_b64_tr_b16 v[196:197], v31 offset:768
  ds_read_b64_tr_b16 v[198:199], v31 offset:3328
  ds_read_b64_tr_b16 v[204:205], v31 offset:832
  ds_read_b64_tr_b16 v[206:207], v31 offset:3392
  ds_read_b64_tr_b16 v[212:213], v31 offset:896
  ds_read_b64_tr_b16 v[214:215], v31 offset:3456
  s_waitcnt vmcnt(23)
  s_waitcnt lgkmcnt(0)
  s_barrier
  ds_read_b64_tr_b16 v[72:73], v28 offset:36864
  ds_read_b64_tr_b16 v[74:75], v28 offset:37248
  ds_read_b64_tr_b16 v[76:77], v28 offset:43008
  ds_read_b64_tr_b16 v[78:79], v28 offset:43392
  ds_read_b64_tr_b16 a[120:121], v28 offset:36896
  ds_read_b64_tr_b16 a[122:123], v28 offset:37280
  ds_read_b64_tr_b16 a[124:125], v28 offset:43040
  ds_read_b64_tr_b16 a[126:127], v28 offset:43424
  ds_read_b64_tr_b16 a[152:153], v28 offset:36928
  ds_read_b64_tr_b16 a[154:155], v28 offset:37312
  ds_read_b64_tr_b16 a[156:157], v28 offset:43072
  ds_read_b64_tr_b16 a[158:159], v28 offset:43456
  s_waitcnt vmcnt(17)
  s_waitcnt lgkmcnt(0)
  s_barrier
  ds_read_b64_tr_b16 v[80:81], v29 offset:12288
  ds_read_b64_tr_b16 v[82:83], v29 offset:12672
  ds_read_b64_tr_b16 v[84:85], v29 offset:18432
  ds_read_b64_tr_b16 v[86:87], v29 offset:18816
  ds_read_b64_tr_b16 a[128:129], v29 offset:12320
  ds_read_b64_tr_b16 a[130:131], v29 offset:12704
  ds_read_b64_tr_b16 a[132:133], v29 offset:18464
  ds_read_b64_tr_b16 a[134:135], v29 offset:18848
  ds_read_b64_tr_b16 a[160:161], v29 offset:12352
  ds_read_b64_tr_b16 a[162:163], v29 offset:12736
  ds_read_b64_tr_b16 a[164:165], v29 offset:18496
  ds_read_b64_tr_b16 a[166:167], v29 offset:18880
  s_waitcnt vmcnt(10)
  s_waitcnt lgkmcnt(0)
  s_barrier
  ds_read_b64_tr_b16 v[88:89], v29 offset:36864
  ds_read_b64_tr_b16 v[90:91], v29 offset:37248
  ds_read_b64_tr_b16 v[92:93], v29 offset:43008
  ds_read_b64_tr_b16 v[94:95], v29 offset:43392
  ds_read_b64_tr_b16 a[136:137], v29 offset:36896
  ds_read_b64_tr_b16 a[138:139], v29 offset:37280
  ds_read_b64_tr_b16 a[140:141], v29 offset:43040
  ds_read_b64_tr_b16 a[142:143], v29 offset:43424
  ds_read_b64_tr_b16 a[168:169], v29 offset:36928
  ds_read_b64_tr_b16 a[170:171], v29 offset:37312
  ds_read_b64_tr_b16 a[172:173], v29 offset:43072
  ds_read_b64_tr_b16 a[174:175], v29 offset:43456
  s_waitcnt vmcnt(5)
  s_waitcnt lgkmcnt(0)
  s_barrier
  s_waitcnt vmcnt(16)
  buffer_load_dword v22, off, s[8:11], s68 sc1
  v_not_b32 v254, v252
  v_xor_b32 v255, 0x2000, v253
  v_or_b32 v254, v254, v255
  v_cmp_ne_u32 vcc, 0, v254
  v_readlane_b32 s64, v252, 8
  s_and_b32 s3, vcc_lo, 0xff
  s_cselect_b32 s63, 0, -1
  s_cmp_eq_u32 s64, 0
  s_cselect_b32 s63, 0, s63
  ds_read_b64_tr_b16 v[216:217], v30 offset:25216
  ds_read_b64_tr_b16 v[218:219], v30 offset:27776
  ds_read_b64_tr_b16 v[224:225], v30 offset:25280
  ds_read_b64_tr_b16 v[226:227], v30 offset:27840
  ds_read_b64_tr_b16 v[232:233], v30 offset:25344
  ds_read_b64_tr_b16 v[234:235], v30 offset:27904
  ds_read_b64_tr_b16 v[240:241], v30 offset:25408
  ds_read_b64_tr_b16 v[242:243], v30 offset:27968
  ds_read_b64_tr_b16 v[248:249], v30 offset:25472
  ds_read_b64_tr_b16 v[250:251], v30 offset:28032
  ds_write_b128 v3, v[32:35] offset:0
  ds_write_b128 v3, v[36:39] offset:1024
  ds_write_b128 v3, v[40:43] offset:2048
  ds_write_b128 v3, v[44:47] offset:3072
  ds_write_b128 v3, v[48:51] offset:4096
  ds_write_b128 v3, v[52:55] offset:5120
  ds_write_b128 v3, v[56:59] offset:6144
  ds_write_b128 v3, v[60:63] offset:7168
  ds_write_b128 v3, v[64:67] offset:8192
  ds_write_b128 v3, v[68:71] offset:9216
  ds_write_b128 v3, v[72:75] offset:10240
  ds_write_b128 v3, v[76:79] offset:11264
  ds_write_b128 v3, v[80:83] offset:12288
  ds_write_b128 v3, v[84:87] offset:13312
  ds_write_b128 v3, v[88:91] offset:14336
  ds_write_b128 v3, v[92:95] offset:15360
  ds_write_b128 v3, v[96:99] offset:16384
  ds_write_b128 v3, v[100:103] offset:17408
  ds_write_b128 v3, v[104:107] offset:18432
  ds_write_b128 v3, v[108:111] offset:19456
  ds_write_b128 v3, v[112:115] offset:20480
  ds_write_b128 v3, v[116:119] offset:21504
  ds_write_b128 v3, v[120:123] offset:22528
  ds_write_b128 v3, v[124:127] offset:23552
  ds_write_b128 v3, v[128:131] offset:24576
  ds_write_b128 v3, v[132:135] offset:25600
  s_waitcnt vmcnt(0)
  s_waitcnt lgkmcnt(0)
  s_barrier
  v_readfirstlane_b32 s38, v22
  s_and_b32 s38, s38, s63
  s_cbranch_scc0 L172_cslow
L173_cback:
  s_mov_b32 m0, s69
  s_nop 0
  buffer_load_dwordx4 v0, s[8:11], s65 offen offset:0 sc1 lds
  buffer_load_dwordx4 v0, s[8:11], s65 offen offset:1024 sc1 lds
  buffer_load_dwordx4 v0, s[8:11], s65 offen offset:2048 sc1 lds
  ds_read_b64_tr_b16 v[220:221], v30 offset:640
  ds_read_b64_tr_b16 v[222:223], v30 offset:3200
  ds_read_b64_tr_b16 v[228:229], v30 offset:704
  ds_read_b64_tr_b16 v[230:231], v30 offset:3264
  ds_read_b64_tr_b16 v[236:237], v30 offset:768
  ds_read_b64_tr_b16 v[238:239], v30 offset:3328
  ds_read_b64_tr_b16 v[244:245], v30 offset:832
  ds_read_b64_tr_b16 v[246:247], v30 offset:3392
  ds_read_b64_tr_b16 v[252:253], v30 offset:896
  ds_read_b64_tr_b16 v[254:255], v30 offset:3456
  s_and_b32 s64, s64, 8192
  s_add_u32 s57, s57, s64
  s_add_u32 s58, s58, s64
  s_add_u32 s65, s65, 393216
  s_waitcnt vmcnt(0) lgkmcnt(0)
  v_mov_b32 v14, s38
  s_barrier
  s_add_u32 s69, s69, 8192
  ds_read_b128 v[60:63], v3 offset:0
  ds_read_b128 v[64:67], v3 offset:1024
  ds_read_b128 v[68:71], v3 offset:2048
  ds_read_b128 v[72:75], v3 offset:3072
  ds_read_b128 v[76:79], v3 offset:4096
  ds_read_b128 v[80:83], v3 offset:5120
  ds_read_b128 v[84:87], v3 offset:6144
  ds_read_b128 v[88:91], v3 offset:7168
  ds_read_b128 v[92:95], v3 offset:8192
  ds_read_b128 v[96:99], v3 offset:9216
  v_mov_b32 v112, 0
  v_mov_b32 v113, 0
  v_mov_b32 v114, 0
  v_mov_b32 v115, 0
  v_mov_b32 v116, 0
  v_mov_b32 v117, 0
  v_mov_b32 v118, 0
  v_mov_b32 v119, 0
  v_mov_b32 v120, 0
  v_mov_b32 v121, 0
  v_mov_b32 v122, 0
  v_mov_b32 v123, 0
  v_mov_b32 v124, 0
  v_mov_b32 v125, 0
  v_mov_b32 v126, 0
  v_mov_b32 v127, 0
  v_mov_b32 v128, 0
  v_mov_b32 v129, 0
  v_mov_b32 v130, 0
  v_mov_b32 v131, 0
  s_cmp_eq_u32 s97, 0
  s_cbranch_scc1 L174_fast
  s_branch L175_slow
L172_cslow:
  v_mbcnt_lo_u32_b32 v24, -1, 0
  v_min_u32 v24, 8, v24
  v_lshlrev_b32 v24, 3, v24
L300001_cen:
  buffer_load_dwordx2 v[22:23], v24, s[12:15], s97 offen sc1
  s_sub_u32 s37, s37, 1
  s_cbranch_scc1 L171_bail
  s_waitcnt vmcnt(0)
  v_not_b32 v25, v22
  v_xor_b32 v26, 0x2000, v23
  v_or_b32 v25, v25, v26
  v_cmp_ne_u32 vcc, 0, v25
  s_and_b32 s3, vcc_lo, 0xff
  s_cbranch_scc0 L300002_cok
  v_lshrrev_b32 v23, 8, v23
  s_nop 1
  v_add_u32_dpp v23, v23, v23 row_shr:1 row_mask:0xf bank_mask:0xf bound_ctrl:1
  s_nop 1
  v_add_u32_dpp v23, v23, v23 row_shr:2 row_mask:0xf bank_mask:0xf bound_ctrl:1
  s_nop 1
  v_add_u32_dpp v23, v23, v23 row_shr:4 row_mask:0xf bank_mask:0xf bound_ctrl:1
  s_nop 0
  v_readlane_b32 s3, v23, 7
  s_cmp_lt_u32 s3, 256
  s_cbranch_scc1 L300001_cen
  s_branch L_restart
L300002_cok:
  v_readlane_b32 s64, v22, 8
  s_cmp_eq_u32 s64, 0
  s_cbranch_scc1 L300001_cen
  s_cmp_lt_u32 s38, s62
  s_cbranch_scc1 L300003_pw
L300004_pwb:
  s_branch L173_cback
L300003_pw:
  buffer_load_dword v14, off, s[8:11], s68 sc1
  s_sub_u32 s37, s37, 1
  s_cbranch_scc1 L171_bail
  s_waitcnt vmcnt(0)
  v_readfirstlane_b32 s38, v14
  s_cmp_lt_u32 s38, s62
  s_cbranch_scc1 L300003_pw
  s_branch L300004_pwb
L174_fast:
L176_top:
  v_bfe_u32 v58, v1, 2, 1
  v_lshlrev_b32 v58, 4, v58
  v_lshlrev_b32 v58, v58, s39
  v_cndmask_b32 v56, v58, 0, s[42:43]
  v_cndmask_b32 v57, 0, v58, s[42:43]
  buffer_load_dwordx4 v[20:23], v2, s[8:11], s56 offen offset:0 sc1
  buffer_load_dwordx4 v[24:27], v2, s[8:11], s56 offen offset:1024 sc1
  buffer_load_dwordx4 v[28:31], v2, s[8:11], s56 offen offset:2048 sc1
  s_add_u32 s62, s36, 2
  s_min_u32 s62, s62, 64
  v_readfirstlane_b32 s38, v14
  s_mov_b32 m0, s69
  s_cmp_lt_u32 s38, s62
  s_cbranch_scc1 L179_pw
L180_pwb:
  s_waitcnt vmcnt(2)
  v_bitop3_b32 v132, v20, v22, s60 bitop3:0x7e
  s_waitcnt vmcnt(1)
  v_bitop3_b32 v133, v24, v26, s60 bitop3:0x7e
  v_or_b32 v132, v132, v133
  s_waitcnt vmcnt(0)
  v_bitop3_b32 v133, v28, v30, s60 bitop3:0x7e
  v_bitop3_b32 v132, v132, v133, 1 bitop3:0xa8
  v_cmp_ne_u32 vcc, 0, v132
  s_cbranch_vccnz L181_f1
L182_b1:
  buffer_load_dwordx4 v[36:39], v8, s[8:11], s58 offen offset:0 sc1
  buffer_load_dwordx4 v[40:43], v8, s[8:11], s58 offen offset:1024 sc1
  buffer_load_dwordx4 v[44:47], v8, s[8:11], s58 offen offset:2048 sc1
L185_b3:
L184_b2:
  v_mfma_f32_4x4x4_16b_bf16 v[32:35], v[56:57], v[20:21], 0
  v_mfma_f32_4x4x4_16b_bf16 v[120:123], v[56:57], v[22:23], 0
  v_mfma_f32_4x4x4_16b_bf16 v[48:51], v[56:57], v[24:25], 0
  v_mfma_f32_4x4x4_16b_bf16 v[124:127], v[56:57], v[26:27], 0
  v_mfma_f32_4x4x4_16b_bf16 v[52:55], v[56:57], v[28:29], 0
  v_mfma_f32_4x4x4_16b_bf16 v[128:131], v[56:57], v[30:31], 0
  s_waitcnt lgkmcnt(0)
  s_waitcnt vmcnt(2)
  v_mfma_f32_4x4x4_16b_bf16 v[32:35], v[56:57], v[36:37], v[32:35]
  v_mfma_f32_4x4x4_16b_bf16 v[120:123], v[56:57], v[38:39], v[120:123]
  v_bitop3_b32 v132, v36, v38, s60 bitop3:0x7e
  s_waitcnt vmcnt(1)
  v_mfma_f32_4x4x4_16b_bf16 v[48:51], v[56:57], v[40:41], v[48:51]
  v_mfma_f32_4x4x4_16b_bf16 v[124:127], v[56:57], v[42:43], v[124:127]
  v_bitop3_b32 v133, v40, v42, s60 bitop3:0x7e
  v_or_b32 v132, v132, v133
  v_cvt_pk_bf16_f32 v36, v32, v33
  v_cvt_pk_bf16_f32 v37, v34, v35
  v_cvt_pk_bf16_f32 v38, v120, v121
  v_cvt_pk_bf16_f32 v39, v122, v123
  ds_write_b128 v0, v[36:39] offset:4096
  s_waitcnt vmcnt(0)
  v_mfma_f32_4x4x4_16b_bf16 v[52:55], v[56:57], v[44:45], v[52:55]
  v_mfma_f32_4x4x4_16b_bf16 v[128:131], v[56:57], v[46:47], v[128:131]
  v_bitop3_b32 v133, v44, v46, s60 bitop3:0x7e
  v_bitop3_b32 v132, v132, v133, 1 bitop3:0xa8
  v_cmp_ne_u32 vcc, 0, v132
  v_cvt_pk_bf16_f32 v40, v48, v49
  v_cvt_pk_bf16_f32 v41, v50, v51
  v_cvt_pk_bf16_f32 v42, v124, v125
  v_cvt_pk_bf16_f32 v43, v126, v127
  ds_write_b128 v0, v[40:43] offset:5120
  v_cvt_pk_bf16_f32 v44, v52, v53
  v_cvt_pk_bf16_f32 v45, v54, v55
  s_cbranch_vccnz L183_f2
  v_cvt_pk_bf16_f32 v46, v128, v129
  v_cvt_pk_bf16_f32 v47, v130, v131
  ds_write_b128 v0, v[44:47] offset:6144
L178_rl:
  v_smfmac_f32_16x16x64_bf16 v[112:115], v[36:39], v[60:67], v13
  v_mov_b32 v120, 0
  v_mov_b32 v121, 0
  v_mov_b32 v122, 0
  v_mov_b32 v123, 0
  v_smfmac_f32_16x16x64_bf16 v[116:119], v[36:39], v[68:75], v13
  v_mov_b32 v124, 0
  v_mov_b32 v125, 0
  v_mov_b32 v126, 0
  v_mov_b32 v127, 0
  v_smfmac_f32_16x16x64_bf16 v[120:123], v[36:39], v[76:83], v13
  v_mov_b32 v128, 0
  v_mov_b32 v129, 0
  v_mov_b32 v130, 0
  v_mov_b32 v131, 0
  s_waitcnt lgkmcnt(0)
  s_barrier
  ds_read_b128 v[20:23], v0 offset:0
  ds_read_b128 v[24:27], v0 offset:1024
  v_smfmac_f32_16x16x64_bf16 v[112:115], v[40:43], v[84:91], v13
  ds_read_b128 v[28:31], v0 offset:2048
  buffer_load_dword v14, off, s[8:11], s68 sc1
  v_smfmac_f32_16x16x64_bf16 v[116:119], v[40:43], v[92:99], v13
  ds_read_b128 v[32:35], v0 offset:3072
  v_smfmac_f32_16x16x64_bf16 v[120:123], v[40:43], a[0:7], v13
  ds_read_b128 v[48:51], v0 offset:7168
  v_not_b32 v132, s61
  v_not_b32 v133, s61
  v_smfmac_f32_16x16x64_bf16 v[112:115], v[44:47], a[8:15], v13
  ds_read_b128 v[52:55], v0 offset:8192
  v_smfmac_f32_16x16x64_bf16 v[116:119], v[44:47], a[16:23], v13
  ds_read_b128 v[56:59], v0 offset:9216
  buffer_store_dwordx2 v[132:133], v7, s[8:11], s57 offen sc1
  v_smfmac_f32_16x16x64_bf16 v[120:123], v[44:47], a[24:31], v13
  ds_read_b128 v[60:63], v3 offset:10240
  s_waitcnt lgkmcnt(7)
  v_smfmac_f32_16x16x64_bf16 v[112:115], v[20:23], a[32:39], v13
  ds_read_b128 v[64:67], v3 offset:11264
  buffer_store_dwordx4 v[100:103], v0, s[8:11], s66 offen offset:0 sc1
  v_smfmac_f32_16x16x64_bf16 v[116:119], v[20:23], a[40:47], v13
  ds_read_b128 v[68:71], v3 offset:12288
  v_smfmac_f32_16x16x64_bf16 v[120:123], v[20:23], a[48:55], v13
  ds_read_b128 v[72:75], v3 offset:13312
  buffer_store_dwordx4 v[104:107], v0, s[8:11], s66 offen offset:1024 sc1
  s_waitcnt lgkmcnt(9)
  v_smfmac_f32_16x16x64_bf16 v[112:115], v[24:27], a[56:63], v13
  ds_read_b128 v[76:79], v3 offset:14336
  v_smfmac_f32_16x16x64_bf16 v[116:119], v[24:27], a[64:71], v13
  ds_read_b128 v[80:83], v3 offset:15360
  buffer_store_dwordx4 v[108:111], v0, s[8:11], s66 offen offset:2048 sc1
  v_smfmac_f32_16x16x64_bf16 v[120:123], v[24:27], a[72:79], v13
  ds_read_b128 v[84:87], v3 offset:16384
  s_waitcnt lgkmcnt(11)
  v_smfmac_f32_16x16x64_bf16 v[112:115], v[28:31], a[80:87], v13
  ds_read_b128 v[88:91], v3 offset:17408
  v_smfmac_f32_16x16x64_bf16 v[116:119], v[28:31], a[88:95], v13
  ds_read_b128 v[92:95], v3 offset:18432
  v_smfmac_f32_16x16x64_bf16 v[120:123], v[28:31], a[96:103], v13
  ds_read_b128 v[96:99], v3 offset:19456
  s_waitcnt lgkmcnt(13)
  v_smfmac_f32_16x16x64_bf16 v[112:115], v[32:35], a[104:111], v13
  s_waitcnt lgkmcnt(12)
  s_waitcnt lgkmcnt(8)
  v_smfmac_f32_16x16x64_bf16 v[112:115], v[48:51], v[60:67], v13
  ds_read_b128 v[60:63], v3 offset:20480
  s_waitcnt lgkmcnt(7)
  v_smfmac_f32_16x16x64_bf16 v[112:115], v[52:55], v[68:75], v13
  ds_read_b128 v[64:67], v3 offset:21504
  s_waitcnt lgkmcnt(6)
  v_smfmac_f32_16x16x64_bf16 v[112:115], v[56:59], v[76:83], v13
  ds_read_b128 v[68:71], v3 offset:22528
  v_smfmac_f32_16x16x64_bf16 v[116:119], v[32:35], a[112:119], v13
  ds_read_b128 v[72:75], v3 offset:23552
  v_smfmac_f32_16x16x64_bf16 v[116:119], v[48:51], a[120:127], v13
  ds_read_b128 v[76:79], v3 offset:24576
  v_add_f32 v112, v112, v114
  v_smfmac_f32_16x16x64_bf16 v[116:119], v[52:55], a[128:135], v13
  ds_read_b128 v[80:83], v3 offset:25600
  v_add_f32 v113, v113, v115
  v_smfmac_f32_16x16x64_bf16 v[116:119], v[56:59], a[136:143], v13
  v_cvt_pk_bf16_f32 v114, v112, v113
  v_smfmac_f32_16x16x64_bf16 v[120:123], v[32:35], a[144:151], v13
  v_cvt_pk_bf16_f32 v115, v112, v113
  ds_write_b64 v4, v[114:115] offset:13312
  v_smfmac_f32_16x16x64_bf16 v[120:123], v[48:51], a[152:159], v13
  v_add_f32 v116, v116, v118
  v_smfmac_f32_16x16x64_bf16 v[120:123], v[52:55], a[160:167], v13
  v_add_f32 v117, v117, v119
  v_smfmac_f32_16x16x64_bf16 v[120:123], v[56:59], a[168:175], v13
  v_cvt_pk_bf16_f32 v118, v116, v117
  s_waitcnt lgkmcnt(9)
  v_smfmac_f32_16x16x64_bf16 v[124:127], v[20:23], v[84:91], v13
  v_cvt_pk_bf16_f32 v119, v116, v117
  ds_write_b64 v4, v[118:119] offset:13824
  s_waitcnt lgkmcnt(8)
  v_smfmac_f32_16x16x64_bf16 v[124:127], v[24:27], v[92:99], v13
  v_add_f32 v120, v120, v122
  v_add_f32 v121, v121, v123
  v_cvt_pk_bf16_f32 v122, v120, v121
  v_cvt_pk_bf16_f32 v123, v120, v121
  ds_write_b64 v4, v[122:123] offset:14336
  v_smfmac_f32_16x16x64_bf16 v[124:127], v[28:31], a[176:183], v13
  v_smfmac_f32_16x16x64_bf16 v[124:127], v[32:35], a[184:191], v13
  s_waitcnt lgkmcnt(0)
  s_barrier
  ds_read_b64_tr_b16 v[112:113], v5 offset:10240
  ds_read_b64_tr_b16 v[114:115], v6 offset:10240
  ds_read_b64_tr_b16 v[100:101], v5 offset:13312
  ds_read_b64_tr_b16 v[102:103], v6 offset:13312
  ds_read_b64_tr_b16 v[116:117], v5 offset:11264
  ds_read_b64_tr_b16 v[118:119], v6 offset:11264
  ds_read_b64_tr_b16 v[104:105], v5 offset:14336
  ds_read_b64_tr_b16 v[106:107], v6 offset:14336
  ds_read_b64_tr_b16 v[120:121], v5 offset:12288
  ds_read_b64_tr_b16 v[122:123], v6 offset:12288
  ds_read_b64_tr_b16 v[108:109], v5 offset:15360
  ds_read_b64_tr_b16 v[110:111], v6 offset:15360
  v_smfmac_f32_16x16x64_bf16 v[124:127], v[36:39], a[192:199], v13
  v_smfmac_f32_16x16x64_bf16 v[124:127], v[40:43], a[200:207], v13
  v_smfmac_f32_16x16x64_bf16 v[124:127], v[44:47], a[208:215], v13
  v_smfmac_f32_16x16x64_bf16 v[124:127], v[48:51], a[216:223], v13
  s_waitcnt lgkmcnt(8)
  v_mfma_f32_16x16x32_bf16 v[132:135], v[100:103], v[112:115], 0
  s_waitcnt lgkmcnt(4)
  v_mfma_f32_16x16x32_bf16 v[132:135], v[104:107], v[116:119], v[132:135]
  s_waitcnt lgkmcnt(0)
  v_mfma_f32_16x16x32_bf16 v[132:135], v[108:111], v[120:123], v[132:135]
  v_smfmac_f32_16x16x64_bf16 v[124:127], v[52:55], a[224:231], v13
  s_nop 3
  v_cndmask_b32 v132, v132, v133, s[42:43]
  v_bfi_b32 v132, 1, s59, v132
  buffer_store_dword v132, v1, s[8:11], s44 offen offset:1024
  ds_write_b32 v1, v132 offset:20480
  v_smfmac_f32_16x16x64_bf16 v[124:127], v[56:59], a[232:239], v13
  v_smfmac_f32_16x16x64_bf16 v[128:131], v[36:39], a[240:247], v13
  v_smfmac_f32_16x16x64_bf16 v[128:131], v[40:43], a[248:255], v13
  v_cvt_pk_bf16_f32 v124, v124, v125
  v_cvt_pk_bf16_f32 v125, v126, v127
  v_smfmac_f32_16x16x64_bf16 v[128:131], v[44:47], v[60:67], v13
  v_smfmac_f32_16x16x64_bf16 v[128:131], v[20:23], v[68:75], v13
  v_smfmac_f32_16x16x64_bf16 v[128:131], v[24:27], v[76:83], v13
  ds_write_b64 v0, v[124:125] offset:17408
  v_mov_b32 v112, 0
  v_mov_b32 v113, 0
  v_mov_b32 v114, 0
  v_mov_b32 v115, 0
  v_mov_b32 v116, 0
  v_mov_b32 v117, 0
  s_nop 0
  v_add_f32 v128, v128, v130
  v_add_f32 v129, v129, v131
  v_cvt_pk_bf16_f32 v128, v128, v129
  ds_write_b32 v0, v128 offset:18440
  v_mov_b32 v118, 0
  v_mov_b32 v119, 0
  v_mov_b32 v120, 0
  v_mov_b32 v121, 0
  v_mov_b32 v122, 0
  v_mov_b32 v123, 0
  s_cmp_eq_u32 s36, 63
  s_waitcnt lgkmcnt(0)
  s_barrier
  s_cbranch_scc1 L188_fin
  buffer_load_dwordx4 v[84:87], v0, s[8:11], s45 offen sc1
  buffer_load_dword v88, v1, s[8:11], s45 offen offset:1024 sc1
  ds_read_b128 v[90:93], v0 offset:19456
  ds_read_b32 v94, v1 offset:20480
  ds_read_b128 v[20:23], v15 offset:24576
  ds_read_b128 v[24:27], v15 offset:25600
  ds_read_b128 v[28:31], v15 offset:26624
  ds_read_b128 v[32:35], v15 offset:27648
  ds_read_b128 v[36:39], v15 offset:28672
  ds_read_b128 v[40:43], v15 offset:29696
  ds_read_b128 v[44:47], v0 offset:16384
  ds_read_b128 v[48:51], v0 offset:17408
  ds_read_b128 v[52:55], v0 offset:18432
  v_mov_b32 v95, 1.0
  v_mov_b32 v134, 0
  v_mov_b32 v135, 0
  v_mov_b32 v124, 0
  v_mov_b32 v125, 0
  v_mov_b32 v126, 0
  v_mov_b32 v127, 0
  v_mov_b32 v128, 0
  v_mov_b32 v129, 0
  v_mov_b32 v130, 0
  v_mov_b32 v131, 0
  buffer_load_dwordx4 v[72:75], v0, s[8:11], s45 offen sc1
  buffer_load_dword v76, v1, s[8:11], s45 offen offset:1024 sc1
  s_waitcnt vmcnt(2) lgkmcnt(9)
L189_rb:
  v_add_f32 v60, v90, v84
  v_add_f32 v61, v91, v85
  v_add_f32 v62, v92, v86
  v_add_f32 v63, v93, v87
  v_add_f32 v64, v94, v88
  v_max3_f32 v66, v60, v61, v62
  v_max3_f32 v66, v66, v63, v64
  v_bitop3_b32 v71, v84, v88, s59 bitop3:0x7e
  v_and_b32 v71, 1, v71
  v_max_f32_dpp v67, v66, v66 quad_perm:[2,3,0,1] row_mask:0xf bank_mask:0xf
  v_max_f32_dpp v66, v66, v66 quad_perm:[2,3,0,1] row_mask:0xf bank_mask:0xf
  v_cmp_ne_u32 vcc, 0, v71
  s_nop 0
  v_permlane16_swap_b32 v66, v67
  v_max_f32 v68, v66, v67
  v_max_f32 v66, v66, v67
  s_cbranch_vccnz L190_fb
  s_nop 0
  v_permlane32_swap_b32 v66, v68
  v_max_f32 v66, v66, v68
  v_mul_f32 v66, s41, v66
  v_fma_f32 v60, v60, s41, -v66
  v_fma_f32 v61, v61, s41, -v66
  v_fma_f32 v62, v62, s41, -v66
  v_fma_f32 v63, v63, s41, -v66
  v_fma_f32 v64, v64, s41, -v66
  v_exp_f32 v60, v60
  v_exp_f32 v61, v61
  v_exp_f32 v62, v62
  v_exp_f32 v63, v63
  v_exp_f32 v64, v64
  v_cvt_pk_bf16_f32 v69, v60, v61
  v_cvt_pk_bf16_f32 v70, v62, v63
  v_add_f32 v89, v60, v61
  v_mov_b32_dpp v56, v69 quad_perm:[0,1,0,1] row_mask:0xf bank_mask:0xf
  v_mov_b32_dpp v57, v70 quad_perm:[0,1,0,1] row_mask:0xf bank_mask:0xf
  v_mov_b32_dpp v58, v69 quad_perm:[2,3,2,3] row_mask:0xf bank_mask:0xf
  v_mov_b32_dpp v59, v70 quad_perm:[2,3,2,3] row_mask:0xf bank_mask:0xf
  v_mov_b32_dpp v66, v64 quad_perm:[0,1,0,1] row_mask:0xf bank_mask:0xf
  v_mov_b32_dpp v67, v64 quad_perm:[2,3,2,3] row_mask:0xf bank_mask:0xf
  s_waitcnt vmcnt(0) lgkmcnt(0)
  v_mfma_f32_16x16x32_bf16 v[80:83], v[20:23], v[56:59], 0
  buffer_load_dwordx4 v0, s[8:11], s65 offen offset:0 sc1 lds
  v_add_f32 v89, v89, v62
  v_cvt_pk_bf16_f32 v132, v66, v67
  v_mfma_f32_16x16x32_bf16 v[76:79], v[24:27], v[56:59], 0
  buffer_load_dwordx4 v0, s[8:11], s65 offen offset:1024 sc1 lds
  v_add_f32 v89, v89, v63
  v_cvt_pk_bf16_f32 v133, v66, v67
  v_mfma_f32_16x16x32_bf16 v[72:75], v[28:31], v[56:59], 0
  buffer_load_dwordx4 v0, s[8:11], s65 offen offset:2048 sc1 lds
  v_add_f32 v89, v89, v64
  v_mfma_f32_16x16x32_bf16 v[80:83], v[44:47], v[132:135], v[80:83]
  v_mfma_f32_16x16x32_bf16 v[76:79], v[44:47], v[130:133], v[76:79]
  v_add_f32_dpp v89, v89, v89 quad_perm:[2,3,0,1] row_mask:0xf bank_mask:0xf
  v_mfma_f32_16x16x32_bf16 v[68:71], v[32:35], v[56:59], 0
  v_mfma_f32_16x16x32_bf16 v[72:75], v[48:51], v[132:135], v[72:75]
  v_mfma_f32_16x16x4_f32 v[96:99], v89, v95, 0
  v_cvt_pk_bf16_f32 v84, v80, v81
  v_cvt_pk_bf16_f32 v85, v82, v83
  v_cvt_pk_bf16_f32 v86, v76, v77
  v_cvt_pk_bf16_f32 v87, v78, v79
  v_mfma_f32_16x16x32_bf16 v[68:71], v[48:51], v[130:133], v[68:71]
  v_cvt_pk_bf16_f32 v88, v72, v73
  v_cvt_pk_bf16_f32 v89, v74, v75
  v_mfma_f32_16x16x32_bf16 v[64:67], v[36:39], v[56:59], 0
  v_mfma_f32_16x16x32_bf16 v[60:63], v[40:43], v[56:59], 0
  v_cvt_pk_bf16_f32 v90, v68, v69
  v_cvt_pk_bf16_f32 v91, v70, v71
  v_mfma_f32_16x16x32_bf16 v[64:67], v[52:55], v[132:135], v[64:67]
  v_rcp_f32 v96, v96
  v_mfma_f32_16x16x32_bf16 v[60:63], v[52:55], v[130:133], v[60:63]
  v_rcp_f32 v97, v97
  v_smfmac_f32_16x16x64_bf16 v[112:115], v[84:87], v[136:143], v13
  v_cvt_pk_bf16_f32 v92, v64, v65
  v_cvt_pk_bf16_f32 v93, v66, v67
  v_smfmac_f32_16x16x64_bf16 v[116:119], v[84:87], v[144:151], v13
  v_cvt_pk_bf16_f32 v94, v60, v61
  v_cvt_pk_bf16_f32 v95, v62, v63
  v_smfmac_f32_16x16x64_bf16 v[112:115], v[88:91], v[176:183], v13
  v_smfmac_f32_16x16x64_bf16 v[116:119], v[88:91], v[184:191], v13
  v_smfmac_f32_16x16x64_bf16 v[112:115], v[92:95], v[216:223], v13
  v_smfmac_f32_16x16x64_bf16 v[116:119], v[92:95], v[224:231], v13
  v_smfmac_f32_16x16x64_bf16 v[120:123], v[84:87], v[152:159], v13
  v_mul_f32 v112, v96, v112
  v_mul_f32 v114, v96, v114
  v_smfmac_f32_16x16x64_bf16 v[124:127], v[84:87], v[160:167], v13
  v_mul_f32 v113, v97, v113
  v_mul_f32 v115, v97, v115
  v_smfmac_f32_16x16x64_bf16 v[120:123], v[88:91], v[192:199], v13
  v_cvt_pk_bf16_f32 v20, v112, v114
  v_cvt_pk_bf16_f32 v21, v113, v115
  v_smfmac_f32_16x16x64_bf16 v[124:127], v[88:91], v[200:207], v13
  v_bfi_b32 v20, 1, s59, v20
  v_mul_f32 v116, v96, v116
  v_mul_f32 v118, v96, v118
  v_smfmac_f32_16x16x64_bf16 v[120:123], v[92:95], v[232:239], v13
  v_mul_f32 v117, v97, v117
  v_mul_f32 v119, v97, v119
  v_cvt_pk_bf16_f32 v22, v116, v118
  v_smfmac_f32_16x16x64_bf16 v[124:127], v[92:95], v[240:247], v13
  v_cvt_pk_bf16_f32 v23, v117, v119
  buffer_store_dwordx4 v[20:23], v9, s[8:11], s47 offen
  v_smfmac_f32_16x16x64_bf16 v[128:131], v[84:87], v[168:175], v13
  v_mul_f32 v120, v96, v120
  v_mul_f32 v122, v96, v122
  v_smfmac_f32_16x16x64_bf16 v[128:131], v[88:91], v[208:215], v13
  v_mul_f32 v121, v97, v121
  v_mul_f32 v123, v97, v123
  v_smfmac_f32_16x16x64_bf16 v[128:131], v[92:95], v[248:255], v13
  v_cvt_pk_bf16_f32 v24, v120, v122
  v_cvt_pk_bf16_f32 v25, v121, v123
  v_bfi_b32 v24, 1, s59, v24
  v_mul_f32 v124, v96, v124
  v_mul_f32 v126, v96, v126
  v_mul_f32 v125, v97, v125
  v_mul_f32 v127, v97, v127
  v_cvt_pk_bf16_f32 v26, v124, v126
  v_cvt_pk_bf16_f32 v27, v125, v127
  buffer_store_dwordx4 v[24:27], v9, s[8:11], s47 offen offset:1024
  v_mul_f32 v128, v96, v128
  v_mul_f32 v130, v96, v130
  v_mul_f32 v129, v97, v129
  v_mul_f32 v131, v97, v131
  v_cvt_pk_bf16_f32 v28, v128, v130
  v_cvt_pk_bf16_f32 v29, v129, v131
  v_bfi_b32 v28, 1, s59, v28
  buffer_store_dwordx2 v[28:29], v10, s[8:11], s47 offen
  ds_read_b128 v[60:63], v3 offset:0
  ds_read_b128 v[64:67], v3 offset:1024
  ds_read_b128 v[68:71], v3 offset:2048
  ds_read_b128 v[72:75], v3 offset:3072
  ds_read_b128 v[76:79], v3 offset:4096
  ds_read_b128 v[80:83], v3 offset:5120
  ds_read_b128 v[84:87], v3 offset:6144
  ds_read_b128 v[88:91], v3 offset:7168
  ds_read_b128 v[92:95], v3 offset:8192
  ds_read_b128 v[96:99], v3 offset:9216
  v_mov_b32 v112, 0
  v_mov_b32 v113, 0
  v_mov_b32 v114, 0
  v_mov_b32 v115, 0
  v_mov_b32 v116, 0
  v_mov_b32 v117, 0
  v_mov_b32 v118, 0
  v_mov_b32 v119, 0
  v_mov_b32 v120, 0
  v_mov_b32 v121, 0
  v_mov_b32 v122, 0
  v_mov_b32 v123, 0
  v_mov_b32 v124, 0
  v_mov_b32 v125, 0
  v_mov_b32 v126, 0
  v_mov_b32 v127, 0
  v_mov_b32 v128, 0
  v_mov_b32 v129, 0
  v_mov_b32 v130, 0
  v_mov_b32 v131, 0
  s_xor_b32 s56, s56, 65536
  s_xor_b32 s58, s58, 131072
  s_add_u32 s65, s65, 393216
  v_xor_b32 v15, 8192, v15
  s_add_u32 s36, s36, 1
  s_xor_b32 s69, s69, 57344
  s_add_u32 s66, s66, 393216
  s_waitcnt vmcnt(0)
  buffer_load_dwordx4 v[32:35], v11, s[8:11], s49 offen sc1
  buffer_load_dwordx4 v[36:39], v11, s[8:11], s51 offen sc1
L192_rc:
  s_waitcnt vmcnt(1)
  v_mfma_f32_16x16x32_bf16 v[48:51], v[16:19], v[32:35], 0
  v_bitop3_b32 v132, v32, v34, s59 bitop3:0x7e
  s_waitcnt vmcnt(0)
  v_mfma_f32_16x16x32_bf16 v[48:51], v[16:19], v[36:39], v[48:51]
  v_bitop3_b32 v133, v36, v38, s59 bitop3:0x7e
  v_bitop3_b32 v132, v132, v133, 1 bitop3:0xa8
  v_cmp_ne_u32 vcc, 0, v132
  s_cbranch_vccnz L193_fc
  s_nop 3
  v_add_f32_dpp v48, v48, v48 row_ror:8 row_mask:0xf bank_mask:0xf
  v_add_f32_dpp v49, v49, v49 row_ror:8 row_mask:0xf bank_mask:0xf
  v_add_f32_dpp v50, v50, v50 row_ror:8 row_mask:0xf bank_mask:0xf
  v_add_f32_dpp v51, v51, v51 row_ror:8 row_mask:0xf bank_mask:0xf
  v_add_f32_dpp v48, v48, v48 row_ror:4 row_mask:0xf bank_mask:0xf
  v_add_f32_dpp v49, v49, v49 row_ror:4 row_mask:0xf bank_mask:0xf
  v_add_f32_dpp v50, v50, v50 row_ror:4 row_mask:0xf bank_mask:0xf
  v_add_f32_dpp v51, v51, v51 row_ror:4 row_mask:0xf bank_mask:0xf
  v_cvt_pk_bf16_f32 v24, v48, v49
  v_cvt_pk_bf16_f32 v25, v50, v51
  v_bfi_b32 v24, 1, s61, v24
  buffer_store_dwordx2 v[24:25], v12, s[8:11], s56 offen
  s_barrier
  buffer_store_dwordx2 v[24:25], v7, s[8:11], s57 offen sc1
  s_xor_b32 s59, s59, 1
  s_mov_b32 s60, s61
  s_xor_b32 s61, s61, s59
  s_xor_b32 s57, s57, 131072
  s_waitcnt vmcnt(1)
  s_barrier
  s_branch L176_top
L188_fin:
  s_add_u32 s66, s66, 393216
  buffer_store_dwordx4 v[100:103], v0, s[8:11], s66 offen offset:0 sc1
  buffer_store_dwordx4 v[104:107], v0, s[8:11], s66 offen offset:1024 sc1
  buffer_store_dwordx4 v[108:111], v0, s[8:11], s66 offen offset:2048 sc1
  s_waitcnt vmcnt(0)
  s_barrier
  s_waitcnt vmcnt(0)
  s_endpgm
L179_pw:
  buffer_load_dword v14, off, s[8:11], s68 sc1
  s_sub_u32 s37, s37, 1
  s_cbranch_scc1 L171_bail
  s_waitcnt vmcnt(0)
  v_readfirstlane_b32 s38, v14
  s_cmp_lt_u32 s38, s62
  s_cbranch_scc1 L179_pw
  s_branch L180_pwb
L181_f1:
  s_mov_b64 exec, vcc
  buffer_load_dwordx4 v[20:23], v2, s[8:11], s56 offen offset:0 sc1
  buffer_load_dwordx4 v[24:27], v2, s[8:11], s56 offen offset:1024 sc1
  buffer_load_dwordx4 v[28:31], v2, s[8:11], s56 offen offset:2048 sc1
  s_mov_b64 exec, -1
  buffer_load_dwordx4 v[36:39], v8, s[8:11], s58 offen offset:0 sc1
  buffer_load_dwordx4 v[40:43], v8, s[8:11], s58 offen offset:1024 sc1
  buffer_load_dwordx4 v[44:47], v8, s[8:11], s58 offen offset:2048 sc1
  s_waitcnt vmcnt(3)
  v_bitop3_b32 v132, v20, v22, s60 bitop3:0x7e
  v_bitop3_b32 v133, v24, v26, s60 bitop3:0x7e
  v_or_b32 v132, v132, v133
  v_bitop3_b32 v133, v28, v30, s60 bitop3:0x7e
  v_bitop3_b32 v132, v132, v133, 1 bitop3:0xa8
  v_cmp_ne_u32 vcc, 0, v132
  s_cbranch_vccz L185_b3
L186_f3:
L187_ag:
  s_mov_b64 exec, vcc
  s_xor_b32 s3, s58, 0
  buffer_load_dwordx4 v[20:23], v2, s[8:11], s56 offen offset:0 sc1
  buffer_load_dwordx4 v[24:27], v2, s[8:11], s56 offen offset:1024 sc1
  buffer_load_dwordx4 v[28:31], v2, s[8:11], s56 offen offset:2048 sc1
  s_sub_u32 s37, s37, 1
  s_cbranch_scc1 L171_bail
  s_waitcnt vmcnt(0)
  v_bitop3_b32 v132, v20, v22, s60 bitop3:0x7e
  v_bitop3_b32 v133, v24, v26, s60 bitop3:0x7e
  v_or_b32 v132, v132, v133
  v_bitop3_b32 v133, v28, v30, s60 bitop3:0x7e
  v_bitop3_b32 v132, v132, v133, 1 bitop3:0xa8
  v_cmp_ne_u32 vcc, 0, v132
  s_mov_b64 exec, -1
  s_cbranch_vccnz L187_ag
  s_branch L185_b3
L183_f2:
  s_xor_b32 s3, s58, 0
  s_sub_u32 s37, s37, 1
  s_cbranch_scc1 L171_bail
  buffer_load_dwordx4 v[36:39], v8, s[8:11], s3 offen offset:0 sc1
  buffer_load_dwordx4 v[40:43], v8, s[8:11], s3 offen offset:1024 sc1
  buffer_load_dwordx4 v[44:47], v8, s[8:11], s3 offen offset:2048 sc1
  s_branch L184_b2
L177_fL:
  s_mov_b64 exec, vcc
  buffer_load_dwordx4 v[36:39], v2, s[8:11], s56 offen offset:0 sc1
  buffer_load_dwordx4 v[40:43], v2, s[8:11], s56 offen offset:1024 sc1
  buffer_load_dwordx4 v[44:47], v2, s[8:11], s56 offen offset:2048 sc1
  s_mov_b64 exec, -1
  s_sub_u32 s37, s37, 1
  s_cbranch_scc1 L171_bail
  s_branch L178_rl
L190_fb:
  s_waitcnt vmcnt(0)
  v_bitop3_b32 v71, v72, v76, s59 bitop3:0x7e
  v_and_b32 v71, 1, v71
  v_cmp_ne_u32 vcc, 0, v71
  v_mov_b32 v84, v72
  v_mov_b32 v85, v73
  v_mov_b32 v86, v74
  v_mov_b32 v87, v75
  v_mov_b32 v88, v76
  s_cbranch_vccz L189_rb
L191_fb2:
  s_sub_u32 s37, s37, 1
  s_cbranch_scc1 L171_bail
  buffer_load_dwordx4 v[84:87], v0, s[8:11], s45 offen sc1
  buffer_load_dword v88, v1, s[8:11], s45 offen offset:1024 sc1
  s_waitcnt vmcnt(0)
  v_bitop3_b32 v71, v84, v88, s59 bitop3:0x7e
  v_and_b32 v71, 1, v71
  v_cmp_ne_u32 vcc, 0, v71
  s_cbranch_vccz L189_rb
  s_branch L191_fb2
L193_fc:
  s_mov_b64 exec, vcc
  buffer_load_dwordx4 v[32:35], v11, s[8:11], s49 offen sc1
  buffer_load_dwordx4 v[36:39], v11, s[8:11], s51 offen sc1
  s_mov_b64 exec, -1
  s_sub_u32 s37, s37, 1
  s_cbranch_scc1 L171_bail
  s_branch L192_rc
L175_slow:
L194_top:
  v_bfe_u32 v58, v1, 2, 1
  v_lshlrev_b32 v58, 4, v58
  v_lshlrev_b32 v58, v58, s39
  v_cndmask_b32 v56, v58, 0, s[42:43]
  v_cndmask_b32 v57, 0, v58, s[42:43]
  buffer_load_dwordx4 v[20:23], v2, s[8:11], s56 offen offset:0 sc1
  buffer_load_dwordx4 v[24:27], v2, s[8:11], s56 offen offset:1024 sc1
  buffer_load_dwordx4 v[28:31], v2, s[8:11], s56 offen offset:2048 sc1
  s_add_u32 s62, s36, 2
  s_min_u32 s62, s62, 64
  v_readfirstlane_b32 s38, v14
  s_mov_b32 m0, s69
  s_cmp_lt_u32 s38, s62
  s_cbranch_scc1 L197_pw
L198_pwb:
  s_waitcnt vmcnt(2)
  v_bitop3_b32 v132, v20, v22, s60 bitop3:0x7e
  s_waitcnt vmcnt(1)
  v_bitop3_b32 v133, v24, v26, s60 bitop3:0x7e
  v_or_b32 v132, v132, v133
  s_waitcnt vmcnt(0)
  v_bitop3_b32 v133, v28, v30, s60 bitop3:0x7e
  v_bitop3_b32 v132, v132, v133, 1 bitop3:0xa8
  v_cmp_ne_u32 vcc, 0, v132
  s_cbranch_vccnz L199_f1
L200_b1:
  buffer_load_dwordx4 v[36:39], v8, s[8:11], s58 offen offset:0 sc1
  buffer_load_dwordx4 v[40:43], v8, s[8:11], s58 offen offset:1024 sc1
  buffer_load_dwordx4 v[44:47], v8, s[8:11], s58 offen offset:2048 sc1
L203_b3:
L202_b2:
  v_mfma_f32_4x4x4_16b_bf16 v[32:35], v[56:57], v[20:21], 0
  v_mfma_f32_4x4x4_16b_bf16 v[120:123], v[56:57], v[22:23], 0
  v_mfma_f32_4x4x4_16b_bf16 v[48:51], v[56:57], v[24:25], 0
  v_mfma_f32_4x4x4_16b_bf16 v[124:127], v[56:57], v[26:27], 0
  v_mfma_f32_4x4x4_16b_bf16 v[52:55], v[56:57], v[28:29], 0
  v_mfma_f32_4x4x4_16b_bf16 v[128:131], v[56:57], v[30:31], 0
  s_waitcnt lgkmcnt(0)
  s_waitcnt vmcnt(2)
  v_mfma_f32_4x4x4_16b_bf16 v[32:35], v[56:57], v[36:37], v[32:35]
  v_mfma_f32_4x4x4_16b_bf16 v[120:123], v[56:57], v[38:39], v[120:123]
  v_bitop3_b32 v132, v36, v38, s60 bitop3:0x7e
  s_waitcnt vmcnt(1)
  v_mfma_f32_4x4x4_16b_bf16 v[48:51], v[56:57], v[40:41], v[48:51]
  v_mfma_f32_4x4x4_16b_bf16 v[124:127], v[56:57], v[42:43], v[124:127]
  v_bitop3_b32 v133, v40, v42, s60 bitop3:0x7e
  v_or_b32 v132, v132, v133
  v_cvt_pk_bf16_f32 v36, v32, v33
  v_cvt_pk_bf16_f32 v37, v34, v35
  v_cvt_pk_bf16_f32 v38, v120, v121
  v_cvt_pk_bf16_f32 v39, v122, v123
  ds_write_b128 v0, v[36:39] offset:4096
  s_waitcnt vmcnt(0)
  v_mfma_f32_4x4x4_16b_bf16 v[52:55], v[56:57], v[44:45], v[52:55]
  v_mfma_f32_4x4x4_16b_bf16 v[128:131], v[56:57], v[46:47], v[128:131]
  v_bitop3_b32 v133, v44, v46, s60 bitop3:0x7e
  v_bitop3_b32 v132, v132, v133, 1 bitop3:0xa8
  v_cmp_ne_u32 vcc, 0, v132
  v_cvt_pk_bf16_f32 v40, v48, v49
  v_cvt_pk_bf16_f32 v41, v50, v51
  v_cvt_pk_bf16_f32 v42, v124, v125
  v_cvt_pk_bf16_f32 v43, v126, v127
  ds_write_b128 v0, v[40:43] offset:5120
  v_cvt_pk_bf16_f32 v44, v52, v53
  v_cvt_pk_bf16_f32 v45, v54, v55
  s_cbranch_vccnz L201_f2
  v_cvt_pk_bf16_f32 v46, v128, v129
  v_cvt_pk_bf16_f32 v47, v130, v131
  ds_write_b128 v0, v[44:47] offset:6144
L196_rl:
  v_smfmac_f32_16x16x64_bf16 v[112:115], v[36:39], v[60:67], v13
  v_mov_b32 v120, 0
  v_mov_b32 v121, 0
  v_mov_b32 v122, 0
  v_mov_b32 v123, 0
  v_smfmac_f32_16x16x64_bf16 v[116:119], v[36:39], v[68:75], v13
  v_mov_b32 v124, 0
  v_mov_b32 v125, 0
  v_mov_b32 v126, 0
  v_mov_b32 v127, 0
  v_smfmac_f32_16x16x64_bf16 v[120:123], v[36:39], v[76:83], v13
  v_mov_b32 v128, 0
  v_mov_b32 v129, 0
  v_mov_b32 v130, 0
  v_mov_b32 v131, 0
  s_waitcnt lgkmcnt(0)
  s_barrier
  ds_read_b128 v[20:23], v0 offset:0
  ds_read_b128 v[24:27], v0 offset:1024
  v_smfmac_f32_16x16x64_bf16 v[112:115], v[40:43], v[84:91], v13
  ds_read_b128 v[28:31], v0 offset:2048
  buffer_load_dword v14, off, s[8:11], s68 sc1
  v_smfmac_f32_16x16x64_bf16 v[116:119], v[40:43], v[92:99], v13
  ds_read_b128 v[32:35], v0 offset:3072
  v_smfmac_f32_16x16x64_bf16 v[120:123], v[40:43], a[0:7], v13
  ds_read_b128 v[48:51], v0 offset:7168
  v_not_b32 v132, s61
  v_not_b32 v133, s61
  v_smfmac_f32_16x16x64_bf16 v[112:115], v[44:47], a[8:15], v13
  ds_read_b128 v[52:55], v0 offset:8192
  v_smfmac_f32_16x16x64_bf16 v[116:119], v[44:47], a[16:23], v13
  ds_read_b128 v[56:59], v0 offset:9216
  buffer_store_dwordx2 v[132:133], v7, s[8:11], s57 offen sc1
  v_smfmac_f32_16x16x64_bf16 v[120:123], v[44:47], a[24:31], v13
  ds_read_b128 v[60:63], v3 offset:10240
  s_waitcnt lgkmcnt(7)
  v_smfmac_f32_16x16x64_bf16 v[112:115], v[20:23], a[32:39], v13
  ds_read_b128 v[64:67], v3 offset:11264
  buffer_store_dwordx4 v[100:103], v0, s[8:11], s66 offen offset:0 sc1
  v_smfmac_f32_16x16x64_bf16 v[116:119], v[20:23], a[40:47], v13
  ds_read_b128 v[68:71], v3 offset:12288
  v_smfmac_f32_16x16x64_bf16 v[120:123], v[20:23], a[48:55], v13
  ds_read_b128 v[72:75], v3 offset:13312
  buffer_store_dwordx4 v[104:107], v0, s[8:11], s66 offen offset:1024 sc1
  s_waitcnt lgkmcnt(9)
  v_smfmac_f32_16x16x64_bf16 v[112:115], v[24:27], a[56:63], v13
  ds_read_b128 v[76:79], v3 offset:14336
  v_smfmac_f32_16x16x64_bf16 v[116:119], v[24:27], a[64:71], v13
  ds_read_b128 v[80:83], v3 offset:15360
  buffer_store_dwordx4 v[108:111], v0, s[8:11], s66 offen offset:2048 sc1
  v_smfmac_f32_16x16x64_bf16 v[120:123], v[24:27], a[72:79], v13
  ds_read_b128 v[84:87], v3 offset:16384
  s_waitcnt lgkmcnt(11)
  v_smfmac_f32_16x16x64_bf16 v[112:115], v[28:31], a[80:87], v13
  ds_read_b128 v[88:91], v3 offset:17408
  v_smfmac_f32_16x16x64_bf16 v[116:119], v[28:31], a[88:95], v13
  ds_read_b128 v[92:95], v3 offset:18432
  v_smfmac_f32_16x16x64_bf16 v[120:123], v[28:31], a[96:103], v13
  ds_read_b128 v[96:99], v3 offset:19456
  s_waitcnt lgkmcnt(13)
  v_smfmac_f32_16x16x64_bf16 v[112:115], v[32:35], a[104:111], v13
  s_waitcnt lgkmcnt(12)
  s_waitcnt lgkmcnt(8)
  v_smfmac_f32_16x16x64_bf16 v[112:115], v[48:51], v[60:67], v13
  ds_read_b128 v[60:63], v3 offset:20480
  s_waitcnt lgkmcnt(7)
  v_smfmac_f32_16x16x64_bf16 v[112:115], v[52:55], v[68:75], v13
  ds_read_b128 v[64:67], v3 offset:21504
  s_waitcnt lgkmcnt(6)
  v_smfmac_f32_16x16x64_bf16 v[112:115], v[56:59], v[76:83], v13
  ds_read_b128 v[68:71], v3 offset:22528
  v_smfmac_f32_16x16x64_bf16 v[116:119], v[32:35], a[112:119], v13
  ds_read_b128 v[72:75], v3 offset:23552
  v_smfmac_f32_16x16x64_bf16 v[116:119], v[48:51], a[120:127], v13
  ds_read_b128 v[76:79], v3 offset:24576
  v_add_f32 v112, v112, v114
  v_smfmac_f32_16x16x64_bf16 v[116:119], v[52:55], a[128:135], v13
  ds_read_b128 v[80:83], v3 offset:25600
  v_add_f32 v113, v113, v115
  v_smfmac_f32_16x16x64_bf16 v[116:119], v[56:59], a[136:143], v13
  v_cvt_pk_bf16_f32 v114, v112, v113
  v_smfmac_f32_16x16x64_bf16 v[120:123], v[32:35], a[144:151], v13
  v_cvt_pk_bf16_f32 v115, v112, v113
  ds_write_b64 v4, v[114:115] offset:13312
  v_smfmac_f32_16x16x64_bf16 v[120:123], v[48:51], a[152:159], v13
  v_add_f32 v116, v116, v118
  v_smfmac_f32_16x16x64_bf16 v[120:123], v[52:55], a[160:167], v13
  v_add_f32 v117, v117, v119
  v_smfmac_f32_16x16x64_bf16 v[120:123], v[56:59], a[168:175], v13
  v_cvt_pk_bf16_f32 v118, v116, v117
  s_waitcnt lgkmcnt(9)
  v_smfmac_f32_16x16x64_bf16 v[124:127], v[20:23], v[84:91], v13
  v_cvt_pk_bf16_f32 v119, v116, v117
  ds_write_b64 v4, v[118:119] offset:13824
  s_waitcnt lgkmcnt(8)
  v_smfmac_f32_16x16x64_bf16 v[124:127], v[24:27], v[92:99], v13
  v_add_f32 v120, v120, v122
  v_add_f32 v121, v121, v123
  v_cvt_pk_bf16_f32 v122, v120, v121
  v_cvt_pk_bf16_f32 v123, v120, v121
  ds_write_b64 v4, v[122:123] offset:14336
  v_smfmac_f32_16x16x64_bf16 v[124:127], v[28:31], a[176:183], v13
  v_smfmac_f32_16x16x64_bf16 v[124:127], v[32:35], a[184:191], v13
  s_waitcnt lgkmcnt(0)
  s_barrier
  ds_read_b64_tr_b16 v[112:113], v5 offset:10240
  ds_read_b64_tr_b16 v[114:115], v6 offset:10240
  ds_read_b64_tr_b16 v[100:101], v5 offset:13312
  ds_read_b64_tr_b16 v[102:103], v6 offset:13312
  ds_read_b64_tr_b16 v[116:117], v5 offset:11264
  ds_read_b64_tr_b16 v[118:119], v6 offset:11264
  ds_read_b64_tr_b16 v[104:105], v5 offset:14336
  ds_read_b64_tr_b16 v[106:107], v6 offset:14336
  ds_read_b64_tr_b16 v[120:121], v5 offset:12288
  ds_read_b64_tr_b16 v[122:123], v6 offset:12288
  ds_read_b64_tr_b16 v[108:109], v5 offset:15360
  ds_read_b64_tr_b16 v[110:111], v6 offset:15360
  v_smfmac_f32_16x16x64_bf16 v[124:127], v[36:39], a[192:199], v13
  v_smfmac_f32_16x16x64_bf16 v[124:127], v[40:43], a[200:207], v13
  v_smfmac_f32_16x16x64_bf16 v[124:127], v[44:47], a[208:215], v13
  v_smfmac_f32_16x16x64_bf16 v[124:127], v[48:51], a[216:223], v13
  s_waitcnt lgkmcnt(8)
  v_mfma_f32_16x16x32_bf16 v[132:135], v[100:103], v[112:115], 0
  s_waitcnt lgkmcnt(4)
  v_mfma_f32_16x16x32_bf16 v[132:135], v[104:107], v[116:119], v[132:135]
  s_waitcnt lgkmcnt(0)
  v_mfma_f32_16x16x32_bf16 v[132:135], v[108:111], v[120:123], v[132:135]
  v_smfmac_f32_16x16x64_bf16 v[124:127], v[52:55], a[224:231], v13
  s_nop 3
  v_cndmask_b32 v132, v132, v133, s[42:43]
  v_bfi_b32 v132, 1, s59, v132
  buffer_store_dword v132, v1, s[8:11], s44 offen offset:1024 sc1
  ds_write_b32 v1, v132 offset:20480
  v_smfmac_f32_16x16x64_bf16 v[124:127], v[56:59], a[232:239], v13
  v_smfmac_f32_16x16x64_bf16 v[128:131], v[36:39], a[240:247], v13
  v_smfmac_f32_16x16x64_bf16 v[128:131], v[40:43], a[248:255], v13
  v_cvt_pk_bf16_f32 v124, v124, v125
  v_cvt_pk_bf16_f32 v125, v126, v127
  v_smfmac_f32_16x16x64_bf16 v[128:131], v[44:47], v[60:67], v13
  v_smfmac_f32_16x16x64_bf16 v[128:131], v[20:23], v[68:75], v13
  v_smfmac_f32_16x16x64_bf16 v[128:131], v[24:27], v[76:83], v13
  ds_write_b64 v0, v[124:125] offset:17408
  v_mov_b32 v112, 0
  v_mov_b32 v113, 0
  v_mov_b32 v114, 0
  v_mov_b32 v115, 0
  v_mov_b32 v116, 0
  v_mov_b32 v117, 0
  s_nop 0
  v_add_f32 v128, v128, v130
  v_add_f32 v129, v129, v131
  v_cvt_pk_bf16_f32 v128, v128, v129
  ds_write_b32 v0, v128 offset:18440
  v_mov_b32 v118, 0
  v_mov_b32 v119, 0
  v_mov_b32 v120, 0
  v_mov_b32 v121, 0
  v_mov_b32 v122, 0
  v_mov_b32 v123, 0
  s_cmp_eq_u32 s36, 63
  s_waitcnt lgkmcnt(0)
  s_barrier
  s_cbranch_scc1 L206_fin
  buffer_load_dwordx4 v[84:87], v0, s[8:11], s45 offen sc1
  buffer_load_dword v88, v1, s[8:11], s45 offen offset:1024 sc1
  ds_read_b128 v[90:93], v0 offset:19456
  ds_read_b32 v94, v1 offset:20480
  ds_read_b128 v[20:23], v15 offset:24576
  ds_read_b128 v[24:27], v15 offset:25600
  ds_read_b128 v[28:31], v15 offset:26624
  ds_read_b128 v[32:35], v15 offset:27648
  ds_read_b128 v[36:39], v15 offset:28672
  ds_read_b128 v[40:43], v15 offset:29696
  ds_read_b128 v[44:47], v0 offset:16384
  ds_read_b128 v[48:51], v0 offset:17408
  ds_read_b128 v[52:55], v0 offset:18432
  v_mov_b32 v95, 1.0
  v_mov_b32 v134, 0
  v_mov_b32 v135, 0
  v_mov_b32 v124, 0
  v_mov_b32 v125, 0
  v_mov_b32 v126, 0
  v_mov_b32 v127, 0
  v_mov_b32 v128, 0
  v_mov_b32 v129, 0
  v_mov_b32 v130, 0
  v_mov_b32 v131, 0
  buffer_load_dwordx4 v[72:75], v0, s[8:11], s45 offen sc1
  buffer_load_dword v76, v1, s[8:11], s45 offen offset:1024 sc1
  s_waitcnt vmcnt(2) lgkmcnt(9)
L207_rb:
  v_add_f32 v60, v90, v84
  v_add_f32 v61, v91, v85
  v_add_f32 v62, v92, v86
  v_add_f32 v63, v93, v87
  v_add_f32 v64, v94, v88
  v_max3_f32 v66, v60, v61, v62
  v_max3_f32 v66, v66, v63, v64
  v_bitop3_b32 v71, v84, v88, s59 bitop3:0x7e
  v_and_b32 v71, 1, v71
  v_max_f32_dpp v67, v66, v66 quad_perm:[2,3,0,1] row_mask:0xf bank_mask:0xf
  v_max_f32_dpp v66, v66, v66 quad_perm:[2,3,0,1] row_mask:0xf bank_mask:0xf
  v_cmp_ne_u32 vcc, 0, v71
  s_nop 0
  v_permlane16_swap_b32 v66, v67
  v_max_f32 v68, v66, v67
  v_max_f32 v66, v66, v67
  s_cbranch_vccnz L208_fb
  s_nop 0
  v_permlane32_swap_b32 v66, v68
  v_max_f32 v66, v66, v68
  v_mul_f32 v66, s41, v66
  v_fma_f32 v60, v60, s41, -v66
  v_fma_f32 v61, v61, s41, -v66
  v_fma_f32 v62, v62, s41, -v66
  v_fma_f32 v63, v63, s41, -v66
  v_fma_f32 v64, v64, s41, -v66
  v_exp_f32 v60, v60
  v_exp_f32 v61, v61
  v_exp_f32 v62, v62
  v_exp_f32 v63, v63
  v_exp_f32 v64, v64
  v_cvt_pk_bf16_f32 v69, v60, v61
  v_cvt_pk_bf16_f32 v70, v62, v63
  v_add_f32 v89, v60, v61
  v_mov_b32_dpp v56, v69 quad_perm:[0,1,0,1] row_mask:0xf bank_mask:0xf
  v_mov_b32_dpp v57, v70 quad_perm:[0,1,0,1] row_mask:0xf bank_mask:0xf
  v_mov_b32_dpp v58, v69 quad_perm:[2,3,2,3] row_mask:0xf bank_mask:0xf
  v_mov_b32_dpp v59, v70 quad_perm:[2,3,2,3] row_mask:0xf bank_mask:0xf
  v_mov_b32_dpp v66, v64 quad_perm:[0,1,0,1] row_mask:0xf bank_mask:0xf
  v_mov_b32_dpp v67, v64 quad_perm:[2,3,2,3] row_mask:0xf bank_mask:0xf
  s_waitcnt vmcnt(0) lgkmcnt(0)
  v_mfma_f32_16x16x32_bf16 v[80:83], v[20:23], v[56:59], 0
  buffer_load_dwordx4 v0, s[8:11], s65 offen offset:0 sc1 lds
  v_add_f32 v89, v89, v62
  v_cvt_pk_bf16_f32 v132, v66, v67
  v_mfma_f32_16x16x32_bf16 v[76:79], v[24:27], v[56:59], 0
  buffer_load_dwordx4 v0, s[8:11], s65 offen offset:1024 sc1 lds
  v_add_f32 v89, v89, v63
  v_cvt_pk_bf16_f32 v133, v66, v67
  v_mfma_f32_16x16x32_bf16 v[72:75], v[28:31], v[56:59], 0
  buffer_load_dwordx4 v0, s[8:11], s65 offen offset:2048 sc1 lds
  v_add_f32 v89, v89, v64
  v_mfma_f32_16x16x32_bf16 v[80:83], v[44:47], v[132:135], v[80:83]
  v_mfma_f32_16x16x32_bf16 v[76:79], v[44:47], v[130:133], v[76:79]
  v_add_f32_dpp v89, v89, v89 quad_perm:[2,3,0,1] row_mask:0xf bank_mask:0xf
  v_mfma_f32_16x16x32_bf16 v[68:71], v[32:35], v[56:59], 0
  v_mfma_f32_16x16x32_bf16 v[72:75], v[48:51], v[132:135], v[72:75]
  v_mfma_f32_16x16x4_f32 v[96:99], v89, v95, 0
  v_cvt_pk_bf16_f32 v84, v80, v81
  v_cvt_pk_bf16_f32 v85, v82, v83
  v_cvt_pk_bf16_f32 v86, v76, v77
  v_cvt_pk_bf16_f32 v87, v78, v79
  v_mfma_f32_16x16x32_bf16 v[68:71], v[48:51], v[130:133], v[68:71]
  v_cvt_pk_bf16_f32 v88, v72, v73
  v_cvt_pk_bf16_f32 v89, v74, v75
  v_mfma_f32_16x16x32_bf16 v[64:67], v[36:39], v[56:59], 0
  v_mfma_f32_16x16x32_bf16 v[60:63], v[40:43], v[56:59], 0
  v_cvt_pk_bf16_f32 v90, v68, v69
  v_cvt_pk_bf16_f32 v91, v70, v71
  v_mfma_f32_16x16x32_bf16 v[64:67], v[52:55], v[132:135], v[64:67]
  v_rcp_f32 v96, v96
  v_mfma_f32_16x16x32_bf16 v[60:63], v[52:55], v[130:133], v[60:63]
  v_rcp_f32 v97, v97
  v_smfmac_f32_16x16x64_bf16 v[112:115], v[84:87], v[136:143], v13
  v_cvt_pk_bf16_f32 v92, v64, v65
  v_cvt_pk_bf16_f32 v93, v66, v67
  v_smfmac_f32_16x16x64_bf16 v[116:119], v[84:87], v[144:151], v13
  v_cvt_pk_bf16_f32 v94, v60, v61
  v_cvt_pk_bf16_f32 v95, v62, v63
  v_smfmac_f32_16x16x64_bf16 v[112:115], v[88:91], v[176:183], v13
  v_smfmac_f32_16x16x64_bf16 v[116:119], v[88:91], v[184:191], v13
  v_smfmac_f32_16x16x64_bf16 v[112:115], v[92:95], v[216:223], v13
  v_smfmac_f32_16x16x64_bf16 v[116:119], v[92:95], v[224:231], v13
  v_smfmac_f32_16x16x64_bf16 v[120:123], v[84:87], v[152:159], v13
  v_mul_f32 v112, v96, v112
  v_mul_f32 v114, v96, v114
  v_smfmac_f32_16x16x64_bf16 v[124:127], v[84:87], v[160:167], v13
  v_mul_f32 v113, v97, v113
  v_mul_f32 v115, v97, v115
  v_smfmac_f32_16x16x64_bf16 v[120:123], v[88:91], v[192:199], v13
  v_cvt_pk_bf16_f32 v20, v112, v114
  v_cvt_pk_bf16_f32 v21, v113, v115
  v_smfmac_f32_16x16x64_bf16 v[124:127], v[88:91], v[200:207], v13
  v_bfi_b32 v20, 1, s59, v20
  v_mul_f32 v116, v96, v116
  v_mul_f32 v118, v96, v118
  v_smfmac_f32_16x16x64_bf16 v[120:123], v[92:95], v[232:239], v13
  v_mul_f32 v117, v97, v117
  v_mul_f32 v119, v97, v119
  v_cvt_pk_bf16_f32 v22, v116, v118
  v_smfmac_f32_16x16x64_bf16 v[124:127], v[92:95], v[240:247], v13
  v_cvt_pk_bf16_f32 v23, v117, v119
  buffer_store_dwordx4 v[20:23], v9, s[8:11], s47 offen sc1
  v_smfmac_f32_16x16x64_bf16 v[128:131], v[84:87], v[168:175], v13
  v_mul_f32 v120, v96, v120
  v_mul_f32 v122, v96, v122
  v_smfmac_f32_16x16x64_bf16 v[128:131], v[88:91], v[208:215], v13
  v_mul_f32 v121, v97, v121
  v_mul_f32 v123, v97, v123
  v_smfmac_f32_16x16x64_bf16 v[128:131], v[92:95], v[248:255], v13
  v_cvt_pk_bf16_f32 v24, v120, v122
  v_cvt_pk_bf16_f32 v25, v121, v123
  v_bfi_b32 v24, 1, s59, v24
  v_mul_f32 v124, v96, v124
  v_mul_f32 v126, v96, v126
  v_mul_f32 v125, v97, v125
  v_mul_f32 v127, v97, v127
  v_cvt_pk_bf16_f32 v26, v124, v126
  v_cvt_pk_bf16_f32 v27, v125, v127
  buffer_store_dwordx4 v[24:27], v9, s[8:11], s47 offen offset:1024 sc1
  v_mul_f32 v128, v96, v128
  v_mul_f32 v130, v96, v130
  v_mul_f32 v129, v97, v129
  v_mul_f32 v131, v97, v131
  v_cvt_pk_bf16_f32 v28, v128, v130
  v_cvt_pk_bf16_f32 v29, v129, v131
  v_bfi_b32 v28, 1, s59, v28
  buffer_store_dwordx2 v[28:29], v10, s[8:11], s47 offen sc1
  ds_read_b128 v[60:63], v3 offset:0
  ds_read_b128 v[64:67], v3 offset:1024
  ds_read_b128 v[68:71], v3 offset:2048
  ds_read_b128 v[72:75], v3 offset:3072
  ds_read_b128 v[76:79], v3 offset:4096
  ds_read_b128 v[80:83], v3 offset:5120
  ds_read_b128 v[84:87], v3 offset:6144
  ds_read_b128 v[88:91], v3 offset:7168
  ds_read_b128 v[92:95], v3 offset:8192
  ds_read_b128 v[96:99], v3 offset:9216
  v_mov_b32 v112, 0
  v_mov_b32 v113, 0
  v_mov_b32 v114, 0
  v_mov_b32 v115, 0
  v_mov_b32 v116, 0
  v_mov_b32 v117, 0
  v_mov_b32 v118, 0
  v_mov_b32 v119, 0
  v_mov_b32 v120, 0
  v_mov_b32 v121, 0
  v_mov_b32 v122, 0
  v_mov_b32 v123, 0
  v_mov_b32 v124, 0
  v_mov_b32 v125, 0
  v_mov_b32 v126, 0
  v_mov_b32 v127, 0
  v_mov_b32 v128, 0
  v_mov_b32 v129, 0
  v_mov_b32 v130, 0
  v_mov_b32 v131, 0
  s_xor_b32 s56, s56, 65536
  s_xor_b32 s58, s58, 131072
  s_add_u32 s65, s65, 393216
  v_xor_b32 v15, 8192, v15
  s_add_u32 s36, s36, 1
  s_xor_b32 s69, s69, 57344
  s_add_u32 s66, s66, 393216
  s_waitcnt vmcnt(0)
  buffer_load_dwordx4 v[32:35], v11, s[8:11], s49 offen sc1
  buffer_load_dwordx4 v[36:39], v11, s[8:11], s51 offen sc1
L210_rc:
  s_waitcnt vmcnt(1)
  v_mfma_f32_16x16x32_bf16 v[48:51], v[16:19], v[32:35], 0
  v_bitop3_b32 v132, v32, v34, s59 bitop3:0x7e
  s_waitcnt vmcnt(0)
  v_mfma_f32_16x16x32_bf16 v[48:51], v[16:19], v[36:39], v[48:51]
  v_bitop3_b32 v133, v36, v38, s59 bitop3:0x7e
  v_bitop3_b32 v132, v132, v133, 1 bitop3:0xa8
  v_cmp_ne_u32 vcc, 0, v132
  s_cbranch_vccnz L211_fc
  s_nop 3
  v_add_f32_dpp v48, v48, v48 row_ror:8 row_mask:0xf bank_mask:0xf
  v_add_f32_dpp v49, v49, v49 row_ror:8 row_mask:0xf bank_mask:0xf
  v_add_f32_dpp v50, v50, v50 row_ror:8 row_mask:0xf bank_mask:0xf
  v_add_f32_dpp v51, v51, v51 row_ror:8 row_mask:0xf bank_mask:0xf
  v_add_f32_dpp v48, v48, v48 row_ror:4 row_mask:0xf bank_mask:0xf
  v_add_f32_dpp v49, v49, v49 row_ror:4 row_mask:0xf bank_mask:0xf
  v_add_f32_dpp v50, v50, v50 row_ror:4 row_mask:0xf bank_mask:0xf
  v_add_f32_dpp v51, v51, v51 row_ror:4 row_mask:0xf bank_mask:0xf
  v_cvt_pk_bf16_f32 v24, v48, v49
  v_cvt_pk_bf16_f32 v25, v50, v51
  v_bfi_b32 v24, 1, s61, v24
  buffer_store_dwordx2 v[24:25], v12, s[8:11], s56 offen sc1
  s_barrier
  buffer_store_dwordx2 v[24:25], v7, s[8:11], s57 offen sc1
  s_xor_b32 s59, s59, 1
  s_mov_b32 s60, s61
  s_xor_b32 s61, s61, s59
  s_xor_b32 s57, s57, 131072
  s_waitcnt vmcnt(1)
  s_barrier
  s_branch L194_top
L206_fin:
  s_add_u32 s66, s66, 393216
  buffer_store_dwordx4 v[100:103], v0, s[8:11], s66 offen offset:0 sc1
  buffer_store_dwordx4 v[104:107], v0, s[8:11], s66 offen offset:1024 sc1
  buffer_store_dwordx4 v[108:111], v0, s[8:11], s66 offen offset:2048 sc1
  s_waitcnt vmcnt(0)
  s_barrier
  s_waitcnt vmcnt(0)
  s_endpgm
L197_pw:
  buffer_load_dword v14, off, s[8:11], s68 sc1
  s_sub_u32 s37, s37, 1
  s_cbranch_scc1 L171_bail
  s_waitcnt vmcnt(0)
  v_readfirstlane_b32 s38, v14
  s_cmp_lt_u32 s38, s62
  s_cbranch_scc1 L197_pw
  s_branch L198_pwb
L199_f1:
  s_mov_b64 exec, vcc
  buffer_load_dwordx4 v[20:23], v2, s[8:11], s56 offen offset:0 sc1
  buffer_load_dwordx4 v[24:27], v2, s[8:11], s56 offen offset:1024 sc1
  buffer_load_dwordx4 v[28:31], v2, s[8:11], s56 offen offset:2048 sc1
  s_mov_b64 exec, -1
  buffer_load_dwordx4 v[36:39], v8, s[8:11], s58 offen offset:0 sc1
  buffer_load_dwordx4 v[40:43], v8, s[8:11], s58 offen offset:1024 sc1
  buffer_load_dwordx4 v[44:47], v8, s[8:11], s58 offen offset:2048 sc1
  s_waitcnt vmcnt(3)
  v_bitop3_b32 v132, v20, v22, s60 bitop3:0x7e
  v_bitop3_b32 v133, v24, v26, s60 bitop3:0x7e
  v_or_b32 v132, v132, v133
  v_bitop3_b32 v133, v28, v30, s60 bitop3:0x7e
  v_bitop3_b32 v132, v132, v133, 1 bitop3:0xa8
  v_cmp_ne_u32 vcc, 0, v132
  s_cbranch_vccz L203_b3
L204_f3:
L205_ag:
  s_mov_b64 exec, vcc
  s_xor_b32 s3, s58, 0
  buffer_load_dwordx4 v[20:23], v2, s[8:11], s56 offen offset:0 sc1
  buffer_load_dwordx4 v[24:27], v2, s[8:11], s56 offen offset:1024 sc1
  buffer_load_dwordx4 v[28:31], v2, s[8:11], s56 offen offset:2048 sc1
  s_sub_u32 s37, s37, 1
  s_cbranch_scc1 L171_bail
  s_waitcnt vmcnt(0)
  v_bitop3_b32 v132, v20, v22, s60 bitop3:0x7e
  v_bitop3_b32 v133, v24, v26, s60 bitop3:0x7e
  v_or_b32 v132, v132, v133
  v_bitop3_b32 v133, v28, v30, s60 bitop3:0x7e
  v_bitop3_b32 v132, v132, v133, 1 bitop3:0xa8
  v_cmp_ne_u32 vcc, 0, v132
  s_mov_b64 exec, -1
  s_cbranch_vccnz L205_ag
  s_branch L203_b3
L201_f2:
  s_xor_b32 s3, s58, 0
  s_sub_u32 s37, s37, 1
  s_cbranch_scc1 L171_bail
  buffer_load_dwordx4 v[36:39], v8, s[8:11], s3 offen offset:0 sc1
  buffer_load_dwordx4 v[40:43], v8, s[8:11], s3 offen offset:1024 sc1
  buffer_load_dwordx4 v[44:47], v8, s[8:11], s3 offen offset:2048 sc1
  s_branch L202_b2
L195_fL:
  s_mov_b64 exec, vcc
  buffer_load_dwordx4 v[36:39], v2, s[8:11], s56 offen offset:0 sc1
  buffer_load_dwordx4 v[40:43], v2, s[8:11], s56 offen offset:1024 sc1
  buffer_load_dwordx4 v[44:47], v2, s[8:11], s56 offen offset:2048 sc1
  s_mov_b64 exec, -1
  s_sub_u32 s37, s37, 1
  s_cbranch_scc1 L171_bail
  s_branch L196_rl
L208_fb:
  s_waitcnt vmcnt(0)
  v_bitop3_b32 v71, v72, v76, s59 bitop3:0x7e
  v_and_b32 v71, 1, v71
  v_cmp_ne_u32 vcc, 0, v71
  v_mov_b32 v84, v72
  v_mov_b32 v85, v73
  v_mov_b32 v86, v74
  v_mov_b32 v87, v75
  v_mov_b32 v88, v76
  s_cbranch_vccz L207_rb
L209_fb2:
  s_sub_u32 s37, s37, 1
  s_cbranch_scc1 L171_bail
  buffer_load_dwordx4 v[84:87], v0, s[8:11], s45 offen sc1
  buffer_load_dword v88, v1, s[8:11], s45 offen offset:1024 sc1
  s_waitcnt vmcnt(0)
  v_bitop3_b32 v71, v84, v88, s59 bitop3:0x7e
  v_and_b32 v71, 1, v71
  v_cmp_ne_u32 vcc, 0, v71
  s_cbranch_vccz L207_rb
  s_branch L209_fb2
L211_fc:
  s_mov_b64 exec, vcc
  buffer_load_dwordx4 v[32:35], v11, s[8:11], s49 offen sc1
  buffer_load_dwordx4 v[36:39], v11, s[8:11], s51 offen sc1
  s_mov_b64 exec, -1
  s_sub_u32 s37, s37, 1
  s_cbranch_scc1 L171_bail
  s_branch L210_rc
L171_bail:
  s_endpgm
L88_recw3:
  s_add_u32 s66, s66, -390144
  s_mul_i32 s3, s6, 384
  s_mul_i32 s100, s7, 192
  s_add_u32 s3, s3, s100
  v_add_u32 v32, 0, v20
  v_mul_u32_u24 v33, 171, v32
  v_lshrrev_b32 v33, 11, v33
  v_mul_u32_u24 v34, 12, v33
  v_sub_u32 v32, v32, v34
  v_lshl_add_u32 v32, v32, 4, s3
  v_lshrrev_b32 v34, 2, v33
  v_and_b32 v35, 3, v33
  v_lshl_add_u32 v35, v35, 4, v34
  v_mul_u32_u24 v35, 12288, v35
  v_add_u32 v21, v35, v32
  v_and_b32 v35, 1, v33
  v_lshlrev_b32 v35, 4, v35
  v_lshl_add_u32 v35, v34, 1, v35
  v_bfe_u32 v34, v33, 1, 1
  v_add_u32 v35, v35, v34
  v_mul_u32_u24 v35, 12288, v35
  v_add_u32 v24, v35, v32
  v_add_u32 v32, 64, v20
  v_mul_u32_u24 v33, 171, v32
  v_lshrrev_b32 v33, 11, v33
  v_mul_u32_u24 v34, 12, v33
  v_sub_u32 v32, v32, v34
  v_lshl_add_u32 v32, v32, 4, s3
  v_lshrrev_b32 v34, 2, v33
  v_and_b32 v35, 3, v33
  v_lshl_add_u32 v35, v35, 4, v34
  v_mul_u32_u24 v35, 12288, v35
  v_add_u32 v22, v35, v32
  v_and_b32 v35, 1, v33
  v_lshlrev_b32 v35, 4, v35
  v_lshl_add_u32 v35, v34, 1, v35
  v_bfe_u32 v34, v33, 1, 1
  v_add_u32 v35, v35, v34
  v_mul_u32_u24 v35, 12288, v35
  v_add_u32 v25, v35, v32
  v_add_u32 v32, 128, v20
  v_mul_u32_u24 v33, 171, v32
  v_lshrrev_b32 v33, 11, v33
  v_mul_u32_u24 v34, 12, v33
  v_sub_u32 v32, v32, v34
  v_lshl_add_u32 v32, v32, 4, s3
  v_lshrrev_b32 v34, 2, v33
  v_and_b32 v35, 3, v33
  v_lshl_add_u32 v35, v35, 4, v34
  v_mul_u32_u24 v35, 12288, v35
  v_add_u32 v23, v35, v32
  v_and_b32 v35, 1, v33
  v_lshlrev_b32 v35, 4, v35
  v_lshl_add_u32 v35, v34, 1, v35
  v_bfe_u32 v34, v33, 1, 1
  v_add_u32 v35, v35, v34
  v_mul_u32_u24 v35, 12288, v35
  v_add_u32 v26, v35, v32
  s_mov_b32 s3, 147456
  s_mov_b32 m0, 132096
  s_nop 0
  buffer_load_dwordx4 v21, s[24:27], s3 offen lds
  s_mov_b32 m0, 133120
  s_nop 0
  buffer_load_dwordx4 v22, s[24:27], s3 offen lds
  s_mov_b32 m0, 134144
  s_nop 0
  buffer_load_dwordx4 v23, s[24:27], s3 offen lds
  s_mov_b32 s3, 933888
  s_mov_b32 m0, 144384
  s_nop 0
  buffer_load_dwordx4 v21, s[24:27], s3 offen lds
  s_mov_b32 m0, 145408
  s_nop 0
  buffer_load_dwordx4 v22, s[24:27], s3 offen lds
  s_mov_b32 m0, 146432
  s_nop 0
  buffer_load_dwordx4 v23, s[24:27], s3 offen lds
  v_and_b32 v40, 15, v20
  v_lshrrev_b32 v41, 4, v20
  v_lshlrev_b32 v0, 4, v20
  v_lshlrev_b32 v1, 2, v20
  v_add_u32 v2, 19456, v0
  v_add_u32 v3, 129024, v0
  v_mov_b32 v15, v0
  v_bfe_u32 v42, v40, 2, 1
  v_lshlrev_b32 v42, 8, v42
  v_bfe_u32 v43, v40, 3, 1
  v_lshl_or_b32 v42, v43, 7, v42
  v_and_b32 v43, 3, v40
  v_lshl_or_b32 v42, v43, 5, v42
  v_lshrrev_b32 v43, 2, v40
  v_xor_b32 v43, v43, v41
  v_lshl_or_b32 v4, v43, 3, v42
  v_lshrrev_b32 v42, 1, v41
  v_lshlrev_b32 v42, 9, v42
  v_and_b32 v43, 1, v41
  v_lshl_or_b32 v42, v43, 7, v42
  v_lshrrev_b32 v44, 2, v40
  v_lshl_or_b32 v42, v44, 5, v42
  v_lshlrev_b32 v43, 1, v43
  v_and_b32 v44, 3, v40
  v_xor_b32 v43, v43, v44
  v_lshl_or_b32 v5, v43, 3, v42
  v_xor_b32 v6, 264, v5
  v_mov_b32 v42, 0x44444444
  v_mov_b32 v43, 0xeeeeeeee
  v_cndmask_b32 v13, v42, v43, s[42:43]
  v_mov_b32 v42, 0x7ffff000
  v_and_b32 v43, 1, v41
  v_lshlrev_b32 v43, 5, v43
  v_and_b32 v44, 3, v40
  v_lshl_or_b32 v43, v44, 3, v43
  v_add_u32 v8, 768, v43
  v_cndmask_b32 v7, v42, v0, s[42:43]
  v_lshrrev_b32 v42, 2, v40
  v_lshlrev_b32 v42, 8, v42
  v_lshl_or_b32 v42, v41, 6, v42
  v_and_b32 v43, 3, v40
  v_lshl_or_b32 v42, v43, 4, v42
  v_add_u32 v9, 7680, v42
  v_lshrrev_b32 v42, 3, v40
  v_lshlrev_b32 v42, 8, v42
  v_lshl_or_b32 v42, v41, 6, v42
  v_and_b32 v43, 7, v40
  v_lshl_or_b32 v42, v43, 3, v42
  v_add_u32 v10, 9728, v42
  s_lshr_b32 s3, s5, 3
  s_mul_i32 s3, s3, 160
  s_and_b32 s100, s5, 7
  s_lshl_b32 s100, s100, 2
  s_add_u32 s3, s3, s100
  s_add_u32 s3, s3, 128
  v_and_b32 v43, 3, v40
  v_add_u32 v45, s3, v43
  v_lshrrev_b32 v42, 2, v40
  v_lshl_add_u32 v42, v41, 2, v42
  v_mul_u32_u24 v42, 10496, v42
  v_lshl_add_u32 v11, v45, 4, v42
  v_mov_b32 v46, 0x7ffff000
  v_lshrrev_b32 v42, 1, v45
  v_lshlrev_b32 v42, 5, v42
  v_lshl_or_b32 v42, v41, 4, v42
  v_and_b32 v43, 1, v45
  v_lshl_or_b32 v42, v43, 3, v42
  v_add_u32 v43, 12288, v42
  v_cmp_gt_u32 vcc, 4096, v42
  s_nop 1
  v_cndmask_b32 v42, v43, v42, vcc
  v_cmp_gt_u32 vcc, 8, v40
  s_nop 1
  v_cndmask_b32 v42, v46, v42, vcc
  v_cmp_gt_u32 vcc, 2, v41
  s_nop 1
  v_cndmask_b32 v12, v46, v42, vcc
  v_bfe_u32 v42, v40, 1, 1
  v_bfe_u32 v43, v40, 2, 1
  v_lshl_or_b32 v42, v42, 1, v43
  v_and_b32 v43, 1, v40
  v_lshlrev_b32 v43, 4, v43
  v_lshlrev_b32 v43, v43, s39
  v_cmp_eq_u32 vcc, 0, v42
  s_nop 1
  v_cndmask_b32 v16, 0, v43, vcc
  v_cmp_eq_u32 vcc, 1, v42
  s_nop 1
  v_cndmask_b32 v17, 0, v43, vcc
  v_cmp_eq_u32 vcc, 2, v42
  s_nop 1
  v_cndmask_b32 v18, 0, v43, vcc
  v_cmp_eq_u32 vcc, 3, v42
  s_nop 1
  v_cndmask_b32 v19, 0, v43, vcc
  v_lshrrev_b32 v42, 1, v45
  v_lshlrev_b32 v42, 5, v42
  v_and_b32 v43, 1, v41
  v_lshl_or_b32 v42, v43, 4, v42
  v_and_b32 v43, 1, v45
  v_lshl_or_b32 v42, v43, 3, v42
  v_and_b32 v57, 127, v42
  v_bfe_i32 v43, v42, 7, 1
  v_and_b32 v43, 128, v43
  v_add_u32 v57, v57, v43
  v_bfe_i32 v43, v42, 8, 1
  v_and_b32 v43, 256, v43
  v_add_u32 v57, v57, v43
  v_bfe_i32 v43, v42, 9, 1
  v_and_b32 v43, 512, v43
  v_add_u32 v57, v57, v43
  v_lshrrev_b32 v42, 10, v42
  v_lshl_add_u32 v57, v42, 10, v57
  v_add_u32 v43, 0, v57
  v_cmp_lt_u32 vcc, 1, v42
  s_nop 1
  v_cndmask_b32 v57, v57, v43, vcc
  v_add_u32 v43, 0, v57
  v_cmp_lt_u32 vcc, 3, v42
  s_nop 1
  v_cndmask_b32 v57, v57, v43, vcc
  v_add_u32 v43, 10240, v57
  v_cmp_lt_u32 vcc, 6, v42
  s_nop 1
  v_cndmask_b32 v57, v57, v43, vcc
  v_and_b32 v42, 7, v20
  v_lshlrev_b32 v42, 4, v42
  v_add_u32 v8, 17408, v42
  v_bfe_i32 v43, v20, 3, 1
  v_and_b32 v43, 128, v43
  v_add_u32 v8, v8, v43
  v_bfe_i32 v43, v20, 4, 1
  v_and_b32 v43, 256, v43
  v_add_u32 v8, v8, v43
  v_bfe_i32 v43, v20, 5, 1
  v_and_b32 v43, 512, v43
  v_add_u32 v8, v8, v43
  v_lshrrev_b32 v42, 3, v20
  v_lshlrev_b32 v42, 10, v42
  v_and_b32 v43, 7, v20
  v_lshl_or_b32 v42, v43, 4, v42
  v_add_u32 v42, s53, v42
  v_cmp_gt_u32 vcc, 24, v20
  s_nop 1
  v_cndmask_b32 v7, v46, v42, vcc
  v_mov_b32 v132, 0
  v_mov_b32 v133, 0
  v_mov_b32 v134, 0
  v_mov_b32 v135, 0
  buffer_store_dwordx4 v[132:135], v9, s[8:11], s47 offen sc1
  buffer_store_dwordx4 v[132:135], v9, s[8:11], s47 offen offset:1024 sc1
  buffer_store_dwordx2 v[132:133], v10, s[8:11], s47 offen sc1
  buffer_store_dword v132, off, s[8:11], s67 sc1
  s_mov_b32 s3, 2015232
  s_mov_b32 m0, 33792
  s_nop 0
  buffer_load_dwordx4 v21, s[24:27], s3 offen lds
  s_mov_b32 m0, 34816
  s_nop 0
  buffer_load_dwordx4 v22, s[24:27], s3 offen lds
  s_mov_b32 m0, 35840
  s_nop 0
  buffer_load_dwordx4 v23, s[24:27], s3 offen lds
  s_mov_b32 s3, 2801664
  s_mov_b32 m0, 46080
  s_nop 0
  buffer_load_dwordx4 v21, s[24:27], s3 offen lds
  s_mov_b32 m0, 47104
  s_nop 0
  buffer_load_dwordx4 v22, s[24:27], s3 offen lds
  s_mov_b32 m0, 48128
  s_nop 0
  buffer_load_dwordx4 v23, s[24:27], s3 offen lds
  v_bfe_u32 v32, v20, 5, 1
  v_lshlrev_b32 v32, 4, v32
  v_bfe_u32 v33, v20, 3, 1
  v_lshl_or_b32 v32, v33, 3, v32
  v_bfe_u32 v33, v20, 4, 1
  v_lshl_or_b32 v32, v33, 2, v32
  v_bfe_u32 v33, v20, 2, 1
  v_or_b32 v32, v32, v33
  v_mul_u32_u24 v32, 192, v32
  v_and_b32 v34, 3, v20
  v_lshl_add_u32 v27, v34, 3, v32
  v_add_u32 v28, 49152, v27
  v_add_u32 v29, 98304, v27
  v_bfe_u32 v32, v20, 4, 1
  v_lshlrev_b32 v32, 3, v32
  v_bfe_u32 v35, v20, 5, 1
  v_lshl_or_b32 v32, v35, 2, v32
  v_or_b32 v32, v32, v33
  v_mul_u32_u24 v32, 1280, v32
  v_bfe_u32 v33, v20, 3, 1
  v_lshl_add_u32 v32, v33, 5, v32
  v_lshl_add_u32 v30, v34, 3, v32
  v_add_u32 v31, 49152, v30
  v_add_u32 v14, 98304, v30
  s_mul_i32 s101, s6, 245760
  s_mul_i32 s100, s7, 122880
  s_add_u32 s101, s101, s100
  s_mul_i32 s65, s6, 12288
  s_mul_i32 s3, s7, 6144
  s_add_u32 s65, s65, s3
  s_add_u32 s65, s65, 58723328
  s_lshl_b32 s68, s6, 7
  s_add_u32 s68, s68, 3149824
  s_mov_b32 s69, 27648
  s_mov_b32 s62, 1
  s_mov_b32 s3, 3637248
  s_mov_b32 m0, 9216
  s_nop 0
  buffer_load_dwordx4 v24, s[24:27], s3 offen lds
  s_mov_b32 m0, 10240
  s_nop 0
  buffer_load_dwordx4 v25, s[24:27], s3 offen lds
  s_mov_b32 m0, 11264
  s_nop 0
  buffer_load_dwordx4 v26, s[24:27], s3 offen lds
  s_mov_b32 s3, 4079616
  s_mov_b32 m0, 21504
  s_nop 0
  buffer_load_dwordx4 v21, s[24:27], s3 offen lds
  s_mov_b32 m0, 22528
  s_nop 0
  buffer_load_dwordx4 v22, s[24:27], s3 offen lds
  s_mov_b32 m0, 23552
  s_nop 0
  buffer_load_dwordx4 v23, s[24:27], s3 offen lds
  s_mov_b32 s3, 4866048
  s_mov_b32 m0, 58368
  s_nop 0
  buffer_load_dwordx4 v21, s[24:27], s3 offen lds
  s_mov_b32 m0, 59392
  s_nop 0
  buffer_load_dwordx4 v22, s[24:27], s3 offen lds
  s_mov_b32 m0, 60416
  s_nop 0
  buffer_load_dwordx4 v23, s[24:27], s3 offen lds
  s_mov_b32 s3, 5947392
  s_mov_b32 m0, 70656
  s_nop 0
  buffer_load_dwordx4 v21, s[24:27], s3 offen lds
  s_mov_b32 m0, 71680
  s_nop 0
  buffer_load_dwordx4 v22, s[24:27], s3 offen lds
  s_mov_b32 m0, 72704
  s_nop 0
  buffer_load_dwordx4 v23, s[24:27], s3 offen lds
  s_mov_b32 s3, 6733824
  s_mov_b32 m0, 82944
  s_nop 0
  buffer_load_dwordx4 v21, s[24:27], s3 offen lds
  s_mov_b32 m0, 83968
  s_nop 0
  buffer_load_dwordx4 v22, s[24:27], s3 offen lds
  s_mov_b32 m0, 84992
  s_nop 0
  buffer_load_dwordx4 v23, s[24:27], s3 offen lds
  s_mov_b32 s3, 7569408
  s_mov_b32 m0, 95232
  s_nop 0
  buffer_load_dwordx4 v24, s[24:27], s3 offen lds
  s_mov_b32 m0, 96256
  s_nop 0
  buffer_load_dwordx4 v25, s[24:27], s3 offen lds
  s_mov_b32 m0, 97280
  s_nop 0
  buffer_load_dwordx4 v26, s[24:27], s3 offen lds
  s_waitcnt vmcnt(24)
  s_waitcnt lgkmcnt(0)
  s_barrier
  s_mov_b32 s3, 147456
  s_mov_b32 m0, 107520
  s_nop 0
  buffer_load_dwordx4 v21, s[16:19], s3 offen lds
  s_mov_b32 m0, 108544
  s_nop 0
  buffer_load_dwordx4 v22, s[16:19], s3 offen lds
  s_mov_b32 m0, 109568
  s_nop 0
  buffer_load_dwordx4 v23, s[16:19], s3 offen lds
  s_mov_b32 s3, 147456
  s_mov_b32 m0, 119808
  s_nop 0
  buffer_load_dwordx4 v21, s[20:23], s3 offen lds
  s_mov_b32 m0, 120832
  s_nop 0
  buffer_load_dwordx4 v22, s[20:23], s3 offen lds
  s_mov_b32 m0, 121856
  s_nop 0
  buffer_load_dwordx4 v23, s[20:23], s3 offen lds
  ds_read_b64_tr_b16 v[96:97], v29 offset:24672
  ds_read_b64_tr_b16 v[98:99], v29 offset:25056
  ds_read_b64_tr_b16 v[100:101], v29 offset:30816
  ds_read_b64_tr_b16 v[102:103], v29 offset:31200
  ds_read_b64_tr_b16 v[104:105], v29 offset:36960
  ds_read_b64_tr_b16 v[106:107], v29 offset:37344
  ds_read_b64_tr_b16 v[108:109], v29 offset:43104
  ds_read_b64_tr_b16 v[110:111], v29 offset:43488
  s_waitcnt vmcnt(24)
  s_waitcnt lgkmcnt(0)
  s_barrier
  s_add_u32 s3, s101, 25600
  s_mov_b32 m0, 138240
  s_nop 0
  buffer_load_dwordx4 v0, s[28:31], s3 offen lds
  s_add_u32 s3, s101, 26624
  s_mov_b32 m0, 139264
  s_nop 0
  buffer_load_dwordx4 v0, s[28:31], s3 offen lds
  s_add_u32 s3, s101, 27648
  s_mov_b32 m0, 140288
  s_nop 0
  buffer_load_dwordx4 v0, s[28:31], s3 offen lds
  s_add_u32 s3, s101, 28672
  s_mov_b32 m0, 141312
  s_nop 0
  buffer_load_dwordx4 v0, s[28:31], s3 offen lds
  s_add_u32 s3, s101, 29696
  s_mov_b32 m0, 142336
  s_nop 0
  buffer_load_dwordx4 v0, s[28:31], s3 offen lds
  ds_read_b64_tr_b16 v[120:121], v27 offset:24736
  ds_read_b64_tr_b16 v[122:123], v27 offset:25120
  ds_read_b64_tr_b16 v[124:125], v27 offset:30880
  ds_read_b64_tr_b16 v[126:127], v27 offset:31264
  ds_read_b64_tr_b16 v[128:129], v27 offset:37024
  ds_read_b64_tr_b16 v[130:131], v27 offset:37408
  ds_read_b64_tr_b16 v[132:133], v27 offset:43168
  ds_read_b64_tr_b16 v[134:135], v27 offset:43552
  ds_read_b64_tr_b16 a[176:177], v27 offset:24672
  ds_read_b64_tr_b16 a[178:179], v27 offset:25056
  ds_read_b64_tr_b16 a[180:181], v27 offset:30816
  ds_read_b64_tr_b16 a[182:183], v27 offset:31200
  ds_read_b64_tr_b16 a[184:185], v27 offset:36960
  ds_read_b64_tr_b16 a[186:187], v27 offset:37344
  ds_read_b64_tr_b16 a[188:189], v27 offset:43104
  ds_read_b64_tr_b16 a[190:191], v27 offset:43488
  s_waitcnt vmcnt(23)
  s_waitcnt lgkmcnt(0)
  s_barrier
  s_mov_b32 s3, 933888
  s_mov_b32 m0, 33792
  s_nop 0
  buffer_load_dwordx4 v21, s[16:19], s3 offen lds
  s_mov_b32 m0, 34816
  s_nop 0
  buffer_load_dwordx4 v22, s[16:19], s3 offen lds
  s_mov_b32 m0, 35840
  s_nop 0
  buffer_load_dwordx4 v23, s[16:19], s3 offen lds
  s_mov_b32 s3, 933888
  s_mov_b32 m0, 46080
  s_nop 0
  buffer_load_dwordx4 v21, s[20:23], s3 offen lds
  s_mov_b32 m0, 47104
  s_nop 0
  buffer_load_dwordx4 v22, s[20:23], s3 offen lds
  s_mov_b32 m0, 48128
  s_nop 0
  buffer_load_dwordx4 v23, s[20:23], s3 offen lds
  ds_read_b64_tr_b16 a[192:193], v27 offset:96
  ds_read_b64_tr_b16 a[194:195], v27 offset:480
  ds_read_b64_tr_b16 a[196:197], v27 offset:6240
  ds_read_b64_tr_b16 a[198:199], v27 offset:6624
  ds_read_b64_tr_b16 a[200:201], v27 offset:12384
  ds_read_b64_tr_b16 a[202:203], v27 offset:12768
  ds_read_b64_tr_b16 a[204:205], v27 offset:18528
  ds_read_b64_tr_b16 a[206:207], v27 offset:18912
  s_waitcnt vmcnt(23)
  s_waitcnt lgkmcnt(0)
  s_barrier
  s_mov_b32 s3, 2015232
  s_mov_b32 m0, 9216
  s_nop 0
  buffer_load_dwordx4 v21, s[16:19], s3 offen lds
  s_mov_b32 m0, 10240
  s_nop 0
  buffer_load_dwordx4 v22, s[16:19], s3 offen lds
  s_mov_b32 m0, 11264
  s_nop 0
  buffer_load_dwordx4 v23, s[16:19], s3 offen lds
  s_mov_b32 s3, 2015232
  s_mov_b32 m0, 21504
  s_nop 0
  buffer_load_dwordx4 v21, s[20:23], s3 offen lds
  s_mov_b32 m0, 22528
  s_nop 0
  buffer_load_dwordx4 v22, s[20:23], s3 offen lds
  s_mov_b32 m0, 23552
  s_nop 0
  buffer_load_dwordx4 v23, s[20:23], s3 offen lds
  ds_read_b64_tr_b16 a[208:209], v28 offset:96
  ds_read_b64_tr_b16 a[210:211], v28 offset:480
  ds_read_b64_tr_b16 a[212:213], v28 offset:6240
  ds_read_b64_tr_b16 a[214:215], v28 offset:6624
  ds_read_b64_tr_b16 a[216:217], v28 offset:12384
  ds_read_b64_tr_b16 a[218:219], v28 offset:12768
  ds_read_b64_tr_b16 a[220:221], v28 offset:18528
  ds_read_b64_tr_b16 a[222:223], v28 offset:18912
  ds_read_b64_tr_b16 a[240:241], v28 offset:12448
  ds_read_b64_tr_b16 a[242:243], v28 offset:12832
  ds_read_b64_tr_b16 a[244:245], v28 offset:18592
  ds_read_b64_tr_b16 a[246:247], v28 offset:18976
  s_waitcnt vmcnt(23)
  s_waitcnt lgkmcnt(0)
  s_barrier
  s_add_u32 s3, s101, 35840
  s_mov_b32 m0, 64512
  s_nop 0
  buffer_load_dwordx4 v0, s[28:31], s3 offen lds
  s_add_u32 s3, s101, 36864
  s_mov_b32 m0, 65536
  s_nop 0
  buffer_load_dwordx4 v0, s[28:31], s3 offen lds
  s_add_u32 s3, s101, 37888
  s_mov_b32 m0, 66560
  s_nop 0
  buffer_load_dwordx4 v0, s[28:31], s3 offen lds
  s_add_u32 s3, s101, 38912
  s_mov_b32 m0, 67584
  s_nop 0
  buffer_load_dwordx4 v0, s[28:31], s3 offen lds
  s_add_u32 s3, s101, 39936
  s_mov_b32 m0, 68608
  s_nop 0
  buffer_load_dwordx4 v0, s[28:31], s3 offen lds
  ds_read_b64_tr_b16 v[112:113], v28 offset:37024
  ds_read_b64_tr_b16 v[114:115], v28 offset:37408
  ds_read_b64_tr_b16 v[116:117], v28 offset:43168
  ds_read_b64_tr_b16 v[118:119], v28 offset:43552
  ds_read_b64_tr_b16 a[224:225], v28 offset:24672
  ds_read_b64_tr_b16 a[226:227], v28 offset:25056
  ds_read_b64_tr_b16 a[228:229], v28 offset:30816
  ds_read_b64_tr_b16 a[230:231], v28 offset:31200
  ds_read_b64_tr_b16 a[232:233], v28 offset:36960
  ds_read_b64_tr_b16 a[234:235], v28 offset:37344
  ds_read_b64_tr_b16 a[236:237], v28 offset:43104
  ds_read_b64_tr_b16 a[238:239], v28 offset:43488
  ds_read_b64_tr_b16 a[248:249], v28 offset:24736
  ds_read_b64_tr_b16 a[250:251], v28 offset:25120
  ds_read_b64_tr_b16 a[252:253], v28 offset:30880
  ds_read_b64_tr_b16 a[254:255], v28 offset:31264
  s_waitcnt vmcnt(22)
  s_waitcnt lgkmcnt(0)
  s_barrier
  s_mov_b32 s3, 2801664
  s_mov_b32 m0, 82944
  s_nop 0
  buffer_load_dwordx4 v21, s[16:19], s3 offen lds
  s_mov_b32 m0, 83968
  s_nop 0
  buffer_load_dwordx4 v22, s[16:19], s3 offen lds
  s_mov_b32 m0, 84992
  s_nop 0
  buffer_load_dwordx4 v23, s[16:19], s3 offen lds
  s_mov_b32 s3, 2801664
  s_mov_b32 m0, 95232
  s_nop 0
  buffer_load_dwordx4 v21, s[20:23], s3 offen lds
  s_mov_b32 m0, 96256
  s_nop 0
  buffer_load_dwordx4 v22, s[20:23], s3 offen lds
  s_mov_b32 m0, 97280
  s_nop 0
  buffer_load_dwordx4 v23, s[20:23], s3 offen lds
  ds_read_b64_tr_b16 a[32:33], v29 offset:12384
  ds_read_b64_tr_b16 a[34:35], v29 offset:12768
  ds_read_b64_tr_b16 a[36:37], v29 offset:18528
  ds_read_b64_tr_b16 a[38:39], v29 offset:18912
  ds_read_b64_tr_b16 a[40:41], v29 offset:12416
  ds_read_b64_tr_b16 a[42:43], v29 offset:12800
  ds_read_b64_tr_b16 a[44:45], v29 offset:18560
  ds_read_b64_tr_b16 a[46:47], v29 offset:18944
  ds_read_b64_tr_b16 a[48:49], v29 offset:12448
  ds_read_b64_tr_b16 a[50:51], v29 offset:12832
  ds_read_b64_tr_b16 a[52:53], v29 offset:18592
  ds_read_b64_tr_b16 a[54:55], v29 offset:18976
  s_waitcnt vmcnt(23)
  s_waitcnt lgkmcnt(0)
  s_barrier
  s_mov_b32 s3, 3637248
  s_mov_b32 m0, 107520
  s_nop 0
  buffer_load_dwordx4 v24, s[16:19], s3 offen lds
  s_mov_b32 m0, 108544
  s_nop 0
  buffer_load_dwordx4 v25, s[16:19], s3 offen lds
  s_mov_b32 m0, 109568
  s_nop 0
  buffer_load_dwordx4 v26, s[16:19], s3 offen lds
  s_mov_b32 s3, 3637248
  s_mov_b32 m0, 119808
  s_nop 0
  buffer_load_dwordx4 v24, s[20:23], s3 offen lds
  s_mov_b32 m0, 120832
  s_nop 0
  buffer_load_dwordx4 v25, s[20:23], s3 offen lds
  s_mov_b32 m0, 121856
  s_nop 0
  buffer_load_dwordx4 v26, s[20:23], s3 offen lds
  ds_read_b64_tr_b16 v[136:137], v14 offset:25536
  ds_read_b64_tr_b16 v[138:139], v14 offset:28096
  ds_read_b64_tr_b16 v[144:145], v14 offset:25600
  ds_read_b64_tr_b16 v[146:147], v14 offset:28160
  ds_read_b64_tr_b16 v[152:153], v14 offset:25664
  ds_read_b64_tr_b16 v[154:155], v14 offset:28224
  ds_read_b64_tr_b16 v[160:161], v14 offset:25728
  ds_read_b64_tr_b16 v[162:163], v14 offset:28288
  ds_read_b64_tr_b16 v[168:169], v14 offset:25792
  ds_read_b64_tr_b16 v[170:171], v14 offset:28352
  s_waitcnt vmcnt(23)
  s_waitcnt lgkmcnt(0)
  s_barrier
  s_add_u32 s3, s101, 66560
  s_mov_b32 m0, 138240
  s_nop 0
  buffer_load_dwordx4 v0, s[28:31], s3 offen lds
  s_add_u32 s3, s101, 67584
  s_mov_b32 m0, 139264
  s_nop 0
  buffer_load_dwordx4 v0, s[28:31], s3 offen lds
  s_add_u32 s3, s101, 68608
  s_mov_b32 m0, 140288
  s_nop 0
  buffer_load_dwordx4 v0, s[28:31], s3 offen lds
  s_add_u32 s3, s101, 69632
  s_mov_b32 m0, 141312
  s_nop 0
  buffer_load_dwordx4 v0, s[28:31], s3 offen lds
  s_add_u32 s3, s101, 70656
  s_mov_b32 m0, 142336
  s_nop 0
  buffer_load_dwordx4 v0, s[28:31], s3 offen lds
  ds_read_b64_tr_b16 a[56:57], v27 offset:36960
  ds_read_b64_tr_b16 a[58:59], v27 offset:37344
  ds_read_b64_tr_b16 a[60:61], v27 offset:43104
  ds_read_b64_tr_b16 a[62:63], v27 offset:43488
  ds_read_b64_tr_b16 a[64:65], v27 offset:36992
  ds_read_b64_tr_b16 a[66:67], v27 offset:37376
  ds_read_b64_tr_b16 a[68:69], v27 offset:43136
  ds_read_b64_tr_b16 a[70:71], v27 offset:43520
  ds_read_b64_tr_b16 a[72:73], v27 offset:37024
  ds_read_b64_tr_b16 a[74:75], v27 offset:37408
  ds_read_b64_tr_b16 a[76:77], v27 offset:43168
  ds_read_b64_tr_b16 a[78:79], v27 offset:43552
  s_waitcnt vmcnt(22)
  s_waitcnt lgkmcnt(0)
  s_barrier
  s_mov_b32 s3, 4079616
  s_mov_b32 m0, 33792
  s_nop 0
  buffer_load_dwordx4 v21, s[16:19], s3 offen lds
  s_mov_b32 m0, 34816
  s_nop 0
  buffer_load_dwordx4 v22, s[16:19], s3 offen lds
  s_mov_b32 m0, 35840
  s_nop 0
  buffer_load_dwordx4 v23, s[16:19], s3 offen lds
  s_mov_b32 s3, 4079616
  s_mov_b32 m0, 46080
  s_nop 0
  buffer_load_dwordx4 v21, s[20:23], s3 offen lds
  s_mov_b32 m0, 47104
  s_nop 0
  buffer_load_dwordx4 v22, s[20:23], s3 offen lds
  s_mov_b32 m0, 48128
  s_nop 0
  buffer_load_dwordx4 v23, s[20:23], s3 offen lds
  ds_read_b64_tr_b16 a[80:81], v27 offset:12384
  ds_read_b64_tr_b16 a[82:83], v27 offset:12768
  ds_read_b64_tr_b16 a[84:85], v27 offset:18528
  ds_read_b64_tr_b16 a[86:87], v27 offset:18912
  ds_read_b64_tr_b16 a[88:89], v27 offset:12416
  ds_read_b64_tr_b16 a[90:91], v27 offset:12800
  ds_read_b64_tr_b16 a[92:93], v27 offset:18560
  ds_read_b64_tr_b16 a[94:95], v27 offset:18944
  ds_read_b64_tr_b16 a[96:97], v27 offset:12448
  ds_read_b64_tr_b16 a[98:99], v27 offset:12832
  ds_read_b64_tr_b16 a[100:101], v27 offset:18592
  ds_read_b64_tr_b16 a[102:103], v27 offset:18976
  s_waitcnt vmcnt(23)
  s_waitcnt lgkmcnt(0)
  s_barrier
  s_mov_b32 s3, 4866048
  s_mov_b32 m0, 9216
  s_nop 0
  buffer_load_dwordx4 v21, s[16:19], s3 offen lds
  s_mov_b32 m0, 10240
  s_nop 0
  buffer_load_dwordx4 v22, s[16:19], s3 offen lds
  s_mov_b32 m0, 11264
  s_nop 0
  buffer_load_dwordx4 v23, s[16:19], s3 offen lds
  s_mov_b32 s3, 4866048
  s_mov_b32 m0, 21504
  s_nop 0
  buffer_load_dwordx4 v21, s[20:23], s3 offen lds
  s_mov_b32 m0, 22528
  s_nop 0
  buffer_load_dwordx4 v22, s[20:23], s3 offen lds
  s_mov_b32 m0, 23552
  s_nop 0
  buffer_load_dwordx4 v23, s[20:23], s3 offen lds
  ds_read_b64_tr_b16 v[140:141], v31 offset:960
  ds_read_b64_tr_b16 v[142:143], v31 offset:3520
  ds_read_b64_tr_b16 v[148:149], v31 offset:1024
  ds_read_b64_tr_b16 v[150:151], v31 offset:3584
  ds_read_b64_tr_b16 v[156:157], v31 offset:1088
  ds_read_b64_tr_b16 v[158:159], v31 offset:3648
  ds_read_b64_tr_b16 v[164:165], v31 offset:1152
  ds_read_b64_tr_b16 v[166:167], v31 offset:3712
  ds_read_b64_tr_b16 v[172:173], v31 offset:1216
  ds_read_b64_tr_b16 v[174:175], v31 offset:3776
  s_waitcnt vmcnt(23)
  s_waitcnt lgkmcnt(0)
  s_barrier
  s_add_u32 s3, s101, 76800
  s_mov_b32 m0, 64512
  s_nop 0
  buffer_load_dwordx4 v0, s[28:31], s3 offen lds
  s_add_u32 s3, s101, 77824
  s_mov_b32 m0, 65536
  s_nop 0
  buffer_load_dwordx4 v0, s[28:31], s3 offen lds
  s_add_u32 s3, s101, 78848
  s_mov_b32 m0, 66560
  s_nop 0
  buffer_load_dwordx4 v0, s[28:31], s3 offen lds
  s_add_u32 s3, s101, 79872
  s_mov_b32 m0, 67584
  s_nop 0
  buffer_load_dwordx4 v0, s[28:31], s3 offen lds
  s_add_u32 s3, s101, 80896
  s_mov_b32 m0, 68608
  s_nop 0
  buffer_load_dwordx4 v0, s[28:31], s3 offen lds
  ds_read_b64_tr_b16 a[104:105], v28 offset:36960
  ds_read_b64_tr_b16 a[106:107], v28 offset:37344
  ds_read_b64_tr_b16 a[108:109], v28 offset:43104
  ds_read_b64_tr_b16 a[110:111], v28 offset:43488
  ds_read_b64_tr_b16 a[112:113], v28 offset:36992
  ds_read_b64_tr_b16 a[114:115], v28 offset:37376
  ds_read_b64_tr_b16 a[116:117], v28 offset:43136
  ds_read_b64_tr_b16 a[118:119], v28 offset:43520
  ds_read_b64_tr_b16 a[144:145], v28 offset:37024
  ds_read_b64_tr_b16 a[146:147], v28 offset:37408
  ds_read_b64_tr_b16 a[148:149], v28 offset:43168
  ds_read_b64_tr_b16 a[150:151], v28 offset:43552
  s_waitcnt vmcnt(22)
  s_waitcnt lgkmcnt(0)
  s_barrier
  s_mov_b32 s3, 5947392
  s_mov_b32 m0, 82944
  s_nop 0
  buffer_load_dwordx4 v21, s[16:19], s3 offen lds
  s_mov_b32 m0, 83968
  s_nop 0
  buffer_load_dwordx4 v22, s[16:19], s3 offen lds
  s_mov_b32 m0, 84992
  s_nop 0
  buffer_load_dwordx4 v23, s[16:19], s3 offen lds
  s_mov_b32 s3, 5947392
  s_mov_b32 m0, 95232
  s_nop 0
  buffer_load_dwordx4 v21, s[20:23], s3 offen lds
  s_mov_b32 m0, 96256
  s_nop 0
  buffer_load_dwordx4 v22, s[20:23], s3 offen lds
  s_mov_b32 m0, 97280
  s_nop 0
  buffer_load_dwordx4 v23, s[20:23], s3 offen lds
  ds_read_b64_tr_b16 v[72:73], v29 offset:12384
  ds_read_b64_tr_b16 v[74:75], v29 offset:12768
  ds_read_b64_tr_b16 v[76:77], v29 offset:18528
  ds_read_b64_tr_b16 v[78:79], v29 offset:18912
  ds_read_b64_tr_b16 a[120:121], v29 offset:12416
  ds_read_b64_tr_b16 a[122:123], v29 offset:12800
  ds_read_b64_tr_b16 a[124:125], v29 offset:18560
  ds_read_b64_tr_b16 a[126:127], v29 offset:18944
  ds_read_b64_tr_b16 a[152:153], v29 offset:12448
  ds_read_b64_tr_b16 a[154:155], v29 offset:12832
  ds_read_b64_tr_b16 a[156:157], v29 offset:18592
  ds_read_b64_tr_b16 a[158:159], v29 offset:18976
  s_waitcnt vmcnt(23)
  s_waitcnt lgkmcnt(0)
  s_barrier
  s_mov_b32 s3, 6733824
  s_mov_b32 m0, 107520
  s_nop 0
  buffer_load_dwordx4 v21, s[16:19], s3 offen lds
  s_mov_b32 m0, 108544
  s_nop 0
  buffer_load_dwordx4 v22, s[16:19], s3 offen lds
  s_mov_b32 m0, 109568
  s_nop 0
  buffer_load_dwordx4 v23, s[16:19], s3 offen lds
  s_mov_b32 s3, 6733824
  s_mov_b32 m0, 119808
  s_nop 0
  buffer_load_dwordx4 v21, s[20:23], s3 offen lds
  s_mov_b32 m0, 120832
  s_nop 0
  buffer_load_dwordx4 v22, s[20:23], s3 offen lds
  s_mov_b32 m0, 121856
  s_nop 0
  buffer_load_dwordx4 v23, s[20:23], s3 offen lds
  ds_read_b64_tr_b16 v[176:177], v14 offset:25536
  ds_read_b64_tr_b16 v[178:179], v14 offset:28096
  ds_read_b64_tr_b16 v[184:185], v14 offset:25600
  ds_read_b64_tr_b16 v[186:187], v14 offset:28160
  ds_read_b64_tr_b16 v[192:193], v14 offset:25664
  ds_read_b64_tr_b16 v[194:195], v14 offset:28224
  ds_read_b64_tr_b16 v[200:201], v14 offset:25728
  ds_read_b64_tr_b16 v[202:203], v14 offset:28288
  ds_read_b64_tr_b16 v[208:209], v14 offset:25792
  ds_read_b64_tr_b16 v[210:211], v14 offset:28352
  s_waitcnt vmcnt(23)
  s_waitcnt lgkmcnt(0)
  s_barrier
  v_min_u32 v254, 8, v20
  v_lshlrev_b32 v254, 3, v254
  buffer_load_dwordx2 v[252:253], v254, s[12:15], s97 offen sc1
  s_mov_b32 s3, 7569408
  s_mov_b32 m0, 132096
  s_nop 0
  buffer_load_dwordx4 v24, s[16:19], s3 offen lds
  s_mov_b32 m0, 133120
  s_nop 0
  buffer_load_dwordx4 v25, s[16:19], s3 offen lds
  s_mov_b32 m0, 134144
  s_nop 0
  buffer_load_dwordx4 v26, s[16:19], s3 offen lds
  s_mov_b32 s3, 7569408
  s_mov_b32 m0, 144384
  s_nop 0
  buffer_load_dwordx4 v24, s[20:23], s3 offen lds
  s_mov_b32 m0, 145408
  s_nop 0
  buffer_load_dwordx4 v25, s[20:23], s3 offen lds
  s_mov_b32 m0, 146432
  s_nop 0
  buffer_load_dwordx4 v26, s[20:23], s3 offen lds
  ds_read_b64_tr_b16 v[80:81], v27 offset:36960
  ds_read_b64_tr_b16 v[82:83], v27 offset:37344
  ds_read_b64_tr_b16 v[84:85], v27 offset:43104
  ds_read_b64_tr_b16 v[86:87], v27 offset:43488
  ds_read_b64_tr_b16 a[128:129], v27 offset:36992
  ds_read_b64_tr_b16 a[130:131], v27 offset:37376
  ds_read_b64_tr_b16 a[132:133], v27 offset:43136
  ds_read_b64_tr_b16 a[134:135], v27 offset:43520
  ds_read_b64_tr_b16 a[160:161], v27 offset:37024
  ds_read_b64_tr_b16 a[162:163], v27 offset:37408
  ds_read_b64_tr_b16 a[164:165], v27 offset:43168
  ds_read_b64_tr_b16 a[166:167], v27 offset:43552
  s_waitcnt vmcnt(24)
  s_waitcnt lgkmcnt(0)
  s_barrier
  s_add_u32 s3, s101, 107520
  s_mov_b32 m0, 39936
  s_nop 0
  buffer_load_dwordx4 v0, s[28:31], s3 offen lds
  s_add_u32 s3, s101, 108544
  s_mov_b32 m0, 40960
  s_nop 0
  buffer_load_dwordx4 v0, s[28:31], s3 offen lds
  s_add_u32 s3, s101, 109568
  s_mov_b32 m0, 41984
  s_nop 0
  buffer_load_dwordx4 v0, s[28:31], s3 offen lds
  s_add_u32 s3, s101, 110592
  s_mov_b32 m0, 43008
  s_nop 0
  buffer_load_dwordx4 v0, s[28:31], s3 offen lds
  s_add_u32 s3, s101, 111616
  s_mov_b32 m0, 44032
  s_nop 0
  buffer_load_dwordx4 v0, s[28:31], s3 offen lds
  ds_read_b64_tr_b16 v[88:89], v27 offset:12384
  ds_read_b64_tr_b16 v[90:91], v27 offset:12768
  ds_read_b64_tr_b16 v[92:93], v27 offset:18528
  ds_read_b64_tr_b16 v[94:95], v27 offset:18912
  ds_read_b64_tr_b16 a[136:137], v27 offset:12416
  ds_read_b64_tr_b16 a[138:139], v27 offset:12800
  ds_read_b64_tr_b16 a[140:141], v27 offset:18560
  ds_read_b64_tr_b16 a[142:143], v27 offset:18944
  ds_read_b64_tr_b16 a[168:169], v27 offset:12448
  ds_read_b64_tr_b16 a[170:171], v27 offset:12832
  ds_read_b64_tr_b16 a[172:173], v27 offset:18592
  ds_read_b64_tr_b16 a[174:175], v27 offset:18976
  s_waitcnt vmcnt(24)
  s_waitcnt lgkmcnt(0)
  s_barrier
  s_add_u32 s3, s101, 117760
  s_mov_b32 m0, 15360
  s_nop 0
  buffer_load_dwordx4 v0, s[28:31], s3 offen lds
  s_add_u32 s3, s101, 118784
  s_mov_b32 m0, 16384
  s_nop 0
  buffer_load_dwordx4 v0, s[28:31], s3 offen lds
  s_add_u32 s3, s101, 119808
  s_mov_b32 m0, 17408
  s_nop 0
  buffer_load_dwordx4 v0, s[28:31], s3 offen lds
  s_add_u32 s3, s101, 120832
  s_mov_b32 m0, 18432
  s_nop 0
  buffer_load_dwordx4 v0, s[28:31], s3 offen lds
  s_add_u32 s3, s101, 121856
  s_mov_b32 m0, 19456
  s_nop 0
  buffer_load_dwordx4 v0, s[28:31], s3 offen lds
  ds_read_b64_tr_b16 v[180:181], v31 offset:960
  ds_read_b64_tr_b16 v[182:183], v31 offset:3520
  ds_read_b64_tr_b16 v[188:189], v31 offset:1024
  ds_read_b64_tr_b16 v[190:191], v31 offset:3584
  ds_read_b64_tr_b16 v[196:197], v31 offset:1088
  ds_read_b64_tr_b16 v[198:199], v31 offset:3648
  ds_read_b64_tr_b16 v[204:205], v31 offset:1152
  ds_read_b64_tr_b16 v[206:207], v31 offset:3712
  ds_read_b64_tr_b16 v[212:213], v31 offset:1216
  ds_read_b64_tr_b16 v[214:215], v31 offset:3776
  s_waitcnt vmcnt(23)
  s_waitcnt lgkmcnt(0)
  s_barrier
  ds_read_b64_tr_b16 v[32:33], v28 offset:36960
  ds_read_b64_tr_b16 v[34:35], v28 offset:37344
  ds_read_b64_tr_b16 v[36:37], v28 offset:43104
  ds_read_b64_tr_b16 v[38:39], v28 offset:43488
  ds_read_b64_tr_b16 v[40:41], v28 offset:36992
  ds_read_b64_tr_b16 v[42:43], v28 offset:37376
  ds_read_b64_tr_b16 v[44:45], v28 offset:43136
  ds_read_b64_tr_b16 v[46:47], v28 offset:43520
  ds_read_b64_tr_b16 v[48:49], v28 offset:37024
  ds_read_b64_tr_b16 v[50:51], v28 offset:37408
  ds_read_b64_tr_b16 v[52:53], v28 offset:43168
  ds_read_b64_tr_b16 v[54:55], v28 offset:43552
  s_waitcnt vmcnt(17)
  s_waitcnt lgkmcnt(0)
  s_barrier
  ds_read_b64_tr_b16 v[56:57], v29 offset:12384
  ds_read_b64_tr_b16 v[58:59], v29 offset:12768
  ds_read_b64_tr_b16 v[60:61], v29 offset:18528
  ds_read_b64_tr_b16 v[62:63], v29 offset:18912
  ds_read_b64_tr_b16 v[64:65], v29 offset:12416
  ds_read_b64_tr_b16 v[66:67], v29 offset:12800
  ds_read_b64_tr_b16 v[68:69], v29 offset:18560
  ds_read_b64_tr_b16 v[70:71], v29 offset:18944
  ds_read_b64_tr_b16 a[0:1], v29 offset:12448
  ds_read_b64_tr_b16 a[2:3], v29 offset:12832
  ds_read_b64_tr_b16 a[4:5], v29 offset:18592
  ds_read_b64_tr_b16 a[6:7], v29 offset:18976
  s_waitcnt vmcnt(10)
  s_waitcnt lgkmcnt(0)
  s_barrier
  ds_read_b64_tr_b16 a[8:9], v29 offset:36960
  ds_read_b64_tr_b16 a[10:11], v29 offset:37344
  ds_read_b64_tr_b16 a[12:13], v29 offset:43104
  ds_read_b64_tr_b16 a[14:15], v29 offset:43488
  ds_read_b64_tr_b16 a[16:17], v29 offset:36992
  ds_read_b64_tr_b16 a[18:19], v29 offset:37376
  ds_read_b64_tr_b16 a[20:21], v29 offset:43136
  ds_read_b64_tr_b16 a[22:23], v29 offset:43520
  ds_read_b64_tr_b16 a[24:25], v29 offset:37024
  ds_read_b64_tr_b16 a[26:27], v29 offset:37408
  ds_read_b64_tr_b16 a[28:29], v29 offset:43168
  ds_read_b64_tr_b16 a[30:31], v29 offset:43552
  s_waitcnt vmcnt(5)
  s_waitcnt lgkmcnt(0)
  s_barrier
  s_waitcnt vmcnt(16)
  buffer_load_dword v22, off, s[8:11], s68 sc1
  v_not_b32 v254, v252
  v_xor_b32 v255, 0x2000, v253
  v_or_b32 v254, v254, v255
  v_cmp_ne_u32 vcc, 0, v254
  v_readlane_b32 s64, v252, 8
  s_and_b32 s3, vcc_lo, 0xff
  s_cselect_b32 s63, 0, -1
  s_cmp_eq_u32 s64, 0
  s_cselect_b32 s63, 0, s63
  ds_read_b64_tr_b16 v[216:217], v30 offset:25536
  ds_read_b64_tr_b16 v[218:219], v30 offset:28096
  ds_read_b64_tr_b16 v[224:225], v30 offset:25600
  ds_read_b64_tr_b16 v[226:227], v30 offset:28160
  ds_read_b64_tr_b16 v[232:233], v30 offset:25664
  ds_read_b64_tr_b16 v[234:235], v30 offset:28224
  ds_read_b64_tr_b16 v[240:241], v30 offset:25728
  ds_read_b64_tr_b16 v[242:243], v30 offset:28288
  ds_read_b64_tr_b16 v[248:249], v30 offset:25792
  ds_read_b64_tr_b16 v[250:251], v30 offset:28352
  ds_write_b128 v3, v[32:35] offset:0
  ds_write_b128 v3, v[36:39] offset:1024
  ds_write_b128 v3, v[40:43] offset:2048
  ds_write_b128 v3, v[44:47] offset:3072
  ds_write_b128 v3, v[48:51] offset:4096
  ds_write_b128 v3, v[52:55] offset:5120
  ds_write_b128 v3, v[56:59] offset:6144
  ds_write_b128 v3, v[60:63] offset:7168
  ds_write_b128 v3, v[64:67] offset:8192
  ds_write_b128 v3, v[68:71] offset:9216
  ds_write_b128 v3, v[72:75] offset:10240
  ds_write_b128 v3, v[76:79] offset:11264
  ds_write_b128 v3, v[80:83] offset:12288
  ds_write_b128 v3, v[84:87] offset:13312
  ds_write_b128 v3, v[88:91] offset:14336
  ds_write_b128 v3, v[92:95] offset:15360
  ds_write_b128 v3, v[96:99] offset:16384
  ds_write_b128 v3, v[100:103] offset:17408
  ds_write_b128 v3, v[104:107] offset:18432
  ds_write_b128 v3, v[108:111] offset:19456
  ds_write_b128 v3, v[112:115] offset:20480
  ds_write_b128 v3, v[116:119] offset:21504
  ds_write_b128 v3, v[120:123] offset:22528
  ds_write_b128 v3, v[124:127] offset:23552
  ds_write_b128 v3, v[128:131] offset:24576
  ds_write_b128 v3, v[132:135] offset:25600
  s_waitcnt vmcnt(0)
  s_waitcnt lgkmcnt(0)
  s_barrier
  v_readfirstlane_b32 s38, v22
  s_and_b32 s38, s38, s63
  s_cbranch_scc0 L213_cslow
L214_cback:
  s_mov_b32 m0, s69
  s_nop 0
  buffer_load_dwordx4 v0, s[8:11], s65 offen offset:0 sc1 lds
  buffer_load_dwordx4 v0, s[8:11], s65 offen offset:1024 sc1 lds
  buffer_load_dwordx4 v0, s[8:11], s65 offen offset:2048 sc1 lds
  ds_read_b64_tr_b16 v[220:221], v30 offset:960
  ds_read_b64_tr_b16 v[222:223], v30 offset:3520
  ds_read_b64_tr_b16 v[228:229], v30 offset:1024
  ds_read_b64_tr_b16 v[230:231], v30 offset:3584
  ds_read_b64_tr_b16 v[236:237], v30 offset:1088
  ds_read_b64_tr_b16 v[238:239], v30 offset:3648
  ds_read_b64_tr_b16 v[244:245], v30 offset:1152
  ds_read_b64_tr_b16 v[246:247], v30 offset:3712
  ds_read_b64_tr_b16 v[252:253], v30 offset:1216
  ds_read_b64_tr_b16 v[254:255], v30 offset:3776
  s_and_b32 s64, s64, 8192
  s_add_u32 s57, s57, s64
  s_add_u32 s58, s58, s64
  s_add_u32 s65, s65, 393216
  s_waitcnt vmcnt(0) lgkmcnt(0)
  v_mov_b32 v14, s38
  s_barrier
  s_add_u32 s69, s69, 8192
  ds_read_b128 v[60:63], v3 offset:0
  ds_read_b128 v[64:67], v3 offset:1024
  ds_read_b128 v[68:71], v3 offset:2048
  ds_read_b128 v[72:75], v3 offset:3072
  ds_read_b128 v[76:79], v3 offset:4096
  ds_read_b128 v[80:83], v3 offset:5120
  ds_read_b128 v[84:87], v3 offset:6144
  ds_read_b128 v[88:91], v3 offset:7168
  ds_read_b128 v[92:95], v3 offset:8192
  ds_read_b128 v[96:99], v3 offset:9216
  ds_read_b128 v[100:103], v0 offset:16384
  ds_read_b128 v[104:107], v0 offset:17408
  ds_read_b128 v[108:111], v0 offset:18432
  v_mov_b32 v112, 0
  v_mov_b32 v113, 0
  v_mov_b32 v114, 0
  v_mov_b32 v115, 0
  v_mov_b32 v116, 0
  v_mov_b32 v117, 0
  v_mov_b32 v118, 0
  v_mov_b32 v119, 0
  v_mov_b32 v120, 0
  v_mov_b32 v121, 0
  v_mov_b32 v122, 0
  v_mov_b32 v123, 0
  v_mov_b32 v124, 0
  v_mov_b32 v125, 0
  v_mov_b32 v126, 0
  v_mov_b32 v127, 0
  v_mov_b32 v128, 0
  v_mov_b32 v129, 0
  v_mov_b32 v130, 0
  v_mov_b32 v131, 0
  s_cmp_eq_u32 s97, 0
  s_cbranch_scc1 L215_fast
  s_branch L216_slow
L213_cslow:
  v_mbcnt_lo_u32_b32 v24, -1, 0
  v_min_u32 v24, 8, v24
  v_lshlrev_b32 v24, 3, v24
L400001_cen:
  buffer_load_dwordx2 v[22:23], v24, s[12:15], s97 offen sc1
  s_sub_u32 s37, s37, 1
  s_cbranch_scc1 L212_bail
  s_waitcnt vmcnt(0)
  v_not_b32 v25, v22
  v_xor_b32 v26, 0x2000, v23
  v_or_b32 v25, v25, v26
  v_cmp_ne_u32 vcc, 0, v25
  s_and_b32 s3, vcc_lo, 0xff
  s_cbranch_scc0 L400002_cok
  v_lshrrev_b32 v23, 8, v23
  s_nop 1
  v_add_u32_dpp v23, v23, v23 row_shr:1 row_mask:0xf bank_mask:0xf bound_ctrl:1
  s_nop 1
  v_add_u32_dpp v23, v23, v23 row_shr:2 row_mask:0xf bank_mask:0xf bound_ctrl:1
  s_nop 1
  v_add_u32_dpp v23, v23, v23 row_shr:4 row_mask:0xf bank_mask:0xf bound_ctrl:1
  s_nop 0
  v_readlane_b32 s3, v23, 7
  s_cmp_lt_u32 s3, 256
  s_cbranch_scc1 L400001_cen
  s_branch L_restart
L400002_cok:
  v_readlane_b32 s64, v22, 8
  s_cmp_eq_u32 s64, 0
  s_cbranch_scc1 L400001_cen
  s_cmp_lt_u32 s38, s62
  s_cbranch_scc1 L400003_pw
L400004_pwb:
  s_branch L214_cback
L400003_pw:
  buffer_load_dword v14, off, s[8:11], s68 sc1
  s_sub_u32 s37, s37, 1
  s_cbranch_scc1 L212_bail
  s_waitcnt vmcnt(0)
  v_readfirstlane_b32 s38, v14
  s_cmp_lt_u32 s38, s62
  s_cbranch_scc1 L400003_pw
  s_branch L400004_pwb
L215_fast:
L217_top:
  v_bfe_u32 v46, v1, 2, 1
  v_lshlrev_b32 v46, 4, v46
  v_lshlrev_b32 v46, v46, s39
  v_cndmask_b32 v44, v46, 0, s[42:43]
  v_cndmask_b32 v45, 0, v46, s[42:43]
  buffer_load_dwordx4 v[20:23], v2, s[8:11], s56 offen offset:0 sc1
  buffer_load_dwordx4 v[24:27], v2, s[8:11], s56 offen offset:1024 sc1
  buffer_load_dwordx4 v[28:31], v2, s[8:11], s56 offen offset:2048 sc1
  s_add_u32 s62, s36, 2
  s_min_u32 s62, s62, 64
  v_readfirstlane_b32 s38, v14
  s_mov_b32 m0, s69
  s_sub_u32 s100, s36, 1
  s_max_i32 s100, s100, 0
  s_cmp_lt_u32 s38, s62
  s_cbranch_scc1 L220_pw
L221_pwb:
  v_mov_b32 v14, s100
  s_waitcnt vmcnt(2)
  v_bitop3_b32 v132, v20, v22, s60 bitop3:0x7e
  s_waitcnt vmcnt(1)
  v_bitop3_b32 v133, v24, v26, s60 bitop3:0x7e
  v_or_b32 v132, v132, v133
  s_waitcnt vmcnt(0)
  v_bitop3_b32 v133, v28, v30, s60 bitop3:0x7e
  v_bitop3_b32 v132, v132, v133, 1 bitop3:0xa8
  v_cmp_ne_u32 vcc, 0, v132
  s_cbranch_vccnz L222_f1
L223_b1:
  buffer_load_dwordx4 v[48:51], v8, s[8:11], s58 offen offset:0 sc1
  buffer_load_dwordx4 v[52:55], v8, s[8:11], s58 offen offset:1024 sc1
  buffer_load_dwordx4 v[56:59], v8, s[8:11], s58 offen offset:2048 sc1
L226_b3:
L225_b2:
  v_mfma_f32_4x4x4_16b_bf16 v[32:35], v[44:45], v[20:21], 0
  v_mfma_f32_4x4x4_16b_bf16 v[120:123], v[44:45], v[22:23], 0
  v_mfma_f32_4x4x4_16b_bf16 v[36:39], v[44:45], v[24:25], 0
  v_mfma_f32_4x4x4_16b_bf16 v[124:127], v[44:45], v[26:27], 0
  v_mfma_f32_4x4x4_16b_bf16 v[40:43], v[44:45], v[28:29], 0
  v_mfma_f32_4x4x4_16b_bf16 v[128:131], v[44:45], v[30:31], 0
  s_waitcnt lgkmcnt(0)
  s_waitcnt vmcnt(2)
  v_mfma_f32_4x4x4_16b_bf16 v[32:35], v[44:45], v[48:49], v[32:35]
  v_mfma_f32_4x4x4_16b_bf16 v[120:123], v[44:45], v[50:51], v[120:123]
  v_bitop3_b32 v132, v48, v50, s60 bitop3:0x7e
  s_waitcnt vmcnt(1)
  v_mfma_f32_4x4x4_16b_bf16 v[36:39], v[44:45], v[52:53], v[36:39]
  v_mfma_f32_4x4x4_16b_bf16 v[124:127], v[44:45], v[54:55], v[124:127]
  v_bitop3_b32 v133, v52, v54, s60 bitop3:0x7e
  v_or_b32 v132, v132, v133
  v_cvt_pk_bf16_f32 v48, v32, v33
  v_cvt_pk_bf16_f32 v49, v34, v35
  v_cvt_pk_bf16_f32 v50, v120, v121
  v_cvt_pk_bf16_f32 v51, v122, v123
  ds_write_b128 v0, v[48:51] offset:7168
  s_waitcnt vmcnt(0)
  v_mfma_f32_4x4x4_16b_bf16 v[40:43], v[44:45], v[56:57], v[40:43]
  v_mfma_f32_4x4x4_16b_bf16 v[128:131], v[44:45], v[58:59], v[128:131]
  v_bitop3_b32 v133, v56, v58, s60 bitop3:0x7e
  v_bitop3_b32 v132, v132, v133, 1 bitop3:0xa8
  v_cmp_ne_u32 vcc, 0, v132
  v_cvt_pk_bf16_f32 v52, v36, v37
  v_cvt_pk_bf16_f32 v53, v38, v39
  v_cvt_pk_bf16_f32 v54, v124, v125
  v_cvt_pk_bf16_f32 v55, v126, v127
  ds_write_b128 v0, v[52:55] offset:8192
  v_cvt_pk_bf16_f32 v56, v40, v41
  v_cvt_pk_bf16_f32 v57, v42, v43
  s_cbranch_vccnz L224_f2
  v_cvt_pk_bf16_f32 v58, v128, v129
  v_cvt_pk_bf16_f32 v59, v130, v131
  ds_write_b128 v0, v[56:59] offset:9216
L219_rl:
  v_smfmac_f32_16x16x64_bf16 v[112:115], v[48:51], v[60:67], v13
  v_mov_b32 v120, 0
  v_mov_b32 v121, 0
  v_mov_b32 v122, 0
  v_mov_b32 v123, 0
  v_smfmac_f32_16x16x64_bf16 v[116:119], v[48:51], v[68:75], v13
  v_mov_b32 v124, 0
  v_mov_b32 v125, 0
  v_mov_b32 v126, 0
  v_mov_b32 v127, 0
  v_smfmac_f32_16x16x64_bf16 v[120:123], v[48:51], v[76:83], v13
  v_mov_b32 v128, 0
  v_mov_b32 v129, 0
  v_mov_b32 v130, 0
  v_mov_b32 v131, 0
  s_waitcnt lgkmcnt(0)
  s_barrier
  ds_read_b128 v[20:23], v0 offset:0
  ds_read_b128 v[24:27], v0 offset:1024
  v_smfmac_f32_16x16x64_bf16 v[112:115], v[52:55], v[84:91], v13
  ds_read_b128 v[28:31], v0 offset:2048
  buffer_store_dword v14, off, s[8:11], s67 sc1
  v_smfmac_f32_16x16x64_bf16 v[116:119], v[52:55], v[92:99], v13
  ds_read_b128 v[32:35], v0 offset:3072
  v_smfmac_f32_16x16x64_bf16 v[120:123], v[52:55], a[0:7], v13
  ds_read_b128 v[36:39], v0 offset:4096
  buffer_load_dword v14, off, s[8:11], s68 sc1
  v_smfmac_f32_16x16x64_bf16 v[112:115], v[56:59], a[8:15], v13
  ds_read_b128 v[40:43], v0 offset:5120
  v_smfmac_f32_16x16x64_bf16 v[116:119], v[56:59], a[16:23], v13
  ds_read_b128 v[44:47], v0 offset:6144
  buffer_store_dwordx4 v[100:103], v0, s[8:11], s66 offen offset:0 sc1
  v_smfmac_f32_16x16x64_bf16 v[120:123], v[56:59], a[24:31], v13
  ds_read_b128 v[60:63], v3 offset:10240
  s_waitcnt lgkmcnt(7)
  v_smfmac_f32_16x16x64_bf16 v[112:115], v[20:23], a[32:39], v13
  ds_read_b128 v[64:67], v3 offset:11264
  buffer_store_dwordx4 v[104:107], v0, s[8:11], s66 offen offset:1024 sc1
  v_smfmac_f32_16x16x64_bf16 v[116:119], v[20:23], a[40:47], v13
  ds_read_b128 v[68:71], v3 offset:12288
  v_smfmac_f32_16x16x64_bf16 v[120:123], v[20:23], a[48:55], v13
  ds_read_b128 v[72:75], v3 offset:13312
  buffer_store_dwordx4 v[108:111], v0, s[8:11], s66 offen offset:2048 sc1
  s_waitcnt lgkmcnt(9)
  v_smfmac_f32_16x16x64_bf16 v[112:115], v[24:27], a[56:63], v13
  ds_read_b128 v[76:79], v3 offset:14336
  v_smfmac_f32_16x16x64_bf16 v[116:119], v[24:27], a[64:71], v13
  ds_read_b128 v[80:83], v3 offset:15360
  v_smfmac_f32_16x16x64_bf16 v[120:123], v[24:27], a[72:79], v13
  ds_read_b128 v[84:87], v3 offset:16384
  s_waitcnt lgkmcnt(11)
  v_smfmac_f32_16x16x64_bf16 v[112:115], v[28:31], a[80:87], v13
  ds_read_b128 v[88:91], v3 offset:17408
  v_smfmac_f32_16x16x64_bf16 v[116:119], v[28:31], a[88:95], v13
  ds_read_b128 v[92:95], v3 offset:18432
  v_smfmac_f32_16x16x64_bf16 v[120:123], v[28:31], a[96:103], v13
  ds_read_b128 v[96:99], v3 offset:19456
  s_waitcnt lgkmcnt(13)
  v_smfmac_f32_16x16x64_bf16 v[112:115], v[32:35], a[104:111], v13
  s_waitcnt lgkmcnt(12)
  s_waitcnt lgkmcnt(8)
  v_smfmac_f32_16x16x64_bf16 v[112:115], v[36:39], v[60:67], v13
  ds_read_b128 v[60:63], v3 offset:20480
  s_waitcnt lgkmcnt(7)
  v_smfmac_f32_16x16x64_bf16 v[112:115], v[40:43], v[68:75], v13
  ds_read_b128 v[64:67], v3 offset:21504
  s_waitcnt lgkmcnt(6)
  v_smfmac_f32_16x16x64_bf16 v[112:115], v[44:47], v[76:83], v13
  ds_read_b128 v[68:71], v3 offset:22528
  v_smfmac_f32_16x16x64_bf16 v[116:119], v[32:35], a[112:119], v13
  ds_read_b128 v[72:75], v3 offset:23552
  v_smfmac_f32_16x16x64_bf16 v[116:119], v[36:39], a[120:127], v13
  ds_read_b128 v[76:79], v3 offset:24576
  v_add_f32 v112, v112, v114
  v_smfmac_f32_16x16x64_bf16 v[116:119], v[40:43], a[128:135], v13
  ds_read_b128 v[80:83], v3 offset:25600
  v_add_f32 v113, v113, v115
  v_smfmac_f32_16x16x64_bf16 v[116:119], v[44:47], a[136:143], v13
  v_cvt_pk_bf16_f32 v114, v112, v113
  v_smfmac_f32_16x16x64_bf16 v[120:123], v[32:35], a[144:151], v13
  v_cvt_pk_bf16_f32 v115, v112, v113
  ds_write_b64 v4, v[114:115] offset:14848
  v_smfmac_f32_16x16x64_bf16 v[120:123], v[36:39], a[152:159], v13
  v_add_f32 v116, v116, v118
  v_smfmac_f32_16x16x64_bf16 v[120:123], v[40:43], a[160:167], v13
  v_add_f32 v117, v117, v119
  v_smfmac_f32_16x16x64_bf16 v[120:123], v[44:47], a[168:175], v13
  v_cvt_pk_bf16_f32 v118, v116, v117
  s_waitcnt lgkmcnt(9)
  v_smfmac_f32_16x16x64_bf16 v[124:127], v[20:23], v[84:91], v13
  v_cvt_pk_bf16_f32 v119, v116, v117
  ds_write_b64 v4, v[118:119] offset:15360
  s_waitcnt lgkmcnt(8)
  v_smfmac_f32_16x16x64_bf16 v[124:127], v[24:27], v[92:99], v13
  v_add_f32 v120, v120, v122
  v_add_f32 v121, v121, v123
  v_cvt_pk_bf16_f32 v122, v120, v121
  v_cvt_pk_bf16_f32 v123, v120, v121
  ds_write_b64 v4, v[122:123] offset:15872
  v_smfmac_f32_16x16x64_bf16 v[124:127], v[28:31], a[176:183], v13
  v_smfmac_f32_16x16x64_bf16 v[124:127], v[32:35], a[184:191], v13
  s_waitcnt lgkmcnt(0)
  s_barrier
  v_smfmac_f32_16x16x64_bf16 v[124:127], v[36:39], a[192:199], v13
  v_smfmac_f32_16x16x64_bf16 v[124:127], v[40:43], a[200:207], v13
  v_smfmac_f32_16x16x64_bf16 v[124:127], v[44:47], a[208:215], v13
  v_smfmac_f32_16x16x64_bf16 v[124:127], v[48:51], a[216:223], v13
  v_smfmac_f32_16x16x64_bf16 v[124:127], v[52:55], a[224:231], v13
  v_smfmac_f32_16x16x64_bf16 v[124:127], v[56:59], a[232:239], v13
  v_smfmac_f32_16x16x64_bf16 v[128:131], v[48:51], a[240:247], v13
  v_smfmac_f32_16x16x64_bf16 v[128:131], v[52:55], a[248:255], v13
  v_cvt_pk_bf16_f32 v124, v124, v125
  v_cvt_pk_bf16_f32 v125, v126, v127
  v_smfmac_f32_16x16x64_bf16 v[128:131], v[56:59], v[60:67], v13
  v_smfmac_f32_16x16x64_bf16 v[128:131], v[28:31], v[68:75], v13
  v_smfmac_f32_16x16x64_bf16 v[128:131], v[32:35], v[76:83], v13
  ds_write_b64 v0, v[124:125] offset:17416
  v_mov_b32 v112, 0
  v_mov_b32 v113, 0
  v_mov_b32 v114, 0
  v_mov_b32 v115, 0
  v_mov_b32 v116, 0
  v_mov_b32 v117, 0
  s_nop 0
  v_add_f32 v128, v128, v130
  v_add_f32 v129, v129, v131
  v_cvt_pk_bf16_f32 v128, v128, v129
  ds_write_b32 v0, v128 offset:18444
  v_mov_b32 v118, 0
  v_mov_b32 v119, 0
  v_mov_b32 v120, 0
  v_mov_b32 v121, 0
  v_mov_b32 v122, 0
  v_mov_b32 v123, 0
  s_cmp_eq_u32 s36, 63
  s_waitcnt lgkmcnt(0)
  s_barrier
  s_cbranch_scc1 L229_fin
  buffer_load_dwordx4 v[84:87], v0, s[8:11], s45 offen sc1
  buffer_load_dword v88, v1, s[8:11], s45 offen offset:1024 sc1
  ds_read_b128 v[90:93], v0 offset:19456
  ds_read_b32 v94, v1 offset:20480
  ds_read_b128 v[20:23], v15 offset:24576
  ds_read_b128 v[24:27], v15 offset:25600
  ds_read_b128 v[28:31], v15 offset:26624
  ds_read_b128 v[32:35], v15 offset:27648
  ds_read_b128 v[36:39], v15 offset:28672
  ds_read_b128 v[40:43], v15 offset:29696
  ds_read_b128 v[44:47], v0 offset:16384
  ds_read_b128 v[48:51], v0 offset:17408
  ds_read_b128 v[52:55], v0 offset:18432
  v_mov_b32 v95, 1.0
  v_mov_b32 v134, 0
  v_mov_b32 v135, 0
  v_mov_b32 v124, 0
  v_mov_b32 v125, 0
  v_mov_b32 v126, 0
  v_mov_b32 v127, 0
  v_mov_b32 v128, 0
  v_mov_b32 v129, 0
  v_mov_b32 v130, 0
  v_mov_b32 v131, 0
  buffer_load_dwordx4 v[72:75], v0, s[8:11], s45 offen sc1
  buffer_load_dword v76, v1, s[8:11], s45 offen offset:1024 sc1
  s_waitcnt vmcnt(2) lgkmcnt(9)
L230_rb:
  v_add_f32 v60, v90, v84
  v_add_f32 v61, v91, v85
  v_add_f32 v62, v92, v86
  v_add_f32 v63, v93, v87
  v_add_f32 v64, v94, v88
  v_max3_f32 v66, v60, v61, v62
  v_max3_f32 v66, v66, v63, v64
  v_bitop3_b32 v71, v84, v88, s59 bitop3:0x7e
  v_and_b32 v71, 1, v71
  v_max_f32_dpp v67, v66, v66 quad_perm:[2,3,0,1] row_mask:0xf bank_mask:0xf
  v_max_f32_dpp v66, v66, v66 quad_perm:[2,3,0,1] row_mask:0xf bank_mask:0xf
  v_cmp_ne_u32 vcc, 0, v71
  s_nop 0
  v_permlane16_swap_b32 v66, v67
  v_max_f32 v68, v66, v67
  v_max_f32 v66, v66, v67
  s_cbranch_vccnz L231_fb
  s_nop 0
  v_permlane32_swap_b32 v66, v68
  v_max_f32 v66, v66, v68
  v_mul_f32 v66, s41, v66
  v_fma_f32 v60, v60, s41, -v66
  v_fma_f32 v61, v61, s41, -v66
  v_fma_f32 v62, v62, s41, -v66
  v_fma_f32 v63, v63, s41, -v66
  v_fma_f32 v64, v64, s41, -v66
  v_exp_f32 v60, v60
  v_exp_f32 v61, v61
  v_exp_f32 v62, v62
  v_exp_f32 v63, v63
  v_exp_f32 v64, v64
  v_cvt_pk_bf16_f32 v69, v60, v61
  v_cvt_pk_bf16_f32 v70, v62, v63
  v_add_f32 v89, v60, v61
  v_mov_b32_dpp v56, v69 quad_perm:[0,1,0,1] row_mask:0xf bank_mask:0xf
  v_mov_b32_dpp v57, v70 quad_perm:[0,1,0,1] row_mask:0xf bank_mask:0xf
  v_mov_b32_dpp v58, v69 quad_perm:[2,3,2,3] row_mask:0xf bank_mask:0xf
  v_mov_b32_dpp v59, v70 quad_perm:[2,3,2,3] row_mask:0xf bank_mask:0xf
  v_mov_b32_dpp v66, v64 quad_perm:[0,1,0,1] row_mask:0xf bank_mask:0xf
  v_mov_b32_dpp v67, v64 quad_perm:[2,3,2,3] row_mask:0xf bank_mask:0xf
  s_waitcnt vmcnt(0) lgkmcnt(0)
  v_mfma_f32_16x16x32_bf16 v[80:83], v[20:23], v[56:59], 0
  buffer_load_dwordx4 v0, s[8:11], s65 offen offset:0 sc1 lds
  v_add_f32 v89, v89, v62
  v_cvt_pk_bf16_f32 v132, v66, v67
  v_mfma_f32_16x16x32_bf16 v[76:79], v[24:27], v[56:59], 0
  buffer_load_dwordx4 v0, s[8:11], s65 offen offset:1024 sc1 lds
  v_add_f32 v89, v89, v63
  v_cvt_pk_bf16_f32 v133, v66, v67
  v_mfma_f32_16x16x32_bf16 v[72:75], v[28:31], v[56:59], 0
  buffer_load_dwordx4 v0, s[8:11], s65 offen offset:2048 sc1 lds
  v_add_f32 v89, v89, v64
  v_mfma_f32_16x16x32_bf16 v[80:83], v[44:47], v[132:135], v[80:83]
  v_mfma_f32_16x16x32_bf16 v[76:79], v[44:47], v[130:133], v[76:79]
  v_add_f32_dpp v89, v89, v89 quad_perm:[2,3,0,1] row_mask:0xf bank_mask:0xf
  v_mfma_f32_16x16x32_bf16 v[68:71], v[32:35], v[56:59], 0
  v_mfma_f32_16x16x32_bf16 v[72:75], v[48:51], v[132:135], v[72:75]
  v_mfma_f32_16x16x4_f32 v[96:99], v89, v95, 0
  v_cvt_pk_bf16_f32 v84, v80, v81
  v_cvt_pk_bf16_f32 v85, v82, v83
  v_cvt_pk_bf16_f32 v86, v76, v77
  v_cvt_pk_bf16_f32 v87, v78, v79
  v_mfma_f32_16x16x32_bf16 v[68:71], v[48:51], v[130:133], v[68:71]
  v_cvt_pk_bf16_f32 v88, v72, v73
  v_cvt_pk_bf16_f32 v89, v74, v75
  v_mfma_f32_16x16x32_bf16 v[64:67], v[36:39], v[56:59], 0
  v_mfma_f32_16x16x32_bf16 v[60:63], v[40:43], v[56:59], 0
  v_cvt_pk_bf16_f32 v90, v68, v69
  v_cvt_pk_bf16_f32 v91, v70, v71
  v_mfma_f32_16x16x32_bf16 v[64:67], v[52:55], v[132:135], v[64:67]
  v_rcp_f32 v96, v96
  v_mfma_f32_16x16x32_bf16 v[60:63], v[52:55], v[130:133], v[60:63]
  v_rcp_f32 v97, v97
  v_smfmac_f32_16x16x64_bf16 v[112:115], v[84:87], v[136:143], v13
  v_cvt_pk_bf16_f32 v92, v64, v65
  v_cvt_pk_bf16_f32 v93, v66, v67
  v_smfmac_f32_16x16x64_bf16 v[116:119], v[84:87], v[144:151], v13
  v_cvt_pk_bf16_f32 v94, v60, v61
  v_cvt_pk_bf16_f32 v95, v62, v63
  v_smfmac_f32_16x16x64_bf16 v[112:115], v[88:91], v[176:183], v13
  v_smfmac_f32_16x16x64_bf16 v[116:119], v[88:91], v[184:191], v13
  v_smfmac_f32_16x16x64_bf16 v[112:115], v[92:95], v[216:223], v13
  v_smfmac_f32_16x16x64_bf16 v[116:119], v[92:95], v[224:231], v13
  v_smfmac_f32_16x16x64_bf16 v[120:123], v[84:87], v[152:159], v13
  v_mul_f32 v112, v96, v112
  v_mul_f32 v114, v96, v114
  v_smfmac_f32_16x16x64_bf16 v[124:127], v[84:87], v[160:167], v13
  v_mul_f32 v113, v97, v113
  v_mul_f32 v115, v97, v115
  v_smfmac_f32_16x16x64_bf16 v[120:123], v[88:91], v[192:199], v13
  v_cvt_pk_bf16_f32 v20, v112, v114
  v_cvt_pk_bf16_f32 v21, v113, v115
  v_smfmac_f32_16x16x64_bf16 v[124:127], v[88:91], v[200:207], v13
  v_bfi_b32 v20, 1, s59, v20
  v_mul_f32 v116, v96, v116
  v_mul_f32 v118, v96, v118
  v_smfmac_f32_16x16x64_bf16 v[120:123], v[92:95], v[232:239], v13
  v_mul_f32 v117, v97, v117
  v_mul_f32 v119, v97, v119
  v_cvt_pk_bf16_f32 v22, v116, v118
  v_smfmac_f32_16x16x64_bf16 v[124:127], v[92:95], v[240:247], v13
  v_cvt_pk_bf16_f32 v23, v117, v119
  buffer_store_dwordx4 v[20:23], v9, s[8:11], s47 offen
  v_smfmac_f32_16x16x64_bf16 v[128:131], v[84:87], v[168:175], v13
  v_mul_f32 v120, v96, v120
  v_mul_f32 v122, v96, v122
  v_smfmac_f32_16x16x64_bf16 v[128:131], v[88:91], v[208:215], v13
  v_mul_f32 v121, v97, v121
  v_mul_f32 v123, v97, v123
  v_smfmac_f32_16x16x64_bf16 v[128:131], v[92:95], v[248:255], v13
  v_cvt_pk_bf16_f32 v24, v120, v122
  v_cvt_pk_bf16_f32 v25, v121, v123
  v_bfi_b32 v24, 1, s59, v24
  v_mul_f32 v124, v96, v124
  v_mul_f32 v126, v96, v126
  v_mul_f32 v125, v97, v125
  v_mul_f32 v127, v97, v127
  v_cvt_pk_bf16_f32 v26, v124, v126
  v_cvt_pk_bf16_f32 v27, v125, v127
  buffer_store_dwordx4 v[24:27], v9, s[8:11], s47 offen offset:1024
  v_mul_f32 v128, v96, v128
  v_mul_f32 v130, v96, v130
  v_mul_f32 v129, v97, v129
  v_mul_f32 v131, v97, v131
  v_cvt_pk_bf16_f32 v28, v128, v130
  v_cvt_pk_bf16_f32 v29, v129, v131
  v_bfi_b32 v28, 1, s59, v28
  buffer_store_dwordx2 v[28:29], v10, s[8:11], s47 offen
  ds_read_b128 v[60:63], v3 offset:0
  ds_read_b128 v[64:67], v3 offset:1024
  ds_read_b128 v[68:71], v3 offset:2048
  ds_read_b128 v[72:75], v3 offset:3072
  ds_read_b128 v[76:79], v3 offset:4096
  ds_read_b128 v[80:83], v3 offset:5120
  ds_read_b128 v[84:87], v3 offset:6144
  ds_read_b128 v[88:91], v3 offset:7168
  ds_read_b128 v[92:95], v3 offset:8192
  ds_read_b128 v[96:99], v3 offset:9216
  ds_read_b128 v[100:103], v0 offset:16384
  ds_read_b128 v[104:107], v0 offset:17408
  ds_read_b128 v[108:111], v0 offset:18432
  v_mov_b32 v112, 0
  v_mov_b32 v113, 0
  v_mov_b32 v114, 0
  v_mov_b32 v115, 0
  v_mov_b32 v116, 0
  v_mov_b32 v117, 0
  v_mov_b32 v118, 0
  v_mov_b32 v119, 0
  v_mov_b32 v120, 0
  v_mov_b32 v121, 0
  v_mov_b32 v122, 0
  v_mov_b32 v123, 0
  v_mov_b32 v124, 0
  v_mov_b32 v125, 0
  v_mov_b32 v126, 0
  v_mov_b32 v127, 0
  v_mov_b32 v128, 0
  v_mov_b32 v129, 0
  v_mov_b32 v130, 0
  v_mov_b32 v131, 0
  s_xor_b32 s56, s56, 65536
  s_xor_b32 s58, s58, 131072
  s_add_u32 s65, s65, 393216
  v_xor_b32 v15, 8192, v15
  s_add_u32 s36, s36, 1
  s_xor_b32 s69, s69, 57344
  s_add_u32 s66, s66, 393216
  s_barrier
  s_xor_b32 s59, s59, 1
  s_mov_b32 s60, s61
  s_xor_b32 s61, s61, s59
  s_xor_b32 s57, s57, 131072
  s_barrier
  s_branch L217_top
L229_fin:
  s_add_u32 s66, s66, 393216
  ds_read_b128 v[100:103], v0 offset:16384
  ds_read_b128 v[104:107], v0 offset:17408
  ds_read_b128 v[108:111], v0 offset:18432
  s_waitcnt lgkmcnt(0)
  buffer_store_dwordx4 v[100:103], v0, s[8:11], s66 offen offset:0 sc1
  buffer_store_dwordx4 v[104:107], v0, s[8:11], s66 offen offset:1024 sc1
  buffer_store_dwordx4 v[108:111], v0, s[8:11], s66 offen offset:2048 sc1
  s_waitcnt vmcnt(0)
  s_barrier
  v_mov_b32 v14, 64
  buffer_store_dword v14, off, s[8:11], s67 sc1
  s_waitcnt vmcnt(0)
  s_endpgm
L220_pw:
  buffer_load_dword v14, off, s[8:11], s68 sc1
  s_sub_u32 s37, s37, 1
  s_cbranch_scc1 L212_bail
  s_waitcnt vmcnt(0)
  v_readfirstlane_b32 s38, v14
  s_cmp_lt_u32 s38, s62
  s_cbranch_scc1 L220_pw
  s_branch L221_pwb
L222_f1:
  s_mov_b64 exec, vcc
  buffer_load_dwordx4 v[20:23], v2, s[8:11], s56 offen offset:0 sc1
  buffer_load_dwordx4 v[24:27], v2, s[8:11], s56 offen offset:1024 sc1
  buffer_load_dwordx4 v[28:31], v2, s[8:11], s56 offen offset:2048 sc1
  s_mov_b64 exec, -1
  buffer_load_dwordx4 v[48:51], v8, s[8:11], s58 offen offset:0 sc1
  buffer_load_dwordx4 v[52:55], v8, s[8:11], s58 offen offset:1024 sc1
  buffer_load_dwordx4 v[56:59], v8, s[8:11], s58 offen offset:2048 sc1
  s_waitcnt vmcnt(3)
  v_bitop3_b32 v132, v20, v22, s60 bitop3:0x7e
  v_bitop3_b32 v133, v24, v26, s60 bitop3:0x7e
  v_or_b32 v132, v132, v133
  v_bitop3_b32 v133, v28, v30, s60 bitop3:0x7e
  v_bitop3_b32 v132, v132, v133, 1 bitop3:0xa8
  v_cmp_ne_u32 vcc, 0, v132
  s_cbranch_vccz L226_b3
L227_f3:
L228_ag:
  s_mov_b64 exec, vcc
  s_xor_b32 s3, s58, 0
  buffer_load_dwordx4 v[20:23], v2, s[8:11], s56 offen offset:0 sc1
  buffer_load_dwordx4 v[24:27], v2, s[8:11], s56 offen offset:1024 sc1
  buffer_load_dwordx4 v[28:31], v2, s[8:11], s56 offen offset:2048 sc1
  s_sub_u32 s37, s37, 1
  s_cbranch_scc1 L212_bail
  s_waitcnt vmcnt(0)
  v_bitop3_b32 v132, v20, v22, s60 bitop3:0x7e
  v_bitop3_b32 v133, v24, v26, s60 bitop3:0x7e
  v_or_b32 v132, v132, v133
  v_bitop3_b32 v133, v28, v30, s60 bitop3:0x7e
  v_bitop3_b32 v132, v132, v133, 1 bitop3:0xa8
  v_cmp_ne_u32 vcc, 0, v132
  s_mov_b64 exec, -1
  s_cbranch_vccnz L228_ag
  s_branch L226_b3
L224_f2:
  s_xor_b32 s3, s58, 0
  s_sub_u32 s37, s37, 1
  s_cbranch_scc1 L212_bail
  buffer_load_dwordx4 v[48:51], v8, s[8:11], s3 offen offset:0 sc1
  buffer_load_dwordx4 v[52:55], v8, s[8:11], s3 offen offset:1024 sc1
  buffer_load_dwordx4 v[56:59], v8, s[8:11], s3 offen offset:2048 sc1
  s_branch L225_b2
L218_fL:
  s_mov_b64 exec, vcc
  buffer_load_dwordx4 v[48:51], v2, s[8:11], s56 offen offset:0 sc1
  buffer_load_dwordx4 v[52:55], v2, s[8:11], s56 offen offset:1024 sc1
  buffer_load_dwordx4 v[56:59], v2, s[8:11], s56 offen offset:2048 sc1
  s_mov_b64 exec, -1
  s_sub_u32 s37, s37, 1
  s_cbranch_scc1 L212_bail
  s_branch L219_rl
L231_fb:
  s_waitcnt vmcnt(0)
  v_bitop3_b32 v71, v72, v76, s59 bitop3:0x7e
  v_and_b32 v71, 1, v71
  v_cmp_ne_u32 vcc, 0, v71
  v_mov_b32 v84, v72
  v_mov_b32 v85, v73
  v_mov_b32 v86, v74
  v_mov_b32 v87, v75
  v_mov_b32 v88, v76
  s_cbranch_vccz L230_rb
L232_fb2:
  s_sub_u32 s37, s37, 1
  s_cbranch_scc1 L212_bail
  buffer_load_dwordx4 v[84:87], v0, s[8:11], s45 offen sc1
  buffer_load_dword v88, v1, s[8:11], s45 offen offset:1024 sc1
  s_waitcnt vmcnt(0)
  v_bitop3_b32 v71, v84, v88, s59 bitop3:0x7e
  v_and_b32 v71, 1, v71
  v_cmp_ne_u32 vcc, 0, v71
  s_cbranch_vccz L230_rb
  s_branch L232_fb2
L216_slow:
L233_top:
  v_bfe_u32 v46, v1, 2, 1
  v_lshlrev_b32 v46, 4, v46
  v_lshlrev_b32 v46, v46, s39
  v_cndmask_b32 v44, v46, 0, s[42:43]
  v_cndmask_b32 v45, 0, v46, s[42:43]
  buffer_load_dwordx4 v[20:23], v2, s[8:11], s56 offen offset:0 sc1
  buffer_load_dwordx4 v[24:27], v2, s[8:11], s56 offen offset:1024 sc1
  buffer_load_dwordx4 v[28:31], v2, s[8:11], s56 offen offset:2048 sc1
  s_add_u32 s62, s36, 2
  s_min_u32 s62, s62, 64
  v_readfirstlane_b32 s38, v14
  s_mov_b32 m0, s69
  s_sub_u32 s100, s36, 1
  s_max_i32 s100, s100, 0
  s_cmp_lt_u32 s38, s62
  s_cbranch_scc1 L236_pw
L237_pwb:
  v_mov_b32 v14, s100
  s_waitcnt vmcnt(2)
  v_bitop3_b32 v132, v20, v22, s60 bitop3:0x7e
  s_waitcnt vmcnt(1)
  v_bitop3_b32 v133, v24, v26, s60 bitop3:0x7e
  v_or_b32 v132, v132, v133
  s_waitcnt vmcnt(0)
  v_bitop3_b32 v133, v28, v30, s60 bitop3:0x7e
  v_bitop3_b32 v132, v132, v133, 1 bitop3:0xa8
  v_cmp_ne_u32 vcc, 0, v132
  s_cbranch_vccnz L238_f1
L239_b1:
  buffer_load_dwordx4 v[48:51], v8, s[8:11], s58 offen offset:0 sc1
  buffer_load_dwordx4 v[52:55], v8, s[8:11], s58 offen offset:1024 sc1
  buffer_load_dwordx4 v[56:59], v8, s[8:11], s58 offen offset:2048 sc1
L242_b3:
L241_b2:
  v_mfma_f32_4x4x4_16b_bf16 v[32:35], v[44:45], v[20:21], 0
  v_mfma_f32_4x4x4_16b_bf16 v[120:123], v[44:45], v[22:23], 0
  v_mfma_f32_4x4x4_16b_bf16 v[36:39], v[44:45], v[24:25], 0
  v_mfma_f32_4x4x4_16b_bf16 v[124:127], v[44:45], v[26:27], 0
  v_mfma_f32_4x4x4_16b_bf16 v[40:43], v[44:45], v[28:29], 0
  v_mfma_f32_4x4x4_16b_bf16 v[128:131], v[44:45], v[30:31], 0
  s_waitcnt lgkmcnt(0)
  s_waitcnt vmcnt(2)
  v_mfma_f32_4x4x4_16b_bf16 v[32:35], v[44:45], v[48:49], v[32:35]
  v_mfma_f32_4x4x4_16b_bf16 v[120:123], v[44:45], v[50:51], v[120:123]
  v_bitop3_b32 v132, v48, v50, s60 bitop3:0x7e
  s_waitcnt vmcnt(1)
  v_mfma_f32_4x4x4_16b_bf16 v[36:39], v[44:45], v[52:53], v[36:39]
  v_mfma_f32_4x4x4_16b_bf16 v[124:127], v[44:45], v[54:55], v[124:127]
  v_bitop3_b32 v133, v52, v54, s60 bitop3:0x7e
  v_or_b32 v132, v132, v133
  v_cvt_pk_bf16_f32 v48, v32, v33
  v_cvt_pk_bf16_f32 v49, v34, v35
  v_cvt_pk_bf16_f32 v50, v120, v121
  v_cvt_pk_bf16_f32 v51, v122, v123
  ds_write_b128 v0, v[48:51] offset:7168
  s_waitcnt vmcnt(0)
  v_mfma_f32_4x4x4_16b_bf16 v[40:43], v[44:45], v[56:57], v[40:43]
  v_mfma_f32_4x4x4_16b_bf16 v[128:131], v[44:45], v[58:59], v[128:131]
  v_bitop3_b32 v133, v56, v58, s60 bitop3:0x7e
  v_bitop3_b32 v132, v132, v133, 1 bitop3:0xa8
  v_cmp_ne_u32 vcc, 0, v132
  v_cvt_pk_bf16_f32 v52, v36, v37
  v_cvt_pk_bf16_f32 v53, v38, v39
  v_cvt_pk_bf16_f32 v54, v124, v125
  v_cvt_pk_bf16_f32 v55, v126, v127
  ds_write_b128 v0, v[52:55] offset:8192
  v_cvt_pk_bf16_f32 v56, v40, v41
  v_cvt_pk_bf16_f32 v57, v42, v43
  s_cbranch_vccnz L240_f2
  v_cvt_pk_bf16_f32 v58, v128, v129
  v_cvt_pk_bf16_f32 v59, v130, v131
  ds_write_b128 v0, v[56:59] offset:9216
L235_rl:
  v_smfmac_f32_16x16x64_bf16 v[112:115], v[48:51], v[60:67], v13
  v_mov_b32 v120, 0
  v_mov_b32 v121, 0
  v_mov_b32 v122, 0
  v_mov_b32 v123, 0
  v_smfmac_f32_16x16x64_bf16 v[116:119], v[48:51], v[68:75], v13
  v_mov_b32 v124, 0
  v_mov_b32 v125, 0
  v_mov_b32 v126, 0
  v_mov_b32 v127, 0
  v_smfmac_f32_16x16x64_bf16 v[120:123], v[48:51], v[76:83], v13
  v_mov_b32 v128, 0
  v_mov_b32 v129, 0
  v_mov_b32 v130, 0
  v_mov_b32 v131, 0
  s_waitcnt lgkmcnt(0)
  s_barrier
  ds_read_b128 v[20:23], v0 offset:0
  ds_read_b128 v[24:27], v0 offset:1024
  v_smfmac_f32_16x16x64_bf16 v[112:115], v[52:55], v[84:91], v13
  ds_read_b128 v[28:31], v0 offset:2048
  buffer_store_dword v14, off, s[8:11], s67 sc1
  v_smfmac_f32_16x16x64_bf16 v[116:119], v[52:55], v[92:99], v13
  ds_read_b128 v[32:35], v0 offset:3072
  v_smfmac_f32_16x16x64_bf16 v[120:123], v[52:55], a[0:7], v13
  ds_read_b128 v[36:39], v0 offset:4096
  buffer_load_dword v14, off, s[8:11], s68 sc1
  v_smfmac_f32_16x16x64_bf16 v[112:115], v[56:59], a[8:15], v13
  ds_read_b128 v[40:43], v0 offset:5120
  v_smfmac_f32_16x16x64_bf16 v[116:119], v[56:59], a[16:23], v13
  ds_read_b128 v[44:47], v0 offset:6144
  buffer_store_dwordx4 v[100:103], v0, s[8:11], s66 offen offset:0 sc1
  v_smfmac_f32_16x16x64_bf16 v[120:123], v[56:59], a[24:31], v13
  ds_read_b128 v[60:63], v3 offset:10240
  s_waitcnt lgkmcnt(7)
  v_smfmac_f32_16x16x64_bf16 v[112:115], v[20:23], a[32:39], v13
  ds_read_b128 v[64:67], v3 offset:11264
  buffer_store_dwordx4 v[104:107], v0, s[8:11], s66 offen offset:1024 sc1
  v_smfmac_f32_16x16x64_bf16 v[116:119], v[20:23], a[40:47], v13
  ds_read_b128 v[68:71], v3 offset:12288
  v_smfmac_f32_16x16x64_bf16 v[120:123], v[20:23], a[48:55], v13
  ds_read_b128 v[72:75], v3 offset:13312
  buffer_store_dwordx4 v[108:111], v0, s[8:11], s66 offen offset:2048 sc1
  s_waitcnt lgkmcnt(9)
  v_smfmac_f32_16x16x64_bf16 v[112:115], v[24:27], a[56:63], v13
  ds_read_b128 v[76:79], v3 offset:14336
  v_smfmac_f32_16x16x64_bf16 v[116:119], v[24:27], a[64:71], v13
  ds_read_b128 v[80:83], v3 offset:15360
  v_smfmac_f32_16x16x64_bf16 v[120:123], v[24:27], a[72:79], v13
  ds_read_b128 v[84:87], v3 offset:16384
  s_waitcnt lgkmcnt(11)
  v_smfmac_f32_16x16x64_bf16 v[112:115], v[28:31], a[80:87], v13
  ds_read_b128 v[88:91], v3 offset:17408
  v_smfmac_f32_16x16x64_bf16 v[116:119], v[28:31], a[88:95], v13
  ds_read_b128 v[92:95], v3 offset:18432
  v_smfmac_f32_16x16x64_bf16 v[120:123], v[28:31], a[96:103], v13
  ds_read_b128 v[96:99], v3 offset:19456
  s_waitcnt lgkmcnt(13)
  v_smfmac_f32_16x16x64_bf16 v[112:115], v[32:35], a[104:111], v13
  s_waitcnt lgkmcnt(12)
  s_waitcnt lgkmcnt(8)
  v_smfmac_f32_16x16x64_bf16 v[112:115], v[36:39], v[60:67], v13
  ds_read_b128 v[60:63], v3 offset:20480
  s_waitcnt lgkmcnt(7)
  v_smfmac_f32_16x16x64_bf16 v[112:115], v[40:43], v[68:75], v13
  ds_read_b128 v[64:67], v3 offset:21504
  s_waitcnt lgkmcnt(6)
  v_smfmac_f32_16x16x64_bf16 v[112:115], v[44:47], v[76:83], v13
  ds_read_b128 v[68:71], v3 offset:22528
  v_smfmac_f32_16x16x64_bf16 v[116:119], v[32:35], a[112:119], v13
  ds_read_b128 v[72:75], v3 offset:23552
  v_smfmac_f32_16x16x64_bf16 v[116:119], v[36:39], a[120:127], v13
  ds_read_b128 v[76:79], v3 offset:24576
  v_add_f32 v112, v112, v114
  v_smfmac_f32_16x16x64_bf16 v[116:119], v[40:43], a[128:135], v13
  ds_read_b128 v[80:83], v3 offset:25600
  v_add_f32 v113, v113, v115
  v_smfmac_f32_16x16x64_bf16 v[116:119], v[44:47], a[136:143], v13
  v_cvt_pk_bf16_f32 v114, v112, v113
  v_smfmac_f32_16x16x64_bf16 v[120:123], v[32:35], a[144:151], v13
  v_cvt_pk_bf16_f32 v115, v112, v113
  ds_write_b64 v4, v[114:115] offset:14848
  v_smfmac_f32_16x16x64_bf16 v[120:123], v[36:39], a[152:159], v13
  v_add_f32 v116, v116, v118
  v_smfmac_f32_16x16x64_bf16 v[120:123], v[40:43], a[160:167], v13
  v_add_f32 v117, v117, v119
  v_smfmac_f32_16x16x64_bf16 v[120:123], v[44:47], a[168:175], v13
  v_cvt_pk_bf16_f32 v118, v116, v117
  s_waitcnt lgkmcnt(9)
  v_smfmac_f32_16x16x64_bf16 v[124:127], v[20:23], v[84:91], v13
  v_cvt_pk_bf16_f32 v119, v116, v117
  ds_write_b64 v4, v[118:119] offset:15360
  s_waitcnt lgkmcnt(8)
  v_smfmac_f32_16x16x64_bf16 v[124:127], v[24:27], v[92:99], v13
  v_add_f32 v120, v120, v122
  v_add_f32 v121, v121, v123
  v_cvt_pk_bf16_f32 v122, v120, v121
  v_cvt_pk_bf16_f32 v123, v120, v121
  ds_write_b64 v4, v[122:123] offset:15872
  v_smfmac_f32_16x16x64_bf16 v[124:127], v[28:31], a[176:183], v13
  v_smfmac_f32_16x16x64_bf16 v[124:127], v[32:35], a[184:191], v13
  s_waitcnt lgkmcnt(0)
  s_barrier
  v_smfmac_f32_16x16x64_bf16 v[124:127], v[36:39], a[192:199], v13
  v_smfmac_f32_16x16x64_bf16 v[124:127], v[40:43], a[200:207], v13
  v_smfmac_f32_16x16x64_bf16 v[124:127], v[44:47], a[208:215], v13
  v_smfmac_f32_16x16x64_bf16 v[124:127], v[48:51], a[216:223], v13
  v_smfmac_f32_16x16x64_bf16 v[124:127], v[52:55], a[224:231], v13
  v_smfmac_f32_16x16x64_bf16 v[124:127], v[56:59], a[232:239], v13
  v_smfmac_f32_16x16x64_bf16 v[128:131], v[48:51], a[240:247], v13
  v_smfmac_f32_16x16x64_bf16 v[128:131], v[52:55], a[248:255], v13
  v_cvt_pk_bf16_f32 v124, v124, v125
  v_cvt_pk_bf16_f32 v125, v126, v127
  v_smfmac_f32_16x16x64_bf16 v[128:131], v[56:59], v[60:67], v13
  v_smfmac_f32_16x16x64_bf16 v[128:131], v[28:31], v[68:75], v13
  v_smfmac_f32_16x16x64_bf16 v[128:131], v[32:35], v[76:83], v13
  ds_write_b64 v0, v[124:125] offset:17416
  v_mov_b32 v112, 0
  v_mov_b32 v113, 0
  v_mov_b32 v114, 0
  v_mov_b32 v115, 0
  v_mov_b32 v116, 0
  v_mov_b32 v117, 0
  s_nop 0
  v_add_f32 v128, v128, v130
  v_add_f32 v129, v129, v131
  v_cvt_pk_bf16_f32 v128, v128, v129
  ds_write_b32 v0, v128 offset:18444
  v_mov_b32 v118, 0
  v_mov_b32 v119, 0
  v_mov_b32 v120, 0
  v_mov_b32 v121, 0
  v_mov_b32 v122, 0
  v_mov_b32 v123, 0
  s_cmp_eq_u32 s36, 63
  s_waitcnt lgkmcnt(0)
  s_barrier
  s_cbranch_scc1 L245_fin
  buffer_load_dwordx4 v[84:87], v0, s[8:11], s45 offen sc1
  buffer_load_dword v88, v1, s[8:11], s45 offen offset:1024 sc1
  ds_read_b128 v[90:93], v0 offset:19456
  ds_read_b32 v94, v1 offset:20480
  ds_read_b128 v[20:23], v15 offset:24576
  ds_read_b128 v[24:27], v15 offset:25600
  ds_read_b128 v[28:31], v15 offset:26624
  ds_read_b128 v[32:35], v15 offset:27648
  ds_read_b128 v[36:39], v15 offset:28672
  ds_read_b128 v[40:43], v15 offset:29696
  ds_read_b128 v[44:47], v0 offset:16384
  ds_read_b128 v[48:51], v0 offset:17408
  ds_read_b128 v[52:55], v0 offset:18432
  v_mov_b32 v95, 1.0
  v_mov_b32 v134, 0
  v_mov_b32 v135, 0
  v_mov_b32 v124, 0
  v_mov_b32 v125, 0
  v_mov_b32 v126, 0
  v_mov_b32 v127, 0
  v_mov_b32 v128, 0
  v_mov_b32 v129, 0
  v_mov_b32 v130, 0
  v_mov_b32 v131, 0
  buffer_load_dwordx4 v[72:75], v0, s[8:11], s45 offen sc1
  buffer_load_dword v76, v1, s[8:11], s45 offen offset:1024 sc1
  s_waitcnt vmcnt(2) lgkmcnt(9)
L246_rb:
  v_add_f32 v60, v90, v84
  v_add_f32 v61, v91, v85
  v_add_f32 v62, v92, v86
  v_add_f32 v63, v93, v87
  v_add_f32 v64, v94, v88
  v_max3_f32 v66, v60, v61, v62
  v_max3_f32 v66, v66, v63, v64
  v_bitop3_b32 v71, v84, v88, s59 bitop3:0x7e
  v_and_b32 v71, 1, v71
  v_max_f32_dpp v67, v66, v66 quad_perm:[2,3,0,1] row_mask:0xf bank_mask:0xf
  v_max_f32_dpp v66, v66, v66 quad_perm:[2,3,0,1] row_mask:0xf bank_mask:0xf
  v_cmp_ne_u32 vcc, 0, v71
  s_nop 0
  v_permlane16_swap_b32 v66, v67
  v_max_f32 v68, v66, v67
  v_max_f32 v66, v66, v67
  s_cbranch_vccnz L247_fb
  s_nop 0
  v_permlane32_swap_b32 v66, v68
  v_max_f32 v66, v66, v68
  v_mul_f32 v66, s41, v66
  v_fma_f32 v60, v60, s41, -v66
  v_fma_f32 v61, v61, s41, -v66
  v_fma_f32 v62, v62, s41, -v66
  v_fma_f32 v63, v63, s41, -v66
  v_fma_f32 v64, v64, s41, -v66
  v_exp_f32 v60, v60
  v_exp_f32 v61, v61
  v_exp_f32 v62, v62
  v_exp_f32 v63, v63
  v_exp_f32 v64, v64
  v_cvt_pk_bf16_f32 v69, v60, v61
  v_cvt_pk_bf16_f32 v70, v62, v63
  v_add_f32 v89, v60, v61
  v_mov_b32_dpp v56, v69 quad_perm:[0,1,0,1] row_mask:0xf bank_mask:0xf
  v_mov_b32_dpp v57, v70 quad_perm:[0,1,0,1] row_mask:0xf bank_mask:0xf
  v_mov_b32_dpp v58, v69 quad_perm:[2,3,2,3] row_mask:0xf bank_mask:0xf
  v_mov_b32_dpp v59, v70 quad_perm:[2,3,2,3] row_mask:0xf bank_mask:0xf
  v_mov_b32_dpp v66, v64 quad_perm:[0,1,0,1] row_mask:0xf bank_mask:0xf
  v_mov_b32_dpp v67, v64 quad_perm:[2,3,2,3] row_mask:0xf bank_mask:0xf
  s_waitcnt vmcnt(0) lgkmcnt(0)
  v_mfma_f32_16x16x32_bf16 v[80:83], v[20:23], v[56:59], 0
  buffer_load_dwordx4 v0, s[8:11], s65 offen offset:0 sc1 lds
  v_add_f32 v89, v89, v62
  v_cvt_pk_bf16_f32 v132, v66, v67
  v_mfma_f32_16x16x32_bf16 v[76:79], v[24:27], v[56:59], 0
  buffer_load_dwordx4 v0, s[8:11], s65 offen offset:1024 sc1 lds
  v_add_f32 v89, v89, v63
  v_cvt_pk_bf16_f32 v133, v66, v67
  v_mfma_f32_16x16x32_bf16 v[72:75], v[28:31], v[56:59], 0
  buffer_load_dwordx4 v0, s[8:11], s65 offen offset:2048 sc1 lds
  v_add_f32 v89, v89, v64
  v_mfma_f32_16x16x32_bf16 v[80:83], v[44:47], v[132:135], v[80:83]
  v_mfma_f32_16x16x32_bf16 v[76:79], v[44:47], v[130:133], v[76:79]
  v_add_f32_dpp v89, v89, v89 quad_perm:[2,3,0,1] row_mask:0xf bank_mask:0xf
  v_mfma_f32_16x16x32_bf16 v[68:71], v[32:35], v[56:59], 0
  v_mfma_f32_16x16x32_bf16 v[72:75], v[48:51], v[132:135], v[72:75]
  v_mfma_f32_16x16x4_f32 v[96:99], v89, v95, 0
  v_cvt_pk_bf16_f32 v84, v80, v81
  v_cvt_pk_bf16_f32 v85, v82, v83
  v_cvt_pk_bf16_f32 v86, v76, v77
  v_cvt_pk_bf16_f32 v87, v78, v79
  v_mfma_f32_16x16x32_bf16 v[68:71], v[48:51], v[130:133], v[68:71]
  v_cvt_pk_bf16_f32 v88, v72, v73
  v_cvt_pk_bf16_f32 v89, v74, v75
  v_mfma_f32_16x16x32_bf16 v[64:67], v[36:39], v[56:59], 0
  v_mfma_f32_16x16x32_bf16 v[60:63], v[40:43], v[56:59], 0
  v_cvt_pk_bf16_f32 v90, v68, v69
  v_cvt_pk_bf16_f32 v91, v70, v71
  v_mfma_f32_16x16x32_bf16 v[64:67], v[52:55], v[132:135], v[64:67]
  v_rcp_f32 v96, v96
  v_mfma_f32_16x16x32_bf16 v[60:63], v[52:55], v[130:133], v[60:63]
  v_rcp_f32 v97, v97
  v_smfmac_f32_16x16x64_bf16 v[112:115], v[84:87], v[136:143], v13
  v_cvt_pk_bf16_f32 v92, v64, v65
  v_cvt_pk_bf16_f32 v93, v66, v67
  v_smfmac_f32_16x16x64_bf16 v[116:119], v[84:87], v[144:151], v13
  v_cvt_pk_bf16_f32 v94, v60, v61
  v_cvt_pk_bf16_f32 v95, v62, v63
  v_smfmac_f32_16x16x64_bf16 v[112:115], v[88:91], v[176:183], v13
  v_smfmac_f32_16x16x64_bf16 v[116:119], v[88:91], v[184:191], v13
  v_smfmac_f32_16x16x64_bf16 v[112:115], v[92:95], v[216:223], v13
  v_smfmac_f32_16x16x64_bf16 v[116:119], v[92:95], v[224:231], v13
  v_smfmac_f32_16x16x64_bf16 v[120:123], v[84:87], v[152:159], v13
  v_mul_f32 v112, v96, v112
  v_mul_f32 v114, v96, v114
  v_smfmac_f32_16x16x64_bf16 v[124:127], v[84:87], v[160:167], v13
  v_mul_f32 v113, v97, v113
  v_mul_f32 v115, v97, v115
  v_smfmac_f32_16x16x64_bf16 v[120:123], v[88:91], v[192:199], v13
  v_cvt_pk_bf16_f32 v20, v112, v114
  v_cvt_pk_bf16_f32 v21, v113, v115
  v_smfmac_f32_16x16x64_bf16 v[124:127], v[88:91], v[200:207], v13
  v_bfi_b32 v20, 1, s59, v20
  v_mul_f32 v116, v96, v116
  v_mul_f32 v118, v96, v118
  v_smfmac_f32_16x16x64_bf16 v[120:123], v[92:95], v[232:239], v13
  v_mul_f32 v117, v97, v117
  v_mul_f32 v119, v97, v119
  v_cvt_pk_bf16_f32 v22, v116, v118
  v_smfmac_f32_16x16x64_bf16 v[124:127], v[92:95], v[240:247], v13
  v_cvt_pk_bf16_f32 v23, v117, v119
  buffer_store_dwordx4 v[20:23], v9, s[8:11], s47 offen sc1
  v_smfmac_f32_16x16x64_bf16 v[128:131], v[84:87], v[168:175], v13
  v_mul_f32 v120, v96, v120
  v_mul_f32 v122, v96, v122
  v_smfmac_f32_16x16x64_bf16 v[128:131], v[88:91], v[208:215], v13
  v_mul_f32 v121, v97, v121
  v_mul_f32 v123, v97, v123
  v_smfmac_f32_16x16x64_bf16 v[128:131], v[92:95], v[248:255], v13
  v_cvt_pk_bf16_f32 v24, v120, v122
  v_cvt_pk_bf16_f32 v25, v121, v123
  v_bfi_b32 v24, 1, s59, v24
  v_mul_f32 v124, v96, v124
  v_mul_f32 v126, v96, v126
  v_mul_f32 v125, v97, v125
  v_mul_f32 v127, v97, v127
  v_cvt_pk_bf16_f32 v26, v124, v126
  v_cvt_pk_bf16_f32 v27, v125, v127
  buffer_store_dwordx4 v[24:27], v9, s[8:11], s47 offen offset:1024 sc1
  v_mul_f32 v128, v96, v128
  v_mul_f32 v130, v96, v130
  v_mul_f32 v129, v97, v129
  v_mul_f32 v131, v97, v131
  v_cvt_pk_bf16_f32 v28, v128, v130
  v_cvt_pk_bf16_f32 v29, v129, v131
  v_bfi_b32 v28, 1, s59, v28
  buffer_store_dwordx2 v[28:29], v10, s[8:11], s47 offen sc1
  ds_read_b128 v[60:63], v3 offset:0
  ds_read_b128 v[64:67], v3 offset:1024
  ds_read_b128 v[68:71], v3 offset:2048
  ds_read_b128 v[72:75], v3 offset:3072
  ds_read_b128 v[76:79], v3 offset:4096
  ds_read_b128 v[80:83], v3 offset:5120
  ds_read_b128 v[84:87], v3 offset:6144
  ds_read_b128 v[88:91], v3 offset:7168
  ds_read_b128 v[92:95], v3 offset:8192
  ds_read_b128 v[96:99], v3 offset:9216
  ds_read_b128 v[100:103], v0 offset:16384
  ds_read_b128 v[104:107], v0 offset:17408
  ds_read_b128 v[108:111], v0 offset:18432
  v_mov_b32 v112, 0
  v_mov_b32 v113, 0
  v_mov_b32 v114, 0
  v_mov_b32 v115, 0
  v_mov_b32 v116, 0
  v_mov_b32 v117, 0
  v_mov_b32 v118, 0
  v_mov_b32 v119, 0
  v_mov_b32 v120, 0
  v_mov_b32 v121, 0
  v_mov_b32 v122, 0
  v_mov_b32 v123, 0
  v_mov_b32 v124, 0
  v_mov_b32 v125, 0
  v_mov_b32 v126, 0
  v_mov_b32 v127, 0
  v_mov_b32 v128, 0
  v_mov_b32 v129, 0
  v_mov_b32 v130, 0
  v_mov_b32 v131, 0
  s_xor_b32 s56, s56, 65536
  s_xor_b32 s58, s58, 131072
  s_add_u32 s65, s65, 393216
  v_xor_b32 v15, 8192, v15
  s_add_u32 s36, s36, 1
  s_xor_b32 s69, s69, 57344
  s_add_u32 s66, s66, 393216
  s_barrier
  s_xor_b32 s59, s59, 1
  s_mov_b32 s60, s61
  s_xor_b32 s61, s61, s59
  s_xor_b32 s57, s57, 131072
  s_barrier
  s_branch L233_top
L245_fin:
  s_add_u32 s66, s66, 393216
  ds_read_b128 v[100:103], v0 offset:16384
  ds_read_b128 v[104:107], v0 offset:17408
  ds_read_b128 v[108:111], v0 offset:18432
  s_waitcnt lgkmcnt(0)
  buffer_store_dwordx4 v[100:103], v0, s[8:11], s66 offen offset:0 sc1
  buffer_store_dwordx4 v[104:107], v0, s[8:11], s66 offen offset:1024 sc1
  buffer_store_dwordx4 v[108:111], v0, s[8:11], s66 offen offset:2048 sc1
  s_waitcnt vmcnt(0)
  s_barrier
  v_mov_b32 v14, 64
  buffer_store_dword v14, off, s[8:11], s67 sc1
  s_waitcnt vmcnt(0)
  s_endpgm
L236_pw:
  buffer_load_dword v14, off, s[8:11], s68 sc1
  s_sub_u32 s37, s37, 1
  s_cbranch_scc1 L212_bail
  s_waitcnt vmcnt(0)
  v_readfirstlane_b32 s38, v14
  s_cmp_lt_u32 s38, s62
  s_cbranch_scc1 L236_pw
  s_branch L237_pwb
L238_f1:
  s_mov_b64 exec, vcc
  buffer_load_dwordx4 v[20:23], v2, s[8:11], s56 offen offset:0 sc1
  buffer_load_dwordx4 v[24:27], v2, s[8:11], s56 offen offset:1024 sc1
  buffer_load_dwordx4 v[28:31], v2, s[8:11], s56 offen offset:2048 sc1
  s_mov_b64 exec, -1
  buffer_load_dwordx4 v[48:51], v8, s[8:11], s58 offen offset:0 sc1
  buffer_load_dwordx4 v[52:55], v8, s[8:11], s58 offen offset:1024 sc1
  buffer_load_dwordx4 v[56:59], v8, s[8:11], s58 offen offset:2048 sc1
  s_waitcnt vmcnt(3)
  v_bitop3_b32 v132, v20, v22, s60 bitop3:0x7e
  v_bitop3_b32 v133, v24, v26, s60 bitop3:0x7e
  v_or_b32 v132, v132, v133
  v_bitop3_b32 v133, v28, v30, s60 bitop3:0x7e
  v_bitop3_b32 v132, v132, v133, 1 bitop3:0xa8
  v_cmp_ne_u32 vcc, 0, v132
  s_cbranch_vccz L242_b3
L243_f3:
L244_ag:
  s_mov_b64 exec, vcc
  s_xor_b32 s3, s58, 0
  buffer_load_dwordx4 v[20:23], v2, s[8:11], s56 offen offset:0 sc1
  buffer_load_dwordx4 v[24:27], v2, s[8:11], s56 offen offset:1024 sc1
  buffer_load_dwordx4 v[28:31], v2, s[8:11], s56 offen offset:2048 sc1
  s_sub_u32 s37, s37, 1
  s_cbranch_scc1 L212_bail
  s_waitcnt vmcnt(0)
  v_bitop3_b32 v132, v20, v22, s60 bitop3:0x7e
  v_bitop3_b32 v133, v24, v26, s60 bitop3:0x7e
  v_or_b32 v132, v132, v133
  v_bitop3_b32 v133, v28, v30, s60 bitop3:0x7e
  v_bitop3_b32 v132, v132, v133, 1 bitop3:0xa8
  v_cmp_ne_u32 vcc, 0, v132
  s_mov_b64 exec, -1
  s_cbranch_vccnz L244_ag
  s_branch L242_b3
L240_f2:
  s_xor_b32 s3, s58, 0
  s_sub_u32 s37, s37, 1
  s_cbranch_scc1 L212_bail
  buffer_load_dwordx4 v[48:51], v8, s[8:11], s3 offen offset:0 sc1
  buffer_load_dwordx4 v[52:55], v8, s[8:11], s3 offen offset:1024 sc1
  buffer_load_dwordx4 v[56:59], v8, s[8:11], s3 offen offset:2048 sc1
  s_branch L241_b2
L234_fL:
  s_mov_b64 exec, vcc
  buffer_load_dwordx4 v[48:51], v2, s[8:11], s56 offen offset:0 sc1
  buffer_load_dwordx4 v[52:55], v2, s[8:11], s56 offen offset:1024 sc1
  buffer_load_dwordx4 v[56:59], v2, s[8:11], s56 offen offset:2048 sc1
  s_mov_b64 exec, -1
  s_sub_u32 s37, s37, 1
  s_cbranch_scc1 L212_bail
  s_branch L235_rl
L247_fb:
  s_waitcnt vmcnt(0)
  v_bitop3_b32 v71, v72, v76, s59 bitop3:0x7e
  v_and_b32 v71, 1, v71
  v_cmp_ne_u32 vcc, 0, v71
  v_mov_b32 v84, v72
  v_mov_b32 v85, v73
  v_mov_b32 v86, v74
  v_mov_b32 v87, v75
  v_mov_b32 v88, v76
  s_cbranch_vccz L246_rb
L248_fb2:
  s_sub_u32 s37, s37, 1
  s_cbranch_scc1 L212_bail
  buffer_load_dwordx4 v[84:87], v0, s[8:11], s45 offen sc1
  buffer_load_dword v88, v1, s[8:11], s45 offen offset:1024 sc1
  s_waitcnt vmcnt(0)
  v_bitop3_b32 v71, v84, v88, s59 bitop3:0x7e
  v_and_b32 v71, 1, v71
  v_cmp_ne_u32 vcc, 0, v71
  s_cbranch_vccz L246_rb
  s_branch L248_fb2
L212_bail:
  s_endpgm
s_endpgm
.section .rodata,"a"
.p2align 6
.amdhsa_kernel parallel_sum__memory_aug_recurrent_mem_tr__glu_gated_bilinear__prompt_kernel
  .amdhsa_next_free_vgpr 512
  .amdhsa_next_free_sgpr 102
  .amdhsa_accum_offset 256
  .amdhsa_group_segment_fixed_size 0
  .amdhsa_kernarg_size 112
  .amdhsa_user_sgpr_count 2
  .amdhsa_user_sgpr_kernarg_segment_ptr 1
  .amdhsa_system_sgpr_workgroup_id_x 1
.end_amdhsa_kernel
```
